```python
import torch

def _softmax(x, axis=-1):
    return torch.softmax(x, dim=axis)

def _gelu(x):
    return torch.nn.functional.gelu(x, approximate='tanh')

def _silu(x):
    return torch.nn.functional.silu(x)

def _sigmoid(x):
    return torch.sigmoid(x)

def _layernorm(x, axis=-1, eps=1e-05):
    m = x.mean(dim=axis, keepdim=True)
    v = x.var(dim=axis, keepdim=True, unbiased=False)
    return (x - m) / torch.sqrt(v + eps)

def _scatter_add(tgt, idx, src, axis=0):
    return tgt.clone().index_add_(axis, idx, src)

def _segment_sum(src, seg, n):
    out = torch.zeros((n,) + src.shape[1:], dtype=src.dtype)
    return out.index_add_(0, seg, src)

def _pad(x, pw):
    flat = tuple((v for pair in reversed(pw) for v in pair))
    return torch.nn.functional.pad(x, flat)
kernel_name = 'adaLN_cond__mha_block__geglu_ffn__prompt'

def setup_inputs():

    _w = lambda a: (lambda t: t.to(torch.bfloat16) if t.is_floating_point() else t)(torch.as_tensor(a))

    def _A_setup():
        B, S, D, H = (1, 2048, 640, 32)
        return {'x': _w((lambda *s: torch.randn(*s, dtype=torch.bfloat16) * 0.05)(B, S, D)), 'wqkv': _w((lambda *s: torch.randn(*s, dtype=torch.bfloat16) * 0.05)(D, 3 * D)), 'wo': _w((lambda *s: torch.randn(*s, dtype=torch.bfloat16) * 0.05)(D, D))}
    _A_in = _A_setup()

    def _B_setup():
        B, S, D, F = (1, 2048, 640, 1536)
        return {'x': _w((lambda *s: torch.randn(*s, dtype=torch.bfloat16) * 0.05)(B, S, D)), 'w_gate': _w((lambda *s: torch.randn(*s, dtype=torch.bfloat16) * 0.05)(D, F)), 'w_up': _w((lambda *s: torch.randn(*s, dtype=torch.bfloat16) * 0.05)(D, F)), 'w_down': _w((lambda *s: torch.randn(*s, dtype=torch.bfloat16) * 0.05)(F, D))}
    _B_in = _B_setup()
    return {'A_x': _A_in['x'], 'A_wqkv': _A_in['wqkv'], 'A_wo': _A_in['wo'], 'B_x': _B_in['x'], 'B_w_gate': _B_in['w_gate'], 'B_w_up': _B_in['w_up'], 'B_w_down': _B_in['w_down'], 'c': _w((lambda *s: torch.randn(*s, dtype=torch.bfloat16) * 0.1)(1, 640) * 8.0), 'w_mod': _w((lambda *s: torch.randn(*s, dtype=torch.bfloat16) * 0.1)(640, 6 * 640) * 640 ** (-0.5) * 8.0)}

def reference(A_x, A_wqkv, A_wo, B_x, B_w_gate, B_w_up, B_w_down, c, w_mod):

    def _A_ref(x, wqkv, wo):
        B, S, D = x.shape
        H = 32
        Dh = D // H
        qkv = (lambda x, *d: x.permute(*d))((x @ wqkv).reshape(B, S, 3, H, Dh), 2, 0, 3, 1, 4)
        q, k, v = (qkv[0], qkv[1], qkv[2])
        scores = torch.einsum('bhqd,bhkd->bhqk', q, k) * Dh ** (-0.5)
        p = _softmax(scores, axis=-1)
        o = torch.einsum('bhqk,bhkd->bhqd', p, v)
        return (lambda x, *d: x.permute(*d))(o, 0, 2, 1, 3).reshape(B, S, D) @ wo

    def _B_ref(x, w_gate, w_up, w_down):
        return _gelu(x @ w_gate) * (x @ w_up) @ w_down
    x = A_x
    mod = (_silu(c) @ w_mod).reshape(c.shape[0], 6, 1, -1)
    sa, ca, ga, sb, cb, gb = (mod[:, 0].clone(), mod[:, 1].clone(), mod[:, 2].clone(), mod[:, 3].clone(), mod[:, 4].clone(), mod[:, 5].clone())
    h = _layernorm(x, axis=-1) * (1 + ca) + sa
    x = x + ga * _A_ref(h, A_wqkv, A_wo)
    h = _layernorm(x, axis=-1) * (1 + cb) + sb
    x = x + gb * _B_ref(h, B_w_gate, B_w_up, B_w_down)
    return x
```

```asm
; @launch grid=(256,1,1) block=(512,1,1) lds=163840
.amdgcn_target "amdgcn-amd-amdhsa--gfx950"
.text
.globl adaLN_cond__mha_block__geglu_ffn__prompt_kernel
.p2align 8
.type adaLN_cond__mha_block__geglu_ffn__prompt_kernel,@function
adaLN_cond__mha_block__geglu_ffn__prompt_kernel:
    s_cmp_ge_u32 s2, 256
    s_cbranch_scc1 L_end
    s_load_dwordx2 s[6:7], s[0:1], 88
    s_load_dwordx4 s[48:51], s[0:1], 0
    s_load_dwordx2 s[52:53], s[0:1], 16
    s_load_dwordx2 s[54:55], s[0:1], 32
    s_load_dwordx4 s[56:59], s[0:1], 40
    s_load_dwordx4 s[60:63], s[0:1], 56
    s_load_dwordx4 s[64:67], s[0:1], 72
    v_mov_b32 v249, v0
    v_lshrrev_b32 v1, 6, v0
    v_and_b32 v0, 63, v0
    v_readfirstlane_b32 s4, v1
    s_waitcnt lgkmcnt(0)
    s_mov_b32 s12, s6
    s_mov_b32 s13, s7
    s_mov_b32 s14, 32768000
    s_mov_b32 s15, 0x00020000
    s_cmp_eq_u32 s2, 255
    s_cbranch_scc0 L_nozero1
    v_lshlrev_b32 v1, 4, v249
    v_add_u32 v1, 31719424, v1
    v_mov_b32 v8, 0
    v_mov_b32 v9, 0
    v_mov_b32 v10, 0
    v_mov_b32 v11, 0
    global_store_dwordx4 v1, v[8:11], s[6:7] sc1
    v_add_u32 v1, 8192, v1
    global_store_dwordx4 v1, v[8:11], s[6:7] sc1
    v_add_u32 v1, 8192, v1
    global_store_dwordx4 v1, v[8:11], s[6:7] sc1
    v_add_u32 v1, 8192, v1
    s_waitcnt vmcnt(0)
    s_barrier
    s_cmp_eq_u32 s4, 7
    s_cbranch_scc0 L_zero_b
    v_mov_b32 v2, 1
    v_lshlrev_b32 v3, 6, v0
    s_mov_b64 exec, 15
    global_store_dword v3, v2, s[66:67] sc1
    s_mov_b64 exec, -1
    s_waitcnt vmcnt(0)
L_zero_b:
L_nozero1:
    s_cmp_ge_u32 s2, 248
    s_cbranch_scc0 L_nozero
    v_mov_b32 v8, 0
    v_mov_b32 v9, 0
    v_mov_b32 v10, 0
    v_mov_b32 v11, 0
    s_sub_u32 s24, s2, 248
    s_mul_i32 s24, s24, 65536
    s_add_u32 s24, s24, 31742976
    v_lshlrev_b32 v1, 4, v249
    v_add_u32 v1, s24, v1
    global_store_dwordx4 v1, v[8:11], s[6:7] sc1
    v_add_u32 v1, 8192, v1
    global_store_dwordx4 v1, v[8:11], s[6:7] sc1
    v_add_u32 v1, 8192, v1
    global_store_dwordx4 v1, v[8:11], s[6:7] sc1
    v_add_u32 v1, 8192, v1
    global_store_dwordx4 v1, v[8:11], s[6:7] sc1
    v_add_u32 v1, 8192, v1
    global_store_dwordx4 v1, v[8:11], s[6:7] sc1
    v_add_u32 v1, 8192, v1
    global_store_dwordx4 v1, v[8:11], s[6:7] sc1
    v_add_u32 v1, 8192, v1
    global_store_dwordx4 v1, v[8:11], s[6:7] sc1
    v_add_u32 v1, 8192, v1
    global_store_dwordx4 v1, v[8:11], s[6:7] sc1
    v_add_u32 v1, 8192, v1
    s_cmp_eq_u32 s2, 255
    s_cbranch_scc0 L_zero_c
    v_lshlrev_b32 v1, 4, v249
    v_add_u32 v1, 25403392, v1
    global_store_dwordx4 v1, v[8:11], s[6:7] sc1
    v_add_u32 v1, 8192, v1
    global_store_dwordx4 v1, v[8:11], s[6:7] sc1
    v_add_u32 v1, 8192, v1
    global_store_dwordx4 v1, v[8:11], s[6:7] sc1
    v_add_u32 v1, 8192, v1
L_zero_c:
    s_waitcnt vmcnt(0)
    s_barrier
    s_cmp_eq_u32 s4, 6
    s_cbranch_scc0 L_nozero
    s_and_b32 s3, s2, 3
    s_lshl_b32 s3, s3, 6
    v_mov_b32 v250, s3
    s_mov_b32 s3, 0
    s_sleep 32
L_zw_z:
    global_load_dword v252, v250, s[66:67] sc1
    s_waitcnt vmcnt(0)
    v_cmp_ne_u32 vcc, 0, v252
    s_nop 0
    s_cmp_eq_u64 vcc, -1
    s_cbranch_scc1 L_zd_z
    s_sleep 8
    s_add_u32 s3, s3, 1
    s_cmp_lt_u32 s3, 0x200000
    s_cbranch_scc1 L_zw_z
L_zd_z:
    s_mov_b32 s24, 152
    s_lshl_b32 s3, s24, 7
    s_add_u32 s3, s3, 31719424
    v_lshlrev_b32 v250, 7, v0
    v_add_u32 v250, s3, v250
    v_mov_b32 v251, 1
    s_mov_b32 exec_lo, 65535
    s_mov_b32 exec_hi, 0
    global_atomic_add v250, v251, s[6:7] sc1
    s_mov_b64 exec, -1
L_nozero:
    s_mov_b32 s8, s62
    s_mov_b32 s9, s63
    s_mov_b32 s10, 4915200
    s_mov_b32 s11, 0x00020000
    s_mov_b32 s20, s60
    s_mov_b32 s21, s61
    s_mov_b32 s22, 1280
    s_mov_b32 s23, 0x00020000
    s_cmp_ge_u32 s2, 184
    s_cbranch_scc1 L_p1_rest
    s_cmp_ge_u32 s2, 120
    s_cbranch_scc1 L_p1_b
    s_lshr_b32 s25, s2, 3
    s_mul_i32 s26, s25, 21846
    s_lshr_b32 s26, s26, 16
    s_mul_i32 s27, s26, 3
    s_sub_u32 s25, s25, s27
    s_and_b32 s24, s2, 7
    s_mul_i32 s24, s24, 5
    s_add_u32 s24, s24, s26
    s_mul_i32 s29, s2, 3277
    s_lshr_b32 s29, s29, 16
    s_mul_i32 s28, s29, 20
    s_sub_u32 s28, s2, s28
    s_mov_b32 s16, s50
    s_mov_b32 s17, s51
    s_mov_b32 s18, 2457600
    s_mov_b32 s19, 0x00020000
    v_lshlrev_b32 v3, 2, v249
    buffer_load_dword v10, v3, s[20:23], 0 offen
    s_cmp_ge_u32 s4, 4
    s_cbranch_scc1 L_p1_a_w
    s_cmp_ge_u32 s2, 100
    s_cbranch_scc1 L_p1_a_ld
    v_lshrrev_b32 v4, 3, v0
    v_mul_u32_u24 v4, 7680, v4
    v_and_b32 v5, 7, v0
    v_lshl_add_u32 v4, v5, 4, v4
    s_lshl_b32 s34, s28, 7
    s_mul_i32 s35, s29, 983040
    s_add_u32 s34, s34, s35
    s_mul_i32 s35, s4, 245760
    s_add_u32 s34, s34, s35
    s_lshl_b32 s35, s4, 12
    s_add_u32 m0, s35, 0
    s_add_u32 s36, s34, 0
    buffer_load_dwordx4 v4, s[8:11], s36 offen nt lds
    s_add_u32 m0, s35, 1024
    s_add_u32 s36, s34, 61440
    buffer_load_dwordx4 v4, s[8:11], s36 offen nt lds
    s_add_u32 m0, s35, 2048
    s_add_u32 s36, s34, 122880
    buffer_load_dwordx4 v4, s[8:11], s36 offen nt lds
    s_add_u32 m0, s35, 3072
    s_add_u32 s36, s34, 184320
    buffer_load_dwordx4 v4, s[8:11], s36 offen nt lds
    s_waitcnt vmcnt(4)
    s_branch L_p1_a_c
L_p1_a_w:
    s_mul_i32 s37, s24, 61440
    s_mul_i32 s38, s25, 1280
    s_add_u32 s37, s37, s38
    s_sub_u32 s38, s4, 4
    s_lshl_b32 s38, s38, 10
    s_add_u32 s38, s38, 0
    v_lshlrev_b32 v15, 4, v0
    v_add_u32 v15, s38, v15
    v_lshrrev_b32 v17, 8, v15
    v_mul_u32_u24 v17, 205, v17
    v_lshrrev_b32 v17, 10, v17
    v_mul_u32_u24 v17, 2560, v17
    v_add_u32 v15, v15, v17
    s_add_u32 m0, s38, 45056
    s_nop 0
    buffer_load_dwordx4 v15, s[16:19], s37 offen nt lds
    s_sub_u32 s38, s4, 4
    s_lshl_b32 s38, s38, 10
    s_add_u32 s38, s38, 4096
    v_lshlrev_b32 v15, 4, v0
    v_add_u32 v15, s38, v15
    v_lshrrev_b32 v17, 8, v15
    v_mul_u32_u24 v17, 205, v17
    v_lshrrev_b32 v17, 10, v17
    v_mul_u32_u24 v17, 2560, v17
    v_add_u32 v15, v15, v17
    s_add_u32 m0, s38, 45056
    s_nop 0
    buffer_load_dwordx4 v15, s[16:19], s37 offen nt lds
    s_sub_u32 s38, s4, 4
    s_lshl_b32 s38, s38, 10
    s_add_u32 s38, s38, 8192
    v_lshlrev_b32 v15, 4, v0
    v_add_u32 v15, s38, v15
    v_lshrrev_b32 v17, 8, v15
    v_mul_u32_u24 v17, 205, v17
    v_lshrrev_b32 v17, 10, v17
    v_mul_u32_u24 v17, 2560, v17
    v_add_u32 v15, v15, v17
    s_add_u32 m0, s38, 45056
    s_nop 0
    buffer_load_dwordx4 v15, s[16:19], s37 offen nt lds
    s_sub_u32 s38, s4, 4
    s_lshl_b32 s38, s38, 10
    s_add_u32 s38, s38, 12288
    v_lshlrev_b32 v15, 4, v0
    v_add_u32 v15, s38, v15
    v_lshrrev_b32 v17, 8, v15
    v_mul_u32_u24 v17, 205, v17
    v_lshrrev_b32 v17, 10, v17
    v_mul_u32_u24 v17, 2560, v17
    v_add_u32 v15, v15, v17
    s_add_u32 m0, s38, 45056
    s_nop 0
    buffer_load_dwordx4 v15, s[16:19], s37 offen nt lds
    s_sub_u32 s38, s4, 4
    s_lshl_b32 s38, s38, 10
    s_add_u32 s38, s38, 16384
    v_lshlrev_b32 v15, 4, v0
    v_add_u32 v15, s38, v15
    v_lshrrev_b32 v17, 8, v15
    v_mul_u32_u24 v17, 205, v17
    v_lshrrev_b32 v17, 10, v17
    v_mul_u32_u24 v17, 2560, v17
    v_add_u32 v15, v15, v17
    s_add_u32 m0, s38, 45056
    s_nop 0
    buffer_load_dwordx4 v15, s[16:19], s37 offen nt lds
    s_cmp_ge_u32 s4, 5
    s_cbranch_scc1 L_p1_a_ns
    s_waitcnt vmcnt(5)
    s_branch L_p1_a_c
L_p1_a_ld:
    s_waitcnt vmcnt(0)
L_p1_a_c:
    v_lshlrev_b32 v11, 16, v10
    v_and_b32 v12, 0xffff0000, v10
    v_mul_f32 v13, 0xbfb8aa3b, v11
    v_mul_f32 v14, 0xbfb8aa3b, v12
    v_exp_f32 v13, v13
    v_exp_f32 v14, v14
    v_add_f32 v13, 1.0, v13
    v_add_f32 v14, 1.0, v14
    v_rcp_f32 v13, v13
    v_rcp_f32 v14, v14
    v_mul_f32 v11, v11, v13
    v_mul_f32 v12, v12, v14
    v_cvt_pk_bf16_f32 v11, v11, v12
    v_lshlrev_b32 v3, 2, v249
    v_add_u32 v3, 40960, v3
    ds_write_b32 v3, v11
L_p1_a_ns:
    v_lshrrev_b32 v16, 5, v0
    s_lshl_b32 s38, s4, 3
    s_add_u32 s38, s38, 0
    v_bfe_u32 v40, v0, 4, 1
    v_lshlrev_b32 v40, 2, v40
    v_and_b32 v41, 3, v0
    v_add_u32 v40, v40, v41
    v_add_u32 v40, s38, v40
    v_lshrrev_b32 v41, 2, v40
    v_mul_u32_u24 v41, 20, v41
    v_and_b32 v42, 3, v40
    v_lshl_add_u32 v41, v42, 2, v41
    v_subrev_u32 v42, 128, v40
    v_mul_u32_u24 v42, 20, v42
    v_add_u32 v42, 16, v42
    v_cmp_le_u32 vcc, 128, v40
    s_nop 1
    v_cndmask_b32 v41, v41, v42, vcc
    v_lshlrev_b32 v41, 1, v41
    v_bfe_u32 v42, v0, 2, 2
    v_lshl_add_u32 v42, v16, 3, v42
    v_mul_u32_u24 v42, 1280, v42
    v_add_u32 v41, v41, v42
    v_add_u32 v80, 45056, v41
    s_lshl_b32 s38, s4, 3
    s_add_u32 s38, s38, 64
    v_bfe_u32 v40, v0, 4, 1
    v_lshlrev_b32 v40, 2, v40
    v_and_b32 v41, 3, v0
    v_add_u32 v40, v40, v41
    v_add_u32 v40, s38, v40
    v_lshrrev_b32 v41, 2, v40
    v_mul_u32_u24 v41, 20, v41
    v_and_b32 v42, 3, v40
    v_lshl_add_u32 v41, v42, 2, v41
    v_subrev_u32 v42, 128, v40
    v_mul_u32_u24 v42, 20, v42
    v_add_u32 v42, 16, v42
    v_cmp_le_u32 vcc, 128, v40
    s_nop 1
    v_cndmask_b32 v41, v41, v42, vcc
    v_lshlrev_b32 v41, 1, v41
    v_bfe_u32 v42, v0, 2, 2
    v_lshl_add_u32 v42, v16, 3, v42
    v_mul_u32_u24 v42, 1280, v42
    v_add_u32 v41, v41, v42
    v_add_u32 v81, 45056, v41
    s_lshl_b32 s38, s4, 3
    s_add_u32 s38, s38, 128
    v_bfe_u32 v40, v0, 4, 1
    v_lshlrev_b32 v40, 2, v40
    v_and_b32 v41, 3, v0
    v_add_u32 v40, v40, v41
    v_add_u32 v40, s38, v40
    v_lshrrev_b32 v41, 2, v40
    v_mul_u32_u24 v41, 20, v41
    v_and_b32 v42, 3, v40
    v_lshl_add_u32 v41, v42, 2, v41
    v_subrev_u32 v42, 128, v40
    v_mul_u32_u24 v42, 20, v42
    v_add_u32 v42, 16, v42
    v_cmp_le_u32 vcc, 128, v40
    s_nop 1
    v_cndmask_b32 v41, v41, v42, vcc
    v_lshlrev_b32 v41, 1, v41
    v_bfe_u32 v42, v0, 2, 2
    v_lshl_add_u32 v42, v16, 3, v42
    v_mul_u32_u24 v42, 1280, v42
    v_add_u32 v41, v41, v42
    v_add_u32 v82, 45056, v41
    v_lshrrev_b32 v5, 4, v0
    v_and_b32 v6, 15, v0
    v_lshlrev_b32 v7, 10, v5
    v_lshrrev_b32 v9, 2, v6
    v_lshl_add_u32 v7, v9, 7, v7
    v_and_b32 v9, 3, v6
    v_lshl_add_u32 v7, v9, 3, v7
    s_lshl_b32 s36, s4, 5
    v_add_u32 v7, s36, v7
    v_lshlrev_b32 v8, 4, v5
    s_lshl_b32 s36, s29, 8
    s_add_u32 s36, s36, 40960
    v_add_u32 v8, s36, v8
    s_cmp_ge_u32 s4, 4
    s_cbranch_scc1 L_p1_a_b1
    s_waitcnt vmcnt(0)
    s_cmp_eq_u32 s4, 0
    s_cbranch_scc0 L_p1_a_b1
    s_and_b32 s3, s2, 3
    s_lshl_b32 s3, s3, 6
    v_mov_b32 v250, s3
    s_mov_b32 s3, 0
L_zw_g:
    global_load_dword v252, v250, s[66:67] sc1
    s_waitcnt vmcnt(0)
    v_cmp_ne_u32 vcc, 0, v252
    s_nop 0
    s_cmp_eq_u64 vcc, -1
    s_cbranch_scc1 L_zd_g
    s_sleep 2
    s_add_u32 s3, s3, 1
    s_cmp_lt_u32 s3, 0x200000
    s_cbranch_scc1 L_zw_g
L_zd_g:
L_p1_a_b1:
    s_waitcnt lgkmcnt(0)
    s_barrier
    s_cmp_ge_u32 s4, 4
    s_cbranch_scc1 L_p1_a_poll
    s_cmp_ge_u32 s2, 100
    s_cbranch_scc1 L_p1_a_gs
    ds_read_b64_tr_b16 v[24:25], v7 offset:0
    ds_read_b64_tr_b16 v[26:27], v7 offset:512
    ds_read_b128 v[28:31], v8 offset:0
    ds_read_b64_tr_b16 v[32:33], v7 offset:4096
    ds_read_b64_tr_b16 v[34:35], v7 offset:4608
    ds_read_b128 v[36:39], v8 offset:64
    ds_read_b64_tr_b16 v[40:41], v7 offset:8192
    ds_read_b64_tr_b16 v[42:43], v7 offset:8704
    ds_read_b128 v[44:47], v8 offset:128
    ds_read_b64_tr_b16 v[48:49], v7 offset:12288
    ds_read_b64_tr_b16 v[50:51], v7 offset:12800
    ds_read_b128 v[52:55], v8 offset:192
    s_waitcnt lgkmcnt(9)
    v_mfma_f32_16x16x32_bf16 v[20:23], v[28:31], v[24:27], 0
    s_waitcnt lgkmcnt(6)
    v_mfma_f32_16x16x32_bf16 v[20:23], v[36:39], v[32:35], v[20:23]
    s_waitcnt lgkmcnt(3)
    v_mfma_f32_16x16x32_bf16 v[20:23], v[44:47], v[40:43], v[20:23]
    s_waitcnt lgkmcnt(0)
    v_mfma_f32_16x16x32_bf16 v[20:23], v[52:55], v[48:51], v[20:23]
    v_lshlrev_b32 v9, 2, v6
    s_mul_i32 s36, s29, 5120
    s_lshl_b32 s37, s28, 8
    s_add_u32 s36, s36, s37
    s_lshl_b32 s37, s4, 6
    s_add_u32 s36, s36, s37
    s_add_u32 s36, s36, 5386240
    s_mov_b32 exec_lo, 0xffff
    s_mov_b32 exec_hi, 0
    s_nop 3
    buffer_store_dword v20, v9, s[12:15], s36 offen sc1
    s_mov_b64 exec, -1
    s_waitcnt vmcnt(0)
    s_add_u32 s36, s28, 0
    s_lshl_b32 s3, s36, 7
    s_add_u32 s3, s3, 31719424
    v_lshlrev_b32 v250, 7, v0
    v_add_u32 v250, s3, v250
    v_mov_b32 v251, 1
    s_mov_b32 exec_lo, 1
    s_mov_b32 exec_hi, 0
    global_atomic_add v250, v251, s[6:7] sc1
    s_mov_b64 exec, -1
    s_branch L_p1_a_gs
L_p1_a_poll:
    s_cmp_eq_u32 s4, 5
    s_cbranch_scc0 L_p1_a_gs
    s_lshr_b32 s36, s24, 2
    s_add_u32 s37, s36, 10
    s_add_u32 s36, s36, 0
    s_and_b32 s47, s2, 15
    s_add_u32 s3, s36, 0
    v_mov_b32 v250, s3
    v_mov_b32 v251, 20
    s_add_u32 s3, s37, 0
    v_writelane_b32 v250, s3, 1
    v_lshlrev_b32 v250, 7, v250
    v_add_u32 v250, 31719424, v250
    s_mov_b32 s3, 0
L_poll_p1g:
    global_load_dword v252, v250, s[6:7] sc1
    s_waitcnt vmcnt(0)
    v_cmp_ge_u32 vcc, v252, v251
    s_nop 0
    s_cmp_eq_u64 vcc, -1
    s_cbranch_scc1 L_polled_p1g
    s_add_u32 s3, s3, 1
    s_cmp_lt_u32 s3, 0x200000
    s_cbranch_scc1 L_poll_p1g
L_polled_p1g:
    v_and_b32 v9, 15, v0
    v_lshlrev_b32 v9, 2, v9
    v_bfe_u32 v10, v0, 4, 1
    v_mul_u32_u24 v10, 2560, v10
    v_add_u32 v9, v9, v10
    s_lshl_b32 s36, s24, 6
    s_add_u32 s36, s36, 5386240
    buffer_load_dword v20, v9, s[12:15], s36 offen
    s_add_u32 s36, s36, 5120
    buffer_load_dword v21, v9, s[12:15], s36 offen
    s_add_u32 s36, s36, 5120
    buffer_load_dword v22, v9, s[12:15], s36 offen
    s_add_u32 s36, s36, 5120
    buffer_load_dword v23, v9, s[12:15], s36 offen
    s_add_u32 s36, s36, 5120
    buffer_load_dword v24, v9, s[12:15], s36 offen
    s_add_u32 s36, s36, 5120
    s_waitcnt vmcnt(0)
    v_add_f32 v20, v20, v21
    v_add_f32 v22, v22, v23
    v_add_f32 v20, v20, v24
    v_add_f32 v20, v20, v22
    v_cvt_pk_bf16_f32 v21, v20, v20
    v_lshlrev_b32 v21, 16, v21
    v_add_f32 v22, 1.0, v21
    v_cvt_pk_bf16_f32 v22, v22, v22
    v_lshlrev_b32 v22, 16, v22
    v_and_b32 v9, 31, v0
    v_cmp_lt_u32 vcc, 15, v9
    s_nop 1
    v_cndmask_b32 v21, v21, v22, vcc
    v_lshlrev_b32 v9, 2, v9
    v_add_u32 v9, 44032, v9
    ds_write_b32 v9, v21
L_p1_a_gs:
    s_waitcnt vmcnt(0) lgkmcnt(0)
    s_barrier
    v_lshlrev_b32 v9, 5, v16
    v_add_u32 v9, 44032, v9
    ds_read_b128 v[24:27], v9
    ds_read_b128 v[28:31], v9 offset:16
    ds_read_b128 v[32:35], v9 offset:64
    ds_read_b128 v[36:39], v9 offset:80
    ds_read_b64_tr_b16 v[84:85], v80
    ds_read_b64_tr_b16 v[86:87], v80 offset:5120
    ds_read_b64_tr_b16 v[88:89], v81
    ds_read_b64_tr_b16 v[90:91], v81 offset:5120
    ds_read_b64_tr_b16 v[92:93], v82
    ds_read_b64_tr_b16 v[94:95], v82 offset:5120
    v_lshlrev_b32 v43, 4, v0
    v_lshlrev_b32 v44, 2, v0
    s_waitcnt lgkmcnt(4)
    v_lshlrev_b32 v48, 16, v84
    v_and_b32 v49, 0xffff0000, v84
    v_lshlrev_b32 v50, 16, v85
    v_and_b32 v51, 0xffff0000, v85
    v_lshlrev_b32 v52, 16, v86
    v_and_b32 v53, 0xffff0000, v86
    v_lshlrev_b32 v54, 16, v87
    v_and_b32 v55, 0xffff0000, v87
    v_mul_f32 v56, v24, v48
    v_fmac_f32 v56, v25, v49
    v_fmac_f32 v56, v26, v50
    v_fmac_f32 v56, v27, v51
    v_fmac_f32 v56, v28, v52
    v_fmac_f32 v56, v29, v53
    v_fmac_f32 v56, v30, v54
    v_fmac_f32 v56, v31, v55
    v_mul_f32 v48, v32, v48
    v_mul_f32 v49, v33, v49
    v_mul_f32 v50, v34, v50
    v_mul_f32 v51, v35, v51
    v_mul_f32 v52, v36, v52
    v_mul_f32 v53, v37, v53
    v_mul_f32 v54, v38, v54
    v_mul_f32 v55, v39, v55
    v_cvt_pk_bf16_f32 v60, v48, v49
    v_cvt_pk_bf16_f32 v61, v50, v51
    v_cvt_pk_bf16_f32 v62, v52, v53
    v_cvt_pk_bf16_f32 v63, v54, v55
    v_mov_b32 v57, v56
    s_mul_i32 s38, s25, 20
    s_add_u32 s38, s38, s4
    s_add_u32 s38, s38, 0
    s_lshr_b32 s39, s38, 2
    s_mul_i32 s39, s39, 163840
    s_and_b32 s40, s38, 3
    s_lshl_b32 s40, s40, 10
    s_add_u32 s39, s39, s40
    s_lshl_b32 s40, s24, 12
    s_add_u32 s39, s39, s40
    s_add_u32 s39, s39, 2621440
    buffer_store_dwordx4 v[60:63], v43, s[12:15], s39 offen sc1
    v_permlane32_swap_b32 v56, v57
    v_add_f32 v72, v56, v57
    s_mul_i32 s39, s24, 7680
    s_lshl_b32 s40, s38, 7
    s_add_u32 s39, s39, s40
    s_add_u32 s39, s39, 5079040
    s_mov_b32 exec_hi, 0
    buffer_store_dword v72, v44, s[12:15], s39 offen sc1
    s_mov_b32 exec_hi, -1
    s_waitcnt lgkmcnt(2)
    v_lshlrev_b32 v48, 16, v88
    v_and_b32 v49, 0xffff0000, v88
    v_lshlrev_b32 v50, 16, v89
    v_and_b32 v51, 0xffff0000, v89
    v_lshlrev_b32 v52, 16, v90
    v_and_b32 v53, 0xffff0000, v90
    v_lshlrev_b32 v54, 16, v91
    v_and_b32 v55, 0xffff0000, v91
    v_mul_f32 v56, v24, v48
    v_fmac_f32 v56, v25, v49
    v_fmac_f32 v56, v26, v50
    v_fmac_f32 v56, v27, v51
    v_fmac_f32 v56, v28, v52
    v_fmac_f32 v56, v29, v53
    v_fmac_f32 v56, v30, v54
    v_fmac_f32 v56, v31, v55
    v_mul_f32 v48, v32, v48
    v_mul_f32 v49, v33, v49
    v_mul_f32 v50, v34, v50
    v_mul_f32 v51, v35, v51
    v_mul_f32 v52, v36, v52
    v_mul_f32 v53, v37, v53
    v_mul_f32 v54, v38, v54
    v_mul_f32 v55, v39, v55
    v_cvt_pk_bf16_f32 v64, v48, v49
    v_cvt_pk_bf16_f32 v65, v50, v51
    v_cvt_pk_bf16_f32 v66, v52, v53
    v_cvt_pk_bf16_f32 v67, v54, v55
    v_mov_b32 v57, v56
    s_mul_i32 s38, s25, 20
    s_add_u32 s38, s38, s4
    s_add_u32 s38, s38, 8
    s_lshr_b32 s39, s38, 2
    s_mul_i32 s39, s39, 163840
    s_and_b32 s40, s38, 3
    s_lshl_b32 s40, s40, 10
    s_add_u32 s39, s39, s40
    s_lshl_b32 s40, s24, 12
    s_add_u32 s39, s39, s40
    s_add_u32 s39, s39, 2621440
    buffer_store_dwordx4 v[64:67], v43, s[12:15], s39 offen sc1
    v_permlane32_swap_b32 v56, v57
    v_add_f32 v73, v56, v57
    s_mul_i32 s39, s24, 7680
    s_lshl_b32 s40, s38, 7
    s_add_u32 s39, s39, s40
    s_add_u32 s39, s39, 5079040
    s_mov_b32 exec_hi, 0
    buffer_store_dword v73, v44, s[12:15], s39 offen sc1
    s_mov_b32 exec_hi, -1
    s_cmp_ge_u32 s4, 4
    s_cbranch_scc1 L_p1_a_done
    s_waitcnt lgkmcnt(0)
    v_lshlrev_b32 v48, 16, v92
    v_and_b32 v49, 0xffff0000, v92
    v_lshlrev_b32 v50, 16, v93
    v_and_b32 v51, 0xffff0000, v93
    v_lshlrev_b32 v52, 16, v94
    v_and_b32 v53, 0xffff0000, v94
    v_lshlrev_b32 v54, 16, v95
    v_and_b32 v55, 0xffff0000, v95
    v_mul_f32 v56, v24, v48
    v_fmac_f32 v56, v25, v49
    v_fmac_f32 v56, v26, v50
    v_fmac_f32 v56, v27, v51
    v_fmac_f32 v56, v28, v52
    v_fmac_f32 v56, v29, v53
    v_fmac_f32 v56, v30, v54
    v_fmac_f32 v56, v31, v55
    v_mul_f32 v48, v32, v48
    v_mul_f32 v49, v33, v49
    v_mul_f32 v50, v34, v50
    v_mul_f32 v51, v35, v51
    v_mul_f32 v52, v36, v52
    v_mul_f32 v53, v37, v53
    v_mul_f32 v54, v38, v54
    v_mul_f32 v55, v39, v55
    v_cvt_pk_bf16_f32 v68, v48, v49
    v_cvt_pk_bf16_f32 v69, v50, v51
    v_cvt_pk_bf16_f32 v70, v52, v53
    v_cvt_pk_bf16_f32 v71, v54, v55
    v_mov_b32 v57, v56
    s_mul_i32 s38, s25, 20
    s_add_u32 s38, s38, s4
    s_add_u32 s38, s38, 16
    s_lshr_b32 s39, s38, 2
    s_mul_i32 s39, s39, 163840
    s_and_b32 s40, s38, 3
    s_lshl_b32 s40, s40, 10
    s_add_u32 s39, s39, s40
    s_lshl_b32 s40, s24, 12
    s_add_u32 s39, s39, s40
    s_add_u32 s39, s39, 2621440
    buffer_store_dwordx4 v[68:71], v43, s[12:15], s39 offen sc1
    v_permlane32_swap_b32 v56, v57
    v_add_f32 v74, v56, v57
    s_mul_i32 s39, s24, 7680
    s_lshl_b32 s40, s38, 7
    s_add_u32 s39, s39, s40
    s_add_u32 s39, s39, 5079040
    s_mov_b32 exec_hi, 0
    buffer_store_dword v74, v44, s[12:15], s39 offen sc1
    s_mov_b32 exec_hi, -1
L_p1_a_done:
    s_mov_b64 exec, -1
    s_waitcnt vmcnt(0) lgkmcnt(0)
    s_barrier
    s_cmp_eq_u32 s4, 4
    s_cbranch_scc0 L_p1_end
    s_mul_i32 s26, s25, 32
    s_add_u32 s26, s26, 40
    s_and_b32 s3, s24, 1
    s_lshl_b32 s3, s3, 4
    s_add_u32 s26, s26, s3
    s_lshl_b32 s3, s26, 7
    s_add_u32 s3, s3, 31719424
    v_lshlrev_b32 v250, 7, v0
    v_add_u32 v250, s3, v250
    v_mov_b32 v251, 1
    s_mov_b32 exec_lo, 65535
    s_mov_b32 exec_hi, 0
    global_atomic_add v250, v251, s[6:7] sc1
    s_mov_b64 exec, -1
    s_branch L_p1_end
L_p1_b:
    s_mov_b32 s16, s48
    s_mov_b32 s17, s49
    s_mov_b32 s18, 2621440
    s_mov_b32 s19, 0x00020000
    s_sub_u32 s24, s2, 120
    s_lshl_b32 s24, s24, 5
    s_lshl_b32 s25, s4, 2
    s_add_u32 s24, s24, s25
    v_lshrrev_b32 v63, 4, v0
    v_add_u32 v63, s24, v63
    v_and_b32 v64, 15, v0
    v_mul_u32_u24 v65, 1280, v63
    v_lshl_add_u32 v65, v64, 4, v65
    buffer_load_dwordx4 v[70:73], v65, s[16:19], 0 offen offset:0 nt
    buffer_load_dwordx4 v[74:77], v65, s[16:19], 0 offen offset:256 nt
    buffer_load_dwordx4 v[78:81], v65, s[16:19], 0 offen offset:512 nt
    buffer_load_dwordx4 v[82:85], v65, s[16:19], 0 offen offset:768 nt
    buffer_load_dwordx4 v[86:89], v65, s[16:19], 0 offen offset:1024 nt
    v_lshrrev_b32 v66, 7, v63
    s_mov_b32 s25, 163840
    v_mul_lo_u32 v66, v66, s25
    v_bfe_u32 v67, v63, 5, 2
    v_lshl_add_u32 v66, v67, 10, v66
    v_and_b32 v67, 31, v63
    v_lshl_add_u32 v66, v67, 4, v66
    v_and_b32 v67, 1, v64
    v_lshl_add_u32 v66, v67, 9, v66
    v_lshrrev_b32 v67, 1, v64
    v_lshl_add_u32 v66, v67, 12, v66
    s_waitcnt vmcnt(0)
    v_lshlrev_b32 v100, 16, v70
    v_and_b32 v101, 0xffff0000, v70
    v_lshlrev_b32 v102, 16, v71
    v_and_b32 v103, 0xffff0000, v71
    v_lshlrev_b32 v104, 16, v72
    v_and_b32 v105, 0xffff0000, v72
    v_lshlrev_b32 v106, 16, v73
    v_and_b32 v107, 0xffff0000, v73
    v_lshlrev_b32 v108, 16, v74
    v_and_b32 v109, 0xffff0000, v74
    v_lshlrev_b32 v110, 16, v75
    v_and_b32 v111, 0xffff0000, v75
    v_lshlrev_b32 v112, 16, v76
    v_and_b32 v113, 0xffff0000, v76
    v_lshlrev_b32 v114, 16, v77
    v_and_b32 v115, 0xffff0000, v77
    v_lshlrev_b32 v116, 16, v78
    v_and_b32 v117, 0xffff0000, v78
    v_lshlrev_b32 v118, 16, v79
    v_and_b32 v119, 0xffff0000, v79
    v_lshlrev_b32 v120, 16, v80
    v_and_b32 v121, 0xffff0000, v80
    v_lshlrev_b32 v122, 16, v81
    v_and_b32 v123, 0xffff0000, v81
    v_lshlrev_b32 v124, 16, v82
    v_and_b32 v125, 0xffff0000, v82
    v_lshlrev_b32 v126, 16, v83
    v_and_b32 v127, 0xffff0000, v83
    v_lshlrev_b32 v128, 16, v84
    v_and_b32 v129, 0xffff0000, v84
    v_lshlrev_b32 v130, 16, v85
    v_and_b32 v131, 0xffff0000, v85
    v_lshlrev_b32 v132, 16, v86
    v_and_b32 v133, 0xffff0000, v86
    v_lshlrev_b32 v134, 16, v87
    v_and_b32 v135, 0xffff0000, v87
    v_lshlrev_b32 v136, 16, v88
    v_and_b32 v137, 0xffff0000, v88
    v_lshlrev_b32 v138, 16, v89
    v_and_b32 v139, 0xffff0000, v89
    v_add_f32 v68, v100, v101
    v_add_f32 v68, v68, v102
    v_add_f32 v68, v68, v103
    v_add_f32 v68, v68, v104
    v_add_f32 v68, v68, v105
    v_add_f32 v68, v68, v106
    v_add_f32 v68, v68, v107
    v_add_f32 v68, v68, v108
    v_add_f32 v68, v68, v109
    v_add_f32 v68, v68, v110
    v_add_f32 v68, v68, v111
    v_add_f32 v68, v68, v112
    v_add_f32 v68, v68, v113
    v_add_f32 v68, v68, v114
    v_add_f32 v68, v68, v115
    v_add_f32 v68, v68, v116
    v_add_f32 v68, v68, v117
    v_add_f32 v68, v68, v118
    v_add_f32 v68, v68, v119
    v_add_f32 v68, v68, v120
    v_add_f32 v68, v68, v121
    v_add_f32 v68, v68, v122
    v_add_f32 v68, v68, v123
    v_add_f32 v68, v68, v124
    v_add_f32 v68, v68, v125
    v_add_f32 v68, v68, v126
    v_add_f32 v68, v68, v127
    v_add_f32 v68, v68, v128
    v_add_f32 v68, v68, v129
    v_add_f32 v68, v68, v130
    v_add_f32 v68, v68, v131
    v_add_f32 v68, v68, v132
    v_add_f32 v68, v68, v133
    v_add_f32 v68, v68, v134
    v_add_f32 v68, v68, v135
    v_add_f32 v68, v68, v136
    v_add_f32 v68, v68, v137
    v_add_f32 v68, v68, v138
    v_add_f32 v68, v68, v139
    s_nop 1
    v_add_f32_dpp v68, v68, v68 row_ror:8 row_mask:0xf bank_mask:0xf
    s_nop 1
    v_add_f32_dpp v68, v68, v68 row_ror:4 row_mask:0xf bank_mask:0xf
    s_nop 1
    v_add_f32_dpp v68, v68, v68 row_ror:2 row_mask:0xf bank_mask:0xf
    s_nop 1
    v_add_f32_dpp v68, v68, v68 row_ror:1 row_mask:0xf bank_mask:0xf
    v_mul_f32 v68, 0x3acccccd, v68
    v_sub_f32 v100, v100, v68
    v_sub_f32 v101, v101, v68
    v_sub_f32 v102, v102, v68
    v_sub_f32 v103, v103, v68
    v_sub_f32 v104, v104, v68
    v_sub_f32 v105, v105, v68
    v_sub_f32 v106, v106, v68
    v_sub_f32 v107, v107, v68
    v_sub_f32 v108, v108, v68
    v_sub_f32 v109, v109, v68
    v_sub_f32 v110, v110, v68
    v_sub_f32 v111, v111, v68
    v_sub_f32 v112, v112, v68
    v_sub_f32 v113, v113, v68
    v_sub_f32 v114, v114, v68
    v_sub_f32 v115, v115, v68
    v_sub_f32 v116, v116, v68
    v_sub_f32 v117, v117, v68
    v_sub_f32 v118, v118, v68
    v_sub_f32 v119, v119, v68
    v_sub_f32 v120, v120, v68
    v_sub_f32 v121, v121, v68
    v_sub_f32 v122, v122, v68
    v_sub_f32 v123, v123, v68
    v_sub_f32 v124, v124, v68
    v_sub_f32 v125, v125, v68
    v_sub_f32 v126, v126, v68
    v_sub_f32 v127, v127, v68
    v_sub_f32 v128, v128, v68
    v_sub_f32 v129, v129, v68
    v_sub_f32 v130, v130, v68
    v_sub_f32 v131, v131, v68
    v_sub_f32 v132, v132, v68
    v_sub_f32 v133, v133, v68
    v_sub_f32 v134, v134, v68
    v_sub_f32 v135, v135, v68
    v_sub_f32 v136, v136, v68
    v_sub_f32 v137, v137, v68
    v_sub_f32 v138, v138, v68
    v_sub_f32 v139, v139, v68
    v_mul_f32 v69, v100, v100
    v_fmac_f32 v69, v101, v101
    v_fmac_f32 v69, v102, v102
    v_fmac_f32 v69, v103, v103
    v_fmac_f32 v69, v104, v104
    v_fmac_f32 v69, v105, v105
    v_fmac_f32 v69, v106, v106
    v_fmac_f32 v69, v107, v107
    v_fmac_f32 v69, v108, v108
    v_fmac_f32 v69, v109, v109
    v_fmac_f32 v69, v110, v110
    v_fmac_f32 v69, v111, v111
    v_fmac_f32 v69, v112, v112
    v_fmac_f32 v69, v113, v113
    v_fmac_f32 v69, v114, v114
    v_fmac_f32 v69, v115, v115
    v_fmac_f32 v69, v116, v116
    v_fmac_f32 v69, v117, v117
    v_fmac_f32 v69, v118, v118
    v_fmac_f32 v69, v119, v119
    v_fmac_f32 v69, v120, v120
    v_fmac_f32 v69, v121, v121
    v_fmac_f32 v69, v122, v122
    v_fmac_f32 v69, v123, v123
    v_fmac_f32 v69, v124, v124
    v_fmac_f32 v69, v125, v125
    v_fmac_f32 v69, v126, v126
    v_fmac_f32 v69, v127, v127
    v_fmac_f32 v69, v128, v128
    v_fmac_f32 v69, v129, v129
    v_fmac_f32 v69, v130, v130
    v_fmac_f32 v69, v131, v131
    v_fmac_f32 v69, v132, v132
    v_fmac_f32 v69, v133, v133
    v_fmac_f32 v69, v134, v134
    v_fmac_f32 v69, v135, v135
    v_fmac_f32 v69, v136, v136
    v_fmac_f32 v69, v137, v137
    v_fmac_f32 v69, v138, v138
    v_fmac_f32 v69, v139, v139
    s_nop 1
    v_add_f32_dpp v69, v69, v69 row_ror:8 row_mask:0xf bank_mask:0xf
    s_nop 1
    v_add_f32_dpp v69, v69, v69 row_ror:4 row_mask:0xf bank_mask:0xf
    s_nop 1
    v_add_f32_dpp v69, v69, v69 row_ror:2 row_mask:0xf bank_mask:0xf
    s_nop 1
    v_add_f32_dpp v69, v69, v69 row_ror:1 row_mask:0xf bank_mask:0xf
    v_mov_b32 v68, 0x3727c5ac
    v_fmac_f32 v68, 0x3acccccd, v69
    v_rsq_f32 v68, v68
    s_nop 0
    v_mul_f32 v100, v100, v68
    v_mul_f32 v101, v101, v68
    v_mul_f32 v102, v102, v68
    v_mul_f32 v103, v103, v68
    v_mul_f32 v104, v104, v68
    v_mul_f32 v105, v105, v68
    v_mul_f32 v106, v106, v68
    v_mul_f32 v107, v107, v68
    v_mul_f32 v108, v108, v68
    v_mul_f32 v109, v109, v68
    v_mul_f32 v110, v110, v68
    v_mul_f32 v111, v111, v68
    v_mul_f32 v112, v112, v68
    v_mul_f32 v113, v113, v68
    v_mul_f32 v114, v114, v68
    v_mul_f32 v115, v115, v68
    v_mul_f32 v116, v116, v68
    v_mul_f32 v117, v117, v68
    v_mul_f32 v118, v118, v68
    v_mul_f32 v119, v119, v68
    v_mul_f32 v120, v120, v68
    v_mul_f32 v121, v121, v68
    v_mul_f32 v122, v122, v68
    v_mul_f32 v123, v123, v68
    v_mul_f32 v124, v124, v68
    v_mul_f32 v125, v125, v68
    v_mul_f32 v126, v126, v68
    v_mul_f32 v127, v127, v68
    v_mul_f32 v128, v128, v68
    v_mul_f32 v129, v129, v68
    v_mul_f32 v130, v130, v68
    v_mul_f32 v131, v131, v68
    v_mul_f32 v132, v132, v68
    v_mul_f32 v133, v133, v68
    v_mul_f32 v134, v134, v68
    v_mul_f32 v135, v135, v68
    v_mul_f32 v136, v136, v68
    v_mul_f32 v137, v137, v68
    v_mul_f32 v138, v138, v68
    v_mul_f32 v139, v139, v68
    v_cvt_pk_bf16_f32 v70, v100, v101
    v_cvt_pk_bf16_f32 v71, v102, v103
    v_cvt_pk_bf16_f32 v72, v104, v105
    v_cvt_pk_bf16_f32 v73, v106, v107
    v_cvt_pk_bf16_f32 v74, v108, v109
    v_cvt_pk_bf16_f32 v75, v110, v111
    v_cvt_pk_bf16_f32 v76, v112, v113
    v_cvt_pk_bf16_f32 v77, v114, v115
    v_cvt_pk_bf16_f32 v78, v116, v117
    v_cvt_pk_bf16_f32 v79, v118, v119
    v_cvt_pk_bf16_f32 v80, v120, v121
    v_cvt_pk_bf16_f32 v81, v122, v123
    v_cvt_pk_bf16_f32 v82, v124, v125
    v_cvt_pk_bf16_f32 v83, v126, v127
    v_cvt_pk_bf16_f32 v84, v128, v129
    v_cvt_pk_bf16_f32 v85, v130, v131
    v_cvt_pk_bf16_f32 v86, v132, v133
    v_cvt_pk_bf16_f32 v87, v134, v135
    v_cvt_pk_bf16_f32 v88, v136, v137
    v_cvt_pk_bf16_f32 v89, v138, v139
    s_mov_b32 s25, 0
    buffer_store_dwordx4 v[70:73], v66, s[12:15], s25 offen sc1
    s_mov_b32 s25, 32768
    buffer_store_dwordx4 v[74:77], v66, s[12:15], s25 offen sc1
    s_mov_b32 s25, 65536
    buffer_store_dwordx4 v[78:81], v66, s[12:15], s25 offen sc1
    s_mov_b32 s25, 98304
    buffer_store_dwordx4 v[82:85], v66, s[12:15], s25 offen sc1
    s_mov_b32 s25, 131072
    buffer_store_dwordx4 v[86:89], v66, s[12:15], s25 offen sc1
    s_mov_b64 exec, -1
    s_waitcnt vmcnt(0) lgkmcnt(0)
    s_barrier
    s_cmp_eq_u32 s4, 4
    s_cbranch_scc0 L_p1_end
    s_and_b32 s3, s2, 3
    s_lshl_b32 s3, s3, 6
    v_mov_b32 v250, s3
    s_mov_b32 s3, 0
L_zw_b:
    global_load_dword v252, v250, s[66:67] sc1
    s_waitcnt vmcnt(0)
    v_cmp_ne_u32 vcc, 0, v252
    s_nop 0
    s_cmp_eq_u64 vcc, -1
    s_cbranch_scc1 L_zd_b
    s_sleep 4
    s_add_u32 s3, s3, 1
    s_cmp_lt_u32 s3, 0x200000
    s_cbranch_scc1 L_zw_b
L_zd_b:
    s_sub_u32 s24, s2, 120
    s_lshr_b32 s24, s24, 2
    s_add_u32 s24, s24, 20
    s_lshl_b32 s3, s24, 7
    s_add_u32 s3, s3, 31719424
    v_lshlrev_b32 v250, 7, v0
    v_add_u32 v250, s3, v250
    v_mov_b32 v251, 1
    s_mov_b32 exec_lo, 1
    s_mov_b32 exec_hi, 0
    global_atomic_add v250, v251, s[6:7] sc1
    s_mov_b64 exec, -1
    s_branch L_p1_end
L_p1_rest:
    s_cmp_ge_u32 s2, 224
    s_cbranch_scc1 L_p1_idle
    s_sub_u32 s28, s2, 184
L_p1_cgo:
L_p1_c_now:
    v_lshlrev_b32 v3, 2, v249
    buffer_load_dword v10, v3, s[20:23], 0 offen
    v_lshrrev_b32 v4, 3, v0
    v_mul_u32_u24 v4, 7680, v4
    v_and_b32 v5, 7, v0
    v_lshl_add_u32 v4, v5, 4, v4
    s_waitcnt vmcnt(0)
    v_lshlrev_b32 v11, 16, v10
    v_and_b32 v12, 0xffff0000, v10
    v_mul_f32 v13, 0xbfb8aa3b, v11
    v_mul_f32 v14, 0xbfb8aa3b, v12
    v_exp_f32 v13, v13
    v_exp_f32 v14, v14
    v_add_f32 v13, 1.0, v13
    v_add_f32 v14, 1.0, v14
    v_rcp_f32 v13, v13
    v_rcp_f32 v14, v14
    v_mul_f32 v11, v11, v13
    v_mul_f32 v12, v12, v14
    v_cvt_pk_bf16_f32 v11, v11, v12
    v_lshlrev_b32 v3, 2, v249
    v_add_u32 v3, 81920, v3
    ds_write_b32 v3, v11
    s_and_b32 s32, s4, 3
    s_lshr_b32 s33, s4, 2
    v_lshrrev_b32 v5, 4, v0
    v_and_b32 v6, 15, v0
    v_lshlrev_b32 v7, 10, v5
    v_lshrrev_b32 v9, 2, v6
    v_lshl_add_u32 v7, v9, 7, v7
    v_and_b32 v9, 3, v6
    v_lshl_add_u32 v7, v9, 3, v7
    s_lshl_b32 s36, s32, 5
    s_mul_i32 s37, s33, 40960
    s_add_u32 s36, s36, s37
    v_add_u32 v7, s36, v7
    v_lshlrev_b32 v8, 4, v5
    s_mul_i32 s36, s33, 640
    s_add_u32 s36, s36, 81920
    v_add_u32 v8, s36, v8
L_p1_c_loop:
    s_lshl_b32 s34, s28, 7
    s_add_u32 s34, s34, 2560
    s_mul_i32 s35, s4, 614400
    s_add_u32 s34, s34, s35
    s_mul_i32 s35, s4, 10240
    s_add_u32 m0, s35, 0
    s_add_u32 s36, s34, 0
    buffer_load_dwordx4 v4, s[8:11], s36 offen nt lds
    s_add_u32 m0, s35, 1024
    s_add_u32 s36, s34, 61440
    buffer_load_dwordx4 v4, s[8:11], s36 offen nt lds
    s_add_u32 m0, s35, 2048
    s_add_u32 s36, s34, 122880
    buffer_load_dwordx4 v4, s[8:11], s36 offen nt lds
    s_add_u32 m0, s35, 3072
    s_add_u32 s36, s34, 184320
    buffer_load_dwordx4 v4, s[8:11], s36 offen nt lds
    s_add_u32 m0, s35, 4096
    s_add_u32 s36, s34, 245760
    buffer_load_dwordx4 v4, s[8:11], s36 offen nt lds
    s_add_u32 m0, s35, 5120
    s_add_u32 s36, s34, 307200
    buffer_load_dwordx4 v4, s[8:11], s36 offen nt lds
    s_add_u32 m0, s35, 6144
    s_add_u32 s36, s34, 368640
    buffer_load_dwordx4 v4, s[8:11], s36 offen nt lds
    s_add_u32 m0, s35, 7168
    s_add_u32 s36, s34, 430080
    buffer_load_dwordx4 v4, s[8:11], s36 offen nt lds
    s_add_u32 m0, s35, 8192
    s_add_u32 s36, s34, 491520
    buffer_load_dwordx4 v4, s[8:11], s36 offen nt lds
    s_add_u32 m0, s35, 9216
    s_add_u32 s36, s34, 552960
    buffer_load_dwordx4 v4, s[8:11], s36 offen nt lds
    v_mov_b32 v20, 0
    v_mov_b32 v21, 0
    v_mov_b32 v22, 0
    v_mov_b32 v23, 0
    s_waitcnt vmcnt(0) lgkmcnt(0)
    s_barrier
    ds_read_b64_tr_b16 v[24:25], v7 offset:0
    ds_read_b64_tr_b16 v[26:27], v7 offset:512
    ds_read_b128 v[28:31], v8 offset:0
    ds_read_b64_tr_b16 v[32:33], v7 offset:4096
    ds_read_b64_tr_b16 v[34:35], v7 offset:4608
    ds_read_b128 v[36:39], v8 offset:64
    ds_read_b64_tr_b16 v[40:41], v7 offset:8192
    ds_read_b64_tr_b16 v[42:43], v7 offset:8704
    ds_read_b128 v[44:47], v8 offset:128
    ds_read_b64_tr_b16 v[48:49], v7 offset:12288
    ds_read_b64_tr_b16 v[50:51], v7 offset:12800
    ds_read_b128 v[52:55], v8 offset:192
    ds_read_b64_tr_b16 v[56:57], v7 offset:16384
    ds_read_b64_tr_b16 v[58:59], v7 offset:16896
    ds_read_b128 v[60:63], v8 offset:256
    s_waitcnt lgkmcnt(12)
    v_mfma_f32_16x16x32_bf16 v[20:23], v[28:31], v[24:27], v[20:23]
    s_waitcnt lgkmcnt(9)
    v_mfma_f32_16x16x32_bf16 v[20:23], v[36:39], v[32:35], v[20:23]
    s_waitcnt lgkmcnt(6)
    v_mfma_f32_16x16x32_bf16 v[20:23], v[44:47], v[40:43], v[20:23]
    s_waitcnt lgkmcnt(3)
    v_mfma_f32_16x16x32_bf16 v[20:23], v[52:55], v[48:51], v[20:23]
    s_waitcnt lgkmcnt(0)
    v_mfma_f32_16x16x32_bf16 v[20:23], v[60:63], v[56:59], v[20:23]
    ds_read_b64_tr_b16 v[24:25], v7 offset:20480
    ds_read_b64_tr_b16 v[26:27], v7 offset:20992
    ds_read_b128 v[28:31], v8 offset:320
    ds_read_b64_tr_b16 v[32:33], v7 offset:24576
    ds_read_b64_tr_b16 v[34:35], v7 offset:25088
    ds_read_b128 v[36:39], v8 offset:384
    ds_read_b64_tr_b16 v[40:41], v7 offset:28672
    ds_read_b64_tr_b16 v[42:43], v7 offset:29184
    ds_read_b128 v[44:47], v8 offset:448
    ds_read_b64_tr_b16 v[48:49], v7 offset:32768
    ds_read_b64_tr_b16 v[50:51], v7 offset:33280
    ds_read_b128 v[52:55], v8 offset:512
    ds_read_b64_tr_b16 v[56:57], v7 offset:36864
    ds_read_b64_tr_b16 v[58:59], v7 offset:37376
    ds_read_b128 v[60:63], v8 offset:576
    s_waitcnt lgkmcnt(12)
    v_mfma_f32_16x16x32_bf16 v[20:23], v[28:31], v[24:27], v[20:23]
    s_waitcnt lgkmcnt(9)
    v_mfma_f32_16x16x32_bf16 v[20:23], v[36:39], v[32:35], v[20:23]
    s_waitcnt lgkmcnt(6)
    v_mfma_f32_16x16x32_bf16 v[20:23], v[44:47], v[40:43], v[20:23]
    s_waitcnt lgkmcnt(3)
    v_mfma_f32_16x16x32_bf16 v[20:23], v[52:55], v[48:51], v[20:23]
    s_waitcnt lgkmcnt(0)
    v_mfma_f32_16x16x32_bf16 v[20:23], v[60:63], v[56:59], v[20:23]
    s_lshl_b32 s36, s4, 6
    s_add_u32 s36, s36, 83968
    v_lshlrev_b32 v9, 2, v6
    v_add_u32 v9, s36, v9
    s_nop 4
    ds_write_b32 v9, v20
    s_waitcnt lgkmcnt(0)
    s_barrier
    v_lshlrev_b32 v9, 2, v0
    v_add_u32 v9, 83968, v9
    ds_read_b32 v20, v9
    ds_read_b32 v21, v9 offset:256
    s_waitcnt lgkmcnt(0)
    v_add_f32 v20, v20, v21
    v_cvt_pk_bf16_f32 v21, v20, v20
    v_lshlrev_b32 v21, 16, v21
    v_add_f32 v22, 1.0, v21
    v_cvt_pk_bf16_f32 v22, v22, v22
    v_lshlrev_b32 v22, 16, v22
    s_cmp_ge_u32 s28, 20
    s_cselect_b32 s36, 1, 0
    s_cmp_lt_u32 s28, 30
    s_cselect_b32 s37, s36, 0
    s_cmp_eq_u32 s37, 1
    s_cselect_b64 vcc, -1, 0
    v_cndmask_b32 v21, v21, v22, vcc
    v_lshlrev_b32 v9, 2, v0
    s_lshl_b32 s36, s28, 8
    s_add_u32 s36, s36, 5435392
    s_cmp_eq_u32 s4, 0
    s_cbranch_scc0 L_p1_c_nost
    buffer_store_dword v21, v9, s[12:15], s36 offen sc1
L_p1_c_nost:
    s_add_u32 s28, s28, 64
    s_cmp_lt_u32 s28, 40
    s_cbranch_scc0 L_p1_c_fin
    s_barrier
    s_branch L_p1_c_loop
L_p1_c_fin:
    s_mov_b64 exec, -1
    s_waitcnt vmcnt(0) lgkmcnt(0)
    s_barrier
    s_cmp_eq_u32 s4, 4
    s_cbranch_scc0 L_p1_end
    s_and_b32 s3, s2, 3
    s_lshl_b32 s3, s3, 6
    v_mov_b32 v250, s3
    s_mov_b32 s3, 0
L_zw_c:
    global_load_dword v252, v250, s[66:67] sc1
    s_waitcnt vmcnt(0)
    v_cmp_ne_u32 vcc, 0, v252
    s_nop 0
    s_cmp_eq_u64 vcc, -1
    s_cbranch_scc1 L_zd_c
    s_sleep 4
    s_add_u32 s3, s3, 1
    s_cmp_lt_u32 s3, 0x200000
    s_cbranch_scc1 L_zw_c
L_zd_c:
    s_mov_b32 s24, 136
    s_lshl_b32 s3, s24, 7
    s_add_u32 s3, s3, 31719424
    v_lshlrev_b32 v250, 7, v0
    v_add_u32 v250, s3, v250
    v_mov_b32 v251, 1
    s_mov_b32 exec_lo, 65535
    s_mov_b32 exec_hi, 0
    global_atomic_add v250, v251, s[6:7] sc1
    s_mov_b64 exec, -1
    s_branch L_p1_end
L_p1_idle:
    s_lshr_b32 s25, s2, 3
    s_sub_u32 s25, s25, 28
    s_cmp_ge_u32 s25, 3
    s_cbranch_scc1 L_p1_nopf
    s_getpc_b64 s[28:29]
L_p1_pc:
    s_sub_u32 s28, s28, L_p1_pc-adaLN_cond__mha_block__geglu_ffn__prompt_kernel
    s_subb_u32 s29, s29, 0
    s_mov_b32 s30, L_end-adaLN_cond__mha_block__geglu_ffn__prompt_kernel
    s_mov_b32 s31, 0x00020000
    s_mul_i32 s25, s25, 40960
    s_lshl_b32 s26, s4, 10
    s_add_u32 s25, s25, s26
    v_lshlrev_b32 v1, 4, v0
    v_add_u32 v1, s25, v1
    buffer_load_dwordx4 v[8:11], v1, s[28:31], 0 offen
    v_add_u32 v1, 8192, v1
    buffer_load_dwordx4 v[8:11], v1, s[28:31], 0 offen
    v_add_u32 v1, 8192, v1
    buffer_load_dwordx4 v[8:11], v1, s[28:31], 0 offen
    v_add_u32 v1, 8192, v1
    buffer_load_dwordx4 v[8:11], v1, s[28:31], 0 offen
    v_add_u32 v1, 8192, v1
    buffer_load_dwordx4 v[8:11], v1, s[28:31], 0 offen
    v_add_u32 v1, 8192, v1
L_p1_nopf:
    s_cmp_eq_u32 s4, 4
    s_cbranch_scc0 L_p1_end
    s_and_b32 s3, s2, 3
    s_lshl_b32 s3, s3, 6
    v_mov_b32 v250, s3
    s_mov_b32 s3, 0
    s_sleep 64
L_zw_i:
    global_load_dword v252, v250, s[66:67] sc1
    s_waitcnt vmcnt(0)
    v_cmp_ne_u32 vcc, 0, v252
    s_nop 0
    s_cmp_eq_u64 vcc, -1
    s_cbranch_scc1 L_zd_i
    s_sleep 16
    s_add_u32 s3, s3, 1
    s_cmp_lt_u32 s3, 0x200000
    s_cbranch_scc1 L_zw_i
L_zd_i:
L_p1_end:
    s_mov_b64 exec, -1
    s_waitcnt vmcnt(0) lgkmcnt(0)
    s_barrier
    s_and_b32 s24, s2, 7
    s_lshr_b32 s25, s2, 3
    s_lshr_b32 s26, s24, 1
    s_lshl_b32 s20, s26, 2
    s_bitcmp1_b32 s24, 0
    s_cbranch_scc1 L_p2_odd
    s_lshr_b32 s27, s25, 3
    s_add_u32 s20, s20, s27
    s_and_b32 s21, s25, 7
    s_branch L_p2_go
L_p2_odd:
    s_cmp_ge_u32 s25, 28
    s_cbranch_scc1 L_p2_d
    s_mul_i32 s27, s25, 9363
    s_lshr_b32 s27, s27, 16
    s_add_u32 s20, s20, s27
    s_mul_i32 s27, s27, 7
    s_sub_u32 s21, s25, s27
    s_add_u32 s21, s21, 8
L_p2_go:
    s_mul_i32 s22, s21, 13108
    s_lshr_b32 s22, s22, 16
    s_mul_i32 s23, s22, 5
    s_sub_u32 s23, s21, s23
    s_mov_b32 s5, s20
    s_cmp_ge_u32 s4, 4
    s_cbranch_scc1 L_p2_prod
    s_lshr_b32 s30, s4, 1
    s_and_b32 s31, s4, 1
    v_lshlrev_b32 v2, 4, v0
    s_lshl_b32 s32, s30, 11
    v_add_u32 v3, s32, v2
    v_add_u32 v4, 0x10000, v3
    s_lshl_b32 s32, s31, 11
    s_add_u32 s32, s32, 16384
    v_add_u32 v5, s32, v2
    v_add_u32 v6, 0x10000, v5
    s_lshl_b32 s35, s20, 2
    s_lshl_b32 s36, s30, 1
    s_add_u32 s35, s35, s36
    v_mov_b32 v64, 0
    v_mov_b32 v65, 0
    v_mov_b32 v66, 0
    v_mov_b32 v67, 0
    v_mov_b32 v68, 0
    v_mov_b32 v69, 0
    v_mov_b32 v70, 0
    v_mov_b32 v71, 0
    v_mov_b32 v72, 0
    v_mov_b32 v73, 0
    v_mov_b32 v74, 0
    v_mov_b32 v75, 0
    v_mov_b32 v76, 0
    v_mov_b32 v77, 0
    v_mov_b32 v78, 0
    v_mov_b32 v79, 0
    v_mov_b32 v80, 0
    v_mov_b32 v81, 0
    v_mov_b32 v82, 0
    v_mov_b32 v83, 0
    v_mov_b32 v84, 0
    v_mov_b32 v85, 0
    v_mov_b32 v86, 0
    v_mov_b32 v87, 0
    v_mov_b32 v88, 0
    v_mov_b32 v89, 0
    v_mov_b32 v90, 0
    v_mov_b32 v91, 0
    v_mov_b32 v92, 0
    v_mov_b32 v93, 0
    v_mov_b32 v94, 0
    v_mov_b32 v95, 0
    v_mov_b32 v96, 0
    v_mov_b32 v97, 0
    v_mov_b32 v98, 0
    v_mov_b32 v99, 0
    v_mov_b32 v100, 0
    v_mov_b32 v101, 0
    v_mov_b32 v102, 0
    v_mov_b32 v103, 0
    v_mov_b32 v104, 0
    v_mov_b32 v105, 0
    v_mov_b32 v106, 0
    v_mov_b32 v107, 0
    v_mov_b32 v108, 0
    v_mov_b32 v109, 0
    v_mov_b32 v110, 0
    v_mov_b32 v111, 0
    v_mov_b32 v112, 0
    v_mov_b32 v113, 0
    v_mov_b32 v114, 0
    v_mov_b32 v115, 0
    v_mov_b32 v116, 0
    v_mov_b32 v117, 0
    v_mov_b32 v118, 0
    v_mov_b32 v119, 0
    v_mov_b32 v120, 0
    v_mov_b32 v121, 0
    v_mov_b32 v122, 0
    v_mov_b32 v123, 0
    v_mov_b32 v124, 0
    v_mov_b32 v125, 0
    v_mov_b32 v126, 0
    v_mov_b32 v127, 0
    s_barrier
    s_cmp_eq_u32 s22, 2
    s_cbranch_scc1 L_p2_v
    s_cmp_eq_u32 s23, 4
    s_cbranch_scc1 L_p2_t
    s_barrier
    ds_read_b128 v[32:35], v3 offset:0
    ds_read_b128 v[36:39], v3 offset:1024
    ds_read_b128 v[40:43], v5 offset:0
    ds_read_b128 v[44:47], v5 offset:1024
    ds_read_b128 v[48:51], v3 offset:4096
    ds_read_b128 v[52:55], v3 offset:5120
    ds_read_b128 v[56:59], v5 offset:4096
    ds_read_b128 v[60:63], v5 offset:5120
    s_waitcnt lgkmcnt(4)
    v_mfma_f32_32x32x16_bf16 v[64:79], v[40:43], v[32:35], v[64:79]
    ds_read_b128 v[128:131], v3 offset:8192
    v_mfma_f32_32x32x16_bf16 v[80:95], v[44:47], v[32:35], v[80:95]
    ds_read_b128 v[132:135], v3 offset:9216
    v_mfma_f32_32x32x16_bf16 v[96:111], v[40:43], v[36:39], v[96:111]
    ds_read_b128 v[136:139], v5 offset:8192
    v_mfma_f32_32x32x16_bf16 v[112:127], v[44:47], v[36:39], v[112:127]
    ds_read_b128 v[140:143], v5 offset:9216
    s_waitcnt lgkmcnt(4)
    v_mfma_f32_32x32x16_bf16 v[64:79], v[56:59], v[48:51], v[64:79]
    ds_read_b128 v[32:35], v3 offset:12288
    v_mfma_f32_32x32x16_bf16 v[80:95], v[60:63], v[48:51], v[80:95]
    ds_read_b128 v[36:39], v3 offset:13312
    v_mfma_f32_32x32x16_bf16 v[96:111], v[56:59], v[52:55], v[96:111]
    ds_read_b128 v[40:43], v5 offset:12288
    v_mfma_f32_32x32x16_bf16 v[112:127], v[60:63], v[52:55], v[112:127]
    ds_read_b128 v[44:47], v5 offset:13312
    s_waitcnt lgkmcnt(4)
    v_mfma_f32_32x32x16_bf16 v[64:79], v[136:139], v[128:131], v[64:79]
    s_barrier
    ds_read_b128 v[48:51], v3 offset:32768
    v_mfma_f32_32x32x16_bf16 v[80:95], v[140:143], v[128:131], v[80:95]
    ds_read_b128 v[52:55], v3 offset:33792
    v_mfma_f32_32x32x16_bf16 v[96:111], v[136:139], v[132:135], v[96:111]
    ds_read_b128 v[56:59], v5 offset:32768
    v_mfma_f32_32x32x16_bf16 v[112:127], v[140:143], v[132:135], v[112:127]
    ds_read_b128 v[60:63], v5 offset:33792
    s_waitcnt lgkmcnt(4)
    v_mfma_f32_32x32x16_bf16 v[64:79], v[40:43], v[32:35], v[64:79]
    ds_read_b128 v[128:131], v3 offset:36864
    v_mfma_f32_32x32x16_bf16 v[80:95], v[44:47], v[32:35], v[80:95]
    ds_read_b128 v[132:135], v3 offset:37888
    v_mfma_f32_32x32x16_bf16 v[96:111], v[40:43], v[36:39], v[96:111]
    ds_read_b128 v[136:139], v5 offset:36864
    v_mfma_f32_32x32x16_bf16 v[112:127], v[44:47], v[36:39], v[112:127]
    ds_read_b128 v[140:143], v5 offset:37888
    s_waitcnt lgkmcnt(4)
    v_mfma_f32_32x32x16_bf16 v[64:79], v[56:59], v[48:51], v[64:79]
    ds_read_b128 v[32:35], v3 offset:40960
    v_mfma_f32_32x32x16_bf16 v[80:95], v[60:63], v[48:51], v[80:95]
    ds_read_b128 v[36:39], v3 offset:41984
    v_mfma_f32_32x32x16_bf16 v[96:111], v[56:59], v[52:55], v[96:111]
    ds_read_b128 v[40:43], v5 offset:40960
    v_mfma_f32_32x32x16_bf16 v[112:127], v[60:63], v[52:55], v[112:127]
    ds_read_b128 v[44:47], v5 offset:41984
    s_waitcnt lgkmcnt(4)
    v_mfma_f32_32x32x16_bf16 v[64:79], v[136:139], v[128:131], v[64:79]
    ds_read_b128 v[48:51], v3 offset:45056
    v_mfma_f32_32x32x16_bf16 v[80:95], v[140:143], v[128:131], v[80:95]
    ds_read_b128 v[52:55], v3 offset:46080
    v_mfma_f32_32x32x16_bf16 v[96:111], v[136:139], v[132:135], v[96:111]
    ds_read_b128 v[56:59], v5 offset:45056
    v_mfma_f32_32x32x16_bf16 v[112:127], v[140:143], v[132:135], v[112:127]
    ds_read_b128 v[60:63], v5 offset:46080
    s_waitcnt lgkmcnt(4)
    v_mfma_f32_32x32x16_bf16 v[64:79], v[40:43], v[32:35], v[64:79]
    s_barrier
    ds_read_b128 v[128:131], v4 offset:0
    v_mfma_f32_32x32x16_bf16 v[80:95], v[44:47], v[32:35], v[80:95]
    ds_read_b128 v[132:135], v4 offset:1024
    v_mfma_f32_32x32x16_bf16 v[96:111], v[40:43], v[36:39], v[96:111]
    ds_read_b128 v[136:139], v6 offset:0
    v_mfma_f32_32x32x16_bf16 v[112:127], v[44:47], v[36:39], v[112:127]
    ds_read_b128 v[140:143], v6 offset:1024
    s_waitcnt lgkmcnt(4)
    v_mfma_f32_32x32x16_bf16 v[64:79], v[56:59], v[48:51], v[64:79]
    ds_read_b128 v[32:35], v4 offset:4096
    v_mfma_f32_32x32x16_bf16 v[80:95], v[60:63], v[48:51], v[80:95]
    ds_read_b128 v[36:39], v4 offset:5120
    v_mfma_f32_32x32x16_bf16 v[96:111], v[56:59], v[52:55], v[96:111]
    ds_read_b128 v[40:43], v6 offset:4096
    v_mfma_f32_32x32x16_bf16 v[112:127], v[60:63], v[52:55], v[112:127]
    ds_read_b128 v[44:47], v6 offset:5120
    s_waitcnt lgkmcnt(4)
    v_mfma_f32_32x32x16_bf16 v[64:79], v[136:139], v[128:131], v[64:79]
    ds_read_b128 v[48:51], v4 offset:8192
    v_mfma_f32_32x32x16_bf16 v[80:95], v[140:143], v[128:131], v[80:95]
    ds_read_b128 v[52:55], v4 offset:9216
    v_mfma_f32_32x32x16_bf16 v[96:111], v[136:139], v[132:135], v[96:111]
    ds_read_b128 v[56:59], v6 offset:8192
    v_mfma_f32_32x32x16_bf16 v[112:127], v[140:143], v[132:135], v[112:127]
    ds_read_b128 v[60:63], v6 offset:9216
    s_waitcnt lgkmcnt(4)
    v_mfma_f32_32x32x16_bf16 v[64:79], v[40:43], v[32:35], v[64:79]
    ds_read_b128 v[128:131], v4 offset:12288
    v_mfma_f32_32x32x16_bf16 v[80:95], v[44:47], v[32:35], v[80:95]
    ds_read_b128 v[132:135], v4 offset:13312
    v_mfma_f32_32x32x16_bf16 v[96:111], v[40:43], v[36:39], v[96:111]
    ds_read_b128 v[136:139], v6 offset:12288
    v_mfma_f32_32x32x16_bf16 v[112:127], v[44:47], v[36:39], v[112:127]
    ds_read_b128 v[140:143], v6 offset:13312
    s_waitcnt lgkmcnt(4)
    v_mfma_f32_32x32x16_bf16 v[64:79], v[56:59], v[48:51], v[64:79]
    s_barrier
    ds_read_b128 v[32:35], v4 offset:32768
    v_mfma_f32_32x32x16_bf16 v[80:95], v[60:63], v[48:51], v[80:95]
    ds_read_b128 v[36:39], v4 offset:33792
    v_mfma_f32_32x32x16_bf16 v[96:111], v[56:59], v[52:55], v[96:111]
    ds_read_b128 v[40:43], v6 offset:32768
    v_mfma_f32_32x32x16_bf16 v[112:127], v[60:63], v[52:55], v[112:127]
    ds_read_b128 v[44:47], v6 offset:33792
    s_waitcnt lgkmcnt(4)
    v_mfma_f32_32x32x16_bf16 v[64:79], v[136:139], v[128:131], v[64:79]
    ds_read_b128 v[48:51], v4 offset:36864
    v_mfma_f32_32x32x16_bf16 v[80:95], v[140:143], v[128:131], v[80:95]
    ds_read_b128 v[52:55], v4 offset:37888
    v_mfma_f32_32x32x16_bf16 v[96:111], v[136:139], v[132:135], v[96:111]
    ds_read_b128 v[56:59], v6 offset:36864
    v_mfma_f32_32x32x16_bf16 v[112:127], v[140:143], v[132:135], v[112:127]
    ds_read_b128 v[60:63], v6 offset:37888
    s_waitcnt lgkmcnt(4)
    v_mfma_f32_32x32x16_bf16 v[64:79], v[40:43], v[32:35], v[64:79]
    ds_read_b128 v[128:131], v4 offset:40960
    v_mfma_f32_32x32x16_bf16 v[80:95], v[44:47], v[32:35], v[80:95]
    ds_read_b128 v[132:135], v4 offset:41984
    v_mfma_f32_32x32x16_bf16 v[96:111], v[40:43], v[36:39], v[96:111]
    ds_read_b128 v[136:139], v6 offset:40960
    v_mfma_f32_32x32x16_bf16 v[112:127], v[44:47], v[36:39], v[112:127]
    ds_read_b128 v[140:143], v6 offset:41984
    s_waitcnt lgkmcnt(4)
    v_mfma_f32_32x32x16_bf16 v[64:79], v[56:59], v[48:51], v[64:79]
    ds_read_b128 v[32:35], v4 offset:45056
    v_mfma_f32_32x32x16_bf16 v[80:95], v[60:63], v[48:51], v[80:95]
    ds_read_b128 v[36:39], v4 offset:46080
    v_mfma_f32_32x32x16_bf16 v[96:111], v[56:59], v[52:55], v[96:111]
    ds_read_b128 v[40:43], v6 offset:45056
    v_mfma_f32_32x32x16_bf16 v[112:127], v[60:63], v[52:55], v[112:127]
    ds_read_b128 v[44:47], v6 offset:46080
    s_waitcnt lgkmcnt(4)
    v_mfma_f32_32x32x16_bf16 v[64:79], v[136:139], v[128:131], v[64:79]
    s_barrier
    ds_read_b128 v[48:51], v3 offset:0
    v_mfma_f32_32x32x16_bf16 v[80:95], v[140:143], v[128:131], v[80:95]
    ds_read_b128 v[52:55], v3 offset:1024
    v_mfma_f32_32x32x16_bf16 v[96:111], v[136:139], v[132:135], v[96:111]
    ds_read_b128 v[56:59], v5 offset:0
    v_mfma_f32_32x32x16_bf16 v[112:127], v[140:143], v[132:135], v[112:127]
    ds_read_b128 v[60:63], v5 offset:1024
    s_waitcnt lgkmcnt(4)
    v_mfma_f32_32x32x16_bf16 v[64:79], v[40:43], v[32:35], v[64:79]
    ds_read_b128 v[128:131], v3 offset:4096
    v_mfma_f32_32x32x16_bf16 v[80:95], v[44:47], v[32:35], v[80:95]
    ds_read_b128 v[132:135], v3 offset:5120
    v_mfma_f32_32x32x16_bf16 v[96:111], v[40:43], v[36:39], v[96:111]
    ds_read_b128 v[136:139], v5 offset:4096
    v_mfma_f32_32x32x16_bf16 v[112:127], v[44:47], v[36:39], v[112:127]
    ds_read_b128 v[140:143], v5 offset:5120
    s_waitcnt lgkmcnt(4)
    v_mfma_f32_32x32x16_bf16 v[64:79], v[56:59], v[48:51], v[64:79]
    ds_read_b128 v[32:35], v3 offset:8192
    v_mfma_f32_32x32x16_bf16 v[80:95], v[60:63], v[48:51], v[80:95]
    ds_read_b128 v[36:39], v3 offset:9216
    v_mfma_f32_32x32x16_bf16 v[96:111], v[56:59], v[52:55], v[96:111]
    ds_read_b128 v[40:43], v5 offset:8192
    v_mfma_f32_32x32x16_bf16 v[112:127], v[60:63], v[52:55], v[112:127]
    ds_read_b128 v[44:47], v5 offset:9216
    s_waitcnt lgkmcnt(4)
    v_mfma_f32_32x32x16_bf16 v[64:79], v[136:139], v[128:131], v[64:79]
    ds_read_b128 v[48:51], v3 offset:12288
    v_mfma_f32_32x32x16_bf16 v[80:95], v[140:143], v[128:131], v[80:95]
    ds_read_b128 v[52:55], v3 offset:13312
    v_mfma_f32_32x32x16_bf16 v[96:111], v[136:139], v[132:135], v[96:111]
    ds_read_b128 v[56:59], v5 offset:12288
    v_mfma_f32_32x32x16_bf16 v[112:127], v[140:143], v[132:135], v[112:127]
    ds_read_b128 v[60:63], v5 offset:13312
    s_waitcnt lgkmcnt(4)
    v_mfma_f32_32x32x16_bf16 v[64:79], v[40:43], v[32:35], v[64:79]
    s_barrier
    ds_read_b128 v[128:131], v3 offset:32768
    v_mfma_f32_32x32x16_bf16 v[80:95], v[44:47], v[32:35], v[80:95]
    ds_read_b128 v[132:135], v3 offset:33792
    v_mfma_f32_32x32x16_bf16 v[96:111], v[40:43], v[36:39], v[96:111]
    ds_read_b128 v[136:139], v5 offset:32768
    v_mfma_f32_32x32x16_bf16 v[112:127], v[44:47], v[36:39], v[112:127]
    ds_read_b128 v[140:143], v5 offset:33792
    s_waitcnt lgkmcnt(4)
    v_mfma_f32_32x32x16_bf16 v[64:79], v[56:59], v[48:51], v[64:79]
    ds_read_b128 v[32:35], v3 offset:36864
    v_mfma_f32_32x32x16_bf16 v[80:95], v[60:63], v[48:51], v[80:95]
    ds_read_b128 v[36:39], v3 offset:37888
    v_mfma_f32_32x32x16_bf16 v[96:111], v[56:59], v[52:55], v[96:111]
    ds_read_b128 v[40:43], v5 offset:36864
    v_mfma_f32_32x32x16_bf16 v[112:127], v[60:63], v[52:55], v[112:127]
    ds_read_b128 v[44:47], v5 offset:37888
    s_waitcnt lgkmcnt(4)
    v_mfma_f32_32x32x16_bf16 v[64:79], v[136:139], v[128:131], v[64:79]
    ds_read_b128 v[48:51], v3 offset:40960
    v_mfma_f32_32x32x16_bf16 v[80:95], v[140:143], v[128:131], v[80:95]
    ds_read_b128 v[52:55], v3 offset:41984
    v_mfma_f32_32x32x16_bf16 v[96:111], v[136:139], v[132:135], v[96:111]
    ds_read_b128 v[56:59], v5 offset:40960
    v_mfma_f32_32x32x16_bf16 v[112:127], v[140:143], v[132:135], v[112:127]
    ds_read_b128 v[60:63], v5 offset:41984
    s_waitcnt lgkmcnt(4)
    v_mfma_f32_32x32x16_bf16 v[64:79], v[40:43], v[32:35], v[64:79]
    ds_read_b128 v[128:131], v3 offset:45056
    v_mfma_f32_32x32x16_bf16 v[80:95], v[44:47], v[32:35], v[80:95]
    ds_read_b128 v[132:135], v3 offset:46080
    v_mfma_f32_32x32x16_bf16 v[96:111], v[40:43], v[36:39], v[96:111]
    ds_read_b128 v[136:139], v5 offset:45056
    v_mfma_f32_32x32x16_bf16 v[112:127], v[44:47], v[36:39], v[112:127]
    ds_read_b128 v[140:143], v5 offset:46080
    s_waitcnt lgkmcnt(4)
    v_mfma_f32_32x32x16_bf16 v[64:79], v[56:59], v[48:51], v[64:79]
    s_barrier
    ds_read_b128 v[32:35], v4 offset:0
    v_mfma_f32_32x32x16_bf16 v[80:95], v[60:63], v[48:51], v[80:95]
    ds_read_b128 v[36:39], v4 offset:1024
    v_mfma_f32_32x32x16_bf16 v[96:111], v[56:59], v[52:55], v[96:111]
    ds_read_b128 v[40:43], v6 offset:0
    v_mfma_f32_32x32x16_bf16 v[112:127], v[60:63], v[52:55], v[112:127]
    ds_read_b128 v[44:47], v6 offset:1024
    s_waitcnt lgkmcnt(4)
    v_mfma_f32_32x32x16_bf16 v[64:79], v[136:139], v[128:131], v[64:79]
    ds_read_b128 v[48:51], v4 offset:4096
    v_mfma_f32_32x32x16_bf16 v[80:95], v[140:143], v[128:131], v[80:95]
    ds_read_b128 v[52:55], v4 offset:5120
    v_mfma_f32_32x32x16_bf16 v[96:111], v[136:139], v[132:135], v[96:111]
    ds_read_b128 v[56:59], v6 offset:4096
    v_mfma_f32_32x32x16_bf16 v[112:127], v[140:143], v[132:135], v[112:127]
    ds_read_b128 v[60:63], v6 offset:5120
    s_waitcnt lgkmcnt(4)
    v_mfma_f32_32x32x16_bf16 v[64:79], v[40:43], v[32:35], v[64:79]
    ds_read_b128 v[128:131], v4 offset:8192
    v_mfma_f32_32x32x16_bf16 v[80:95], v[44:47], v[32:35], v[80:95]
    ds_read_b128 v[132:135], v4 offset:9216
    v_mfma_f32_32x32x16_bf16 v[96:111], v[40:43], v[36:39], v[96:111]
    ds_read_b128 v[136:139], v6 offset:8192
    v_mfma_f32_32x32x16_bf16 v[112:127], v[44:47], v[36:39], v[112:127]
    ds_read_b128 v[140:143], v6 offset:9216
    s_waitcnt lgkmcnt(4)
    v_mfma_f32_32x32x16_bf16 v[64:79], v[56:59], v[48:51], v[64:79]
    ds_read_b128 v[32:35], v4 offset:12288
    v_mfma_f32_32x32x16_bf16 v[80:95], v[60:63], v[48:51], v[80:95]
    ds_read_b128 v[36:39], v4 offset:13312
    v_mfma_f32_32x32x16_bf16 v[96:111], v[56:59], v[52:55], v[96:111]
    ds_read_b128 v[40:43], v6 offset:12288
    v_mfma_f32_32x32x16_bf16 v[112:127], v[60:63], v[52:55], v[112:127]
    ds_read_b128 v[44:47], v6 offset:13312
    s_waitcnt lgkmcnt(4)
    v_mfma_f32_32x32x16_bf16 v[64:79], v[136:139], v[128:131], v[64:79]
    s_barrier
    ds_read_b128 v[48:51], v4 offset:32768
    v_mfma_f32_32x32x16_bf16 v[80:95], v[140:143], v[128:131], v[80:95]
    ds_read_b128 v[52:55], v4 offset:33792
    v_mfma_f32_32x32x16_bf16 v[96:111], v[136:139], v[132:135], v[96:111]
    ds_read_b128 v[56:59], v6 offset:32768
    v_mfma_f32_32x32x16_bf16 v[112:127], v[140:143], v[132:135], v[112:127]
    ds_read_b128 v[60:63], v6 offset:33792
    s_waitcnt lgkmcnt(4)
    v_mfma_f32_32x32x16_bf16 v[64:79], v[40:43], v[32:35], v[64:79]
    ds_read_b128 v[128:131], v4 offset:36864
    v_mfma_f32_32x32x16_bf16 v[80:95], v[44:47], v[32:35], v[80:95]
    ds_read_b128 v[132:135], v4 offset:37888
    v_mfma_f32_32x32x16_bf16 v[96:111], v[40:43], v[36:39], v[96:111]
    ds_read_b128 v[136:139], v6 offset:36864
    v_mfma_f32_32x32x16_bf16 v[112:127], v[44:47], v[36:39], v[112:127]
    ds_read_b128 v[140:143], v6 offset:37888
    s_waitcnt lgkmcnt(4)
    v_mfma_f32_32x32x16_bf16 v[64:79], v[56:59], v[48:51], v[64:79]
    ds_read_b128 v[32:35], v4 offset:40960
    v_mfma_f32_32x32x16_bf16 v[80:95], v[60:63], v[48:51], v[80:95]
    ds_read_b128 v[36:39], v4 offset:41984
    v_mfma_f32_32x32x16_bf16 v[96:111], v[56:59], v[52:55], v[96:111]
    ds_read_b128 v[40:43], v6 offset:40960
    v_mfma_f32_32x32x16_bf16 v[112:127], v[60:63], v[52:55], v[112:127]
    ds_read_b128 v[44:47], v6 offset:41984
    s_waitcnt lgkmcnt(4)
    v_mfma_f32_32x32x16_bf16 v[64:79], v[136:139], v[128:131], v[64:79]
    ds_read_b128 v[48:51], v4 offset:45056
    v_mfma_f32_32x32x16_bf16 v[80:95], v[140:143], v[128:131], v[80:95]
    ds_read_b128 v[52:55], v4 offset:46080
    v_mfma_f32_32x32x16_bf16 v[96:111], v[136:139], v[132:135], v[96:111]
    ds_read_b128 v[56:59], v6 offset:45056
    v_mfma_f32_32x32x16_bf16 v[112:127], v[140:143], v[132:135], v[112:127]
    ds_read_b128 v[60:63], v6 offset:46080
    s_waitcnt lgkmcnt(4)
    v_mfma_f32_32x32x16_bf16 v[64:79], v[40:43], v[32:35], v[64:79]
    s_barrier
    ds_read_b128 v[128:131], v3 offset:0
    v_mfma_f32_32x32x16_bf16 v[80:95], v[44:47], v[32:35], v[80:95]
    ds_read_b128 v[132:135], v3 offset:1024
    v_mfma_f32_32x32x16_bf16 v[96:111], v[40:43], v[36:39], v[96:111]
    ds_read_b128 v[136:139], v5 offset:0
    v_mfma_f32_32x32x16_bf16 v[112:127], v[44:47], v[36:39], v[112:127]
    ds_read_b128 v[140:143], v5 offset:1024
    s_waitcnt lgkmcnt(4)
    v_mfma_f32_32x32x16_bf16 v[64:79], v[56:59], v[48:51], v[64:79]
    ds_read_b128 v[32:35], v3 offset:4096
    v_mfma_f32_32x32x16_bf16 v[80:95], v[60:63], v[48:51], v[80:95]
    ds_read_b128 v[36:39], v3 offset:5120
    v_mfma_f32_32x32x16_bf16 v[96:111], v[56:59], v[52:55], v[96:111]
    ds_read_b128 v[40:43], v5 offset:4096
    v_mfma_f32_32x32x16_bf16 v[112:127], v[60:63], v[52:55], v[112:127]
    ds_read_b128 v[44:47], v5 offset:5120
    s_waitcnt lgkmcnt(4)
    v_mfma_f32_32x32x16_bf16 v[64:79], v[136:139], v[128:131], v[64:79]
    ds_read_b128 v[48:51], v3 offset:8192
    v_mfma_f32_32x32x16_bf16 v[80:95], v[140:143], v[128:131], v[80:95]
    ds_read_b128 v[52:55], v3 offset:9216
    v_mfma_f32_32x32x16_bf16 v[96:111], v[136:139], v[132:135], v[96:111]
    ds_read_b128 v[56:59], v5 offset:8192
    v_mfma_f32_32x32x16_bf16 v[112:127], v[140:143], v[132:135], v[112:127]
    ds_read_b128 v[60:63], v5 offset:9216
    s_waitcnt lgkmcnt(4)
    v_mfma_f32_32x32x16_bf16 v[64:79], v[40:43], v[32:35], v[64:79]
    ds_read_b128 v[128:131], v3 offset:12288
    v_mfma_f32_32x32x16_bf16 v[80:95], v[44:47], v[32:35], v[80:95]
    ds_read_b128 v[132:135], v3 offset:13312
    v_mfma_f32_32x32x16_bf16 v[96:111], v[40:43], v[36:39], v[96:111]
    ds_read_b128 v[136:139], v5 offset:12288
    v_mfma_f32_32x32x16_bf16 v[112:127], v[44:47], v[36:39], v[112:127]
    ds_read_b128 v[140:143], v5 offset:13312
    s_waitcnt lgkmcnt(4)
    v_mfma_f32_32x32x16_bf16 v[64:79], v[56:59], v[48:51], v[64:79]
    s_barrier
    ds_read_b128 v[32:35], v3 offset:32768
    v_mfma_f32_32x32x16_bf16 v[80:95], v[60:63], v[48:51], v[80:95]
    ds_read_b128 v[36:39], v3 offset:33792
    v_mfma_f32_32x32x16_bf16 v[96:111], v[56:59], v[52:55], v[96:111]
    ds_read_b128 v[40:43], v5 offset:32768
    v_mfma_f32_32x32x16_bf16 v[112:127], v[60:63], v[52:55], v[112:127]
    ds_read_b128 v[44:47], v5 offset:33792
    s_waitcnt lgkmcnt(4)
    v_mfma_f32_32x32x16_bf16 v[64:79], v[136:139], v[128:131], v[64:79]
    ds_read_b128 v[48:51], v3 offset:36864
    v_mfma_f32_32x32x16_bf16 v[80:95], v[140:143], v[128:131], v[80:95]
    ds_read_b128 v[52:55], v3 offset:37888
    v_mfma_f32_32x32x16_bf16 v[96:111], v[136:139], v[132:135], v[96:111]
    ds_read_b128 v[56:59], v5 offset:36864
    v_mfma_f32_32x32x16_bf16 v[112:127], v[140:143], v[132:135], v[112:127]
    ds_read_b128 v[60:63], v5 offset:37888
    s_waitcnt lgkmcnt(4)
    v_mfma_f32_32x32x16_bf16 v[64:79], v[40:43], v[32:35], v[64:79]
    ds_read_b128 v[128:131], v3 offset:40960
    v_mfma_f32_32x32x16_bf16 v[80:95], v[44:47], v[32:35], v[80:95]
    ds_read_b128 v[132:135], v3 offset:41984
    v_mfma_f32_32x32x16_bf16 v[96:111], v[40:43], v[36:39], v[96:111]
    ds_read_b128 v[136:139], v5 offset:40960
    v_mfma_f32_32x32x16_bf16 v[112:127], v[44:47], v[36:39], v[112:127]
    ds_read_b128 v[140:143], v5 offset:41984
    s_waitcnt lgkmcnt(4)
    v_mfma_f32_32x32x16_bf16 v[64:79], v[56:59], v[48:51], v[64:79]
    ds_read_b128 v[32:35], v3 offset:45056
    v_mfma_f32_32x32x16_bf16 v[80:95], v[60:63], v[48:51], v[80:95]
    ds_read_b128 v[36:39], v3 offset:46080
    v_mfma_f32_32x32x16_bf16 v[96:111], v[56:59], v[52:55], v[96:111]
    ds_read_b128 v[40:43], v5 offset:45056
    v_mfma_f32_32x32x16_bf16 v[112:127], v[60:63], v[52:55], v[112:127]
    ds_read_b128 v[44:47], v5 offset:46080
    s_waitcnt lgkmcnt(4)
    v_mfma_f32_32x32x16_bf16 v[64:79], v[136:139], v[128:131], v[64:79]
    v_mfma_f32_32x32x16_bf16 v[80:95], v[140:143], v[128:131], v[80:95]
    v_mfma_f32_32x32x16_bf16 v[96:111], v[136:139], v[132:135], v[96:111]
    v_mfma_f32_32x32x16_bf16 v[112:127], v[140:143], v[132:135], v[112:127]
    s_waitcnt lgkmcnt(0)
    v_mfma_f32_32x32x16_bf16 v[64:79], v[40:43], v[32:35], v[64:79]
    v_mfma_f32_32x32x16_bf16 v[80:95], v[44:47], v[32:35], v[80:95]
    v_mfma_f32_32x32x16_bf16 v[96:111], v[40:43], v[36:39], v[96:111]
    v_mfma_f32_32x32x16_bf16 v[112:127], v[44:47], v[36:39], v[112:127]
    v_and_b32 v7, 31, v0
    v_lshrrev_b32 v8, 5, v0
    s_lshl_b32 s34, s31, 8
    s_add_u32 s34, s34, 133120
    s_cmp_eq_u32 s22, 0
    s_mov_b32 s45, 163840
    s_mov_b32 s46, 2560
    s_mov_b32 s47, 8069120
    s_cselect_b32 s40, 81920, s45
    s_cselect_b32 s41, 1280, s46
    s_cselect_b32 s42, 5447680, s47
    s_cselect_b32 s44, 0x3ea52b5c, 1.0
    s_mul_i32 s36, s35, s41
    s_add_u32 s42, s42, s36
    s_add_u32 s43, s42, s41
    v_lshlrev_b32 v11, 4, v8
    v_add_u32 v11, s34, v11
    ds_read_b128 v[32:35], v11 offset:0
    ds_read_b128 v[36:39], v11 offset:32
    ds_read_b128 v[40:43], v11 offset:64
    ds_read_b128 v[44:47], v11 offset:96
    ds_read_b128 v[48:51], v11 offset:128
    ds_read_b128 v[52:55], v11 offset:160
    ds_read_b128 v[56:59], v11 offset:192
    ds_read_b128 v[60:63], v11 offset:224
    s_lshl_b32 s36, s23, 3
    s_lshl_b32 s37, s31, 2
    s_add_u32 s36, s36, s37
    s_mul_i32 s36, s36, s40
    s_add_u32 s42, s42, s36
    s_add_u32 s43, s43, s36
    v_lshlrev_b32 v16, 4, v0
    s_waitcnt lgkmcnt(0)
    v_fma_f32 v64, v64, s44, v32
    v_fma_f32 v65, v65, s44, v33
    v_fma_f32 v66, v66, s44, v34
    v_fma_f32 v67, v67, s44, v35
    v_fma_f32 v68, v68, s44, v36
    v_fma_f32 v69, v69, s44, v37
    v_fma_f32 v70, v70, s44, v38
    v_fma_f32 v71, v71, s44, v39
    v_fma_f32 v72, v72, s44, v40
    v_fma_f32 v73, v73, s44, v41
    v_fma_f32 v74, v74, s44, v42
    v_fma_f32 v75, v75, s44, v43
    v_fma_f32 v76, v76, s44, v44
    v_fma_f32 v77, v77, s44, v45
    v_fma_f32 v78, v78, s44, v46
    v_fma_f32 v79, v79, s44, v47
    v_cvt_pk_bf16_f32 v64, v64, v65
    v_cvt_pk_bf16_f32 v65, v66, v67
    v_cvt_pk_bf16_f32 v66, v68, v69
    v_cvt_pk_bf16_f32 v67, v70, v71
    v_cvt_pk_bf16_f32 v68, v72, v73
    v_cvt_pk_bf16_f32 v69, v74, v75
    v_cvt_pk_bf16_f32 v70, v76, v77
    v_cvt_pk_bf16_f32 v71, v78, v79
    s_nop 0
    v_permlane32_swap_b32 v64, v66
    v_permlane32_swap_b32 v65, v67
    v_permlane32_swap_b32 v68, v70
    v_permlane32_swap_b32 v69, v71
    s_mul_i32 s36, s40, 0
    s_add_u32 s36, s36, s42
    buffer_store_dwordx4 v[64:67], v16, s[12:15], s36 offen sc1
    s_mul_i32 s36, s40, 1
    s_add_u32 s36, s36, s42
    buffer_store_dwordx4 v[68:71], v16, s[12:15], s36 offen sc1
    v_fma_f32 v96, v96, s44, v32
    v_fma_f32 v97, v97, s44, v33
    v_fma_f32 v98, v98, s44, v34
    v_fma_f32 v99, v99, s44, v35
    v_fma_f32 v100, v100, s44, v36
    v_fma_f32 v101, v101, s44, v37
    v_fma_f32 v102, v102, s44, v38
    v_fma_f32 v103, v103, s44, v39
    v_fma_f32 v104, v104, s44, v40
    v_fma_f32 v105, v105, s44, v41
    v_fma_f32 v106, v106, s44, v42
    v_fma_f32 v107, v107, s44, v43
    v_fma_f32 v108, v108, s44, v44
    v_fma_f32 v109, v109, s44, v45
    v_fma_f32 v110, v110, s44, v46
    v_fma_f32 v111, v111, s44, v47
    v_cvt_pk_bf16_f32 v96, v96, v97
    v_cvt_pk_bf16_f32 v97, v98, v99
    v_cvt_pk_bf16_f32 v98, v100, v101
    v_cvt_pk_bf16_f32 v99, v102, v103
    v_cvt_pk_bf16_f32 v100, v104, v105
    v_cvt_pk_bf16_f32 v101, v106, v107
    v_cvt_pk_bf16_f32 v102, v108, v109
    v_cvt_pk_bf16_f32 v103, v110, v111
    s_nop 0
    v_permlane32_swap_b32 v96, v98
    v_permlane32_swap_b32 v97, v99
    v_permlane32_swap_b32 v100, v102
    v_permlane32_swap_b32 v101, v103
    s_mul_i32 s36, s40, 0
    s_add_u32 s36, s36, s43
    buffer_store_dwordx4 v[96:99], v16, s[12:15], s36 offen sc1
    s_mul_i32 s36, s40, 1
    s_add_u32 s36, s36, s43
    buffer_store_dwordx4 v[100:103], v16, s[12:15], s36 offen sc1
    v_fma_f32 v80, v80, s44, v48
    v_fma_f32 v81, v81, s44, v49
    v_fma_f32 v82, v82, s44, v50
    v_fma_f32 v83, v83, s44, v51
    v_fma_f32 v84, v84, s44, v52
    v_fma_f32 v85, v85, s44, v53
    v_fma_f32 v86, v86, s44, v54
    v_fma_f32 v87, v87, s44, v55
    v_fma_f32 v88, v88, s44, v56
    v_fma_f32 v89, v89, s44, v57
    v_fma_f32 v90, v90, s44, v58
    v_fma_f32 v91, v91, s44, v59
    v_fma_f32 v92, v92, s44, v60
    v_fma_f32 v93, v93, s44, v61
    v_fma_f32 v94, v94, s44, v62
    v_fma_f32 v95, v95, s44, v63
    v_cvt_pk_bf16_f32 v80, v80, v81
    v_cvt_pk_bf16_f32 v81, v82, v83
    v_cvt_pk_bf16_f32 v82, v84, v85
    v_cvt_pk_bf16_f32 v83, v86, v87
    v_cvt_pk_bf16_f32 v84, v88, v89
    v_cvt_pk_bf16_f32 v85, v90, v91
    v_cvt_pk_bf16_f32 v86, v92, v93
    v_cvt_pk_bf16_f32 v87, v94, v95
    s_nop 0
    v_permlane32_swap_b32 v80, v82
    v_permlane32_swap_b32 v81, v83
    v_permlane32_swap_b32 v84, v86
    v_permlane32_swap_b32 v85, v87
    s_mul_i32 s36, s40, 2
    s_add_u32 s36, s36, s42
    buffer_store_dwordx4 v[80:83], v16, s[12:15], s36 offen sc1
    s_mul_i32 s36, s40, 3
    s_add_u32 s36, s36, s42
    buffer_store_dwordx4 v[84:87], v16, s[12:15], s36 offen sc1
    v_fma_f32 v112, v112, s44, v48
    v_fma_f32 v113, v113, s44, v49
    v_fma_f32 v114, v114, s44, v50
    v_fma_f32 v115, v115, s44, v51
    v_fma_f32 v116, v116, s44, v52
    v_fma_f32 v117, v117, s44, v53
    v_fma_f32 v118, v118, s44, v54
    v_fma_f32 v119, v119, s44, v55
    v_fma_f32 v120, v120, s44, v56
    v_fma_f32 v121, v121, s44, v57
    v_fma_f32 v122, v122, s44, v58
    v_fma_f32 v123, v123, s44, v59
    v_fma_f32 v124, v124, s44, v60
    v_fma_f32 v125, v125, s44, v61
    v_fma_f32 v126, v126, s44, v62
    v_fma_f32 v127, v127, s44, v63
    v_cvt_pk_bf16_f32 v112, v112, v113
    v_cvt_pk_bf16_f32 v113, v114, v115
    v_cvt_pk_bf16_f32 v114, v116, v117
    v_cvt_pk_bf16_f32 v115, v118, v119
    v_cvt_pk_bf16_f32 v116, v120, v121
    v_cvt_pk_bf16_f32 v117, v122, v123
    v_cvt_pk_bf16_f32 v118, v124, v125
    v_cvt_pk_bf16_f32 v119, v126, v127
    s_nop 0
    v_permlane32_swap_b32 v112, v114
    v_permlane32_swap_b32 v113, v115
    v_permlane32_swap_b32 v116, v118
    v_permlane32_swap_b32 v117, v119
    s_mul_i32 s36, s40, 2
    s_add_u32 s36, s36, s43
    buffer_store_dwordx4 v[112:115], v16, s[12:15], s36 offen sc1
    s_mul_i32 s36, s40, 3
    s_add_u32 s36, s36, s43
    buffer_store_dwordx4 v[116:119], v16, s[12:15], s36 offen sc1
    s_branch L_p2_end
L_p2_t:
    s_barrier
    ds_read_b128 v[32:35], v3 offset:0
    ds_read_b128 v[36:39], v3 offset:1024
    ds_read_b128 v[40:43], v5 offset:0
    ds_read_b128 v[44:47], v5 offset:1024
    ds_read_b128 v[48:51], v3 offset:4096
    ds_read_b128 v[52:55], v3 offset:5120
    ds_read_b128 v[56:59], v5 offset:4096
    ds_read_b128 v[60:63], v5 offset:5120
    s_waitcnt lgkmcnt(4)
    v_mfma_f32_32x32x16_bf16 v[64:79], v[40:43], v[32:35], v[64:79]
    ds_read_b128 v[128:131], v3 offset:8192
    v_mfma_f32_32x32x16_bf16 v[80:95], v[44:47], v[32:35], v[80:95]
    ds_read_b128 v[132:135], v3 offset:9216
    v_mfma_f32_32x32x16_bf16 v[96:111], v[40:43], v[36:39], v[96:111]
    ds_read_b128 v[136:139], v5 offset:8192
    v_mfma_f32_32x32x16_bf16 v[112:127], v[44:47], v[36:39], v[112:127]
    ds_read_b128 v[140:143], v5 offset:9216
    s_waitcnt lgkmcnt(4)
    v_mfma_f32_32x32x16_bf16 v[64:79], v[56:59], v[48:51], v[64:79]
    ds_read_b128 v[32:35], v3 offset:12288
    v_mfma_f32_32x32x16_bf16 v[80:95], v[60:63], v[48:51], v[80:95]
    ds_read_b128 v[36:39], v3 offset:13312
    v_mfma_f32_32x32x16_bf16 v[96:111], v[56:59], v[52:55], v[96:111]
    ds_read_b128 v[40:43], v5 offset:12288
    v_mfma_f32_32x32x16_bf16 v[112:127], v[60:63], v[52:55], v[112:127]
    ds_read_b128 v[44:47], v5 offset:13312
    s_waitcnt lgkmcnt(4)
    v_mfma_f32_32x32x16_bf16 v[64:79], v[136:139], v[128:131], v[64:79]
    s_barrier
    ds_read_b128 v[48:51], v3 offset:32768
    v_mfma_f32_32x32x16_bf16 v[80:95], v[140:143], v[128:131], v[80:95]
    ds_read_b128 v[52:55], v3 offset:33792
    v_mfma_f32_32x32x16_bf16 v[96:111], v[136:139], v[132:135], v[96:111]
    ds_read_b128 v[56:59], v5 offset:32768
    v_mfma_f32_32x32x16_bf16 v[112:127], v[140:143], v[132:135], v[112:127]
    ds_read_b128 v[60:63], v5 offset:33792
    s_waitcnt lgkmcnt(4)
    v_mfma_f32_32x32x16_bf16 v[64:79], v[40:43], v[32:35], v[64:79]
    ds_read_b128 v[128:131], v3 offset:36864
    v_mfma_f32_32x32x16_bf16 v[80:95], v[44:47], v[32:35], v[80:95]
    ds_read_b128 v[132:135], v3 offset:37888
    v_mfma_f32_32x32x16_bf16 v[96:111], v[40:43], v[36:39], v[96:111]
    ds_read_b128 v[136:139], v5 offset:36864
    v_mfma_f32_32x32x16_bf16 v[112:127], v[44:47], v[36:39], v[112:127]
    ds_read_b128 v[140:143], v5 offset:37888
    s_waitcnt lgkmcnt(4)
    v_mfma_f32_32x32x16_bf16 v[64:79], v[56:59], v[48:51], v[64:79]
    ds_read_b128 v[32:35], v3 offset:40960
    v_mfma_f32_32x32x16_bf16 v[80:95], v[60:63], v[48:51], v[80:95]
    ds_read_b128 v[36:39], v3 offset:41984
    v_mfma_f32_32x32x16_bf16 v[96:111], v[56:59], v[52:55], v[96:111]
    ds_read_b128 v[40:43], v5 offset:40960
    v_mfma_f32_32x32x16_bf16 v[112:127], v[60:63], v[52:55], v[112:127]
    ds_read_b128 v[44:47], v5 offset:41984
    s_waitcnt lgkmcnt(4)
    v_mfma_f32_32x32x16_bf16 v[64:79], v[136:139], v[128:131], v[64:79]
    ds_read_b128 v[48:51], v3 offset:45056
    v_mfma_f32_32x32x16_bf16 v[80:95], v[140:143], v[128:131], v[80:95]
    ds_read_b128 v[52:55], v3 offset:46080
    v_mfma_f32_32x32x16_bf16 v[96:111], v[136:139], v[132:135], v[96:111]
    ds_read_b128 v[56:59], v5 offset:45056
    v_mfma_f32_32x32x16_bf16 v[112:127], v[140:143], v[132:135], v[112:127]
    ds_read_b128 v[60:63], v5 offset:46080
    s_waitcnt lgkmcnt(4)
    v_mfma_f32_32x32x16_bf16 v[64:79], v[40:43], v[32:35], v[64:79]
    s_barrier
    ds_read_b128 v[128:131], v4 offset:0
    v_mfma_f32_32x32x16_bf16 v[80:95], v[44:47], v[32:35], v[80:95]
    ds_read_b128 v[132:135], v4 offset:1024
    v_mfma_f32_32x32x16_bf16 v[96:111], v[40:43], v[36:39], v[96:111]
    ds_read_b128 v[136:139], v6 offset:0
    v_mfma_f32_32x32x16_bf16 v[112:127], v[44:47], v[36:39], v[112:127]
    ds_read_b128 v[140:143], v6 offset:1024
    s_waitcnt lgkmcnt(4)
    v_mfma_f32_32x32x16_bf16 v[64:79], v[56:59], v[48:51], v[64:79]
    ds_read_b128 v[32:35], v4 offset:4096
    v_mfma_f32_32x32x16_bf16 v[80:95], v[60:63], v[48:51], v[80:95]
    ds_read_b128 v[36:39], v4 offset:5120
    v_mfma_f32_32x32x16_bf16 v[96:111], v[56:59], v[52:55], v[96:111]
    ds_read_b128 v[40:43], v6 offset:4096
    v_mfma_f32_32x32x16_bf16 v[112:127], v[60:63], v[52:55], v[112:127]
    ds_read_b128 v[44:47], v6 offset:5120
    s_waitcnt lgkmcnt(4)
    v_mfma_f32_32x32x16_bf16 v[64:79], v[136:139], v[128:131], v[64:79]
    ds_read_b128 v[48:51], v4 offset:8192
    v_mfma_f32_32x32x16_bf16 v[80:95], v[140:143], v[128:131], v[80:95]
    ds_read_b128 v[52:55], v4 offset:9216
    v_mfma_f32_32x32x16_bf16 v[96:111], v[136:139], v[132:135], v[96:111]
    ds_read_b128 v[56:59], v6 offset:8192
    v_mfma_f32_32x32x16_bf16 v[112:127], v[140:143], v[132:135], v[112:127]
    ds_read_b128 v[60:63], v6 offset:9216
    s_waitcnt lgkmcnt(4)
    v_mfma_f32_32x32x16_bf16 v[64:79], v[40:43], v[32:35], v[64:79]
    ds_read_b128 v[128:131], v4 offset:12288
    v_mfma_f32_32x32x16_bf16 v[80:95], v[44:47], v[32:35], v[80:95]
    ds_read_b128 v[132:135], v4 offset:13312
    v_mfma_f32_32x32x16_bf16 v[96:111], v[40:43], v[36:39], v[96:111]
    ds_read_b128 v[136:139], v6 offset:12288
    v_mfma_f32_32x32x16_bf16 v[112:127], v[44:47], v[36:39], v[112:127]
    ds_read_b128 v[140:143], v6 offset:13312
    s_waitcnt lgkmcnt(4)
    v_mfma_f32_32x32x16_bf16 v[64:79], v[56:59], v[48:51], v[64:79]
    s_barrier
    ds_read_b128 v[32:35], v4 offset:32768
    v_mfma_f32_32x32x16_bf16 v[80:95], v[60:63], v[48:51], v[80:95]
    ds_read_b128 v[36:39], v4 offset:33792
    v_mfma_f32_32x32x16_bf16 v[96:111], v[56:59], v[52:55], v[96:111]
    ds_read_b128 v[40:43], v6 offset:32768
    v_mfma_f32_32x32x16_bf16 v[112:127], v[60:63], v[52:55], v[112:127]
    ds_read_b128 v[44:47], v6 offset:33792
    s_waitcnt lgkmcnt(4)
    v_mfma_f32_32x32x16_bf16 v[64:79], v[136:139], v[128:131], v[64:79]
    ds_read_b128 v[48:51], v4 offset:36864
    v_mfma_f32_32x32x16_bf16 v[80:95], v[140:143], v[128:131], v[80:95]
    ds_read_b128 v[52:55], v4 offset:37888
    v_mfma_f32_32x32x16_bf16 v[96:111], v[136:139], v[132:135], v[96:111]
    ds_read_b128 v[56:59], v6 offset:36864
    v_mfma_f32_32x32x16_bf16 v[112:127], v[140:143], v[132:135], v[112:127]
    ds_read_b128 v[60:63], v6 offset:37888
    s_waitcnt lgkmcnt(4)
    v_mfma_f32_32x32x16_bf16 v[64:79], v[40:43], v[32:35], v[64:79]
    ds_read_b128 v[128:131], v4 offset:40960
    v_mfma_f32_32x32x16_bf16 v[80:95], v[44:47], v[32:35], v[80:95]
    ds_read_b128 v[132:135], v4 offset:41984
    v_mfma_f32_32x32x16_bf16 v[96:111], v[40:43], v[36:39], v[96:111]
    ds_read_b128 v[136:139], v6 offset:40960
    v_mfma_f32_32x32x16_bf16 v[112:127], v[44:47], v[36:39], v[112:127]
    ds_read_b128 v[140:143], v6 offset:41984
    s_waitcnt lgkmcnt(4)
    v_mfma_f32_32x32x16_bf16 v[64:79], v[56:59], v[48:51], v[64:79]
    ds_read_b128 v[32:35], v4 offset:45056
    v_mfma_f32_32x32x16_bf16 v[80:95], v[60:63], v[48:51], v[80:95]
    ds_read_b128 v[36:39], v4 offset:46080
    v_mfma_f32_32x32x16_bf16 v[96:111], v[56:59], v[52:55], v[96:111]
    ds_read_b128 v[40:43], v6 offset:45056
    v_mfma_f32_32x32x16_bf16 v[112:127], v[60:63], v[52:55], v[112:127]
    ds_read_b128 v[44:47], v6 offset:46080
    s_waitcnt lgkmcnt(4)
    v_mfma_f32_32x32x16_bf16 v[64:79], v[136:139], v[128:131], v[64:79]
    s_barrier
    ds_read_b128 v[48:51], v3 offset:0
    v_mfma_f32_32x32x16_bf16 v[80:95], v[140:143], v[128:131], v[80:95]
    ds_read_b128 v[52:55], v3 offset:1024
    v_mfma_f32_32x32x16_bf16 v[96:111], v[136:139], v[132:135], v[96:111]
    ds_read_b128 v[56:59], v5 offset:0
    v_mfma_f32_32x32x16_bf16 v[112:127], v[140:143], v[132:135], v[112:127]
    ds_read_b128 v[60:63], v5 offset:1024
    s_waitcnt lgkmcnt(4)
    v_mfma_f32_32x32x16_bf16 v[64:79], v[40:43], v[32:35], v[64:79]
    ds_read_b128 v[128:131], v3 offset:4096
    v_mfma_f32_32x32x16_bf16 v[80:95], v[44:47], v[32:35], v[80:95]
    ds_read_b128 v[132:135], v3 offset:5120
    v_mfma_f32_32x32x16_bf16 v[96:111], v[40:43], v[36:39], v[96:111]
    ds_read_b128 v[136:139], v5 offset:4096
    v_mfma_f32_32x32x16_bf16 v[112:127], v[44:47], v[36:39], v[112:127]
    ds_read_b128 v[140:143], v5 offset:5120
    s_waitcnt lgkmcnt(4)
    v_mfma_f32_32x32x16_bf16 v[64:79], v[56:59], v[48:51], v[64:79]
    ds_read_b128 v[32:35], v3 offset:8192
    v_mfma_f32_32x32x16_bf16 v[80:95], v[60:63], v[48:51], v[80:95]
    ds_read_b128 v[36:39], v3 offset:9216
    v_mfma_f32_32x32x16_bf16 v[96:111], v[56:59], v[52:55], v[96:111]
    ds_read_b128 v[40:43], v5 offset:8192
    v_mfma_f32_32x32x16_bf16 v[112:127], v[60:63], v[52:55], v[112:127]
    ds_read_b128 v[44:47], v5 offset:9216
    s_waitcnt lgkmcnt(4)
    v_mfma_f32_32x32x16_bf16 v[64:79], v[136:139], v[128:131], v[64:79]
    ds_read_b128 v[48:51], v3 offset:12288
    v_mfma_f32_32x32x16_bf16 v[80:95], v[140:143], v[128:131], v[80:95]
    ds_read_b128 v[52:55], v3 offset:13312
    v_mfma_f32_32x32x16_bf16 v[96:111], v[136:139], v[132:135], v[96:111]
    ds_read_b128 v[56:59], v5 offset:12288
    v_mfma_f32_32x32x16_bf16 v[112:127], v[140:143], v[132:135], v[112:127]
    ds_read_b128 v[60:63], v5 offset:13312
    s_waitcnt lgkmcnt(4)
    v_mfma_f32_32x32x16_bf16 v[64:79], v[40:43], v[32:35], v[64:79]
    s_barrier
    ds_read_b128 v[128:131], v3 offset:32768
    v_mfma_f32_32x32x16_bf16 v[80:95], v[44:47], v[32:35], v[80:95]
    ds_read_b128 v[132:135], v3 offset:33792
    v_mfma_f32_32x32x16_bf16 v[96:111], v[40:43], v[36:39], v[96:111]
    ds_read_b128 v[136:139], v5 offset:32768
    v_mfma_f32_32x32x16_bf16 v[112:127], v[44:47], v[36:39], v[112:127]
    ds_read_b128 v[140:143], v5 offset:33792
    s_waitcnt lgkmcnt(4)
    v_mfma_f32_32x32x16_bf16 v[64:79], v[56:59], v[48:51], v[64:79]
    ds_read_b128 v[32:35], v3 offset:36864
    v_mfma_f32_32x32x16_bf16 v[80:95], v[60:63], v[48:51], v[80:95]
    ds_read_b128 v[36:39], v3 offset:37888
    v_mfma_f32_32x32x16_bf16 v[96:111], v[56:59], v[52:55], v[96:111]
    ds_read_b128 v[40:43], v5 offset:36864
    v_mfma_f32_32x32x16_bf16 v[112:127], v[60:63], v[52:55], v[112:127]
    ds_read_b128 v[44:47], v5 offset:37888
    s_waitcnt lgkmcnt(4)
    v_mfma_f32_32x32x16_bf16 v[64:79], v[136:139], v[128:131], v[64:79]
    ds_read_b128 v[48:51], v3 offset:40960
    v_mfma_f32_32x32x16_bf16 v[80:95], v[140:143], v[128:131], v[80:95]
    ds_read_b128 v[52:55], v3 offset:41984
    v_mfma_f32_32x32x16_bf16 v[96:111], v[136:139], v[132:135], v[96:111]
    ds_read_b128 v[56:59], v5 offset:40960
    v_mfma_f32_32x32x16_bf16 v[112:127], v[140:143], v[132:135], v[112:127]
    ds_read_b128 v[60:63], v5 offset:41984
    s_waitcnt lgkmcnt(4)
    v_mfma_f32_32x32x16_bf16 v[64:79], v[40:43], v[32:35], v[64:79]
    ds_read_b128 v[128:131], v3 offset:45056
    v_mfma_f32_32x32x16_bf16 v[80:95], v[44:47], v[32:35], v[80:95]
    ds_read_b128 v[132:135], v3 offset:46080
    v_mfma_f32_32x32x16_bf16 v[96:111], v[40:43], v[36:39], v[96:111]
    ds_read_b128 v[136:139], v5 offset:45056
    v_mfma_f32_32x32x16_bf16 v[112:127], v[44:47], v[36:39], v[112:127]
    ds_read_b128 v[140:143], v5 offset:46080
    s_waitcnt lgkmcnt(4)
    v_mfma_f32_32x32x16_bf16 v[64:79], v[56:59], v[48:51], v[64:79]
    s_barrier
    ds_read_b128 v[32:35], v4 offset:0
    v_mfma_f32_32x32x16_bf16 v[80:95], v[60:63], v[48:51], v[80:95]
    ds_read_b128 v[36:39], v4 offset:1024
    v_mfma_f32_32x32x16_bf16 v[96:111], v[56:59], v[52:55], v[96:111]
    ds_read_b128 v[40:43], v6 offset:0
    v_mfma_f32_32x32x16_bf16 v[112:127], v[60:63], v[52:55], v[112:127]
    ds_read_b128 v[44:47], v6 offset:1024
    s_waitcnt lgkmcnt(4)
    v_mfma_f32_32x32x16_bf16 v[64:79], v[136:139], v[128:131], v[64:79]
    ds_read_b128 v[48:51], v4 offset:4096
    v_mfma_f32_32x32x16_bf16 v[80:95], v[140:143], v[128:131], v[80:95]
    ds_read_b128 v[52:55], v4 offset:5120
    v_mfma_f32_32x32x16_bf16 v[96:111], v[136:139], v[132:135], v[96:111]
    ds_read_b128 v[56:59], v6 offset:4096
    v_mfma_f32_32x32x16_bf16 v[112:127], v[140:143], v[132:135], v[112:127]
    ds_read_b128 v[60:63], v6 offset:5120
    s_waitcnt lgkmcnt(4)
    v_mfma_f32_32x32x16_bf16 v[64:79], v[40:43], v[32:35], v[64:79]
    ds_read_b128 v[128:131], v4 offset:8192
    v_mfma_f32_32x32x16_bf16 v[80:95], v[44:47], v[32:35], v[80:95]
    ds_read_b128 v[132:135], v4 offset:9216
    v_mfma_f32_32x32x16_bf16 v[96:111], v[40:43], v[36:39], v[96:111]
    ds_read_b128 v[136:139], v6 offset:8192
    v_mfma_f32_32x32x16_bf16 v[112:127], v[44:47], v[36:39], v[112:127]
    ds_read_b128 v[140:143], v6 offset:9216
    s_waitcnt lgkmcnt(4)
    v_mfma_f32_32x32x16_bf16 v[64:79], v[56:59], v[48:51], v[64:79]
    ds_read_b128 v[32:35], v4 offset:12288
    v_mfma_f32_32x32x16_bf16 v[80:95], v[60:63], v[48:51], v[80:95]
    ds_read_b128 v[36:39], v4 offset:13312
    v_mfma_f32_32x32x16_bf16 v[96:111], v[56:59], v[52:55], v[96:111]
    ds_read_b128 v[40:43], v6 offset:12288
    v_mfma_f32_32x32x16_bf16 v[112:127], v[60:63], v[52:55], v[112:127]
    ds_read_b128 v[44:47], v6 offset:13312
    s_waitcnt lgkmcnt(4)
    v_mfma_f32_32x32x16_bf16 v[64:79], v[136:139], v[128:131], v[64:79]
    s_barrier
    ds_read_b128 v[48:51], v4 offset:32768
    v_mfma_f32_32x32x16_bf16 v[80:95], v[140:143], v[128:131], v[80:95]
    ds_read_b128 v[52:55], v4 offset:33792
    v_mfma_f32_32x32x16_bf16 v[96:111], v[136:139], v[132:135], v[96:111]
    ds_read_b128 v[56:59], v6 offset:32768
    v_mfma_f32_32x32x16_bf16 v[112:127], v[140:143], v[132:135], v[112:127]
    ds_read_b128 v[60:63], v6 offset:33792
    s_waitcnt lgkmcnt(4)
    v_mfma_f32_32x32x16_bf16 v[64:79], v[40:43], v[32:35], v[64:79]
    ds_read_b128 v[128:131], v4 offset:36864
    v_mfma_f32_32x32x16_bf16 v[80:95], v[44:47], v[32:35], v[80:95]
    ds_read_b128 v[132:135], v4 offset:37888
    v_mfma_f32_32x32x16_bf16 v[96:111], v[40:43], v[36:39], v[96:111]
    ds_read_b128 v[136:139], v6 offset:36864
    v_mfma_f32_32x32x16_bf16 v[112:127], v[44:47], v[36:39], v[112:127]
    ds_read_b128 v[140:143], v6 offset:37888
    s_waitcnt lgkmcnt(4)
    v_mfma_f32_32x32x16_bf16 v[64:79], v[56:59], v[48:51], v[64:79]
    ds_read_b128 v[32:35], v4 offset:40960
    v_mfma_f32_32x32x16_bf16 v[80:95], v[60:63], v[48:51], v[80:95]
    ds_read_b128 v[36:39], v4 offset:41984
    v_mfma_f32_32x32x16_bf16 v[96:111], v[56:59], v[52:55], v[96:111]
    ds_read_b128 v[40:43], v6 offset:40960
    v_mfma_f32_32x32x16_bf16 v[112:127], v[60:63], v[52:55], v[112:127]
    ds_read_b128 v[44:47], v6 offset:41984
    s_waitcnt lgkmcnt(4)
    v_mfma_f32_32x32x16_bf16 v[64:79], v[136:139], v[128:131], v[64:79]
    ds_read_b128 v[48:51], v4 offset:45056
    v_mfma_f32_32x32x16_bf16 v[80:95], v[140:143], v[128:131], v[80:95]
    ds_read_b128 v[52:55], v4 offset:46080
    v_mfma_f32_32x32x16_bf16 v[96:111], v[136:139], v[132:135], v[96:111]
    ds_read_b128 v[56:59], v6 offset:45056
    v_mfma_f32_32x32x16_bf16 v[112:127], v[140:143], v[132:135], v[112:127]
    ds_read_b128 v[60:63], v6 offset:46080
    s_waitcnt lgkmcnt(4)
    v_mfma_f32_32x32x16_bf16 v[64:79], v[40:43], v[32:35], v[64:79]
    s_barrier
    ds_read_b128 v[128:131], v3 offset:0
    v_mfma_f32_32x32x16_bf16 v[80:95], v[44:47], v[32:35], v[80:95]
    ds_read_b128 v[132:135], v3 offset:1024
    v_mfma_f32_32x32x16_bf16 v[96:111], v[40:43], v[36:39], v[96:111]
    ds_read_b128 v[136:139], v5 offset:0
    v_mfma_f32_32x32x16_bf16 v[112:127], v[44:47], v[36:39], v[112:127]
    ds_read_b128 v[140:143], v5 offset:1024
    s_waitcnt lgkmcnt(4)
    v_mfma_f32_32x32x16_bf16 v[64:79], v[56:59], v[48:51], v[64:79]
    ds_read_b128 v[32:35], v3 offset:4096
    v_mfma_f32_32x32x16_bf16 v[80:95], v[60:63], v[48:51], v[80:95]
    ds_read_b128 v[36:39], v3 offset:5120
    v_mfma_f32_32x32x16_bf16 v[96:111], v[56:59], v[52:55], v[96:111]
    ds_read_b128 v[40:43], v5 offset:4096
    v_mfma_f32_32x32x16_bf16 v[112:127], v[60:63], v[52:55], v[112:127]
    ds_read_b128 v[44:47], v5 offset:5120
    s_waitcnt lgkmcnt(4)
    v_mfma_f32_32x32x16_bf16 v[64:79], v[136:139], v[128:131], v[64:79]
    ds_read_b128 v[48:51], v3 offset:8192
    v_mfma_f32_32x32x16_bf16 v[80:95], v[140:143], v[128:131], v[80:95]
    ds_read_b128 v[52:55], v3 offset:9216
    v_mfma_f32_32x32x16_bf16 v[96:111], v[136:139], v[132:135], v[96:111]
    ds_read_b128 v[56:59], v5 offset:8192
    v_mfma_f32_32x32x16_bf16 v[112:127], v[140:143], v[132:135], v[112:127]
    ds_read_b128 v[60:63], v5 offset:9216
    s_waitcnt lgkmcnt(4)
    v_mfma_f32_32x32x16_bf16 v[64:79], v[40:43], v[32:35], v[64:79]
    ds_read_b128 v[128:131], v3 offset:12288
    v_mfma_f32_32x32x16_bf16 v[80:95], v[44:47], v[32:35], v[80:95]
    ds_read_b128 v[132:135], v3 offset:13312
    v_mfma_f32_32x32x16_bf16 v[96:111], v[40:43], v[36:39], v[96:111]
    ds_read_b128 v[136:139], v5 offset:12288
    v_mfma_f32_32x32x16_bf16 v[112:127], v[44:47], v[36:39], v[112:127]
    ds_read_b128 v[140:143], v5 offset:13312
    s_waitcnt lgkmcnt(4)
    v_mfma_f32_32x32x16_bf16 v[64:79], v[56:59], v[48:51], v[64:79]
    s_barrier
    ds_read_b128 v[32:35], v3 offset:32768
    v_mfma_f32_32x32x16_bf16 v[80:95], v[60:63], v[48:51], v[80:95]
    ds_read_b128 v[36:39], v3 offset:33792
    v_mfma_f32_32x32x16_bf16 v[96:111], v[56:59], v[52:55], v[96:111]
    ds_read_b128 v[40:43], v5 offset:32768
    v_mfma_f32_32x32x16_bf16 v[112:127], v[60:63], v[52:55], v[112:127]
    ds_read_b128 v[44:47], v5 offset:33792
    s_waitcnt lgkmcnt(4)
    v_mfma_f32_32x32x16_bf16 v[64:79], v[136:139], v[128:131], v[64:79]
    ds_read_b128 v[48:51], v3 offset:36864
    v_mfma_f32_32x32x16_bf16 v[80:95], v[140:143], v[128:131], v[80:95]
    ds_read_b128 v[52:55], v3 offset:37888
    v_mfma_f32_32x32x16_bf16 v[96:111], v[136:139], v[132:135], v[96:111]
    ds_read_b128 v[56:59], v5 offset:36864
    v_mfma_f32_32x32x16_bf16 v[112:127], v[140:143], v[132:135], v[112:127]
    ds_read_b128 v[60:63], v5 offset:37888
    s_waitcnt lgkmcnt(4)
    v_mfma_f32_32x32x16_bf16 v[64:79], v[40:43], v[32:35], v[64:79]
    ds_read_b128 v[128:131], v3 offset:40960
    v_mfma_f32_32x32x16_bf16 v[80:95], v[44:47], v[32:35], v[80:95]
    ds_read_b128 v[132:135], v3 offset:41984
    v_mfma_f32_32x32x16_bf16 v[96:111], v[40:43], v[36:39], v[96:111]
    ds_read_b128 v[136:139], v5 offset:40960
    v_mfma_f32_32x32x16_bf16 v[112:127], v[44:47], v[36:39], v[112:127]
    ds_read_b128 v[140:143], v5 offset:41984
    s_waitcnt lgkmcnt(4)
    v_mfma_f32_32x32x16_bf16 v[64:79], v[56:59], v[48:51], v[64:79]
    ds_read_b128 v[32:35], v3 offset:45056
    v_mfma_f32_32x32x16_bf16 v[80:95], v[60:63], v[48:51], v[80:95]
    ds_read_b128 v[36:39], v3 offset:46080
    v_mfma_f32_32x32x16_bf16 v[96:111], v[56:59], v[52:55], v[96:111]
    ds_read_b128 v[40:43], v5 offset:45056
    v_mfma_f32_32x32x16_bf16 v[112:127], v[60:63], v[52:55], v[112:127]
    ds_read_b128 v[44:47], v5 offset:46080
    s_waitcnt lgkmcnt(4)
    v_mfma_f32_32x32x16_bf16 v[64:79], v[136:139], v[128:131], v[64:79]
    v_mfma_f32_32x32x16_bf16 v[80:95], v[140:143], v[128:131], v[80:95]
    v_mfma_f32_32x32x16_bf16 v[96:111], v[136:139], v[132:135], v[96:111]
    v_mfma_f32_32x32x16_bf16 v[112:127], v[140:143], v[132:135], v[112:127]
    s_waitcnt lgkmcnt(0)
    v_mfma_f32_32x32x16_bf16 v[64:79], v[40:43], v[32:35], v[64:79]
    v_mfma_f32_32x32x16_bf16 v[80:95], v[44:47], v[32:35], v[80:95]
    v_mfma_f32_32x32x16_bf16 v[96:111], v[40:43], v[36:39], v[96:111]
    v_mfma_f32_32x32x16_bf16 v[112:127], v[44:47], v[36:39], v[112:127]
    v_and_b32 v7, 31, v0
    v_lshrrev_b32 v8, 5, v0
    s_lshl_b32 s34, s31, 8
    s_add_u32 s34, s34, 133120
    s_cmp_eq_u32 s22, 0
    s_mov_b32 s45, 163840
    s_mov_b32 s46, 2560
    s_mov_b32 s47, 8069120
    s_cselect_b32 s40, 81920, s45
    s_cselect_b32 s41, 1280, s46
    s_cselect_b32 s42, 5447680, s47
    s_cselect_b32 s44, 0x3ea52b5c, 1.0
    s_mul_i32 s36, s35, s41
    s_add_u32 s42, s42, s36
    s_add_u32 s43, s42, s41
    v_lshlrev_b32 v11, 4, v8
    v_add_u32 v11, s34, v11
    ds_read_b128 v[32:35], v11 offset:0
    ds_read_b128 v[36:39], v11 offset:32
    ds_read_b128 v[40:43], v11 offset:64
    ds_read_b128 v[44:47], v11 offset:96
    ds_read_b128 v[48:51], v11 offset:128
    ds_read_b128 v[52:55], v11 offset:160
    ds_read_b128 v[56:59], v11 offset:192
    ds_read_b128 v[60:63], v11 offset:224
    v_mul_lo_u32 v16, v8, s40
    v_lshl_add_u32 v16, v7, 3, v16
    s_lshl_b32 s36, s31, 4
    s_mul_i32 s36, s36, s40
    s_add_u32 s36, s36, 1024
    s_add_u32 s42, s42, s36
    s_add_u32 s43, s43, s36
    s_waitcnt lgkmcnt(0)
    v_fma_f32 v64, v64, s44, v32
    v_fma_f32 v65, v65, s44, v33
    v_fma_f32 v66, v66, s44, v34
    v_fma_f32 v67, v67, s44, v35
    v_fma_f32 v68, v68, s44, v36
    v_fma_f32 v69, v69, s44, v37
    v_fma_f32 v70, v70, s44, v38
    v_fma_f32 v71, v71, s44, v39
    v_fma_f32 v72, v72, s44, v40
    v_fma_f32 v73, v73, s44, v41
    v_fma_f32 v74, v74, s44, v42
    v_fma_f32 v75, v75, s44, v43
    v_fma_f32 v76, v76, s44, v44
    v_fma_f32 v77, v77, s44, v45
    v_fma_f32 v78, v78, s44, v46
    v_fma_f32 v79, v79, s44, v47
    v_cvt_pk_bf16_f32 v64, v64, v65
    v_cvt_pk_bf16_f32 v65, v66, v67
    v_cvt_pk_bf16_f32 v66, v68, v69
    v_cvt_pk_bf16_f32 v67, v70, v71
    v_cvt_pk_bf16_f32 v68, v72, v73
    v_cvt_pk_bf16_f32 v69, v74, v75
    v_cvt_pk_bf16_f32 v70, v76, v77
    v_cvt_pk_bf16_f32 v71, v78, v79
    s_mul_i32 s36, s40, 0
    s_add_u32 s36, s36, s42
    buffer_store_dwordx2 v[64:65], v16, s[12:15], s36 offen sc1
    s_mul_i32 s36, s40, 2
    s_add_u32 s36, s36, s42
    buffer_store_dwordx2 v[66:67], v16, s[12:15], s36 offen sc1
    s_mul_i32 s36, s40, 4
    s_add_u32 s36, s36, s42
    buffer_store_dwordx2 v[68:69], v16, s[12:15], s36 offen sc1
    s_mul_i32 s36, s40, 6
    s_add_u32 s36, s36, s42
    buffer_store_dwordx2 v[70:71], v16, s[12:15], s36 offen sc1
    v_fma_f32 v96, v96, s44, v32
    v_fma_f32 v97, v97, s44, v33
    v_fma_f32 v98, v98, s44, v34
    v_fma_f32 v99, v99, s44, v35
    v_fma_f32 v100, v100, s44, v36
    v_fma_f32 v101, v101, s44, v37
    v_fma_f32 v102, v102, s44, v38
    v_fma_f32 v103, v103, s44, v39
    v_fma_f32 v104, v104, s44, v40
    v_fma_f32 v105, v105, s44, v41
    v_fma_f32 v106, v106, s44, v42
    v_fma_f32 v107, v107, s44, v43
    v_fma_f32 v108, v108, s44, v44
    v_fma_f32 v109, v109, s44, v45
    v_fma_f32 v110, v110, s44, v46
    v_fma_f32 v111, v111, s44, v47
    v_cvt_pk_bf16_f32 v96, v96, v97
    v_cvt_pk_bf16_f32 v97, v98, v99
    v_cvt_pk_bf16_f32 v98, v100, v101
    v_cvt_pk_bf16_f32 v99, v102, v103
    v_cvt_pk_bf16_f32 v100, v104, v105
    v_cvt_pk_bf16_f32 v101, v106, v107
    v_cvt_pk_bf16_f32 v102, v108, v109
    v_cvt_pk_bf16_f32 v103, v110, v111
    s_mul_i32 s36, s40, 0
    s_add_u32 s36, s36, s43
    buffer_store_dwordx2 v[96:97], v16, s[12:15], s36 offen sc1
    s_mul_i32 s36, s40, 2
    s_add_u32 s36, s36, s43
    buffer_store_dwordx2 v[98:99], v16, s[12:15], s36 offen sc1
    s_mul_i32 s36, s40, 4
    s_add_u32 s36, s36, s43
    buffer_store_dwordx2 v[100:101], v16, s[12:15], s36 offen sc1
    s_mul_i32 s36, s40, 6
    s_add_u32 s36, s36, s43
    buffer_store_dwordx2 v[102:103], v16, s[12:15], s36 offen sc1
    v_fma_f32 v80, v80, s44, v48
    v_fma_f32 v81, v81, s44, v49
    v_fma_f32 v82, v82, s44, v50
    v_fma_f32 v83, v83, s44, v51
    v_fma_f32 v84, v84, s44, v52
    v_fma_f32 v85, v85, s44, v53
    v_fma_f32 v86, v86, s44, v54
    v_fma_f32 v87, v87, s44, v55
    v_fma_f32 v88, v88, s44, v56
    v_fma_f32 v89, v89, s44, v57
    v_fma_f32 v90, v90, s44, v58
    v_fma_f32 v91, v91, s44, v59
    v_fma_f32 v92, v92, s44, v60
    v_fma_f32 v93, v93, s44, v61
    v_fma_f32 v94, v94, s44, v62
    v_fma_f32 v95, v95, s44, v63
    v_cvt_pk_bf16_f32 v80, v80, v81
    v_cvt_pk_bf16_f32 v81, v82, v83
    v_cvt_pk_bf16_f32 v82, v84, v85
    v_cvt_pk_bf16_f32 v83, v86, v87
    v_cvt_pk_bf16_f32 v84, v88, v89
    v_cvt_pk_bf16_f32 v85, v90, v91
    v_cvt_pk_bf16_f32 v86, v92, v93
    v_cvt_pk_bf16_f32 v87, v94, v95
    s_mul_i32 s36, s40, 8
    s_add_u32 s36, s36, s42
    buffer_store_dwordx2 v[80:81], v16, s[12:15], s36 offen sc1
    s_mul_i32 s36, s40, 10
    s_add_u32 s36, s36, s42
    buffer_store_dwordx2 v[82:83], v16, s[12:15], s36 offen sc1
    s_mul_i32 s36, s40, 12
    s_add_u32 s36, s36, s42
    buffer_store_dwordx2 v[84:85], v16, s[12:15], s36 offen sc1
    s_mul_i32 s36, s40, 14
    s_add_u32 s36, s36, s42
    buffer_store_dwordx2 v[86:87], v16, s[12:15], s36 offen sc1
    v_fma_f32 v112, v112, s44, v48
    v_fma_f32 v113, v113, s44, v49
    v_fma_f32 v114, v114, s44, v50
    v_fma_f32 v115, v115, s44, v51
    v_fma_f32 v116, v116, s44, v52
    v_fma_f32 v117, v117, s44, v53
    v_fma_f32 v118, v118, s44, v54
    v_fma_f32 v119, v119, s44, v55
    v_fma_f32 v120, v120, s44, v56
    v_fma_f32 v121, v121, s44, v57
    v_fma_f32 v122, v122, s44, v58
    v_fma_f32 v123, v123, s44, v59
    v_fma_f32 v124, v124, s44, v60
    v_fma_f32 v125, v125, s44, v61
    v_fma_f32 v126, v126, s44, v62
    v_fma_f32 v127, v127, s44, v63
    v_cvt_pk_bf16_f32 v112, v112, v113
    v_cvt_pk_bf16_f32 v113, v114, v115
    v_cvt_pk_bf16_f32 v114, v116, v117
    v_cvt_pk_bf16_f32 v115, v118, v119
    v_cvt_pk_bf16_f32 v116, v120, v121
    v_cvt_pk_bf16_f32 v117, v122, v123
    v_cvt_pk_bf16_f32 v118, v124, v125
    v_cvt_pk_bf16_f32 v119, v126, v127
    s_mul_i32 s36, s40, 8
    s_add_u32 s36, s36, s43
    buffer_store_dwordx2 v[112:113], v16, s[12:15], s36 offen sc1
    s_mul_i32 s36, s40, 10
    s_add_u32 s36, s36, s43
    buffer_store_dwordx2 v[114:115], v16, s[12:15], s36 offen sc1
    s_mul_i32 s36, s40, 12
    s_add_u32 s36, s36, s43
    buffer_store_dwordx2 v[116:117], v16, s[12:15], s36 offen sc1
    s_mul_i32 s36, s40, 14
    s_add_u32 s36, s36, s43
    buffer_store_dwordx2 v[118:119], v16, s[12:15], s36 offen sc1
    s_branch L_p2_end
L_p2_v:
    s_barrier
    ds_read_b128 v[32:35], v3 offset:0
    ds_read_b128 v[36:39], v3 offset:1024
    ds_read_b128 v[40:43], v5 offset:0
    ds_read_b128 v[44:47], v5 offset:1024
    ds_read_b128 v[48:51], v3 offset:4096
    ds_read_b128 v[52:55], v3 offset:5120
    ds_read_b128 v[56:59], v5 offset:4096
    ds_read_b128 v[60:63], v5 offset:5120
    s_waitcnt lgkmcnt(4)
    v_mfma_f32_32x32x16_bf16 v[64:79], v[32:35], v[40:43], v[64:79]
    ds_read_b128 v[128:131], v3 offset:8192
    v_mfma_f32_32x32x16_bf16 v[80:95], v[32:35], v[44:47], v[80:95]
    ds_read_b128 v[132:135], v3 offset:9216
    v_mfma_f32_32x32x16_bf16 v[96:111], v[36:39], v[40:43], v[96:111]
    ds_read_b128 v[136:139], v5 offset:8192
    v_mfma_f32_32x32x16_bf16 v[112:127], v[36:39], v[44:47], v[112:127]
    ds_read_b128 v[140:143], v5 offset:9216
    s_waitcnt lgkmcnt(4)
    v_mfma_f32_32x32x16_bf16 v[64:79], v[48:51], v[56:59], v[64:79]
    ds_read_b128 v[32:35], v3 offset:12288
    v_mfma_f32_32x32x16_bf16 v[80:95], v[48:51], v[60:63], v[80:95]
    ds_read_b128 v[36:39], v3 offset:13312
    v_mfma_f32_32x32x16_bf16 v[96:111], v[52:55], v[56:59], v[96:111]
    ds_read_b128 v[40:43], v5 offset:12288
    v_mfma_f32_32x32x16_bf16 v[112:127], v[52:55], v[60:63], v[112:127]
    ds_read_b128 v[44:47], v5 offset:13312
    s_waitcnt lgkmcnt(4)
    v_mfma_f32_32x32x16_bf16 v[64:79], v[128:131], v[136:139], v[64:79]
    s_barrier
    ds_read_b128 v[48:51], v3 offset:32768
    v_mfma_f32_32x32x16_bf16 v[80:95], v[128:131], v[140:143], v[80:95]
    ds_read_b128 v[52:55], v3 offset:33792
    v_mfma_f32_32x32x16_bf16 v[96:111], v[132:135], v[136:139], v[96:111]
    ds_read_b128 v[56:59], v5 offset:32768
    v_mfma_f32_32x32x16_bf16 v[112:127], v[132:135], v[140:143], v[112:127]
    ds_read_b128 v[60:63], v5 offset:33792
    s_waitcnt lgkmcnt(4)
    v_mfma_f32_32x32x16_bf16 v[64:79], v[32:35], v[40:43], v[64:79]
    ds_read_b128 v[128:131], v3 offset:36864
    v_mfma_f32_32x32x16_bf16 v[80:95], v[32:35], v[44:47], v[80:95]
    ds_read_b128 v[132:135], v3 offset:37888
    v_mfma_f32_32x32x16_bf16 v[96:111], v[36:39], v[40:43], v[96:111]
    ds_read_b128 v[136:139], v5 offset:36864
    v_mfma_f32_32x32x16_bf16 v[112:127], v[36:39], v[44:47], v[112:127]
    ds_read_b128 v[140:143], v5 offset:37888
    s_waitcnt lgkmcnt(4)
    v_mfma_f32_32x32x16_bf16 v[64:79], v[48:51], v[56:59], v[64:79]
    ds_read_b128 v[32:35], v3 offset:40960
    v_mfma_f32_32x32x16_bf16 v[80:95], v[48:51], v[60:63], v[80:95]
    ds_read_b128 v[36:39], v3 offset:41984
    v_mfma_f32_32x32x16_bf16 v[96:111], v[52:55], v[56:59], v[96:111]
    ds_read_b128 v[40:43], v5 offset:40960
    v_mfma_f32_32x32x16_bf16 v[112:127], v[52:55], v[60:63], v[112:127]
    ds_read_b128 v[44:47], v5 offset:41984
    s_waitcnt lgkmcnt(4)
    v_mfma_f32_32x32x16_bf16 v[64:79], v[128:131], v[136:139], v[64:79]
    ds_read_b128 v[48:51], v3 offset:45056
    v_mfma_f32_32x32x16_bf16 v[80:95], v[128:131], v[140:143], v[80:95]
    ds_read_b128 v[52:55], v3 offset:46080
    v_mfma_f32_32x32x16_bf16 v[96:111], v[132:135], v[136:139], v[96:111]
    ds_read_b128 v[56:59], v5 offset:45056
    v_mfma_f32_32x32x16_bf16 v[112:127], v[132:135], v[140:143], v[112:127]
    ds_read_b128 v[60:63], v5 offset:46080
    s_waitcnt lgkmcnt(4)
    v_mfma_f32_32x32x16_bf16 v[64:79], v[32:35], v[40:43], v[64:79]
    s_barrier
    ds_read_b128 v[128:131], v4 offset:0
    v_mfma_f32_32x32x16_bf16 v[80:95], v[32:35], v[44:47], v[80:95]
    ds_read_b128 v[132:135], v4 offset:1024
    v_mfma_f32_32x32x16_bf16 v[96:111], v[36:39], v[40:43], v[96:111]
    ds_read_b128 v[136:139], v6 offset:0
    v_mfma_f32_32x32x16_bf16 v[112:127], v[36:39], v[44:47], v[112:127]
    ds_read_b128 v[140:143], v6 offset:1024
    s_waitcnt lgkmcnt(4)
    v_mfma_f32_32x32x16_bf16 v[64:79], v[48:51], v[56:59], v[64:79]
    ds_read_b128 v[32:35], v4 offset:4096
    v_mfma_f32_32x32x16_bf16 v[80:95], v[48:51], v[60:63], v[80:95]
    ds_read_b128 v[36:39], v4 offset:5120
    v_mfma_f32_32x32x16_bf16 v[96:111], v[52:55], v[56:59], v[96:111]
    ds_read_b128 v[40:43], v6 offset:4096
    v_mfma_f32_32x32x16_bf16 v[112:127], v[52:55], v[60:63], v[112:127]
    ds_read_b128 v[44:47], v6 offset:5120
    s_waitcnt lgkmcnt(4)
    v_mfma_f32_32x32x16_bf16 v[64:79], v[128:131], v[136:139], v[64:79]
    ds_read_b128 v[48:51], v4 offset:8192
    v_mfma_f32_32x32x16_bf16 v[80:95], v[128:131], v[140:143], v[80:95]
    ds_read_b128 v[52:55], v4 offset:9216
    v_mfma_f32_32x32x16_bf16 v[96:111], v[132:135], v[136:139], v[96:111]
    ds_read_b128 v[56:59], v6 offset:8192
    v_mfma_f32_32x32x16_bf16 v[112:127], v[132:135], v[140:143], v[112:127]
    ds_read_b128 v[60:63], v6 offset:9216
    s_waitcnt lgkmcnt(4)
    v_mfma_f32_32x32x16_bf16 v[64:79], v[32:35], v[40:43], v[64:79]
    ds_read_b128 v[128:131], v4 offset:12288
    v_mfma_f32_32x32x16_bf16 v[80:95], v[32:35], v[44:47], v[80:95]
    ds_read_b128 v[132:135], v4 offset:13312
    v_mfma_f32_32x32x16_bf16 v[96:111], v[36:39], v[40:43], v[96:111]
    ds_read_b128 v[136:139], v6 offset:12288
    v_mfma_f32_32x32x16_bf16 v[112:127], v[36:39], v[44:47], v[112:127]
    ds_read_b128 v[140:143], v6 offset:13312
    s_waitcnt lgkmcnt(4)
    v_mfma_f32_32x32x16_bf16 v[64:79], v[48:51], v[56:59], v[64:79]
    s_barrier
    ds_read_b128 v[32:35], v4 offset:32768
    v_mfma_f32_32x32x16_bf16 v[80:95], v[48:51], v[60:63], v[80:95]
    ds_read_b128 v[36:39], v4 offset:33792
    v_mfma_f32_32x32x16_bf16 v[96:111], v[52:55], v[56:59], v[96:111]
    ds_read_b128 v[40:43], v6 offset:32768
    v_mfma_f32_32x32x16_bf16 v[112:127], v[52:55], v[60:63], v[112:127]
    ds_read_b128 v[44:47], v6 offset:33792
    s_waitcnt lgkmcnt(4)
    v_mfma_f32_32x32x16_bf16 v[64:79], v[128:131], v[136:139], v[64:79]
    ds_read_b128 v[48:51], v4 offset:36864
    v_mfma_f32_32x32x16_bf16 v[80:95], v[128:131], v[140:143], v[80:95]
    ds_read_b128 v[52:55], v4 offset:37888
    v_mfma_f32_32x32x16_bf16 v[96:111], v[132:135], v[136:139], v[96:111]
    ds_read_b128 v[56:59], v6 offset:36864
    v_mfma_f32_32x32x16_bf16 v[112:127], v[132:135], v[140:143], v[112:127]
    ds_read_b128 v[60:63], v6 offset:37888
    s_waitcnt lgkmcnt(4)
    v_mfma_f32_32x32x16_bf16 v[64:79], v[32:35], v[40:43], v[64:79]
    ds_read_b128 v[128:131], v4 offset:40960
    v_mfma_f32_32x32x16_bf16 v[80:95], v[32:35], v[44:47], v[80:95]
    ds_read_b128 v[132:135], v4 offset:41984
    v_mfma_f32_32x32x16_bf16 v[96:111], v[36:39], v[40:43], v[96:111]
    ds_read_b128 v[136:139], v6 offset:40960
    v_mfma_f32_32x32x16_bf16 v[112:127], v[36:39], v[44:47], v[112:127]
    ds_read_b128 v[140:143], v6 offset:41984
    s_waitcnt lgkmcnt(4)
    v_mfma_f32_32x32x16_bf16 v[64:79], v[48:51], v[56:59], v[64:79]
    ds_read_b128 v[32:35], v4 offset:45056
    v_mfma_f32_32x32x16_bf16 v[80:95], v[48:51], v[60:63], v[80:95]
    ds_read_b128 v[36:39], v4 offset:46080
    v_mfma_f32_32x32x16_bf16 v[96:111], v[52:55], v[56:59], v[96:111]
    ds_read_b128 v[40:43], v6 offset:45056
    v_mfma_f32_32x32x16_bf16 v[112:127], v[52:55], v[60:63], v[112:127]
    ds_read_b128 v[44:47], v6 offset:46080
    s_waitcnt lgkmcnt(4)
    v_mfma_f32_32x32x16_bf16 v[64:79], v[128:131], v[136:139], v[64:79]
    s_barrier
    ds_read_b128 v[48:51], v3 offset:0
    v_mfma_f32_32x32x16_bf16 v[80:95], v[128:131], v[140:143], v[80:95]
    ds_read_b128 v[52:55], v3 offset:1024
    v_mfma_f32_32x32x16_bf16 v[96:111], v[132:135], v[136:139], v[96:111]
    ds_read_b128 v[56:59], v5 offset:0
    v_mfma_f32_32x32x16_bf16 v[112:127], v[132:135], v[140:143], v[112:127]
    ds_read_b128 v[60:63], v5 offset:1024
    s_waitcnt lgkmcnt(4)
    v_mfma_f32_32x32x16_bf16 v[64:79], v[32:35], v[40:43], v[64:79]
    ds_read_b128 v[128:131], v3 offset:4096
    v_mfma_f32_32x32x16_bf16 v[80:95], v[32:35], v[44:47], v[80:95]
    ds_read_b128 v[132:135], v3 offset:5120
    v_mfma_f32_32x32x16_bf16 v[96:111], v[36:39], v[40:43], v[96:111]
    ds_read_b128 v[136:139], v5 offset:4096
    v_mfma_f32_32x32x16_bf16 v[112:127], v[36:39], v[44:47], v[112:127]
    ds_read_b128 v[140:143], v5 offset:5120
    s_waitcnt lgkmcnt(4)
    v_mfma_f32_32x32x16_bf16 v[64:79], v[48:51], v[56:59], v[64:79]
    ds_read_b128 v[32:35], v3 offset:8192
    v_mfma_f32_32x32x16_bf16 v[80:95], v[48:51], v[60:63], v[80:95]
    ds_read_b128 v[36:39], v3 offset:9216
    v_mfma_f32_32x32x16_bf16 v[96:111], v[52:55], v[56:59], v[96:111]
    ds_read_b128 v[40:43], v5 offset:8192
    v_mfma_f32_32x32x16_bf16 v[112:127], v[52:55], v[60:63], v[112:127]
    ds_read_b128 v[44:47], v5 offset:9216
    s_waitcnt lgkmcnt(4)
    v_mfma_f32_32x32x16_bf16 v[64:79], v[128:131], v[136:139], v[64:79]
    ds_read_b128 v[48:51], v3 offset:12288
    v_mfma_f32_32x32x16_bf16 v[80:95], v[128:131], v[140:143], v[80:95]
    ds_read_b128 v[52:55], v3 offset:13312
    v_mfma_f32_32x32x16_bf16 v[96:111], v[132:135], v[136:139], v[96:111]
    ds_read_b128 v[56:59], v5 offset:12288
    v_mfma_f32_32x32x16_bf16 v[112:127], v[132:135], v[140:143], v[112:127]
    ds_read_b128 v[60:63], v5 offset:13312
    s_waitcnt lgkmcnt(4)
    v_mfma_f32_32x32x16_bf16 v[64:79], v[32:35], v[40:43], v[64:79]
    s_barrier
    ds_read_b128 v[128:131], v3 offset:32768
    v_mfma_f32_32x32x16_bf16 v[80:95], v[32:35], v[44:47], v[80:95]
    ds_read_b128 v[132:135], v3 offset:33792
    v_mfma_f32_32x32x16_bf16 v[96:111], v[36:39], v[40:43], v[96:111]
    ds_read_b128 v[136:139], v5 offset:32768
    v_mfma_f32_32x32x16_bf16 v[112:127], v[36:39], v[44:47], v[112:127]
    ds_read_b128 v[140:143], v5 offset:33792
    s_waitcnt lgkmcnt(4)
    v_mfma_f32_32x32x16_bf16 v[64:79], v[48:51], v[56:59], v[64:79]
    ds_read_b128 v[32:35], v3 offset:36864
    v_mfma_f32_32x32x16_bf16 v[80:95], v[48:51], v[60:63], v[80:95]
    ds_read_b128 v[36:39], v3 offset:37888
    v_mfma_f32_32x32x16_bf16 v[96:111], v[52:55], v[56:59], v[96:111]
    ds_read_b128 v[40:43], v5 offset:36864
    v_mfma_f32_32x32x16_bf16 v[112:127], v[52:55], v[60:63], v[112:127]
    ds_read_b128 v[44:47], v5 offset:37888
    s_waitcnt lgkmcnt(4)
    v_mfma_f32_32x32x16_bf16 v[64:79], v[128:131], v[136:139], v[64:79]
    ds_read_b128 v[48:51], v3 offset:40960
    v_mfma_f32_32x32x16_bf16 v[80:95], v[128:131], v[140:143], v[80:95]
    ds_read_b128 v[52:55], v3 offset:41984
    v_mfma_f32_32x32x16_bf16 v[96:111], v[132:135], v[136:139], v[96:111]
    ds_read_b128 v[56:59], v5 offset:40960
    v_mfma_f32_32x32x16_bf16 v[112:127], v[132:135], v[140:143], v[112:127]
    ds_read_b128 v[60:63], v5 offset:41984
    s_waitcnt lgkmcnt(4)
    v_mfma_f32_32x32x16_bf16 v[64:79], v[32:35], v[40:43], v[64:79]
    ds_read_b128 v[128:131], v3 offset:45056
    v_mfma_f32_32x32x16_bf16 v[80:95], v[32:35], v[44:47], v[80:95]
    ds_read_b128 v[132:135], v3 offset:46080
    v_mfma_f32_32x32x16_bf16 v[96:111], v[36:39], v[40:43], v[96:111]
    ds_read_b128 v[136:139], v5 offset:45056
    v_mfma_f32_32x32x16_bf16 v[112:127], v[36:39], v[44:47], v[112:127]
    ds_read_b128 v[140:143], v5 offset:46080
    s_waitcnt lgkmcnt(4)
    v_mfma_f32_32x32x16_bf16 v[64:79], v[48:51], v[56:59], v[64:79]
    s_barrier
    ds_read_b128 v[32:35], v4 offset:0
    v_mfma_f32_32x32x16_bf16 v[80:95], v[48:51], v[60:63], v[80:95]
    ds_read_b128 v[36:39], v4 offset:1024
    v_mfma_f32_32x32x16_bf16 v[96:111], v[52:55], v[56:59], v[96:111]
    ds_read_b128 v[40:43], v6 offset:0
    v_mfma_f32_32x32x16_bf16 v[112:127], v[52:55], v[60:63], v[112:127]
    ds_read_b128 v[44:47], v6 offset:1024
    s_waitcnt lgkmcnt(4)
    v_mfma_f32_32x32x16_bf16 v[64:79], v[128:131], v[136:139], v[64:79]
    ds_read_b128 v[48:51], v4 offset:4096
    v_mfma_f32_32x32x16_bf16 v[80:95], v[128:131], v[140:143], v[80:95]
    ds_read_b128 v[52:55], v4 offset:5120
    v_mfma_f32_32x32x16_bf16 v[96:111], v[132:135], v[136:139], v[96:111]
    ds_read_b128 v[56:59], v6 offset:4096
    v_mfma_f32_32x32x16_bf16 v[112:127], v[132:135], v[140:143], v[112:127]
    ds_read_b128 v[60:63], v6 offset:5120
    s_waitcnt lgkmcnt(4)
    v_mfma_f32_32x32x16_bf16 v[64:79], v[32:35], v[40:43], v[64:79]
    ds_read_b128 v[128:131], v4 offset:8192
    v_mfma_f32_32x32x16_bf16 v[80:95], v[32:35], v[44:47], v[80:95]
    ds_read_b128 v[132:135], v4 offset:9216
    v_mfma_f32_32x32x16_bf16 v[96:111], v[36:39], v[40:43], v[96:111]
    ds_read_b128 v[136:139], v6 offset:8192
    v_mfma_f32_32x32x16_bf16 v[112:127], v[36:39], v[44:47], v[112:127]
    ds_read_b128 v[140:143], v6 offset:9216
    s_waitcnt lgkmcnt(4)
    v_mfma_f32_32x32x16_bf16 v[64:79], v[48:51], v[56:59], v[64:79]
    ds_read_b128 v[32:35], v4 offset:12288
    v_mfma_f32_32x32x16_bf16 v[80:95], v[48:51], v[60:63], v[80:95]
    ds_read_b128 v[36:39], v4 offset:13312
    v_mfma_f32_32x32x16_bf16 v[96:111], v[52:55], v[56:59], v[96:111]
    ds_read_b128 v[40:43], v6 offset:12288
    v_mfma_f32_32x32x16_bf16 v[112:127], v[52:55], v[60:63], v[112:127]
    ds_read_b128 v[44:47], v6 offset:13312
    s_waitcnt lgkmcnt(4)
    v_mfma_f32_32x32x16_bf16 v[64:79], v[128:131], v[136:139], v[64:79]
    s_barrier
    ds_read_b128 v[48:51], v4 offset:32768
    v_mfma_f32_32x32x16_bf16 v[80:95], v[128:131], v[140:143], v[80:95]
    ds_read_b128 v[52:55], v4 offset:33792
    v_mfma_f32_32x32x16_bf16 v[96:111], v[132:135], v[136:139], v[96:111]
    ds_read_b128 v[56:59], v6 offset:32768
    v_mfma_f32_32x32x16_bf16 v[112:127], v[132:135], v[140:143], v[112:127]
    ds_read_b128 v[60:63], v6 offset:33792
    s_waitcnt lgkmcnt(4)
    v_mfma_f32_32x32x16_bf16 v[64:79], v[32:35], v[40:43], v[64:79]
    ds_read_b128 v[128:131], v4 offset:36864
    v_mfma_f32_32x32x16_bf16 v[80:95], v[32:35], v[44:47], v[80:95]
    ds_read_b128 v[132:135], v4 offset:37888
    v_mfma_f32_32x32x16_bf16 v[96:111], v[36:39], v[40:43], v[96:111]
    ds_read_b128 v[136:139], v6 offset:36864
    v_mfma_f32_32x32x16_bf16 v[112:127], v[36:39], v[44:47], v[112:127]
    ds_read_b128 v[140:143], v6 offset:37888
    s_waitcnt lgkmcnt(4)
    v_mfma_f32_32x32x16_bf16 v[64:79], v[48:51], v[56:59], v[64:79]
    ds_read_b128 v[32:35], v4 offset:40960
    v_mfma_f32_32x32x16_bf16 v[80:95], v[48:51], v[60:63], v[80:95]
    ds_read_b128 v[36:39], v4 offset:41984
    v_mfma_f32_32x32x16_bf16 v[96:111], v[52:55], v[56:59], v[96:111]
    ds_read_b128 v[40:43], v6 offset:40960
    v_mfma_f32_32x32x16_bf16 v[112:127], v[52:55], v[60:63], v[112:127]
    ds_read_b128 v[44:47], v6 offset:41984
    s_waitcnt lgkmcnt(4)
    v_mfma_f32_32x32x16_bf16 v[64:79], v[128:131], v[136:139], v[64:79]
    ds_read_b128 v[48:51], v4 offset:45056
    v_mfma_f32_32x32x16_bf16 v[80:95], v[128:131], v[140:143], v[80:95]
    ds_read_b128 v[52:55], v4 offset:46080
    v_mfma_f32_32x32x16_bf16 v[96:111], v[132:135], v[136:139], v[96:111]
    ds_read_b128 v[56:59], v6 offset:45056
    v_mfma_f32_32x32x16_bf16 v[112:127], v[132:135], v[140:143], v[112:127]
    ds_read_b128 v[60:63], v6 offset:46080
    s_waitcnt lgkmcnt(4)
    v_mfma_f32_32x32x16_bf16 v[64:79], v[32:35], v[40:43], v[64:79]
    s_barrier
    ds_read_b128 v[128:131], v3 offset:0
    v_mfma_f32_32x32x16_bf16 v[80:95], v[32:35], v[44:47], v[80:95]
    ds_read_b128 v[132:135], v3 offset:1024
    v_mfma_f32_32x32x16_bf16 v[96:111], v[36:39], v[40:43], v[96:111]
    ds_read_b128 v[136:139], v5 offset:0
    v_mfma_f32_32x32x16_bf16 v[112:127], v[36:39], v[44:47], v[112:127]
    ds_read_b128 v[140:143], v5 offset:1024
    s_waitcnt lgkmcnt(4)
    v_mfma_f32_32x32x16_bf16 v[64:79], v[48:51], v[56:59], v[64:79]
    ds_read_b128 v[32:35], v3 offset:4096
    v_mfma_f32_32x32x16_bf16 v[80:95], v[48:51], v[60:63], v[80:95]
    ds_read_b128 v[36:39], v3 offset:5120
    v_mfma_f32_32x32x16_bf16 v[96:111], v[52:55], v[56:59], v[96:111]
    ds_read_b128 v[40:43], v5 offset:4096
    v_mfma_f32_32x32x16_bf16 v[112:127], v[52:55], v[60:63], v[112:127]
    ds_read_b128 v[44:47], v5 offset:5120
    s_waitcnt lgkmcnt(4)
    v_mfma_f32_32x32x16_bf16 v[64:79], v[128:131], v[136:139], v[64:79]
    ds_read_b128 v[48:51], v3 offset:8192
    v_mfma_f32_32x32x16_bf16 v[80:95], v[128:131], v[140:143], v[80:95]
    ds_read_b128 v[52:55], v3 offset:9216
    v_mfma_f32_32x32x16_bf16 v[96:111], v[132:135], v[136:139], v[96:111]
    ds_read_b128 v[56:59], v5 offset:8192
    v_mfma_f32_32x32x16_bf16 v[112:127], v[132:135], v[140:143], v[112:127]
    ds_read_b128 v[60:63], v5 offset:9216
    s_waitcnt lgkmcnt(4)
    v_mfma_f32_32x32x16_bf16 v[64:79], v[32:35], v[40:43], v[64:79]
    ds_read_b128 v[128:131], v3 offset:12288
    v_mfma_f32_32x32x16_bf16 v[80:95], v[32:35], v[44:47], v[80:95]
    ds_read_b128 v[132:135], v3 offset:13312
    v_mfma_f32_32x32x16_bf16 v[96:111], v[36:39], v[40:43], v[96:111]
    ds_read_b128 v[136:139], v5 offset:12288
    v_mfma_f32_32x32x16_bf16 v[112:127], v[36:39], v[44:47], v[112:127]
    ds_read_b128 v[140:143], v5 offset:13312
    s_waitcnt lgkmcnt(4)
    v_mfma_f32_32x32x16_bf16 v[64:79], v[48:51], v[56:59], v[64:79]
    s_barrier
    ds_read_b128 v[32:35], v3 offset:32768
    v_mfma_f32_32x32x16_bf16 v[80:95], v[48:51], v[60:63], v[80:95]
    ds_read_b128 v[36:39], v3 offset:33792
    v_mfma_f32_32x32x16_bf16 v[96:111], v[52:55], v[56:59], v[96:111]
    ds_read_b128 v[40:43], v5 offset:32768
    v_mfma_f32_32x32x16_bf16 v[112:127], v[52:55], v[60:63], v[112:127]
    ds_read_b128 v[44:47], v5 offset:33792
    s_waitcnt lgkmcnt(4)
    v_mfma_f32_32x32x16_bf16 v[64:79], v[128:131], v[136:139], v[64:79]
    ds_read_b128 v[48:51], v3 offset:36864
    v_mfma_f32_32x32x16_bf16 v[80:95], v[128:131], v[140:143], v[80:95]
    ds_read_b128 v[52:55], v3 offset:37888
    v_mfma_f32_32x32x16_bf16 v[96:111], v[132:135], v[136:139], v[96:111]
    ds_read_b128 v[56:59], v5 offset:36864
    v_mfma_f32_32x32x16_bf16 v[112:127], v[132:135], v[140:143], v[112:127]
    ds_read_b128 v[60:63], v5 offset:37888
    s_waitcnt lgkmcnt(4)
    v_mfma_f32_32x32x16_bf16 v[64:79], v[32:35], v[40:43], v[64:79]
    ds_read_b128 v[128:131], v3 offset:40960
    v_mfma_f32_32x32x16_bf16 v[80:95], v[32:35], v[44:47], v[80:95]
    ds_read_b128 v[132:135], v3 offset:41984
    v_mfma_f32_32x32x16_bf16 v[96:111], v[36:39], v[40:43], v[96:111]
    ds_read_b128 v[136:139], v5 offset:40960
    v_mfma_f32_32x32x16_bf16 v[112:127], v[36:39], v[44:47], v[112:127]
    ds_read_b128 v[140:143], v5 offset:41984
    s_waitcnt lgkmcnt(4)
    v_mfma_f32_32x32x16_bf16 v[64:79], v[48:51], v[56:59], v[64:79]
    ds_read_b128 v[32:35], v3 offset:45056
    v_mfma_f32_32x32x16_bf16 v[80:95], v[48:51], v[60:63], v[80:95]
    ds_read_b128 v[36:39], v3 offset:46080
    v_mfma_f32_32x32x16_bf16 v[96:111], v[52:55], v[56:59], v[96:111]
    ds_read_b128 v[40:43], v5 offset:45056
    v_mfma_f32_32x32x16_bf16 v[112:127], v[52:55], v[60:63], v[112:127]
    ds_read_b128 v[44:47], v5 offset:46080
    s_waitcnt lgkmcnt(4)
    v_mfma_f32_32x32x16_bf16 v[64:79], v[128:131], v[136:139], v[64:79]
    v_mfma_f32_32x32x16_bf16 v[80:95], v[128:131], v[140:143], v[80:95]
    v_mfma_f32_32x32x16_bf16 v[96:111], v[132:135], v[136:139], v[96:111]
    v_mfma_f32_32x32x16_bf16 v[112:127], v[132:135], v[140:143], v[112:127]
    s_waitcnt lgkmcnt(0)
    v_mfma_f32_32x32x16_bf16 v[64:79], v[32:35], v[40:43], v[64:79]
    v_mfma_f32_32x32x16_bf16 v[80:95], v[32:35], v[44:47], v[80:95]
    v_mfma_f32_32x32x16_bf16 v[96:111], v[36:39], v[40:43], v[96:111]
    v_mfma_f32_32x32x16_bf16 v[112:127], v[36:39], v[44:47], v[112:127]
    v_and_b32 v7, 31, v0
    v_lshrrev_b32 v8, 5, v0
    s_lshl_b32 s34, s31, 8
    s_add_u32 s34, s34, 133120
    s_mul_i32 s36, s35, 2560
    s_add_u32 s42, s36, 8070400
    v_lshlrev_b32 v11, 2, v7
    v_add_u32 v11, s34, v11
    ds_read_b32 v32, v11
    ds_read_b32 v33, v11 offset:128
    s_mov_b32 s40, 163840
    s_cmp_eq_u32 s23, 4
    s_cbranch_scc1 L_p2_vt
    s_lshl_b32 s36, s23, 3
    s_lshl_b32 s37, s31, 2
    s_add_u32 s36, s36, s37
    s_mul_i32 s36, s36, s40
    s_add_u32 s42, s42, s36
    v_lshrrev_b32 v12, 4, v7
    v_mul_lo_u32 v12, v12, s40
    v_and_b32 v13, 15, v7
    v_lshl_add_u32 v12, v13, 4, v12
    v_lshl_add_u32 v16, v8, 8, v12
    s_lshl_b32 s41, s40, 1
    s_mov_b32 s44, 512
    s_branch L_p2_vgo
L_p2_vt:
    s_lshl_b32 s36, s31, 4
    s_mul_i32 s36, s36, s40
    s_add_u32 s42, s42, s36
    s_add_u32 s42, s42, 1024
    v_lshrrev_b32 v12, 2, v7
    v_mul_lo_u32 v12, v12, s40
    v_and_b32 v13, 3, v7
    v_lshl_add_u32 v12, v13, 4, v12
    v_lshl_add_u32 v16, v8, 6, v12
    s_lshl_b32 s41, s40, 3
    s_mov_b32 s44, 128
L_p2_vgo:
    s_waitcnt lgkmcnt(0)
    v_add_f32 v64, v64, v32
    v_add_f32 v65, v65, v32
    v_add_f32 v66, v66, v32
    v_add_f32 v67, v67, v32
    v_add_f32 v68, v68, v32
    v_add_f32 v69, v69, v32
    v_add_f32 v70, v70, v32
    v_add_f32 v71, v71, v32
    v_cvt_pk_bf16_f32 v64, v64, v65
    v_cvt_pk_bf16_f32 v65, v66, v67
    v_cvt_pk_bf16_f32 v66, v68, v69
    v_cvt_pk_bf16_f32 v67, v70, v71
    s_add_u32 s36, s42, 0
    buffer_store_dwordx4 v[64:67], v16, s[12:15], s36 offen sc1
    v_add_f32 v72, v72, v32
    v_add_f32 v73, v73, v32
    v_add_f32 v74, v74, v32
    v_add_f32 v75, v75, v32
    v_add_f32 v76, v76, v32
    v_add_f32 v77, v77, v32
    v_add_f32 v78, v78, v32
    v_add_f32 v79, v79, v32
    v_cvt_pk_bf16_f32 v72, v72, v73
    v_cvt_pk_bf16_f32 v73, v74, v75
    v_cvt_pk_bf16_f32 v74, v76, v77
    v_cvt_pk_bf16_f32 v75, v78, v79
    s_add_u32 s36, s42, 0
    s_add_u32 s36, s36, s44
    buffer_store_dwordx4 v[72:75], v16, s[12:15], s36 offen sc1
    v_add_f32 v80, v80, v33
    v_add_f32 v81, v81, v33
    v_add_f32 v82, v82, v33
    v_add_f32 v83, v83, v33
    v_add_f32 v84, v84, v33
    v_add_f32 v85, v85, v33
    v_add_f32 v86, v86, v33
    v_add_f32 v87, v87, v33
    v_cvt_pk_bf16_f32 v80, v80, v81
    v_cvt_pk_bf16_f32 v81, v82, v83
    v_cvt_pk_bf16_f32 v82, v84, v85
    v_cvt_pk_bf16_f32 v83, v86, v87
    s_add_u32 s36, s42, 0
    s_add_u32 s36, s36, s41
    buffer_store_dwordx4 v[80:83], v16, s[12:15], s36 offen sc1
    v_add_f32 v88, v88, v33
    v_add_f32 v89, v89, v33
    v_add_f32 v90, v90, v33
    v_add_f32 v91, v91, v33
    v_add_f32 v92, v92, v33
    v_add_f32 v93, v93, v33
    v_add_f32 v94, v94, v33
    v_add_f32 v95, v95, v33
    v_cvt_pk_bf16_f32 v88, v88, v89
    v_cvt_pk_bf16_f32 v89, v90, v91
    v_cvt_pk_bf16_f32 v90, v92, v93
    v_cvt_pk_bf16_f32 v91, v94, v95
    s_add_u32 s36, s42, 0
    s_add_u32 s36, s36, s41
    s_add_u32 s36, s36, s44
    buffer_store_dwordx4 v[88:91], v16, s[12:15], s36 offen sc1
    v_add_f32 v96, v96, v32
    v_add_f32 v97, v97, v32
    v_add_f32 v98, v98, v32
    v_add_f32 v99, v99, v32
    v_add_f32 v100, v100, v32
    v_add_f32 v101, v101, v32
    v_add_f32 v102, v102, v32
    v_add_f32 v103, v103, v32
    v_cvt_pk_bf16_f32 v96, v96, v97
    v_cvt_pk_bf16_f32 v97, v98, v99
    v_cvt_pk_bf16_f32 v98, v100, v101
    v_cvt_pk_bf16_f32 v99, v102, v103
    s_add_u32 s36, s42, 2560
    buffer_store_dwordx4 v[96:99], v16, s[12:15], s36 offen sc1
    v_add_f32 v104, v104, v32
    v_add_f32 v105, v105, v32
    v_add_f32 v106, v106, v32
    v_add_f32 v107, v107, v32
    v_add_f32 v108, v108, v32
    v_add_f32 v109, v109, v32
    v_add_f32 v110, v110, v32
    v_add_f32 v111, v111, v32
    v_cvt_pk_bf16_f32 v104, v104, v105
    v_cvt_pk_bf16_f32 v105, v106, v107
    v_cvt_pk_bf16_f32 v106, v108, v109
    v_cvt_pk_bf16_f32 v107, v110, v111
    s_add_u32 s36, s42, 2560
    s_add_u32 s36, s36, s44
    buffer_store_dwordx4 v[104:107], v16, s[12:15], s36 offen sc1
    v_add_f32 v112, v112, v33
    v_add_f32 v113, v113, v33
    v_add_f32 v114, v114, v33
    v_add_f32 v115, v115, v33
    v_add_f32 v116, v116, v33
    v_add_f32 v117, v117, v33
    v_add_f32 v118, v118, v33
    v_add_f32 v119, v119, v33
    v_cvt_pk_bf16_f32 v112, v112, v113
    v_cvt_pk_bf16_f32 v113, v114, v115
    v_cvt_pk_bf16_f32 v114, v116, v117
    v_cvt_pk_bf16_f32 v115, v118, v119
    s_add_u32 s36, s42, 2560
    s_add_u32 s36, s36, s41
    buffer_store_dwordx4 v[112:115], v16, s[12:15], s36 offen sc1
    v_add_f32 v120, v120, v33
    v_add_f32 v121, v121, v33
    v_add_f32 v122, v122, v33
    v_add_f32 v123, v123, v33
    v_add_f32 v124, v124, v33
    v_add_f32 v125, v125, v33
    v_add_f32 v126, v126, v33
    v_add_f32 v127, v127, v33
    v_cvt_pk_bf16_f32 v120, v120, v121
    v_cvt_pk_bf16_f32 v121, v122, v123
    v_cvt_pk_bf16_f32 v122, v124, v125
    v_cvt_pk_bf16_f32 v123, v126, v127
    s_add_u32 s36, s42, 2560
    s_add_u32 s36, s36, s41
    s_add_u32 s36, s36, s44
    buffer_store_dwordx4 v[120:123], v16, s[12:15], s36 offen sc1
    s_branch L_p2_end
L_p2_prod:
    s_sub_u32 s30, s4, 4
    v_lshlrev_b32 v2, 4, v0
    s_mul_i32 s32, s20, 163840
    s_lshl_b32 s33, s30, 12
    s_add_u32 s32, s32, s33
    s_add_u32 s32, s32, 0
    s_mul_i32 s34, s21, 163840
    s_add_u32 s34, s34, s33
    s_add_u32 s34, s34, 2621440
    v_and_b32 v3, 31, v0
    v_lshlrev_b32 v3, 4, v3
    v_lshrrev_b32 v4, 5, v0
    v_mul_u32_u24 v4, 7680, v4
    v_add_u32 v4, v4, v3
    s_mul_i32 s37, s30, 76800
    s_lshl_b32 s38, s21, 9
    s_add_u32 s37, s37, s38
    s_add_u32 s37, s37, 5079040
    s_cmp_eq_u32 s4, 4
    s_cbranch_scc0 L_p2_nopoll
    s_mul_i32 s38, s22, 32
    s_add_u32 s38, s38, 40
    s_add_u32 s39, s20, 20
    s_and_b32 s47, s2, 15
    s_add_u32 s3, s38, 0
    s_add_u32 s3, s3, s47
    v_mov_b32 v250, s3
    v_mov_b32 v251, 20
    s_add_u32 s3, s38, 16
    s_add_u32 s3, s3, s47
    v_writelane_b32 v250, s3, 1
    s_add_u32 s3, s39, 0
    v_writelane_b32 v250, s3, 2
    s_mov_b32 s3, 4
    v_writelane_b32 v251, s3, 2
    v_lshlrev_b32 v250, 7, v250
    v_add_u32 v250, 31719424, v250
    s_mov_b32 s3, 0
L_poll_p2:
    global_load_dword v252, v250, s[6:7] sc1
    s_waitcnt vmcnt(0)
    v_cmp_ge_u32 vcc, v252, v251
    s_nop 0
    s_cmp_eq_u64 vcc, -1
    s_cbranch_scc1 L_polled_p2
    s_add_u32 s3, s3, 1
    s_cmp_lt_u32 s3, 0x200000
    s_cbranch_scc1 L_poll_p2
L_polled_p2:
L_p2_nopoll:
    s_barrier
    s_add_u32 m0, s33, 0
    s_add_u32 s38, s32, 0
    buffer_load_dwordx4 v2, s[12:15], s38 offen offset:0 lds
    buffer_load_dwordx4 v2, s[12:15], s38 offen offset:1024 lds
    buffer_load_dwordx4 v2, s[12:15], s38 offen offset:2048 lds
    buffer_load_dwordx4 v2, s[12:15], s38 offen offset:3072 lds
    s_add_u32 m0, s33, 16384
    s_add_u32 s38, s34, 0
    buffer_load_dwordx4 v2, s[12:15], s38 offen offset:0 lds
    buffer_load_dwordx4 v2, s[12:15], s38 offen offset:1024 lds
    buffer_load_dwordx4 v2, s[12:15], s38 offen offset:2048 lds
    buffer_load_dwordx4 v2, s[12:15], s38 offen offset:3072 lds
    s_add_u32 m0, s33, 32768
    s_add_u32 s38, s32, 16384
    buffer_load_dwordx4 v2, s[12:15], s38 offen offset:0 lds
    buffer_load_dwordx4 v2, s[12:15], s38 offen offset:1024 lds
    buffer_load_dwordx4 v2, s[12:15], s38 offen offset:2048 lds
    buffer_load_dwordx4 v2, s[12:15], s38 offen offset:3072 lds
    s_add_u32 m0, s33, 49152
    s_add_u32 s38, s34, 16384
    buffer_load_dwordx4 v2, s[12:15], s38 offen offset:0 lds
    buffer_load_dwordx4 v2, s[12:15], s38 offen offset:1024 lds
    buffer_load_dwordx4 v2, s[12:15], s38 offen offset:2048 lds
    buffer_load_dwordx4 v2, s[12:15], s38 offen offset:3072 lds
    s_waitcnt vmcnt(8)
    s_barrier
    s_add_u32 m0, s33, 65536
    s_add_u32 s38, s32, 32768
    buffer_load_dwordx4 v2, s[12:15], s38 offen offset:0 lds
    buffer_load_dwordx4 v2, s[12:15], s38 offen offset:1024 lds
    buffer_load_dwordx4 v2, s[12:15], s38 offen offset:2048 lds
    buffer_load_dwordx4 v2, s[12:15], s38 offen offset:3072 lds
    s_add_u32 m0, s33, 81920
    s_add_u32 s38, s34, 32768
    buffer_load_dwordx4 v2, s[12:15], s38 offen offset:0 lds
    buffer_load_dwordx4 v2, s[12:15], s38 offen offset:1024 lds
    buffer_load_dwordx4 v2, s[12:15], s38 offen offset:2048 lds
    buffer_load_dwordx4 v2, s[12:15], s38 offen offset:3072 lds
    s_add_u32 m0, s33, 98304
    s_add_u32 s38, s32, 49152
    buffer_load_dwordx4 v2, s[12:15], s38 offen offset:0 lds
    buffer_load_dwordx4 v2, s[12:15], s38 offen offset:1024 lds
    buffer_load_dwordx4 v2, s[12:15], s38 offen offset:2048 lds
    buffer_load_dwordx4 v2, s[12:15], s38 offen offset:3072 lds
    s_add_u32 m0, s33, 114688
    s_add_u32 s38, s34, 49152
    buffer_load_dwordx4 v2, s[12:15], s38 offen offset:0 lds
    buffer_load_dwordx4 v2, s[12:15], s38 offen offset:1024 lds
    buffer_load_dwordx4 v2, s[12:15], s38 offen offset:2048 lds
    buffer_load_dwordx4 v2, s[12:15], s38 offen offset:3072 lds
    buffer_load_dwordx4 v[12:15], v4, s[12:15], s37 offen
    s_add_u32 s37, s37, 15360
    buffer_load_dwordx4 v[16:19], v4, s[12:15], s37 offen
    s_add_u32 s37, s37, 15360
    buffer_load_dwordx4 v[20:23], v4, s[12:15], s37 offen
    s_add_u32 s37, s37, 15360
    buffer_load_dwordx4 v[24:27], v4, s[12:15], s37 offen
    s_add_u32 s37, s37, 15360
    buffer_load_dwordx4 v[28:31], v4, s[12:15], s37 offen
    s_waitcnt vmcnt(21)
    s_barrier
    s_waitcnt vmcnt(13)
    s_barrier
    s_add_u32 m0, s33, 0
    s_add_u32 s38, s32, 65536
    buffer_load_dwordx4 v2, s[12:15], s38 offen offset:0 lds
    buffer_load_dwordx4 v2, s[12:15], s38 offen offset:1024 lds
    buffer_load_dwordx4 v2, s[12:15], s38 offen offset:2048 lds
    buffer_load_dwordx4 v2, s[12:15], s38 offen offset:3072 lds
    s_add_u32 m0, s33, 16384
    s_add_u32 s38, s34, 65536
    buffer_load_dwordx4 v2, s[12:15], s38 offen offset:0 lds
    buffer_load_dwordx4 v2, s[12:15], s38 offen offset:1024 lds
    buffer_load_dwordx4 v2, s[12:15], s38 offen offset:2048 lds
    buffer_load_dwordx4 v2, s[12:15], s38 offen offset:3072 lds
    s_waitcnt vmcnt(8)
    v_add_f32 v12, v12, v16
    v_add_f32 v12, v12, v20
    v_add_f32 v12, v12, v24
    v_add_f32 v12, v12, v28
    v_add_f32 v13, v13, v17
    v_add_f32 v13, v13, v21
    v_add_f32 v13, v13, v25
    v_add_f32 v13, v13, v29
    v_add_f32 v14, v14, v18
    v_add_f32 v14, v14, v22
    v_add_f32 v14, v14, v26
    v_add_f32 v14, v14, v30
    v_add_f32 v15, v15, v19
    v_add_f32 v15, v15, v23
    v_add_f32 v15, v15, v27
    v_add_f32 v15, v15, v31
    v_mov_b32 v40, v12
    v_mov_b32 v41, v13
    v_mov_b32 v42, v14
    v_mov_b32 v43, v15
    s_nop 1
    v_permlane32_swap_b32 v12, v40
    v_permlane32_swap_b32 v13, v41
    v_permlane32_swap_b32 v14, v42
    v_permlane32_swap_b32 v15, v43
    s_cmp_eq_u32 s22, 0
    s_cselect_b32 s38, 0x3ea52b5c, 1.0
    v_add_f32 v12, v12, v40
    v_mul_f32 v12, s38, v12
    v_add_f32 v13, v13, v41
    v_mul_f32 v13, s38, v13
    v_add_f32 v14, v14, v42
    v_mul_f32 v14, s38, v14
    v_add_f32 v15, v15, v43
    v_mul_f32 v15, s38, v15
    s_lshl_b32 s38, s30, 9
    s_add_u32 s38, s38, 131072
    v_add_u32 v3, s38, v3
    ds_write_b128 v3, v[12:15]
    s_waitcnt lgkmcnt(0)
    s_barrier
    s_add_u32 m0, s33, 32768
    s_add_u32 s38, s32, 81920
    buffer_load_dwordx4 v2, s[12:15], s38 offen offset:0 lds
    buffer_load_dwordx4 v2, s[12:15], s38 offen offset:1024 lds
    buffer_load_dwordx4 v2, s[12:15], s38 offen offset:2048 lds
    buffer_load_dwordx4 v2, s[12:15], s38 offen offset:3072 lds
    s_add_u32 m0, s33, 49152
    s_add_u32 s38, s34, 81920
    buffer_load_dwordx4 v2, s[12:15], s38 offen offset:0 lds
    buffer_load_dwordx4 v2, s[12:15], s38 offen offset:1024 lds
    buffer_load_dwordx4 v2, s[12:15], s38 offen offset:2048 lds
    buffer_load_dwordx4 v2, s[12:15], s38 offen offset:3072 lds
    s_waitcnt vmcnt(8)
    s_barrier
    s_add_u32 m0, s33, 65536
    s_add_u32 s38, s32, 98304
    buffer_load_dwordx4 v2, s[12:15], s38 offen offset:0 lds
    buffer_load_dwordx4 v2, s[12:15], s38 offen offset:1024 lds
    buffer_load_dwordx4 v2, s[12:15], s38 offen offset:2048 lds
    buffer_load_dwordx4 v2, s[12:15], s38 offen offset:3072 lds
    s_add_u32 m0, s33, 81920
    s_add_u32 s38, s34, 98304
    buffer_load_dwordx4 v2, s[12:15], s38 offen offset:0 lds
    buffer_load_dwordx4 v2, s[12:15], s38 offen offset:1024 lds
    buffer_load_dwordx4 v2, s[12:15], s38 offen offset:2048 lds
    buffer_load_dwordx4 v2, s[12:15], s38 offen offset:3072 lds
    s_cmp_eq_u32 s30, 0
    s_cbranch_scc0 L_p2_nosum
    v_and_b32 v3, 31, v0
    v_lshlrev_b32 v3, 4, v3
    v_add_u32 v3, 131072, v3
    ds_read_b128 v[12:15], v3
    ds_read_b128 v[16:19], v3 offset:512
    ds_read_b128 v[20:23], v3 offset:1024
    ds_read_b128 v[24:27], v3 offset:1536
    s_waitcnt lgkmcnt(0)
    v_add_f32 v12, v12, v16
    v_add_f32 v20, v20, v24
    v_add_f32 v12, v12, v20
    v_add_f32 v13, v13, v17
    v_add_f32 v21, v21, v25
    v_add_f32 v13, v13, v21
    v_add_f32 v14, v14, v18
    v_add_f32 v22, v22, v26
    v_add_f32 v14, v14, v22
    v_add_f32 v15, v15, v19
    v_add_f32 v23, v23, v27
    v_add_f32 v15, v15, v23
    ds_write_b128 v3, v[12:15] offset:2048
    s_waitcnt lgkmcnt(0)
L_p2_nosum:
    s_waitcnt vmcnt(8)
    s_barrier
    s_add_u32 m0, s33, 98304
    s_add_u32 s38, s32, 114688
    buffer_load_dwordx4 v2, s[12:15], s38 offen offset:0 lds
    buffer_load_dwordx4 v2, s[12:15], s38 offen offset:1024 lds
    buffer_load_dwordx4 v2, s[12:15], s38 offen offset:2048 lds
    buffer_load_dwordx4 v2, s[12:15], s38 offen offset:3072 lds
    s_add_u32 m0, s33, 114688
    s_add_u32 s38, s34, 114688
    buffer_load_dwordx4 v2, s[12:15], s38 offen offset:0 lds
    buffer_load_dwordx4 v2, s[12:15], s38 offen offset:1024 lds
    buffer_load_dwordx4 v2, s[12:15], s38 offen offset:2048 lds
    buffer_load_dwordx4 v2, s[12:15], s38 offen offset:3072 lds
    s_waitcnt vmcnt(8)
    s_barrier
    s_add_u32 m0, s33, 0
    s_add_u32 s38, s32, 131072
    buffer_load_dwordx4 v2, s[12:15], s38 offen offset:0 lds
    buffer_load_dwordx4 v2, s[12:15], s38 offen offset:1024 lds
    buffer_load_dwordx4 v2, s[12:15], s38 offen offset:2048 lds
    buffer_load_dwordx4 v2, s[12:15], s38 offen offset:3072 lds
    s_add_u32 m0, s33, 16384
    s_add_u32 s38, s34, 131072
    buffer_load_dwordx4 v2, s[12:15], s38 offen offset:0 lds
    buffer_load_dwordx4 v2, s[12:15], s38 offen offset:1024 lds
    buffer_load_dwordx4 v2, s[12:15], s38 offen offset:2048 lds
    buffer_load_dwordx4 v2, s[12:15], s38 offen offset:3072 lds
    s_waitcnt vmcnt(8)
    s_barrier
    s_add_u32 m0, s33, 32768
    s_add_u32 s38, s32, 147456
    buffer_load_dwordx4 v2, s[12:15], s38 offen offset:0 lds
    buffer_load_dwordx4 v2, s[12:15], s38 offen offset:1024 lds
    buffer_load_dwordx4 v2, s[12:15], s38 offen offset:2048 lds
    buffer_load_dwordx4 v2, s[12:15], s38 offen offset:3072 lds
    s_add_u32 m0, s33, 49152
    s_add_u32 s38, s34, 147456
    buffer_load_dwordx4 v2, s[12:15], s38 offen offset:0 lds
    buffer_load_dwordx4 v2, s[12:15], s38 offen offset:1024 lds
    buffer_load_dwordx4 v2, s[12:15], s38 offen offset:2048 lds
    buffer_load_dwordx4 v2, s[12:15], s38 offen offset:3072 lds
    s_waitcnt vmcnt(8)
    s_barrier
    s_waitcnt vmcnt(0)
    s_barrier
    s_cmp_eq_u32 s4, 7
    s_cbranch_scc0 L_p2_end
    s_and_b32 s47, s2, 15
    s_mov_b32 s3, 152
    s_add_u32 s3, s3, s47
    v_mov_b32 v250, s3
    v_mov_b32 v251, 8
    v_lshlrev_b32 v250, 7, v250
    v_add_u32 v250, 31719424, v250
    s_mov_b32 s3, 0
L_poll_p2c:
    global_load_dword v252, v250, s[6:7] sc1
    s_waitcnt vmcnt(0)
    v_cmp_ge_u32 vcc, v252, v251
    s_nop 0
    s_cmp_eq_u64 vcc, -1
    s_cbranch_scc1 L_polled_p2c
    s_add_u32 s3, s3, 1
    s_cmp_lt_u32 s3, 0x200000
    s_cbranch_scc1 L_poll_p2c
L_polled_p2c:
    s_branch L_p2_end
L_p2_d:
    s_sub_u32 s24, s25, 28
    s_lshl_b32 s26, s26, 2
    s_add_u32 s24, s24, s26
    s_mov_b32 s21, 15
    s_mov_b32 s5, 0
    s_cmp_eq_u32 s4, 7
    s_cbranch_scc0 L_p2_end
    s_and_b32 s47, s2, 15
    s_mov_b32 s3, 152
    s_add_u32 s3, s3, s47
    v_mov_b32 v250, s3
    v_mov_b32 v251, 8
    v_lshlrev_b32 v250, 7, v250
    v_add_u32 v250, 31719424, v250
    s_mov_b32 s3, 0
L_poll_p2s:
    global_load_dword v252, v250, s[6:7] sc1
    s_waitcnt vmcnt(0)
    v_cmp_ge_u32 vcc, v252, v251
    s_nop 0
    s_cmp_eq_u64 vcc, -1
    s_cbranch_scc1 L_polled_p2s
    s_add_u32 s3, s3, 1
    s_cmp_lt_u32 s3, 0x200000
    s_cbranch_scc1 L_poll_p2s
L_polled_p2s:
L_p2_end:
    s_mov_b64 exec, -1
    s_waitcnt vmcnt(0) lgkmcnt(0)
    s_barrier
    s_and_b32 s24, s2, 7
    s_lshr_b32 s25, s2, 3
    s_lshr_b32 s26, s25, 3
    s_lshl_b32 s20, s24, 2
    s_add_u32 s20, s20, s26
    v_lshlrev_b32 v7, 4, v0
    v_mov_b32 v164, 4026531840
    v_mov_b32 v165, 4026531840
    v_mov_b32 v166, 4026531840
    v_mov_b32 v167, 4026531840
    v_mov_b32 v168, 4026531840
    v_mov_b32 v169, 4026531840
    v_mov_b32 v170, 4026531840
    v_mov_b32 v171, 4026531840
    v_mov_b32 v172, 4026531840
    v_mov_b32 v173, 4026531840
    v_mov_b32 v174, 4026531840
    v_mov_b32 v175, 4026531840
    v_mov_b32 v176, 4026531840
    v_mov_b32 v184, 4026531840
    v_mov_b32 v240, 0
    v_mov_b32 v241, 0
    v_mov_b32 v242, 0
    v_mov_b32 v243, 0
    v_mov_b32 v244, 0
    v_mov_b32 v245, 0
    v_mov_b32 v246, 0
    v_mov_b32 v247, 0
    s_mov_b32 s16, s6
    s_mov_b32 s17, s7
    s_mov_b32 s18, 0
    s_mov_b32 s19, 0x00020000
    s_mov_b32 s32, s6
    s_mov_b32 s33, s7
    s_mov_b32 s34, 0
    s_mov_b32 s35, 0x00020000
    s_mov_b32 s36, s6
    s_mov_b32 s37, s7
    s_mov_b32 s38, 0
    s_mov_b32 s39, 0x00020000
    s_mov_b32 s40, s6
    s_mov_b32 s41, s7
    s_mov_b32 s42, 0
    s_mov_b32 s43, 0x00020000
    v_mov_b32 v13, 0
    v_mov_b32 v14, 0
    s_cmp_ge_u32 s4, 4
    s_cbranch_scc1 L_p3_e
    s_cmp_eq_u32 s4, 0
    s_cbranch_scc0 L_p3_go
    s_mul_i32 s30, s21, 64
    s_add_u32 s30, s30, 184
    s_and_b32 s3, s5, 3
    s_lshl_b32 s3, s3, 4
    s_add_u32 s30, s30, s3
    s_lshl_b32 s3, s30, 7
    s_add_u32 s3, s3, 31719424
    v_lshlrev_b32 v250, 7, v0
    v_add_u32 v250, s3, v250
    v_mov_b32 v251, 1
    s_mov_b32 exec_lo, 65535
    s_mov_b32 exec_hi, 0
    global_atomic_add v250, v251, s[6:7] sc1
    s_mov_b64 exec, -1
    s_lshr_b32 s30, s20, 3
    s_mul_i32 s30, s30, 64
    s_add_u32 s31, s30, 504
    s_add_u32 s32, s30, 824
    s_add_u32 s30, s30, 184
    s_and_b32 s47, s2, 15
    s_add_u32 s3, s30, 0
    s_add_u32 s3, s3, s47
    v_mov_b32 v250, s3
    v_mov_b32 v251, 4
    s_add_u32 s3, s30, 16
    s_add_u32 s3, s3, s47
    v_writelane_b32 v250, s3, 1
    s_add_u32 s3, s30, 32
    s_add_u32 s3, s3, s47
    v_writelane_b32 v250, s3, 2
    s_add_u32 s3, s30, 48
    s_add_u32 s3, s3, s47
    v_writelane_b32 v250, s3, 3
    s_mov_b32 s3, 440
    s_add_u32 s3, s3, s47
    v_writelane_b32 v250, s3, 4
    s_mov_b32 s3, 456
    s_add_u32 s3, s3, s47
    v_writelane_b32 v250, s3, 5
    s_mov_b32 s3, 472
    s_add_u32 s3, s3, s47
    v_writelane_b32 v250, s3, 6
    s_mov_b32 s3, 488
    s_add_u32 s3, s3, s47
    v_writelane_b32 v250, s3, 7
    s_add_u32 s3, s31, 0
    s_add_u32 s3, s3, s47
    v_writelane_b32 v250, s3, 8
    s_add_u32 s3, s31, 16
    s_add_u32 s3, s3, s47
    v_writelane_b32 v250, s3, 9
    s_add_u32 s3, s31, 32
    s_add_u32 s3, s3, s47
    v_writelane_b32 v250, s3, 10
    s_add_u32 s3, s31, 48
    s_add_u32 s3, s3, s47
    v_writelane_b32 v250, s3, 11
    s_mov_b32 s3, 760
    s_add_u32 s3, s3, s47
    v_writelane_b32 v250, s3, 12
    s_mov_b32 s3, 776
    s_add_u32 s3, s3, s47
    v_writelane_b32 v250, s3, 13
    s_mov_b32 s3, 792
    s_add_u32 s3, s3, s47
    v_writelane_b32 v250, s3, 14
    s_mov_b32 s3, 808
    s_add_u32 s3, s3, s47
    v_writelane_b32 v250, s3, 15
    s_add_u32 s3, s32, 0
    s_add_u32 s3, s3, s47
    v_writelane_b32 v250, s3, 16
    s_add_u32 s3, s32, 16
    s_add_u32 s3, s3, s47
    v_writelane_b32 v250, s3, 17
    s_add_u32 s3, s32, 32
    s_add_u32 s3, s3, s47
    v_writelane_b32 v250, s3, 18
    s_add_u32 s3, s32, 48
    s_add_u32 s3, s3, s47
    v_writelane_b32 v250, s3, 19
    s_mov_b32 s3, 1080
    s_add_u32 s3, s3, s47
    v_writelane_b32 v250, s3, 20
    s_mov_b32 s3, 1096
    s_add_u32 s3, s3, s47
    v_writelane_b32 v250, s3, 21
    s_mov_b32 s3, 1112
    s_add_u32 s3, s3, s47
    v_writelane_b32 v250, s3, 22
    s_mov_b32 s3, 1128
    s_add_u32 s3, s3, s47
    v_writelane_b32 v250, s3, 23
    v_lshlrev_b32 v250, 7, v250
    v_add_u32 v250, 31719424, v250
    s_mov_b32 s3, 0
L_poll_p3:
    global_load_dword v252, v250, s[6:7] sc1
    s_waitcnt vmcnt(0)
    v_cmp_ge_u32 vcc, v252, v251
    s_nop 0
    s_cmp_eq_u64 vcc, -1
    s_cbranch_scc1 L_polled_p3
    s_add_u32 s3, s3, 1
    s_cmp_lt_u32 s3, 0x200000
    s_cbranch_scc1 L_poll_p3
L_polled_p3:
    s_branch L_p3_go
L_p3_e:
    s_sub_u32 s30, s4, 4
    s_lshl_b32 s31, s2, 2
    s_add_u32 s30, s30, s31
    s_lshl_b32 s30, s30, 1
    s_add_u32 s30, s30, 0
    s_sub_u32 s31, s4, 4
    s_lshl_b32 s31, s31, 12
    s_add_u32 s31, s31, 65536
    v_mov_b32 v174, 4026531840
    v_mov_b32 v164, 4026531840
    v_mov_b32 v165, 4026531840
    v_mov_b32 v166, 4026531840
    v_mov_b32 v167, 4026531840
    v_mov_b32 v176, 4026531840
    s_mov_b32 s16, s6
    s_mov_b32 s17, s7
    s_mov_b32 s18, 0
    s_mov_b32 s19, 0x00020000
    s_mov_b32 s32, s6
    s_mov_b32 s33, s7
    s_mov_b32 s34, 0
    s_mov_b32 s35, 0x00020000
    v_mov_b32 v240, 0
    v_mov_b32 v241, 0
    v_mov_b32 v242, 0
    v_mov_b32 v243, 0
    v_mov_b32 v172, s31
    s_cmp_ge_u32 s30, 1640
    s_cbranch_scc1 L_p3_e0_done
    v_lshrrev_b32 v8, 3, v0
    v_and_b32 v9, 7, v0
    v_lshlrev_b32 v9, 4, v9
    v_lshrrev_b32 v10, 4, v0
    v_and_b32 v11, 15, v0
    s_cmp_ge_u32 s30, 680
    s_cbranch_scc1 L_p3_e0_gu
    s_cmp_ge_u32 s30, 200
    s_cbranch_scc1 L_p3_e0_wd
    s_mov_b32 s16, s52
    s_mov_b32 s17, s53
    s_mov_b32 s18, 819200
    s_mov_b32 s19, 0x00020000
    s_mov_b32 s32, s52
    s_mov_b32 s33, s53
    s_mov_b32 s34, 819200
    s_mov_b32 s35, 0x00020000
    s_sub_u32 s30, s30, 0
    s_mul_i32 s28, s30, 6554
    s_lshr_b32 s28, s28, 16
    s_mul_i32 s29, s28, 10
    s_sub_u32 s29, s30, s29
    s_lshl_b32 s27, s29, 7
    s_lshl_b32 s26, s28, 5
    s_add_u32 s26, s26, 0
    v_add_u32 v13, s26, v8
    v_lshrrev_b32 v14, 4, v13
    v_mul_u32_u24 v14, 20, v14
    v_and_b32 v15, 15, v13
    v_add_u32 v14, v14, v15
    v_subrev_u32 v15, 512, v13
    v_lshrrev_b32 v5, 2, v15
    v_mul_u32_u24 v5, 20, v5
    v_and_b32 v15, 3, v15
    v_add_u32 v15, v15, v5
    v_add_u32 v15, 16, v15
    v_cmp_le_u32 vcc, 512, v13
    s_nop 1
    v_cndmask_b32 v13, v14, v15, vcc
    v_mul_u32_u24 v13, 1280, v13
    v_add_u32 v13, v13, v9
    v_add_u32 v240, s27, v13
    s_lshl_b32 s26, s28, 5
    s_add_u32 s26, s26, 8
    v_add_u32 v13, s26, v8
    v_lshrrev_b32 v14, 4, v13
    v_mul_u32_u24 v14, 20, v14
    v_and_b32 v15, 15, v13
    v_add_u32 v14, v14, v15
    v_subrev_u32 v15, 512, v13
    v_lshrrev_b32 v5, 2, v15
    v_mul_u32_u24 v5, 20, v5
    v_and_b32 v15, 3, v15
    v_add_u32 v15, v15, v5
    v_add_u32 v15, 16, v15
    v_cmp_le_u32 vcc, 512, v13
    s_nop 1
    v_cndmask_b32 v13, v14, v15, vcc
    v_mul_u32_u24 v13, 1280, v13
    v_add_u32 v13, v13, v9
    v_add_u32 v241, s27, v13
    s_lshl_b32 s26, s28, 5
    s_add_u32 s26, s26, 16
    v_add_u32 v13, s26, v8
    v_lshrrev_b32 v14, 4, v13
    v_mul_u32_u24 v14, 20, v14
    v_and_b32 v15, 15, v13
    v_add_u32 v14, v14, v15
    v_subrev_u32 v15, 512, v13
    v_lshrrev_b32 v5, 2, v15
    v_mul_u32_u24 v5, 20, v5
    v_and_b32 v15, 3, v15
    v_add_u32 v15, v15, v5
    v_add_u32 v15, 16, v15
    v_cmp_le_u32 vcc, 512, v13
    s_nop 1
    v_cndmask_b32 v13, v14, v15, vcc
    v_mul_u32_u24 v13, 1280, v13
    v_add_u32 v13, v13, v9
    v_add_u32 v242, s27, v13
    s_lshl_b32 s26, s28, 5
    s_add_u32 s26, s26, 24
    v_add_u32 v13, s26, v8
    v_lshrrev_b32 v14, 4, v13
    v_mul_u32_u24 v14, 20, v14
    v_and_b32 v15, 15, v13
    v_add_u32 v14, v14, v15
    v_subrev_u32 v15, 512, v13
    v_lshrrev_b32 v5, 2, v15
    v_mul_u32_u24 v5, 20, v5
    v_and_b32 v15, 3, v15
    v_add_u32 v15, v15, v5
    v_add_u32 v15, 16, v15
    v_cmp_le_u32 vcc, 512, v13
    s_nop 1
    v_cndmask_b32 v13, v14, v15, vcc
    v_mul_u32_u24 v13, 1280, v13
    v_add_u32 v13, v13, v9
    v_add_u32 v243, s27, v13
    v_lshlrev_b32 v13, 3, v10
    v_lshrrev_b32 v14, 2, v11
    v_add_u32 v13, v13, v14
    v_lshlrev_b32 v13, 7, v13
    v_and_b32 v14, 3, v11
    v_lshl_add_u32 v13, v14, 3, v13
    v_add_u32 v172, s31, v13
    s_mov_b32 s21, 102400
    s_mul_i32 s22, s28, 5120
    s_add_u32 s22, s22, 15933440
    s_mov_b32 s23, 5
    s_mov_b32 s24, 13108
    s_branch L_p3_e0_go
L_p3_e0_wd:
    s_mov_b32 s16, s58
    s_mov_b32 s17, s59
    s_mov_b32 s18, 1966080
    s_mov_b32 s19, 0x00020000
    s_mov_b32 s32, s58
    s_mov_b32 s33, s59
    s_mov_b32 s34, 1966080
    s_mov_b32 s35, 0x00020000
    s_sub_u32 s30, s30, 200
    s_mul_i32 s28, s30, 6554
    s_lshr_b32 s28, s28, 16
    s_mul_i32 s29, s28, 10
    s_sub_u32 s29, s30, s29
    s_lshl_b32 s27, s29, 7
    s_lshl_b32 s26, s28, 5
    s_add_u32 s26, s26, 0
    v_add_u32 v13, s26, v8
    v_mul_u32_u24 v13, 1280, v13
    v_add_u32 v13, v13, v9
    v_add_u32 v240, s27, v13
    s_lshl_b32 s26, s28, 5
    s_add_u32 s26, s26, 8
    v_add_u32 v13, s26, v8
    v_mul_u32_u24 v13, 1280, v13
    v_add_u32 v13, v13, v9
    v_add_u32 v241, s27, v13
    s_lshl_b32 s26, s28, 5
    s_add_u32 s26, s26, 16
    v_add_u32 v13, s26, v8
    v_mul_u32_u24 v13, 1280, v13
    v_add_u32 v13, v13, v9
    v_add_u32 v242, s27, v13
    s_lshl_b32 s26, s28, 5
    s_add_u32 s26, s26, 24
    v_add_u32 v13, s26, v8
    v_mul_u32_u24 v13, 1280, v13
    v_add_u32 v13, v13, v9
    v_add_u32 v243, s27, v13
    v_lshlrev_b32 v13, 3, v10
    v_lshrrev_b32 v14, 2, v11
    v_add_u32 v13, v13, v14
    v_lshlrev_b32 v13, 7, v13
    v_and_b32 v14, 3, v11
    v_lshl_add_u32 v13, v14, 3, v13
    v_add_u32 v172, s31, v13
    s_mov_b32 s21, 245760
    s_mul_i32 s22, s28, 5120
    s_add_u32 s22, s22, 16752640
    s_mov_b32 s23, 5
    s_mov_b32 s24, 13108
    s_branch L_p3_e0_go
L_p3_e0_gu:
    s_mov_b32 s16, s54
    s_mov_b32 s17, s55
    s_mov_b32 s18, 1966080
    s_mov_b32 s19, 0x00020000
    s_mov_b32 s32, s56
    s_mov_b32 s33, s57
    s_mov_b32 s34, 1966080
    s_mov_b32 s35, 0x00020000
    s_sub_u32 s30, s30, 680
    s_mul_i32 s28, s30, 2731
    s_lshr_b32 s28, s28, 16
    s_mul_i32 s29, s28, 24
    s_sub_u32 s29, s30, s29
    s_lshl_b32 s27, s29, 7
    s_mul_i32 s26, s28, 49152
    s_add_u32 s27, s27, s26
    v_mul_u32_u24 v13, 3072, v8
    v_add_u32 v13, v13, v9
    s_add_u32 s26, s27, 0
    v_add_u32 v240, s26, v13
    s_add_u32 s26, s27, 24576
    v_add_u32 v241, s26, v13
    s_add_u32 s26, s27, 0
    v_add_u32 v242, s26, v13
    s_add_u32 s26, s27, 24576
    v_add_u32 v243, s26, v13
    v_and_b32 v13, 1, v10
    v_lshlrev_b32 v13, 11, v13
    v_lshrrev_b32 v14, 1, v10
    v_lshlrev_b32 v14, 3, v14
    v_lshrrev_b32 v15, 2, v11
    v_add_u32 v14, v14, v15
    v_lshl_add_u32 v13, v14, 7, v13
    v_and_b32 v14, 3, v11
    v_lshl_add_u32 v13, v14, 3, v13
    v_add_u32 v172, s31, v13
    s_mov_b32 s21, 245760
    s_mul_i32 s22, s28, 6144
    s_add_u32 s22, s22, 18718720
    s_mov_b32 s23, 6
    s_mov_b32 s24, 10923
    v_and_b32 v13, 31, v0
    v_cmp_eq_u32 vcc, 1, v13
    v_mov_b32 v14, 5120
    v_mov_b32 v15, 2560
    v_cndmask_b32 v14, v14, v15, vcc
    v_lshrrev_b32 v15, 5, v0
    v_lshl_add_u32 v14, v15, 5, v14
    s_lshl_b32 s26, s28, 6
    s_add_u32 s26, s26, 5435392
    v_add_u32 v176, s26, v14
    s_lshl_b32 s26, s29, 9
    s_add_u32 s26, s26, 25403392
    v_lshlrev_b32 v14, 2, v0
    v_add_u32 v174, s26, v14
L_p3_e0_go:
    s_lshl_b32 s26, s29, 2
    s_add_u32 s26, s26, 0
    s_mul_i32 s27, s26, s24
    s_lshr_b32 s27, s27, 16
    s_mul_i32 s25, s27, s23
    s_sub_u32 s25, s26, s25
    s_mul_i32 s27, s27, s21
    s_lshl_b32 s25, s25, 10
    s_add_u32 s27, s27, s25
    s_add_u32 s27, s27, s22
    v_add_u32 v164, s27, v7
    s_lshl_b32 s26, s29, 2
    s_add_u32 s26, s26, 1
    s_mul_i32 s27, s26, s24
    s_lshr_b32 s27, s27, 16
    s_mul_i32 s25, s27, s23
    s_sub_u32 s25, s26, s25
    s_mul_i32 s27, s27, s21
    s_lshl_b32 s25, s25, 10
    s_add_u32 s27, s27, s25
    s_add_u32 s27, s27, s22
    v_add_u32 v165, s27, v7
    s_lshl_b32 s26, s29, 2
    s_add_u32 s26, s26, 2
    s_mul_i32 s27, s26, s24
    s_lshr_b32 s27, s27, 16
    s_mul_i32 s25, s27, s23
    s_sub_u32 s25, s26, s25
    s_mul_i32 s27, s27, s21
    s_lshl_b32 s25, s25, 10
    s_add_u32 s27, s27, s25
    s_add_u32 s27, s27, s22
    v_add_u32 v166, s27, v7
    s_lshl_b32 s26, s29, 2
    s_add_u32 s26, s26, 3
    s_mul_i32 s27, s26, s24
    s_lshr_b32 s27, s27, 16
    s_mul_i32 s25, s27, s23
    s_sub_u32 s25, s26, s25
    s_mul_i32 s27, s27, s21
    s_lshl_b32 s25, s25, 10
    s_add_u32 s27, s27, s25
    s_add_u32 s27, s27, s22
    v_add_u32 v167, s27, v7
L_p3_e0_done:
    s_sub_u32 s30, s4, 4
    s_lshl_b32 s31, s2, 2
    s_add_u32 s30, s30, s31
    s_lshl_b32 s30, s30, 1
    s_add_u32 s30, s30, 1
    s_sub_u32 s31, s4, 4
    s_lshl_b32 s31, s31, 12
    s_add_u32 s31, s31, 147456
    v_mov_b32 v175, 4026531840
    v_mov_b32 v168, 4026531840
    v_mov_b32 v169, 4026531840
    v_mov_b32 v170, 4026531840
    v_mov_b32 v171, 4026531840
    v_mov_b32 v184, 4026531840
    s_mov_b32 s36, s6
    s_mov_b32 s37, s7
    s_mov_b32 s38, 0
    s_mov_b32 s39, 0x00020000
    s_mov_b32 s40, s6
    s_mov_b32 s41, s7
    s_mov_b32 s42, 0
    s_mov_b32 s43, 0x00020000
    v_mov_b32 v244, 0
    v_mov_b32 v245, 0
    v_mov_b32 v246, 0
    v_mov_b32 v247, 0
    v_mov_b32 v173, s31
    s_cmp_ge_u32 s30, 1640
    s_cbranch_scc1 L_p3_e1_done
    v_lshrrev_b32 v8, 3, v0
    v_and_b32 v9, 7, v0
    v_lshlrev_b32 v9, 4, v9
    v_lshrrev_b32 v10, 4, v0
    v_and_b32 v11, 15, v0
    s_cmp_ge_u32 s30, 680
    s_cbranch_scc1 L_p3_e1_gu
    s_cmp_ge_u32 s30, 200
    s_cbranch_scc1 L_p3_e1_wd
    s_mov_b32 s36, s52
    s_mov_b32 s37, s53
    s_mov_b32 s38, 819200
    s_mov_b32 s39, 0x00020000
    s_mov_b32 s40, s52
    s_mov_b32 s41, s53
    s_mov_b32 s42, 819200
    s_mov_b32 s43, 0x00020000
    s_sub_u32 s30, s30, 0
    s_mul_i32 s28, s30, 6554
    s_lshr_b32 s28, s28, 16
    s_mul_i32 s29, s28, 10
    s_sub_u32 s29, s30, s29
    s_lshl_b32 s27, s29, 7
    s_lshl_b32 s26, s28, 5
    s_add_u32 s26, s26, 0
    v_add_u32 v13, s26, v8
    v_lshrrev_b32 v14, 4, v13
    v_mul_u32_u24 v14, 20, v14
    v_and_b32 v15, 15, v13
    v_add_u32 v14, v14, v15
    v_subrev_u32 v15, 512, v13
    v_lshrrev_b32 v5, 2, v15
    v_mul_u32_u24 v5, 20, v5
    v_and_b32 v15, 3, v15
    v_add_u32 v15, v15, v5
    v_add_u32 v15, 16, v15
    v_cmp_le_u32 vcc, 512, v13
    s_nop 1
    v_cndmask_b32 v13, v14, v15, vcc
    v_mul_u32_u24 v13, 1280, v13
    v_add_u32 v13, v13, v9
    v_add_u32 v244, s27, v13
    s_lshl_b32 s26, s28, 5
    s_add_u32 s26, s26, 8
    v_add_u32 v13, s26, v8
    v_lshrrev_b32 v14, 4, v13
    v_mul_u32_u24 v14, 20, v14
    v_and_b32 v15, 15, v13
    v_add_u32 v14, v14, v15
    v_subrev_u32 v15, 512, v13
    v_lshrrev_b32 v5, 2, v15
    v_mul_u32_u24 v5, 20, v5
    v_and_b32 v15, 3, v15
    v_add_u32 v15, v15, v5
    v_add_u32 v15, 16, v15
    v_cmp_le_u32 vcc, 512, v13
    s_nop 1
    v_cndmask_b32 v13, v14, v15, vcc
    v_mul_u32_u24 v13, 1280, v13
    v_add_u32 v13, v13, v9
    v_add_u32 v245, s27, v13
    s_lshl_b32 s26, s28, 5
    s_add_u32 s26, s26, 16
    v_add_u32 v13, s26, v8
    v_lshrrev_b32 v14, 4, v13
    v_mul_u32_u24 v14, 20, v14
    v_and_b32 v15, 15, v13
    v_add_u32 v14, v14, v15
    v_subrev_u32 v15, 512, v13
    v_lshrrev_b32 v5, 2, v15
    v_mul_u32_u24 v5, 20, v5
    v_and_b32 v15, 3, v15
    v_add_u32 v15, v15, v5
    v_add_u32 v15, 16, v15
    v_cmp_le_u32 vcc, 512, v13
    s_nop 1
    v_cndmask_b32 v13, v14, v15, vcc
    v_mul_u32_u24 v13, 1280, v13
    v_add_u32 v13, v13, v9
    v_add_u32 v246, s27, v13
    s_lshl_b32 s26, s28, 5
    s_add_u32 s26, s26, 24
    v_add_u32 v13, s26, v8
    v_lshrrev_b32 v14, 4, v13
    v_mul_u32_u24 v14, 20, v14
    v_and_b32 v15, 15, v13
    v_add_u32 v14, v14, v15
    v_subrev_u32 v15, 512, v13
    v_lshrrev_b32 v5, 2, v15
    v_mul_u32_u24 v5, 20, v5
    v_and_b32 v15, 3, v15
    v_add_u32 v15, v15, v5
    v_add_u32 v15, 16, v15
    v_cmp_le_u32 vcc, 512, v13
    s_nop 1
    v_cndmask_b32 v13, v14, v15, vcc
    v_mul_u32_u24 v13, 1280, v13
    v_add_u32 v13, v13, v9
    v_add_u32 v247, s27, v13
    v_lshlrev_b32 v13, 3, v10
    v_lshrrev_b32 v14, 2, v11
    v_add_u32 v13, v13, v14
    v_lshlrev_b32 v13, 7, v13
    v_and_b32 v14, 3, v11
    v_lshl_add_u32 v13, v14, 3, v13
    v_add_u32 v173, s31, v13
    s_mov_b32 s21, 102400
    s_mul_i32 s22, s28, 5120
    s_add_u32 s22, s22, 15933440
    s_mov_b32 s23, 5
    s_mov_b32 s24, 13108
    s_branch L_p3_e1_go
L_p3_e1_wd:
    s_mov_b32 s36, s58
    s_mov_b32 s37, s59
    s_mov_b32 s38, 1966080
    s_mov_b32 s39, 0x00020000
    s_mov_b32 s40, s58
    s_mov_b32 s41, s59
    s_mov_b32 s42, 1966080
    s_mov_b32 s43, 0x00020000
    s_sub_u32 s30, s30, 200
    s_mul_i32 s28, s30, 6554
    s_lshr_b32 s28, s28, 16
    s_mul_i32 s29, s28, 10
    s_sub_u32 s29, s30, s29
    s_lshl_b32 s27, s29, 7
    s_lshl_b32 s26, s28, 5
    s_add_u32 s26, s26, 0
    v_add_u32 v13, s26, v8
    v_mul_u32_u24 v13, 1280, v13
    v_add_u32 v13, v13, v9
    v_add_u32 v244, s27, v13
    s_lshl_b32 s26, s28, 5
    s_add_u32 s26, s26, 8
    v_add_u32 v13, s26, v8
    v_mul_u32_u24 v13, 1280, v13
    v_add_u32 v13, v13, v9
    v_add_u32 v245, s27, v13
    s_lshl_b32 s26, s28, 5
    s_add_u32 s26, s26, 16
    v_add_u32 v13, s26, v8
    v_mul_u32_u24 v13, 1280, v13
    v_add_u32 v13, v13, v9
    v_add_u32 v246, s27, v13
    s_lshl_b32 s26, s28, 5
    s_add_u32 s26, s26, 24
    v_add_u32 v13, s26, v8
    v_mul_u32_u24 v13, 1280, v13
    v_add_u32 v13, v13, v9
    v_add_u32 v247, s27, v13
    v_lshlrev_b32 v13, 3, v10
    v_lshrrev_b32 v14, 2, v11
    v_add_u32 v13, v13, v14
    v_lshlrev_b32 v13, 7, v13
    v_and_b32 v14, 3, v11
    v_lshl_add_u32 v13, v14, 3, v13
    v_add_u32 v173, s31, v13
    s_mov_b32 s21, 245760
    s_mul_i32 s22, s28, 5120
    s_add_u32 s22, s22, 16752640
    s_mov_b32 s23, 5
    s_mov_b32 s24, 13108
    s_branch L_p3_e1_go
L_p3_e1_gu:
    s_mov_b32 s36, s54
    s_mov_b32 s37, s55
    s_mov_b32 s38, 1966080
    s_mov_b32 s39, 0x00020000
    s_mov_b32 s40, s56
    s_mov_b32 s41, s57
    s_mov_b32 s42, 1966080
    s_mov_b32 s43, 0x00020000
    s_sub_u32 s30, s30, 680
    s_mul_i32 s28, s30, 2731
    s_lshr_b32 s28, s28, 16
    s_mul_i32 s29, s28, 24
    s_sub_u32 s29, s30, s29
    s_lshl_b32 s27, s29, 7
    s_mul_i32 s26, s28, 49152
    s_add_u32 s27, s27, s26
    v_mul_u32_u24 v13, 3072, v8
    v_add_u32 v13, v13, v9
    s_add_u32 s26, s27, 0
    v_add_u32 v244, s26, v13
    s_add_u32 s26, s27, 24576
    v_add_u32 v245, s26, v13
    s_add_u32 s26, s27, 0
    v_add_u32 v246, s26, v13
    s_add_u32 s26, s27, 24576
    v_add_u32 v247, s26, v13
    v_and_b32 v13, 1, v10
    v_lshlrev_b32 v13, 11, v13
    v_lshrrev_b32 v14, 1, v10
    v_lshlrev_b32 v14, 3, v14
    v_lshrrev_b32 v15, 2, v11
    v_add_u32 v14, v14, v15
    v_lshl_add_u32 v13, v14, 7, v13
    v_and_b32 v14, 3, v11
    v_lshl_add_u32 v13, v14, 3, v13
    v_add_u32 v173, s31, v13
    s_mov_b32 s21, 245760
    s_mul_i32 s22, s28, 6144
    s_add_u32 s22, s22, 18718720
    s_mov_b32 s23, 6
    s_mov_b32 s24, 10923
    v_and_b32 v13, 31, v0
    v_cmp_eq_u32 vcc, 1, v13
    v_mov_b32 v14, 5120
    v_mov_b32 v15, 2560
    v_cndmask_b32 v14, v14, v15, vcc
    v_lshrrev_b32 v15, 5, v0
    v_lshl_add_u32 v14, v15, 5, v14
    s_lshl_b32 s26, s28, 6
    s_add_u32 s26, s26, 5435392
    v_add_u32 v184, s26, v14
    s_lshl_b32 s26, s29, 9
    s_add_u32 s26, s26, 25403392
    v_lshlrev_b32 v14, 2, v0
    v_add_u32 v175, s26, v14
L_p3_e1_go:
    s_lshl_b32 s26, s29, 2
    s_add_u32 s26, s26, 0
    s_mul_i32 s27, s26, s24
    s_lshr_b32 s27, s27, 16
    s_mul_i32 s25, s27, s23
    s_sub_u32 s25, s26, s25
    s_mul_i32 s27, s27, s21
    s_lshl_b32 s25, s25, 10
    s_add_u32 s27, s27, s25
    s_add_u32 s27, s27, s22
    v_add_u32 v168, s27, v7
    s_lshl_b32 s26, s29, 2
    s_add_u32 s26, s26, 1
    s_mul_i32 s27, s26, s24
    s_lshr_b32 s27, s27, 16
    s_mul_i32 s25, s27, s23
    s_sub_u32 s25, s26, s25
    s_mul_i32 s27, s27, s21
    s_lshl_b32 s25, s25, 10
    s_add_u32 s27, s27, s25
    s_add_u32 s27, s27, s22
    v_add_u32 v169, s27, v7
    s_lshl_b32 s26, s29, 2
    s_add_u32 s26, s26, 2
    s_mul_i32 s27, s26, s24
    s_lshr_b32 s27, s27, 16
    s_mul_i32 s25, s27, s23
    s_sub_u32 s25, s26, s25
    s_mul_i32 s27, s27, s21
    s_lshl_b32 s25, s25, 10
    s_add_u32 s27, s27, s25
    s_add_u32 s27, s27, s22
    v_add_u32 v170, s27, v7
    s_lshl_b32 s26, s29, 2
    s_add_u32 s26, s26, 3
    s_mul_i32 s27, s26, s24
    s_lshr_b32 s27, s27, 16
    s_mul_i32 s25, s27, s23
    s_sub_u32 s25, s26, s25
    s_mul_i32 s27, s27, s21
    s_lshl_b32 s25, s25, 10
    s_add_u32 s27, s27, s25
    s_add_u32 s27, s27, s22
    v_add_u32 v171, s27, v7
L_p3_e1_done:
L_p3_go:
    s_barrier
    s_lshr_b32 s25, s2, 3
    s_and_b32 s21, s25, 7
    s_and_b32 s23, s4, 3
    s_lshr_b32 s24, s4, 2
    s_mov_b32 s44, 0x000fffff
    s_mov_b32 s45, 0x000fffff
    s_mov_b32 s46, 0
    v_lshlrev_b32 v7, 4, v0
    v_and_b32 v5, 31, v0
    v_lshlrev_b32 v6, 3, v5
    s_lshl_b32 s22, s21, 3
    s_lshl_b32 s25, s23, 1
    s_add_u32 s22, s22, s25
    s_mul_i32 s27, s20, 81920
    s_mul_i32 s28, s22, 1280
    s_add_u32 s28, s27, s28
    s_add_u32 s28, s28, 5447680
    s_mul_i32 s26, s20, 163840
    s_add_u32 s26, s26, 8069120
    s_mul_i32 s29, s24, 81920
    s_lshl_b32 s25, s23, 10
    s_add_u32 s27, s26, s25
    s_mov_b32 m0, s25
    s_cmp_ge_u32 s4, 4
    s_cbranch_scc1 L_p3_nodma
    buffer_load_dwordx4 v[88:91], v7, s[12:15], s28 offen
    buffer_load_dwordx4 v[96:99], v7, s[12:15], s28 offen offset:1280
    v_lshrrev_b32 v9, 5, v0
    v_mul_u32_u24 v9, 1280, v9
    v_add_u32 v9, v9, v6
    buffer_load_dwordx2 v[92:93], v9, s[12:15], s28 offen offset:1024
    buffer_load_dwordx4 v7, s[12:15], s27 offen lds
    s_add_u32 m0, m0, 81920
    s_add_u32 s3, s27, 81920
    buffer_load_dwordx4 v7, s[12:15], s3 offen lds
    s_add_u32 s27, s27, 4096
    s_sub_u32 m0, m0, 77824
    s_nop 0
    buffer_load_dwordx4 v7, s[12:15], s27 offen lds
    s_add_u32 m0, m0, 81920
    s_add_u32 s3, s27, 81920
    buffer_load_dwordx4 v7, s[12:15], s3 offen lds
    s_add_u32 s27, s27, 4096
    s_sub_u32 m0, m0, 77824
L_p3_nodma:
    v_mov_b32 v8, 0x3f803f80
    v_cmp_eq_u32 vcc, 20, v5
    s_nop 1
    v_cndmask_b32 v8, 0, v8, vcc
    v_mov_b32 v116, v8
    v_mov_b32 v117, v8
    v_mov_b32 v118, v8
    v_mov_b32 v119, v8
    v_mov_b32 v120, v8
    v_mov_b32 v121, v8
    v_mov_b32 v122, v8
    v_mov_b32 v123, v8
    v_mov_b32 v124, v8
    v_mov_b32 v125, v8
    v_mov_b32 v126, v8
    v_mov_b32 v127, v8
    v_mov_b32 v128, v8
    v_mov_b32 v129, v8
    v_mov_b32 v130, v8
    v_mov_b32 v131, v8
    v_lshlrev_b32 v2, 4, v0
    v_lshrrev_b32 v6, 5, v0
    v_lshlrev_b32 v3, 3, v5
    v_add_u32 v3, 1024, v3
    v_lshlrev_b32 v4, 8, v6
    v_lshl_add_u32 v4, v5, 4, v4
    v_add_u32 v12, 512, v4
    v_lshlrev_b32 v9, 6, v6
    v_lshl_add_u32 v9, v5, 4, v9
    v_add_u32 v9, 768, v9
    v_add_u32 v10, 128, v9
    v_cmp_le_u32 vcc, 16, v5
    s_nop 1
    v_cndmask_b32 v4, v4, v9, vcc
    v_cndmask_b32 v12, v12, v10, vcc
    v_add_u32 v4, 1280, v4
    v_add_u32 v12, 1280, v12
    v_add_u32 v2, s29, v2
    v_add_u32 v3, s29, v3
    v_add_u32 v4, s29, v4
    v_add_u32 v12, s29, v12
    s_mul_i32 s30, s23, 2560
    s_add_u32 s30, s30, 53248
    v_add_u32 v13, s30, v7
    v_lshlrev_b32 v14, 3, v0
    v_add_u32 v14, s30, v14
    v_mov_b32 v56, 0
    v_mov_b32 v72, 0
    v_mov_b32 v57, 0
    v_mov_b32 v73, 0
    v_mov_b32 v58, 0
    v_mov_b32 v74, 0
    v_mov_b32 v59, 0
    v_mov_b32 v75, 0
    v_mov_b32 v60, 0
    v_mov_b32 v76, 0
    v_mov_b32 v61, 0
    v_mov_b32 v77, 0
    v_mov_b32 v62, 0
    v_mov_b32 v78, 0
    v_mov_b32 v63, 0
    v_mov_b32 v79, 0
    v_mov_b32 v64, 0
    v_mov_b32 v80, 0
    v_mov_b32 v65, 0
    v_mov_b32 v81, 0
    v_mov_b32 v66, 0
    v_mov_b32 v82, 0
    v_mov_b32 v67, 0
    v_mov_b32 v83, 0
    v_mov_b32 v68, 0
    v_mov_b32 v84, 0
    v_mov_b32 v69, 0
    v_mov_b32 v85, 0
    v_mov_b32 v70, 0
    v_mov_b32 v86, 0
    v_mov_b32 v71, 0
    v_mov_b32 v87, 0
    s_cmp_ge_u32 s4, 4
    s_cbranch_scc1 L_p3_img
    s_waitcnt vmcnt(4)
    ds_write_b128 v13, v[88:91]
    ds_write_b128 v13, v[96:99] offset:1024
    ds_write_b64 v14, v[92:93] offset:2048
    v_mov_b32 v100, 0
    v_mov_b32 v101, 0
    s_nop 1
    v_permlane32_swap_b32 v92, v100
    v_permlane32_swap_b32 v93, v101
    s_waitcnt vmcnt(0) lgkmcnt(0)
    s_barrier
    ds_read_b128 v[104:107], v2 offset:0
    ds_read_b64 v[112:113], v3 offset:0
    s_mov_b64 exec, s[44:45]
    ds_read_b128 v[116:119], v4 offset:0
    ds_read_b128 v[124:127], v12 offset:0
    s_mov_b64 exec, -1
    s_waitcnt lgkmcnt(0)
    v_mfma_f32_32x32x16_bf16 v[16:31], v[104:107], v[88:91], 0
    v_mfma_f32_32x32x8bf16_1k v[16:31], v[112:113], v[92:93], v[16:31]
    s_nop 15
    s_setprio 1
    v_exp_f32 v16, v16
    v_exp_f32 v17, v17
    v_exp_f32 v18, v18
    v_cvt_pk_bf16_f32 v48, v16, v17
    s_mov_b64 exec, s[44:45]
    ds_read_b128 v[120:123], v4 offset:2560
    ds_read_b128 v[128:131], v12 offset:2560
    s_mov_b64 exec, -1
    ds_read_b128 v[108:111], v2 offset:2560
    ds_read_b64 v[114:115], v3 offset:2560
    v_exp_f32 v19, v19
    v_exp_f32 v20, v20
    v_cvt_pk_bf16_f32 v49, v18, v19
    v_mfma_f32_32x32x16_bf16 v[32:47], v[104:107], v[96:99], 0
    v_exp_f32 v21, v21
    v_exp_f32 v22, v22
    v_cvt_pk_bf16_f32 v50, v20, v21
    v_exp_f32 v23, v23
    v_exp_f32 v24, v24
    v_mfma_f32_32x32x8bf16_1k v[32:47], v[112:113], v[100:101], v[32:47]
    v_cvt_pk_bf16_f32 v51, v22, v23
    s_setprio 0
    buffer_load_dwordx4 v7, s[12:15], s27 offen lds
    s_add_u32 m0, m0, 81920
    s_add_u32 s3, s27, 81920
    buffer_load_dwordx4 v7, s[12:15], s3 offen lds
    s_add_u32 s27, s27, 4096
    s_sub_u32 m0, m0, 77824
    s_nop 0
    buffer_load_dwordx4 v7, s[12:15], s27 offen lds
    s_add_u32 m0, m0, 81920
    s_add_u32 s3, s27, 81920
    buffer_load_dwordx4 v7, s[12:15], s3 offen lds
    s_add_u32 s27, s27, 4096
    s_sub_u32 m0, m0, 77824
    v_exp_f32 v25, v25
    v_exp_f32 v26, v26
    v_cvt_pk_bf16_f32 v52, v24, v25
    v_exp_f32 v27, v27
    v_exp_f32 v28, v28
    v_mfma_f32_32x32x16_bf16 v[56:71], v[116:119], v[48:51], v[56:71]
    v_cvt_pk_bf16_f32 v53, v26, v27
    v_exp_f32 v29, v29
    v_exp_f32 v30, v30
    v_cvt_pk_bf16_f32 v54, v28, v29
    v_exp_f32 v31, v31
    s_setprio 1
    v_exp_f32 v32, v32
    v_cvt_pk_bf16_f32 v55, v30, v31
    v_exp_f32 v33, v33
    v_exp_f32 v34, v34
    v_mfma_f32_32x32x16_bf16 v[56:71], v[124:127], v[52:55], v[56:71]
    v_cvt_pk_bf16_f32 v48, v32, v33
    v_exp_f32 v35, v35
    v_exp_f32 v36, v36
    v_cvt_pk_bf16_f32 v49, v34, v35
    s_waitcnt lgkmcnt(0)
    v_mfma_f32_32x32x16_bf16 v[16:31], v[108:111], v[88:91], 0
    v_exp_f32 v37, v37
    v_exp_f32 v38, v38
    v_cvt_pk_bf16_f32 v50, v36, v37
    v_exp_f32 v39, v39
    v_exp_f32 v40, v40
    v_mfma_f32_32x32x8bf16_1k v[16:31], v[114:115], v[92:93], v[16:31]
    v_cvt_pk_bf16_f32 v51, v38, v39
    s_setprio 0
    buffer_load_dwordx4 v7, s[12:15], s27 offen lds
    s_add_u32 m0, m0, 81920
    s_add_u32 s3, s27, 81920
    buffer_load_dwordx4 v7, s[12:15], s3 offen lds
    s_add_u32 s27, s27, 4096
    s_sub_u32 m0, m0, 77824
    s_nop 0
    buffer_load_dwordx4 v7, s[12:15], s27 offen lds
    s_add_u32 m0, m0, 81920
    s_add_u32 s3, s27, 81920
    buffer_load_dwordx4 v7, s[12:15], s3 offen lds
    s_add_u32 s27, s27, 4096
    s_sub_u32 m0, m0, 77824
    v_exp_f32 v41, v41
    v_exp_f32 v42, v42
    v_cvt_pk_bf16_f32 v52, v40, v41
    v_exp_f32 v43, v43
    v_exp_f32 v44, v44
    v_mfma_f32_32x32x16_bf16 v[72:87], v[116:119], v[48:51], v[72:87]
    v_cvt_pk_bf16_f32 v53, v42, v43
    v_exp_f32 v45, v45
    v_exp_f32 v46, v46
    v_cvt_pk_bf16_f32 v54, v44, v45
    v_exp_f32 v47, v47
    s_setprio 1
    v_exp_f32 v16, v16
    v_cvt_pk_bf16_f32 v55, v46, v47
    v_exp_f32 v17, v17
    v_exp_f32 v18, v18
    v_mfma_f32_32x32x16_bf16 v[72:87], v[124:127], v[52:55], v[72:87]
    v_cvt_pk_bf16_f32 v48, v16, v17
    s_mov_b64 exec, s[44:45]
    ds_read_b128 v[116:119], v4 offset:5120
    ds_read_b128 v[124:127], v12 offset:5120
    s_mov_b64 exec, -1
    ds_read_b128 v[104:107], v2 offset:5120
    ds_read_b64 v[112:113], v3 offset:5120
    v_exp_f32 v19, v19
    v_exp_f32 v20, v20
    v_cvt_pk_bf16_f32 v49, v18, v19
    v_mfma_f32_32x32x16_bf16 v[32:47], v[108:111], v[96:99], 0
    v_exp_f32 v21, v21
    v_exp_f32 v22, v22
    v_cvt_pk_bf16_f32 v50, v20, v21
    v_exp_f32 v23, v23
    v_exp_f32 v24, v24
    v_mfma_f32_32x32x8bf16_1k v[32:47], v[114:115], v[100:101], v[32:47]
    v_cvt_pk_bf16_f32 v51, v22, v23
    s_setprio 0
    buffer_load_dwordx4 v7, s[12:15], s27 offen lds
    s_add_u32 m0, m0, 81920
    s_add_u32 s3, s27, 81920
    buffer_load_dwordx4 v7, s[12:15], s3 offen lds
    s_add_u32 s27, s27, 4096
    s_sub_u32 m0, m0, 77824
    s_nop 0
    buffer_load_dwordx4 v7, s[12:15], s27 offen lds
    s_add_u32 m0, m0, 81920
    s_add_u32 s3, s27, 81920
    buffer_load_dwordx4 v7, s[12:15], s3 offen lds
    s_add_u32 s27, s27, 4096
    s_sub_u32 m0, m0, 77824
    v_exp_f32 v25, v25
    v_exp_f32 v26, v26
    v_cvt_pk_bf16_f32 v52, v24, v25
    v_exp_f32 v27, v27
    v_exp_f32 v28, v28
    v_mfma_f32_32x32x16_bf16 v[56:71], v[120:123], v[48:51], v[56:71]
    v_cvt_pk_bf16_f32 v53, v26, v27
    v_exp_f32 v29, v29
    v_exp_f32 v30, v30
    v_cvt_pk_bf16_f32 v54, v28, v29
    v_exp_f32 v31, v31
    s_setprio 1
    v_exp_f32 v32, v32
    v_cvt_pk_bf16_f32 v55, v30, v31
    v_exp_f32 v33, v33
    v_exp_f32 v34, v34
    v_mfma_f32_32x32x16_bf16 v[56:71], v[128:131], v[52:55], v[56:71]
    v_cvt_pk_bf16_f32 v48, v32, v33
    v_exp_f32 v35, v35
    v_exp_f32 v36, v36
    v_cvt_pk_bf16_f32 v49, v34, v35
    s_waitcnt lgkmcnt(0)
    v_mfma_f32_32x32x16_bf16 v[16:31], v[104:107], v[88:91], 0
    v_exp_f32 v37, v37
    v_exp_f32 v38, v38
    v_cvt_pk_bf16_f32 v50, v36, v37
    v_exp_f32 v39, v39
    v_exp_f32 v40, v40
    v_mfma_f32_32x32x8bf16_1k v[16:31], v[112:113], v[92:93], v[16:31]
    v_cvt_pk_bf16_f32 v51, v38, v39
    s_setprio 0
    v_exp_f32 v41, v41
    v_exp_f32 v42, v42
    v_cvt_pk_bf16_f32 v52, v40, v41
    v_exp_f32 v43, v43
    v_exp_f32 v44, v44
    v_mfma_f32_32x32x16_bf16 v[72:87], v[120:123], v[48:51], v[72:87]
    v_cvt_pk_bf16_f32 v53, v42, v43
    v_exp_f32 v45, v45
    v_exp_f32 v46, v46
    v_cvt_pk_bf16_f32 v54, v44, v45
    v_exp_f32 v47, v47
    s_waitcnt vmcnt(8)
    s_barrier
    s_setprio 1
    v_exp_f32 v16, v16
    v_cvt_pk_bf16_f32 v55, v46, v47
    v_exp_f32 v17, v17
    v_exp_f32 v18, v18
    v_mfma_f32_32x32x16_bf16 v[72:87], v[128:131], v[52:55], v[72:87]
    v_cvt_pk_bf16_f32 v48, v16, v17
    s_mov_b64 exec, s[44:45]
    ds_read_b128 v[120:123], v4 offset:7680
    ds_read_b128 v[128:131], v12 offset:7680
    s_mov_b64 exec, -1
    ds_read_b128 v[108:111], v2 offset:7680
    ds_read_b64 v[114:115], v3 offset:7680
    v_exp_f32 v19, v19
    v_exp_f32 v20, v20
    v_cvt_pk_bf16_f32 v49, v18, v19
    v_mfma_f32_32x32x16_bf16 v[32:47], v[104:107], v[96:99], 0
    v_exp_f32 v21, v21
    v_exp_f32 v22, v22
    v_cvt_pk_bf16_f32 v50, v20, v21
    v_exp_f32 v23, v23
    v_exp_f32 v24, v24
    v_mfma_f32_32x32x8bf16_1k v[32:47], v[112:113], v[100:101], v[32:47]
    v_cvt_pk_bf16_f32 v51, v22, v23
    s_setprio 0
    v_exp_f32 v25, v25
    v_exp_f32 v26, v26
    v_cvt_pk_bf16_f32 v52, v24, v25
    v_exp_f32 v27, v27
    v_exp_f32 v28, v28
    v_mfma_f32_32x32x16_bf16 v[56:71], v[116:119], v[48:51], v[56:71]
    v_cvt_pk_bf16_f32 v53, v26, v27
    v_exp_f32 v29, v29
    v_exp_f32 v30, v30
    v_cvt_pk_bf16_f32 v54, v28, v29
    v_exp_f32 v31, v31
    s_setprio 1
    v_exp_f32 v32, v32
    v_cvt_pk_bf16_f32 v55, v30, v31
    v_exp_f32 v33, v33
    v_exp_f32 v34, v34
    v_mfma_f32_32x32x16_bf16 v[56:71], v[124:127], v[52:55], v[56:71]
    v_cvt_pk_bf16_f32 v48, v32, v33
    v_exp_f32 v35, v35
    v_exp_f32 v36, v36
    v_cvt_pk_bf16_f32 v49, v34, v35
    s_waitcnt lgkmcnt(0)
    v_mfma_f32_32x32x16_bf16 v[16:31], v[108:111], v[88:91], 0
    v_exp_f32 v37, v37
    v_exp_f32 v38, v38
    v_cvt_pk_bf16_f32 v50, v36, v37
    v_exp_f32 v39, v39
    v_exp_f32 v40, v40
    v_mfma_f32_32x32x8bf16_1k v[16:31], v[114:115], v[92:93], v[16:31]
    v_cvt_pk_bf16_f32 v51, v38, v39
    s_setprio 0
    v_exp_f32 v41, v41
    v_exp_f32 v42, v42
    v_cvt_pk_bf16_f32 v52, v40, v41
    v_exp_f32 v43, v43
    v_exp_f32 v44, v44
    v_mfma_f32_32x32x16_bf16 v[72:87], v[116:119], v[48:51], v[72:87]
    v_cvt_pk_bf16_f32 v53, v42, v43
    v_exp_f32 v45, v45
    v_exp_f32 v46, v46
    v_cvt_pk_bf16_f32 v54, v44, v45
    v_exp_f32 v47, v47
    s_setprio 1
    v_exp_f32 v16, v16
    v_cvt_pk_bf16_f32 v55, v46, v47
    v_exp_f32 v17, v17
    v_exp_f32 v18, v18
    v_mfma_f32_32x32x16_bf16 v[72:87], v[124:127], v[52:55], v[72:87]
    v_cvt_pk_bf16_f32 v48, v16, v17
    s_mov_b64 exec, s[44:45]
    ds_read_b128 v[116:119], v4 offset:10240
    ds_read_b128 v[124:127], v12 offset:10240
    s_mov_b64 exec, -1
    ds_read_b128 v[104:107], v2 offset:10240
    ds_read_b64 v[112:113], v3 offset:10240
    v_exp_f32 v19, v19
    v_exp_f32 v20, v20
    v_cvt_pk_bf16_f32 v49, v18, v19
    v_mfma_f32_32x32x16_bf16 v[32:47], v[108:111], v[96:99], 0
    v_exp_f32 v21, v21
    v_exp_f32 v22, v22
    v_cvt_pk_bf16_f32 v50, v20, v21
    v_exp_f32 v23, v23
    v_exp_f32 v24, v24
    v_mfma_f32_32x32x8bf16_1k v[32:47], v[114:115], v[100:101], v[32:47]
    v_cvt_pk_bf16_f32 v51, v22, v23
    s_setprio 0
    buffer_load_dwordx4 v7, s[12:15], s27 offen lds
    s_add_u32 m0, m0, 81920
    s_add_u32 s3, s27, 81920
    buffer_load_dwordx4 v7, s[12:15], s3 offen lds
    s_add_u32 s27, s27, 4096
    s_sub_u32 m0, m0, 77824
    v_exp_f32 v25, v25
    v_exp_f32 v26, v26
    v_cvt_pk_bf16_f32 v52, v24, v25
    v_exp_f32 v27, v27
    v_exp_f32 v28, v28
    v_mfma_f32_32x32x16_bf16 v[56:71], v[120:123], v[48:51], v[56:71]
    v_cvt_pk_bf16_f32 v53, v26, v27
    v_exp_f32 v29, v29
    v_exp_f32 v30, v30
    v_cvt_pk_bf16_f32 v54, v28, v29
    v_exp_f32 v31, v31
    s_setprio 1
    v_exp_f32 v32, v32
    v_cvt_pk_bf16_f32 v55, v30, v31
    v_exp_f32 v33, v33
    v_exp_f32 v34, v34
    v_mfma_f32_32x32x16_bf16 v[56:71], v[128:131], v[52:55], v[56:71]
    v_cvt_pk_bf16_f32 v48, v32, v33
    v_exp_f32 v35, v35
    v_exp_f32 v36, v36
    v_cvt_pk_bf16_f32 v49, v34, v35
    s_waitcnt lgkmcnt(0)
    v_mfma_f32_32x32x16_bf16 v[16:31], v[104:107], v[88:91], 0
    v_exp_f32 v37, v37
    v_exp_f32 v38, v38
    v_cvt_pk_bf16_f32 v50, v36, v37
    v_exp_f32 v39, v39
    v_exp_f32 v40, v40
    v_mfma_f32_32x32x8bf16_1k v[16:31], v[112:113], v[92:93], v[16:31]
    v_cvt_pk_bf16_f32 v51, v38, v39
    s_setprio 0
    buffer_load_dwordx4 v7, s[12:15], s27 offen lds
    s_add_u32 m0, m0, 81920
    s_add_u32 s3, s27, 81920
    buffer_load_dwordx4 v7, s[12:15], s3 offen lds
    s_add_u32 s27, s27, 4096
    s_sub_u32 m0, m0, 77824
    v_exp_f32 v41, v41
    v_exp_f32 v42, v42
    v_cvt_pk_bf16_f32 v52, v40, v41
    v_exp_f32 v43, v43
    v_exp_f32 v44, v44
    v_mfma_f32_32x32x16_bf16 v[72:87], v[120:123], v[48:51], v[72:87]
    v_cvt_pk_bf16_f32 v53, v42, v43
    v_exp_f32 v45, v45
    v_exp_f32 v46, v46
    v_cvt_pk_bf16_f32 v54, v44, v45
    v_exp_f32 v47, v47
    s_setprio 1
    v_exp_f32 v16, v16
    v_cvt_pk_bf16_f32 v55, v46, v47
    v_exp_f32 v17, v17
    v_exp_f32 v18, v18
    v_mfma_f32_32x32x16_bf16 v[72:87], v[128:131], v[52:55], v[72:87]
    v_cvt_pk_bf16_f32 v48, v16, v17
    s_mov_b64 exec, s[44:45]
    ds_read_b128 v[120:123], v4 offset:12800
    ds_read_b128 v[128:131], v12 offset:12800
    s_mov_b64 exec, -1
    ds_read_b128 v[108:111], v2 offset:12800
    ds_read_b64 v[114:115], v3 offset:12800
    v_exp_f32 v19, v19
    v_exp_f32 v20, v20
    v_cvt_pk_bf16_f32 v49, v18, v19
    v_mfma_f32_32x32x16_bf16 v[32:47], v[104:107], v[96:99], 0
    v_exp_f32 v21, v21
    v_exp_f32 v22, v22
    v_cvt_pk_bf16_f32 v50, v20, v21
    v_exp_f32 v23, v23
    v_exp_f32 v24, v24
    v_mfma_f32_32x32x8bf16_1k v[32:47], v[112:113], v[100:101], v[32:47]
    v_cvt_pk_bf16_f32 v51, v22, v23
    s_setprio 0
    buffer_load_dwordx4 v7, s[12:15], s27 offen lds
    s_add_u32 m0, m0, 81920
    s_add_u32 s3, s27, 81920
    buffer_load_dwordx4 v7, s[12:15], s3 offen lds
    s_add_u32 s27, s27, 4096
    s_sub_u32 m0, m0, 77824
    v_exp_f32 v25, v25
    v_exp_f32 v26, v26
    v_cvt_pk_bf16_f32 v52, v24, v25
    v_exp_f32 v27, v27
    v_exp_f32 v28, v28
    v_mfma_f32_32x32x16_bf16 v[56:71], v[116:119], v[48:51], v[56:71]
    v_cvt_pk_bf16_f32 v53, v26, v27
    v_exp_f32 v29, v29
    v_exp_f32 v30, v30
    v_cvt_pk_bf16_f32 v54, v28, v29
    v_exp_f32 v31, v31
    s_setprio 1
    v_exp_f32 v32, v32
    v_cvt_pk_bf16_f32 v55, v30, v31
    v_exp_f32 v33, v33
    v_exp_f32 v34, v34
    v_mfma_f32_32x32x16_bf16 v[56:71], v[124:127], v[52:55], v[56:71]
    v_cvt_pk_bf16_f32 v48, v32, v33
    v_exp_f32 v35, v35
    v_exp_f32 v36, v36
    v_cvt_pk_bf16_f32 v49, v34, v35
    s_waitcnt lgkmcnt(0)
    v_mfma_f32_32x32x16_bf16 v[16:31], v[108:111], v[88:91], 0
    v_exp_f32 v37, v37
    v_exp_f32 v38, v38
    v_cvt_pk_bf16_f32 v50, v36, v37
    v_exp_f32 v39, v39
    v_exp_f32 v40, v40
    v_mfma_f32_32x32x8bf16_1k v[16:31], v[114:115], v[92:93], v[16:31]
    v_cvt_pk_bf16_f32 v51, v38, v39
    s_setprio 0
    buffer_load_dwordx4 v7, s[12:15], s27 offen lds
    s_add_u32 m0, m0, 81920
    s_add_u32 s3, s27, 81920
    buffer_load_dwordx4 v7, s[12:15], s3 offen lds
    s_add_u32 s27, s27, 4096
    s_sub_u32 m0, m0, 77824
    v_exp_f32 v41, v41
    v_exp_f32 v42, v42
    v_cvt_pk_bf16_f32 v52, v40, v41
    v_exp_f32 v43, v43
    v_exp_f32 v44, v44
    v_mfma_f32_32x32x16_bf16 v[72:87], v[116:119], v[48:51], v[72:87]
    v_cvt_pk_bf16_f32 v53, v42, v43
    v_exp_f32 v45, v45
    v_exp_f32 v46, v46
    v_cvt_pk_bf16_f32 v54, v44, v45
    v_exp_f32 v47, v47
    s_waitcnt vmcnt(8)
    s_barrier
    s_setprio 1
    v_exp_f32 v16, v16
    v_cvt_pk_bf16_f32 v55, v46, v47
    v_exp_f32 v17, v17
    v_exp_f32 v18, v18
    v_mfma_f32_32x32x16_bf16 v[72:87], v[124:127], v[52:55], v[72:87]
    v_cvt_pk_bf16_f32 v48, v16, v17
    s_mov_b64 exec, s[44:45]
    ds_read_b128 v[116:119], v4 offset:15360
    ds_read_b128 v[124:127], v12 offset:15360
    s_mov_b64 exec, -1
    ds_read_b128 v[104:107], v2 offset:15360
    ds_read_b64 v[112:113], v3 offset:15360
    v_exp_f32 v19, v19
    v_exp_f32 v20, v20
    v_cvt_pk_bf16_f32 v49, v18, v19
    v_mfma_f32_32x32x16_bf16 v[32:47], v[108:111], v[96:99], 0
    v_exp_f32 v21, v21
    v_exp_f32 v22, v22
    v_cvt_pk_bf16_f32 v50, v20, v21
    v_exp_f32 v23, v23
    v_exp_f32 v24, v24
    v_mfma_f32_32x32x8bf16_1k v[32:47], v[114:115], v[100:101], v[32:47]
    v_cvt_pk_bf16_f32 v51, v22, v23
    s_setprio 0
    buffer_load_dwordx4 v7, s[12:15], s27 offen lds
    s_add_u32 m0, m0, 81920
    s_add_u32 s3, s27, 81920
    buffer_load_dwordx4 v7, s[12:15], s3 offen lds
    s_add_u32 s27, s27, 4096
    s_sub_u32 m0, m0, 77824
    v_exp_f32 v25, v25
    v_exp_f32 v26, v26
    v_cvt_pk_bf16_f32 v52, v24, v25
    v_exp_f32 v27, v27
    v_exp_f32 v28, v28
    v_mfma_f32_32x32x16_bf16 v[56:71], v[120:123], v[48:51], v[56:71]
    v_cvt_pk_bf16_f32 v53, v26, v27
    v_exp_f32 v29, v29
    v_exp_f32 v30, v30
    v_cvt_pk_bf16_f32 v54, v28, v29
    v_exp_f32 v31, v31
    s_setprio 1
    v_exp_f32 v32, v32
    v_cvt_pk_bf16_f32 v55, v30, v31
    v_exp_f32 v33, v33
    v_exp_f32 v34, v34
    v_mfma_f32_32x32x16_bf16 v[56:71], v[128:131], v[52:55], v[56:71]
    v_cvt_pk_bf16_f32 v48, v32, v33
    v_exp_f32 v35, v35
    v_exp_f32 v36, v36
    v_cvt_pk_bf16_f32 v49, v34, v35
    s_waitcnt lgkmcnt(0)
    v_mfma_f32_32x32x16_bf16 v[16:31], v[104:107], v[88:91], 0
    v_exp_f32 v37, v37
    v_exp_f32 v38, v38
    v_cvt_pk_bf16_f32 v50, v36, v37
    v_exp_f32 v39, v39
    v_exp_f32 v40, v40
    v_mfma_f32_32x32x8bf16_1k v[16:31], v[112:113], v[92:93], v[16:31]
    v_cvt_pk_bf16_f32 v51, v38, v39
    s_setprio 0
    buffer_load_dwordx4 v7, s[12:15], s27 offen lds
    s_add_u32 m0, m0, 81920
    s_add_u32 s3, s27, 81920
    buffer_load_dwordx4 v7, s[12:15], s3 offen lds
    s_add_u32 s27, s27, 4096
    s_sub_u32 m0, m0, 77824
    v_exp_f32 v41, v41
    v_exp_f32 v42, v42
    v_cvt_pk_bf16_f32 v52, v40, v41
    v_exp_f32 v43, v43
    v_exp_f32 v44, v44
    v_mfma_f32_32x32x16_bf16 v[72:87], v[120:123], v[48:51], v[72:87]
    v_cvt_pk_bf16_f32 v53, v42, v43
    v_exp_f32 v45, v45
    v_exp_f32 v46, v46
    v_cvt_pk_bf16_f32 v54, v44, v45
    v_exp_f32 v47, v47
    s_setprio 1
    v_exp_f32 v16, v16
    v_cvt_pk_bf16_f32 v55, v46, v47
    v_exp_f32 v17, v17
    v_exp_f32 v18, v18
    v_mfma_f32_32x32x16_bf16 v[72:87], v[128:131], v[52:55], v[72:87]
    v_cvt_pk_bf16_f32 v48, v16, v17
    s_mov_b64 exec, s[44:45]
    ds_read_b128 v[120:123], v4 offset:17920
    ds_read_b128 v[128:131], v12 offset:17920
    s_mov_b64 exec, -1
    ds_read_b128 v[108:111], v2 offset:17920
    ds_read_b64 v[114:115], v3 offset:17920
    v_exp_f32 v19, v19
    v_exp_f32 v20, v20
    v_cvt_pk_bf16_f32 v49, v18, v19
    v_mfma_f32_32x32x16_bf16 v[32:47], v[104:107], v[96:99], 0
    v_exp_f32 v21, v21
    v_exp_f32 v22, v22
    v_cvt_pk_bf16_f32 v50, v20, v21
    v_exp_f32 v23, v23
    v_exp_f32 v24, v24
    v_mfma_f32_32x32x8bf16_1k v[32:47], v[112:113], v[100:101], v[32:47]
    v_cvt_pk_bf16_f32 v51, v22, v23
    s_setprio 0
    buffer_load_dwordx4 v7, s[12:15], s27 offen lds
    s_add_u32 m0, m0, 81920
    s_add_u32 s3, s27, 81920
    buffer_load_dwordx4 v7, s[12:15], s3 offen lds
    s_add_u32 s27, s27, 4096
    s_sub_u32 m0, m0, 77824
    v_exp_f32 v25, v25
    v_exp_f32 v26, v26
    v_cvt_pk_bf16_f32 v52, v24, v25
    v_exp_f32 v27, v27
    v_exp_f32 v28, v28
    v_mfma_f32_32x32x16_bf16 v[56:71], v[116:119], v[48:51], v[56:71]
    v_cvt_pk_bf16_f32 v53, v26, v27
    v_exp_f32 v29, v29
    v_exp_f32 v30, v30
    v_cvt_pk_bf16_f32 v54, v28, v29
    v_exp_f32 v31, v31
    s_setprio 1
    v_exp_f32 v32, v32
    v_cvt_pk_bf16_f32 v55, v30, v31
    v_exp_f32 v33, v33
    v_exp_f32 v34, v34
    v_mfma_f32_32x32x16_bf16 v[56:71], v[124:127], v[52:55], v[56:71]
    v_cvt_pk_bf16_f32 v48, v32, v33
    v_exp_f32 v35, v35
    v_exp_f32 v36, v36
    v_cvt_pk_bf16_f32 v49, v34, v35
    s_waitcnt lgkmcnt(0)
    v_mfma_f32_32x32x16_bf16 v[16:31], v[108:111], v[88:91], 0
    v_exp_f32 v37, v37
    v_exp_f32 v38, v38
    v_cvt_pk_bf16_f32 v50, v36, v37
    v_exp_f32 v39, v39
    v_exp_f32 v40, v40
    v_mfma_f32_32x32x8bf16_1k v[16:31], v[114:115], v[92:93], v[16:31]
    v_cvt_pk_bf16_f32 v51, v38, v39
    s_setprio 0
    buffer_load_dwordx4 v7, s[12:15], s27 offen lds
    s_add_u32 m0, m0, 81920
    s_add_u32 s3, s27, 81920
    buffer_load_dwordx4 v7, s[12:15], s3 offen lds
    s_add_u32 s27, s27, 4096
    s_sub_u32 m0, m0, 77824
    v_exp_f32 v41, v41
    v_exp_f32 v42, v42
    v_cvt_pk_bf16_f32 v52, v40, v41
    v_exp_f32 v43, v43
    v_exp_f32 v44, v44
    v_mfma_f32_32x32x16_bf16 v[72:87], v[116:119], v[48:51], v[72:87]
    v_cvt_pk_bf16_f32 v53, v42, v43
    v_exp_f32 v45, v45
    v_exp_f32 v46, v46
    v_cvt_pk_bf16_f32 v54, v44, v45
    v_exp_f32 v47, v47
    s_setprio 1
    v_exp_f32 v16, v16
    v_cvt_pk_bf16_f32 v55, v46, v47
    v_exp_f32 v17, v17
    v_exp_f32 v18, v18
    v_mfma_f32_32x32x16_bf16 v[72:87], v[124:127], v[52:55], v[72:87]
    v_cvt_pk_bf16_f32 v48, v16, v17
    s_mov_b64 exec, s[44:45]
    ds_read_b128 v[116:119], v4 offset:20480
    ds_read_b128 v[124:127], v12 offset:20480
    s_mov_b64 exec, -1
    ds_read_b128 v[104:107], v2 offset:20480
    ds_read_b64 v[112:113], v3 offset:20480
    v_exp_f32 v19, v19
    v_exp_f32 v20, v20
    v_cvt_pk_bf16_f32 v49, v18, v19
    v_mfma_f32_32x32x16_bf16 v[32:47], v[108:111], v[96:99], 0
    v_exp_f32 v21, v21
    v_exp_f32 v22, v22
    v_cvt_pk_bf16_f32 v50, v20, v21
    v_exp_f32 v23, v23
    v_exp_f32 v24, v24
    v_mfma_f32_32x32x8bf16_1k v[32:47], v[114:115], v[100:101], v[32:47]
    v_cvt_pk_bf16_f32 v51, v22, v23
    s_setprio 0
    v_exp_f32 v25, v25
    v_exp_f32 v26, v26
    v_cvt_pk_bf16_f32 v52, v24, v25
    v_exp_f32 v27, v27
    v_exp_f32 v28, v28
    v_mfma_f32_32x32x16_bf16 v[56:71], v[120:123], v[48:51], v[56:71]
    v_cvt_pk_bf16_f32 v53, v26, v27
    v_exp_f32 v29, v29
    v_exp_f32 v30, v30
    v_cvt_pk_bf16_f32 v54, v28, v29
    v_exp_f32 v31, v31
    s_setprio 1
    v_exp_f32 v32, v32
    v_cvt_pk_bf16_f32 v55, v30, v31
    v_exp_f32 v33, v33
    v_exp_f32 v34, v34
    v_mfma_f32_32x32x16_bf16 v[56:71], v[128:131], v[52:55], v[56:71]
    v_cvt_pk_bf16_f32 v48, v32, v33
    v_exp_f32 v35, v35
    v_exp_f32 v36, v36
    v_cvt_pk_bf16_f32 v49, v34, v35
    s_waitcnt lgkmcnt(0)
    v_mfma_f32_32x32x16_bf16 v[16:31], v[104:107], v[88:91], 0
    v_exp_f32 v37, v37
    v_exp_f32 v38, v38
    v_cvt_pk_bf16_f32 v50, v36, v37
    v_exp_f32 v39, v39
    v_exp_f32 v40, v40
    v_mfma_f32_32x32x8bf16_1k v[16:31], v[112:113], v[92:93], v[16:31]
    v_cvt_pk_bf16_f32 v51, v38, v39
    s_setprio 0
    v_exp_f32 v41, v41
    v_exp_f32 v42, v42
    v_cvt_pk_bf16_f32 v52, v40, v41
    v_exp_f32 v43, v43
    v_exp_f32 v44, v44
    v_mfma_f32_32x32x16_bf16 v[72:87], v[120:123], v[48:51], v[72:87]
    v_cvt_pk_bf16_f32 v53, v42, v43
    v_exp_f32 v45, v45
    v_exp_f32 v46, v46
    v_cvt_pk_bf16_f32 v54, v44, v45
    v_exp_f32 v47, v47
    s_setprio 1
    v_exp_f32 v16, v16
    v_cvt_pk_bf16_f32 v55, v46, v47
    v_exp_f32 v17, v17
    v_exp_f32 v18, v18
    v_mfma_f32_32x32x16_bf16 v[72:87], v[128:131], v[52:55], v[72:87]
    v_cvt_pk_bf16_f32 v48, v16, v17
    s_mov_b64 exec, s[44:45]
    ds_read_b128 v[120:123], v4 offset:23040
    ds_read_b128 v[128:131], v12 offset:23040
    s_mov_b64 exec, -1
    ds_read_b128 v[108:111], v2 offset:23040
    ds_read_b64 v[114:115], v3 offset:23040
    v_exp_f32 v19, v19
    v_exp_f32 v20, v20
    v_cvt_pk_bf16_f32 v49, v18, v19
    v_mfma_f32_32x32x16_bf16 v[32:47], v[104:107], v[96:99], 0
    v_exp_f32 v21, v21
    v_exp_f32 v22, v22
    v_cvt_pk_bf16_f32 v50, v20, v21
    v_exp_f32 v23, v23
    v_exp_f32 v24, v24
    v_mfma_f32_32x32x8bf16_1k v[32:47], v[112:113], v[100:101], v[32:47]
    v_cvt_pk_bf16_f32 v51, v22, v23
    s_setprio 0
    v_exp_f32 v25, v25
    v_exp_f32 v26, v26
    v_cvt_pk_bf16_f32 v52, v24, v25
    v_exp_f32 v27, v27
    v_exp_f32 v28, v28
    v_mfma_f32_32x32x16_bf16 v[56:71], v[116:119], v[48:51], v[56:71]
    v_cvt_pk_bf16_f32 v53, v26, v27
    v_exp_f32 v29, v29
    v_exp_f32 v30, v30
    v_cvt_pk_bf16_f32 v54, v28, v29
    v_exp_f32 v31, v31
    s_setprio 1
    v_exp_f32 v32, v32
    v_cvt_pk_bf16_f32 v55, v30, v31
    v_exp_f32 v33, v33
    v_exp_f32 v34, v34
    v_mfma_f32_32x32x16_bf16 v[56:71], v[124:127], v[52:55], v[56:71]
    v_cvt_pk_bf16_f32 v48, v32, v33
    v_exp_f32 v35, v35
    v_exp_f32 v36, v36
    v_cvt_pk_bf16_f32 v49, v34, v35
    s_waitcnt lgkmcnt(0)
    v_mfma_f32_32x32x16_bf16 v[16:31], v[108:111], v[88:91], 0
    v_exp_f32 v37, v37
    v_exp_f32 v38, v38
    v_cvt_pk_bf16_f32 v50, v36, v37
    v_exp_f32 v39, v39
    v_exp_f32 v40, v40
    v_mfma_f32_32x32x8bf16_1k v[16:31], v[114:115], v[92:93], v[16:31]
    v_cvt_pk_bf16_f32 v51, v38, v39
    s_setprio 0
    v_exp_f32 v41, v41
    v_exp_f32 v42, v42
    v_cvt_pk_bf16_f32 v52, v40, v41
    v_exp_f32 v43, v43
    v_exp_f32 v44, v44
    v_mfma_f32_32x32x16_bf16 v[72:87], v[116:119], v[48:51], v[72:87]
    v_cvt_pk_bf16_f32 v53, v42, v43
    v_exp_f32 v45, v45
    v_exp_f32 v46, v46
    v_cvt_pk_bf16_f32 v54, v44, v45
    v_exp_f32 v47, v47
    s_setprio 1
    v_exp_f32 v16, v16
    v_cvt_pk_bf16_f32 v55, v46, v47
    v_exp_f32 v17, v17
    v_exp_f32 v18, v18
    v_mfma_f32_32x32x16_bf16 v[72:87], v[124:127], v[52:55], v[72:87]
    v_cvt_pk_bf16_f32 v48, v16, v17
    s_mov_b64 exec, s[44:45]
    ds_read_b128 v[116:119], v4 offset:25600
    ds_read_b128 v[124:127], v12 offset:25600
    s_mov_b64 exec, -1
    ds_read_b128 v[104:107], v2 offset:25600
    ds_read_b64 v[112:113], v3 offset:25600
    v_exp_f32 v19, v19
    v_exp_f32 v20, v20
    v_cvt_pk_bf16_f32 v49, v18, v19
    v_mfma_f32_32x32x16_bf16 v[32:47], v[108:111], v[96:99], 0
    v_exp_f32 v21, v21
    v_exp_f32 v22, v22
    v_cvt_pk_bf16_f32 v50, v20, v21
    v_exp_f32 v23, v23
    v_exp_f32 v24, v24
    v_mfma_f32_32x32x8bf16_1k v[32:47], v[114:115], v[100:101], v[32:47]
    v_cvt_pk_bf16_f32 v51, v22, v23
    s_setprio 0
    v_exp_f32 v25, v25
    v_exp_f32 v26, v26
    v_cvt_pk_bf16_f32 v52, v24, v25
    v_exp_f32 v27, v27
    v_exp_f32 v28, v28
    v_mfma_f32_32x32x16_bf16 v[56:71], v[120:123], v[48:51], v[56:71]
    v_cvt_pk_bf16_f32 v53, v26, v27
    v_exp_f32 v29, v29
    v_exp_f32 v30, v30
    v_cvt_pk_bf16_f32 v54, v28, v29
    v_exp_f32 v31, v31
    s_setprio 1
    v_exp_f32 v32, v32
    v_cvt_pk_bf16_f32 v55, v30, v31
    v_exp_f32 v33, v33
    v_exp_f32 v34, v34
    v_mfma_f32_32x32x16_bf16 v[56:71], v[128:131], v[52:55], v[56:71]
    v_cvt_pk_bf16_f32 v48, v32, v33
    v_exp_f32 v35, v35
    v_exp_f32 v36, v36
    v_cvt_pk_bf16_f32 v49, v34, v35
    s_waitcnt lgkmcnt(0)
    v_mfma_f32_32x32x16_bf16 v[16:31], v[104:107], v[88:91], 0
    v_exp_f32 v37, v37
    v_exp_f32 v38, v38
    v_cvt_pk_bf16_f32 v50, v36, v37
    v_exp_f32 v39, v39
    v_exp_f32 v40, v40
    v_mfma_f32_32x32x8bf16_1k v[16:31], v[112:113], v[92:93], v[16:31]
    v_cvt_pk_bf16_f32 v51, v38, v39
    s_setprio 0
    v_exp_f32 v41, v41
    v_exp_f32 v42, v42
    v_cvt_pk_bf16_f32 v52, v40, v41
    v_exp_f32 v43, v43
    v_exp_f32 v44, v44
    v_mfma_f32_32x32x16_bf16 v[72:87], v[120:123], v[48:51], v[72:87]
    v_cvt_pk_bf16_f32 v53, v42, v43
    v_exp_f32 v45, v45
    v_exp_f32 v46, v46
    v_cvt_pk_bf16_f32 v54, v44, v45
    v_exp_f32 v47, v47
    s_setprio 1
    v_exp_f32 v16, v16
    v_cvt_pk_bf16_f32 v55, v46, v47
    v_exp_f32 v17, v17
    v_exp_f32 v18, v18
    v_mfma_f32_32x32x16_bf16 v[72:87], v[128:131], v[52:55], v[72:87]
    v_cvt_pk_bf16_f32 v48, v16, v17
    s_mov_b64 exec, s[44:45]
    ds_read_b128 v[120:123], v4 offset:28160
    ds_read_b128 v[128:131], v12 offset:28160
    s_mov_b64 exec, -1
    ds_read_b128 v[108:111], v2 offset:28160
    ds_read_b64 v[114:115], v3 offset:28160
    v_exp_f32 v19, v19
    v_exp_f32 v20, v20
    v_cvt_pk_bf16_f32 v49, v18, v19
    v_mfma_f32_32x32x16_bf16 v[32:47], v[104:107], v[96:99], 0
    v_exp_f32 v21, v21
    v_exp_f32 v22, v22
    v_cvt_pk_bf16_f32 v50, v20, v21
    v_exp_f32 v23, v23
    v_exp_f32 v24, v24
    v_mfma_f32_32x32x8bf16_1k v[32:47], v[112:113], v[100:101], v[32:47]
    v_cvt_pk_bf16_f32 v51, v22, v23
    s_setprio 0
    v_exp_f32 v25, v25
    v_exp_f32 v26, v26
    v_cvt_pk_bf16_f32 v52, v24, v25
    v_exp_f32 v27, v27
    v_exp_f32 v28, v28
    v_mfma_f32_32x32x16_bf16 v[56:71], v[116:119], v[48:51], v[56:71]
    v_cvt_pk_bf16_f32 v53, v26, v27
    v_exp_f32 v29, v29
    v_exp_f32 v30, v30
    v_cvt_pk_bf16_f32 v54, v28, v29
    v_exp_f32 v31, v31
    s_setprio 1
    v_exp_f32 v32, v32
    v_cvt_pk_bf16_f32 v55, v30, v31
    v_exp_f32 v33, v33
    v_exp_f32 v34, v34
    v_mfma_f32_32x32x16_bf16 v[56:71], v[124:127], v[52:55], v[56:71]
    v_cvt_pk_bf16_f32 v48, v32, v33
    v_exp_f32 v35, v35
    v_exp_f32 v36, v36
    v_cvt_pk_bf16_f32 v49, v34, v35
    s_waitcnt lgkmcnt(0)
    v_mfma_f32_32x32x16_bf16 v[16:31], v[108:111], v[88:91], 0
    v_exp_f32 v37, v37
    v_exp_f32 v38, v38
    v_cvt_pk_bf16_f32 v50, v36, v37
    v_exp_f32 v39, v39
    v_exp_f32 v40, v40
    v_mfma_f32_32x32x8bf16_1k v[16:31], v[114:115], v[92:93], v[16:31]
    v_cvt_pk_bf16_f32 v51, v38, v39
    s_setprio 0
    v_exp_f32 v41, v41
    v_exp_f32 v42, v42
    v_cvt_pk_bf16_f32 v52, v40, v41
    v_exp_f32 v43, v43
    v_exp_f32 v44, v44
    v_mfma_f32_32x32x16_bf16 v[72:87], v[116:119], v[48:51], v[72:87]
    v_cvt_pk_bf16_f32 v53, v42, v43
    v_exp_f32 v45, v45
    v_exp_f32 v46, v46
    v_cvt_pk_bf16_f32 v54, v44, v45
    v_exp_f32 v47, v47
    s_waitcnt vmcnt(0)
    s_barrier
    s_setprio 1
    v_exp_f32 v16, v16
    v_cvt_pk_bf16_f32 v55, v46, v47
    v_exp_f32 v17, v17
    v_exp_f32 v18, v18
    v_mfma_f32_32x32x16_bf16 v[72:87], v[124:127], v[52:55], v[72:87]
    v_cvt_pk_bf16_f32 v48, v16, v17
    s_mov_b64 exec, s[44:45]
    ds_read_b128 v[116:119], v4 offset:30720
    ds_read_b128 v[124:127], v12 offset:30720
    s_mov_b64 exec, -1
    ds_read_b128 v[104:107], v2 offset:30720
    ds_read_b64 v[112:113], v3 offset:30720
    v_exp_f32 v19, v19
    v_exp_f32 v20, v20
    v_cvt_pk_bf16_f32 v49, v18, v19
    v_mfma_f32_32x32x16_bf16 v[32:47], v[108:111], v[96:99], 0
    v_exp_f32 v21, v21
    v_exp_f32 v22, v22
    v_cvt_pk_bf16_f32 v50, v20, v21
    v_exp_f32 v23, v23
    v_exp_f32 v24, v24
    v_mfma_f32_32x32x8bf16_1k v[32:47], v[114:115], v[100:101], v[32:47]
    v_cvt_pk_bf16_f32 v51, v22, v23
    s_setprio 0
    v_exp_f32 v25, v25
    v_exp_f32 v26, v26
    v_cvt_pk_bf16_f32 v52, v24, v25
    v_exp_f32 v27, v27
    v_exp_f32 v28, v28
    v_mfma_f32_32x32x16_bf16 v[56:71], v[120:123], v[48:51], v[56:71]
    v_cvt_pk_bf16_f32 v53, v26, v27
    v_exp_f32 v29, v29
    v_exp_f32 v30, v30
    v_cvt_pk_bf16_f32 v54, v28, v29
    v_exp_f32 v31, v31
    s_setprio 1
    v_exp_f32 v32, v32
    v_cvt_pk_bf16_f32 v55, v30, v31
    v_exp_f32 v33, v33
    v_exp_f32 v34, v34
    v_mfma_f32_32x32x16_bf16 v[56:71], v[128:131], v[52:55], v[56:71]
    v_cvt_pk_bf16_f32 v48, v32, v33
    v_exp_f32 v35, v35
    v_exp_f32 v36, v36
    v_cvt_pk_bf16_f32 v49, v34, v35
    s_waitcnt lgkmcnt(0)
    v_mfma_f32_32x32x16_bf16 v[16:31], v[104:107], v[88:91], 0
    v_exp_f32 v37, v37
    v_exp_f32 v38, v38
    v_cvt_pk_bf16_f32 v50, v36, v37
    v_exp_f32 v39, v39
    v_exp_f32 v40, v40
    v_mfma_f32_32x32x8bf16_1k v[16:31], v[112:113], v[92:93], v[16:31]
    v_cvt_pk_bf16_f32 v51, v38, v39
    s_setprio 0
    v_exp_f32 v41, v41
    v_exp_f32 v42, v42
    v_cvt_pk_bf16_f32 v52, v40, v41
    v_exp_f32 v43, v43
    v_exp_f32 v44, v44
    v_mfma_f32_32x32x16_bf16 v[72:87], v[120:123], v[48:51], v[72:87]
    v_cvt_pk_bf16_f32 v53, v42, v43
    v_exp_f32 v45, v45
    v_exp_f32 v46, v46
    v_cvt_pk_bf16_f32 v54, v44, v45
    v_exp_f32 v47, v47
    s_setprio 1
    v_exp_f32 v16, v16
    v_cvt_pk_bf16_f32 v55, v46, v47
    v_exp_f32 v17, v17
    v_exp_f32 v18, v18
    v_mfma_f32_32x32x16_bf16 v[72:87], v[128:131], v[52:55], v[72:87]
    v_cvt_pk_bf16_f32 v48, v16, v17
    s_mov_b64 exec, s[44:45]
    ds_read_b128 v[120:123], v4 offset:33280
    ds_read_b128 v[128:131], v12 offset:33280
    s_mov_b64 exec, -1
    ds_read_b128 v[108:111], v2 offset:33280
    ds_read_b64 v[114:115], v3 offset:33280
    v_exp_f32 v19, v19
    v_exp_f32 v20, v20
    v_cvt_pk_bf16_f32 v49, v18, v19
    v_mfma_f32_32x32x16_bf16 v[32:47], v[104:107], v[96:99], 0
    v_exp_f32 v21, v21
    v_exp_f32 v22, v22
    v_cvt_pk_bf16_f32 v50, v20, v21
    v_exp_f32 v23, v23
    v_exp_f32 v24, v24
    v_mfma_f32_32x32x8bf16_1k v[32:47], v[112:113], v[100:101], v[32:47]
    v_cvt_pk_bf16_f32 v51, v22, v23
    s_setprio 0
    v_exp_f32 v25, v25
    v_exp_f32 v26, v26
    v_cvt_pk_bf16_f32 v52, v24, v25
    v_exp_f32 v27, v27
    v_exp_f32 v28, v28
    v_mfma_f32_32x32x16_bf16 v[56:71], v[116:119], v[48:51], v[56:71]
    v_cvt_pk_bf16_f32 v53, v26, v27
    v_exp_f32 v29, v29
    v_exp_f32 v30, v30
    v_cvt_pk_bf16_f32 v54, v28, v29
    v_exp_f32 v31, v31
    s_setprio 1
    v_exp_f32 v32, v32
    v_cvt_pk_bf16_f32 v55, v30, v31
    v_exp_f32 v33, v33
    v_exp_f32 v34, v34
    v_mfma_f32_32x32x16_bf16 v[56:71], v[124:127], v[52:55], v[56:71]
    v_cvt_pk_bf16_f32 v48, v32, v33
    v_exp_f32 v35, v35
    v_exp_f32 v36, v36
    v_cvt_pk_bf16_f32 v49, v34, v35
    s_waitcnt lgkmcnt(0)
    v_mfma_f32_32x32x16_bf16 v[16:31], v[108:111], v[88:91], 0
    v_exp_f32 v37, v37
    v_exp_f32 v38, v38
    v_cvt_pk_bf16_f32 v50, v36, v37
    v_exp_f32 v39, v39
    v_exp_f32 v40, v40
    v_mfma_f32_32x32x8bf16_1k v[16:31], v[114:115], v[92:93], v[16:31]
    v_cvt_pk_bf16_f32 v51, v38, v39
    s_setprio 0
    v_exp_f32 v41, v41
    v_exp_f32 v42, v42
    v_cvt_pk_bf16_f32 v52, v40, v41
    v_exp_f32 v43, v43
    v_exp_f32 v44, v44
    v_mfma_f32_32x32x16_bf16 v[72:87], v[116:119], v[48:51], v[72:87]
    v_cvt_pk_bf16_f32 v53, v42, v43
    v_exp_f32 v45, v45
    v_exp_f32 v46, v46
    v_cvt_pk_bf16_f32 v54, v44, v45
    v_exp_f32 v47, v47
    s_setprio 1
    v_exp_f32 v16, v16
    v_cvt_pk_bf16_f32 v55, v46, v47
    v_exp_f32 v17, v17
    v_exp_f32 v18, v18
    v_mfma_f32_32x32x16_bf16 v[72:87], v[124:127], v[52:55], v[72:87]
    v_cvt_pk_bf16_f32 v48, v16, v17
    s_mov_b64 exec, s[44:45]
    ds_read_b128 v[116:119], v4 offset:35840
    ds_read_b128 v[124:127], v12 offset:35840
    s_mov_b64 exec, -1
    ds_read_b128 v[104:107], v2 offset:35840
    ds_read_b64 v[112:113], v3 offset:35840
    v_exp_f32 v19, v19
    v_exp_f32 v20, v20
    v_cvt_pk_bf16_f32 v49, v18, v19
    v_mfma_f32_32x32x16_bf16 v[32:47], v[108:111], v[96:99], 0
    v_exp_f32 v21, v21
    v_exp_f32 v22, v22
    v_cvt_pk_bf16_f32 v50, v20, v21
    v_exp_f32 v23, v23
    v_exp_f32 v24, v24
    v_mfma_f32_32x32x8bf16_1k v[32:47], v[114:115], v[100:101], v[32:47]
    v_cvt_pk_bf16_f32 v51, v22, v23
    s_setprio 0
    v_exp_f32 v25, v25
    v_exp_f32 v26, v26
    v_cvt_pk_bf16_f32 v52, v24, v25
    v_exp_f32 v27, v27
    v_exp_f32 v28, v28
    v_mfma_f32_32x32x16_bf16 v[56:71], v[120:123], v[48:51], v[56:71]
    v_cvt_pk_bf16_f32 v53, v26, v27
    v_exp_f32 v29, v29
    v_exp_f32 v30, v30
    v_cvt_pk_bf16_f32 v54, v28, v29
    v_exp_f32 v31, v31
    s_setprio 1
    v_exp_f32 v32, v32
    v_cvt_pk_bf16_f32 v55, v30, v31
    v_exp_f32 v33, v33
    v_exp_f32 v34, v34
    v_mfma_f32_32x32x16_bf16 v[56:71], v[128:131], v[52:55], v[56:71]
    v_cvt_pk_bf16_f32 v48, v32, v33
    v_exp_f32 v35, v35
    v_exp_f32 v36, v36
    v_cvt_pk_bf16_f32 v49, v34, v35
    s_waitcnt lgkmcnt(0)
    v_mfma_f32_32x32x16_bf16 v[16:31], v[104:107], v[88:91], 0
    v_exp_f32 v37, v37
    v_exp_f32 v38, v38
    v_cvt_pk_bf16_f32 v50, v36, v37
    v_exp_f32 v39, v39
    v_exp_f32 v40, v40
    v_mfma_f32_32x32x8bf16_1k v[16:31], v[112:113], v[92:93], v[16:31]
    v_cvt_pk_bf16_f32 v51, v38, v39
    s_setprio 0
    v_exp_f32 v41, v41
    v_exp_f32 v42, v42
    v_cvt_pk_bf16_f32 v52, v40, v41
    v_exp_f32 v43, v43
    v_exp_f32 v44, v44
    v_mfma_f32_32x32x16_bf16 v[72:87], v[120:123], v[48:51], v[72:87]
    v_cvt_pk_bf16_f32 v53, v42, v43
    v_exp_f32 v45, v45
    v_exp_f32 v46, v46
    v_cvt_pk_bf16_f32 v54, v44, v45
    v_exp_f32 v47, v47
    s_setprio 1
    v_exp_f32 v16, v16
    v_cvt_pk_bf16_f32 v55, v46, v47
    v_exp_f32 v17, v17
    v_exp_f32 v18, v18
    v_mfma_f32_32x32x16_bf16 v[72:87], v[128:131], v[52:55], v[72:87]
    v_cvt_pk_bf16_f32 v48, v16, v17
    s_mov_b64 exec, s[44:45]
    ds_read_b128 v[120:123], v4 offset:38400
    ds_read_b128 v[128:131], v12 offset:38400
    s_mov_b64 exec, -1
    ds_read_b128 v[108:111], v2 offset:38400
    ds_read_b64 v[114:115], v3 offset:38400
    v_exp_f32 v19, v19
    v_exp_f32 v20, v20
    v_cvt_pk_bf16_f32 v49, v18, v19
    v_mfma_f32_32x32x16_bf16 v[32:47], v[104:107], v[96:99], 0
    v_exp_f32 v21, v21
    v_exp_f32 v22, v22
    v_cvt_pk_bf16_f32 v50, v20, v21
    v_exp_f32 v23, v23
    v_exp_f32 v24, v24
    v_mfma_f32_32x32x8bf16_1k v[32:47], v[112:113], v[100:101], v[32:47]
    v_cvt_pk_bf16_f32 v51, v22, v23
    s_setprio 0
    v_exp_f32 v25, v25
    v_exp_f32 v26, v26
    v_cvt_pk_bf16_f32 v52, v24, v25
    v_exp_f32 v27, v27
    v_exp_f32 v28, v28
    v_mfma_f32_32x32x16_bf16 v[56:71], v[116:119], v[48:51], v[56:71]
    v_cvt_pk_bf16_f32 v53, v26, v27
    v_exp_f32 v29, v29
    v_exp_f32 v30, v30
    v_cvt_pk_bf16_f32 v54, v28, v29
    v_exp_f32 v31, v31
    s_setprio 1
    v_exp_f32 v32, v32
    v_cvt_pk_bf16_f32 v55, v30, v31
    v_exp_f32 v33, v33
    v_exp_f32 v34, v34
    v_mfma_f32_32x32x16_bf16 v[56:71], v[124:127], v[52:55], v[56:71]
    v_cvt_pk_bf16_f32 v48, v32, v33
    v_exp_f32 v35, v35
    v_exp_f32 v36, v36
    v_cvt_pk_bf16_f32 v49, v34, v35
    s_waitcnt lgkmcnt(0)
    v_mfma_f32_32x32x16_bf16 v[16:31], v[108:111], v[88:91], 0
    v_exp_f32 v37, v37
    v_exp_f32 v38, v38
    v_cvt_pk_bf16_f32 v50, v36, v37
    v_exp_f32 v39, v39
    v_exp_f32 v40, v40
    v_mfma_f32_32x32x8bf16_1k v[16:31], v[114:115], v[92:93], v[16:31]
    v_cvt_pk_bf16_f32 v51, v38, v39
    s_setprio 0
    v_exp_f32 v41, v41
    v_exp_f32 v42, v42
    v_cvt_pk_bf16_f32 v52, v40, v41
    v_exp_f32 v43, v43
    v_exp_f32 v44, v44
    v_mfma_f32_32x32x16_bf16 v[72:87], v[116:119], v[48:51], v[72:87]
    v_cvt_pk_bf16_f32 v53, v42, v43
    v_exp_f32 v45, v45
    v_exp_f32 v46, v46
    v_cvt_pk_bf16_f32 v54, v44, v45
    v_exp_f32 v47, v47
    s_barrier
    s_setprio 1
    v_exp_f32 v16, v16
    v_cvt_pk_bf16_f32 v55, v46, v47
    v_exp_f32 v17, v17
    v_exp_f32 v18, v18
    v_mfma_f32_32x32x16_bf16 v[72:87], v[124:127], v[52:55], v[72:87]
    v_cvt_pk_bf16_f32 v48, v16, v17
    s_mov_b64 exec, s[44:45]
    ds_read_b128 v[116:119], v4 offset:40960
    ds_read_b128 v[124:127], v12 offset:40960
    s_mov_b64 exec, -1
    ds_read_b128 v[104:107], v2 offset:40960
    ds_read_b64 v[112:113], v3 offset:40960
    v_exp_f32 v19, v19
    v_exp_f32 v20, v20
    v_cvt_pk_bf16_f32 v49, v18, v19
    v_mfma_f32_32x32x16_bf16 v[32:47], v[108:111], v[96:99], 0
    v_exp_f32 v21, v21
    v_exp_f32 v22, v22
    v_cvt_pk_bf16_f32 v50, v20, v21
    v_exp_f32 v23, v23
    v_exp_f32 v24, v24
    v_mfma_f32_32x32x8bf16_1k v[32:47], v[114:115], v[100:101], v[32:47]
    v_cvt_pk_bf16_f32 v51, v22, v23
    s_setprio 0
    buffer_load_dwordx4 v7, s[12:15], s27 offen lds
    s_add_u32 m0, m0, 81920
    s_add_u32 s3, s27, 81920
    buffer_load_dwordx4 v7, s[12:15], s3 offen lds
    s_add_u32 s27, s27, 4096
    s_sub_u32 m0, m0, 77824
    v_exp_f32 v25, v25
    v_exp_f32 v26, v26
    v_cvt_pk_bf16_f32 v52, v24, v25
    v_exp_f32 v27, v27
    v_exp_f32 v28, v28
    v_mfma_f32_32x32x16_bf16 v[56:71], v[120:123], v[48:51], v[56:71]
    v_cvt_pk_bf16_f32 v53, v26, v27
    v_exp_f32 v29, v29
    v_exp_f32 v30, v30
    v_cvt_pk_bf16_f32 v54, v28, v29
    v_exp_f32 v31, v31
    s_setprio 1
    v_exp_f32 v32, v32
    v_cvt_pk_bf16_f32 v55, v30, v31
    v_exp_f32 v33, v33
    v_exp_f32 v34, v34
    v_mfma_f32_32x32x16_bf16 v[56:71], v[128:131], v[52:55], v[56:71]
    v_cvt_pk_bf16_f32 v48, v32, v33
    v_exp_f32 v35, v35
    v_exp_f32 v36, v36
    v_cvt_pk_bf16_f32 v49, v34, v35
    s_waitcnt lgkmcnt(0)
    v_mfma_f32_32x32x16_bf16 v[16:31], v[104:107], v[88:91], 0
    v_exp_f32 v37, v37
    v_exp_f32 v38, v38
    v_cvt_pk_bf16_f32 v50, v36, v37
    v_exp_f32 v39, v39
    v_exp_f32 v40, v40
    v_mfma_f32_32x32x8bf16_1k v[16:31], v[112:113], v[92:93], v[16:31]
    v_cvt_pk_bf16_f32 v51, v38, v39
    s_setprio 0
    buffer_load_dwordx4 v7, s[12:15], s27 offen lds
    s_add_u32 m0, m0, 81920
    s_add_u32 s3, s27, 81920
    buffer_load_dwordx4 v7, s[12:15], s3 offen lds
    s_add_u32 s27, s27, 4096
    s_sub_u32 m0, m0, 77824
    v_exp_f32 v41, v41
    v_exp_f32 v42, v42
    v_cvt_pk_bf16_f32 v52, v40, v41
    v_exp_f32 v43, v43
    v_exp_f32 v44, v44
    v_mfma_f32_32x32x16_bf16 v[72:87], v[120:123], v[48:51], v[72:87]
    v_cvt_pk_bf16_f32 v53, v42, v43
    v_exp_f32 v45, v45
    v_exp_f32 v46, v46
    v_cvt_pk_bf16_f32 v54, v44, v45
    v_exp_f32 v47, v47
    s_setprio 1
    v_exp_f32 v16, v16
    v_cvt_pk_bf16_f32 v55, v46, v47
    v_exp_f32 v17, v17
    v_exp_f32 v18, v18
    v_mfma_f32_32x32x16_bf16 v[72:87], v[128:131], v[52:55], v[72:87]
    v_cvt_pk_bf16_f32 v48, v16, v17
    s_mov_b64 exec, s[44:45]
    ds_read_b128 v[120:123], v4 offset:43520
    ds_read_b128 v[128:131], v12 offset:43520
    s_mov_b64 exec, -1
    ds_read_b128 v[108:111], v2 offset:43520
    ds_read_b64 v[114:115], v3 offset:43520
    v_exp_f32 v19, v19
    v_exp_f32 v20, v20
    v_cvt_pk_bf16_f32 v49, v18, v19
    v_mfma_f32_32x32x16_bf16 v[32:47], v[104:107], v[96:99], 0
    v_exp_f32 v21, v21
    v_exp_f32 v22, v22
    v_cvt_pk_bf16_f32 v50, v20, v21
    v_exp_f32 v23, v23
    v_exp_f32 v24, v24
    v_mfma_f32_32x32x8bf16_1k v[32:47], v[112:113], v[100:101], v[32:47]
    v_cvt_pk_bf16_f32 v51, v22, v23
    s_setprio 0
    buffer_load_dwordx4 v7, s[12:15], s27 offen lds
    s_add_u32 m0, m0, 81920
    s_add_u32 s3, s27, 81920
    buffer_load_dwordx4 v7, s[12:15], s3 offen lds
    s_add_u32 s27, s27, 4096
    s_sub_u32 m0, m0, 77824
    v_exp_f32 v25, v25
    v_exp_f32 v26, v26
    v_cvt_pk_bf16_f32 v52, v24, v25
    v_exp_f32 v27, v27
    v_exp_f32 v28, v28
    v_mfma_f32_32x32x16_bf16 v[56:71], v[116:119], v[48:51], v[56:71]
    v_cvt_pk_bf16_f32 v53, v26, v27
    v_exp_f32 v29, v29
    v_exp_f32 v30, v30
    v_cvt_pk_bf16_f32 v54, v28, v29
    v_exp_f32 v31, v31
    s_setprio 1
    v_exp_f32 v32, v32
    v_cvt_pk_bf16_f32 v55, v30, v31
    v_exp_f32 v33, v33
    v_exp_f32 v34, v34
    v_mfma_f32_32x32x16_bf16 v[56:71], v[124:127], v[52:55], v[56:71]
    v_cvt_pk_bf16_f32 v48, v32, v33
    v_exp_f32 v35, v35
    v_exp_f32 v36, v36
    v_cvt_pk_bf16_f32 v49, v34, v35
    s_waitcnt lgkmcnt(0)
    v_mfma_f32_32x32x16_bf16 v[16:31], v[108:111], v[88:91], 0
    v_exp_f32 v37, v37
    v_exp_f32 v38, v38
    v_cvt_pk_bf16_f32 v50, v36, v37
    v_exp_f32 v39, v39
    v_exp_f32 v40, v40
    v_mfma_f32_32x32x8bf16_1k v[16:31], v[114:115], v[92:93], v[16:31]
    v_cvt_pk_bf16_f32 v51, v38, v39
    s_setprio 0
    buffer_load_dwordx4 v7, s[12:15], s27 offen lds
    s_add_u32 m0, m0, 81920
    s_add_u32 s3, s27, 81920
    buffer_load_dwordx4 v7, s[12:15], s3 offen lds
    s_add_u32 s27, s27, 4096
    s_sub_u32 m0, m0, 77824
    v_exp_f32 v41, v41
    v_exp_f32 v42, v42
    v_cvt_pk_bf16_f32 v52, v40, v41
    v_exp_f32 v43, v43
    v_exp_f32 v44, v44
    v_mfma_f32_32x32x16_bf16 v[72:87], v[116:119], v[48:51], v[72:87]
    v_cvt_pk_bf16_f32 v53, v42, v43
    v_exp_f32 v45, v45
    v_exp_f32 v46, v46
    v_cvt_pk_bf16_f32 v54, v44, v45
    v_exp_f32 v47, v47
    s_setprio 1
    v_exp_f32 v16, v16
    v_cvt_pk_bf16_f32 v55, v46, v47
    v_exp_f32 v17, v17
    v_exp_f32 v18, v18
    v_mfma_f32_32x32x16_bf16 v[72:87], v[124:127], v[52:55], v[72:87]
    v_cvt_pk_bf16_f32 v48, v16, v17
    s_mov_b64 exec, s[44:45]
    ds_read_b128 v[116:119], v4 offset:46080
    ds_read_b128 v[124:127], v12 offset:46080
    s_mov_b64 exec, -1
    ds_read_b128 v[104:107], v2 offset:46080
    ds_read_b64 v[112:113], v3 offset:46080
    v_exp_f32 v19, v19
    v_exp_f32 v20, v20
    v_cvt_pk_bf16_f32 v49, v18, v19
    v_mfma_f32_32x32x16_bf16 v[32:47], v[108:111], v[96:99], 0
    v_exp_f32 v21, v21
    v_exp_f32 v22, v22
    v_cvt_pk_bf16_f32 v50, v20, v21
    v_exp_f32 v23, v23
    v_exp_f32 v24, v24
    v_mfma_f32_32x32x8bf16_1k v[32:47], v[114:115], v[100:101], v[32:47]
    v_cvt_pk_bf16_f32 v51, v22, v23
    s_setprio 0
    v_exp_f32 v25, v25
    v_exp_f32 v26, v26
    v_cvt_pk_bf16_f32 v52, v24, v25
    v_exp_f32 v27, v27
    v_exp_f32 v28, v28
    v_mfma_f32_32x32x16_bf16 v[56:71], v[120:123], v[48:51], v[56:71]
    v_cvt_pk_bf16_f32 v53, v26, v27
    v_exp_f32 v29, v29
    v_exp_f32 v30, v30
    v_cvt_pk_bf16_f32 v54, v28, v29
    v_exp_f32 v31, v31
    s_setprio 1
    v_exp_f32 v32, v32
    v_cvt_pk_bf16_f32 v55, v30, v31
    v_exp_f32 v33, v33
    v_exp_f32 v34, v34
    v_mfma_f32_32x32x16_bf16 v[56:71], v[128:131], v[52:55], v[56:71]
    v_cvt_pk_bf16_f32 v48, v32, v33
    v_exp_f32 v35, v35
    v_exp_f32 v36, v36
    v_cvt_pk_bf16_f32 v49, v34, v35
    s_waitcnt lgkmcnt(0)
    v_mfma_f32_32x32x16_bf16 v[16:31], v[104:107], v[88:91], 0
    v_exp_f32 v37, v37
    v_exp_f32 v38, v38
    v_cvt_pk_bf16_f32 v50, v36, v37
    v_exp_f32 v39, v39
    v_exp_f32 v40, v40
    v_mfma_f32_32x32x8bf16_1k v[16:31], v[112:113], v[92:93], v[16:31]
    v_cvt_pk_bf16_f32 v51, v38, v39
    s_setprio 0
    v_exp_f32 v41, v41
    v_exp_f32 v42, v42
    v_cvt_pk_bf16_f32 v52, v40, v41
    v_exp_f32 v43, v43
    v_exp_f32 v44, v44
    v_mfma_f32_32x32x16_bf16 v[72:87], v[120:123], v[48:51], v[72:87]
    v_cvt_pk_bf16_f32 v53, v42, v43
    v_exp_f32 v45, v45
    v_exp_f32 v46, v46
    v_cvt_pk_bf16_f32 v54, v44, v45
    v_exp_f32 v47, v47
    s_setprio 1
    v_exp_f32 v16, v16
    v_cvt_pk_bf16_f32 v55, v46, v47
    v_exp_f32 v17, v17
    v_exp_f32 v18, v18
    v_mfma_f32_32x32x16_bf16 v[72:87], v[128:131], v[52:55], v[72:87]
    v_cvt_pk_bf16_f32 v48, v16, v17
    s_mov_b64 exec, s[44:45]
    ds_read_b128 v[120:123], v4 offset:48640
    ds_read_b128 v[128:131], v12 offset:48640
    s_mov_b64 exec, -1
    ds_read_b128 v[108:111], v2 offset:48640
    ds_read_b64 v[114:115], v3 offset:48640
    v_exp_f32 v19, v19
    v_exp_f32 v20, v20
    v_cvt_pk_bf16_f32 v49, v18, v19
    v_mfma_f32_32x32x16_bf16 v[32:47], v[104:107], v[96:99], 0
    v_exp_f32 v21, v21
    v_exp_f32 v22, v22
    v_cvt_pk_bf16_f32 v50, v20, v21
    v_exp_f32 v23, v23
    v_exp_f32 v24, v24
    v_mfma_f32_32x32x8bf16_1k v[32:47], v[112:113], v[100:101], v[32:47]
    v_cvt_pk_bf16_f32 v51, v22, v23
    s_setprio 0
    v_exp_f32 v25, v25
    v_exp_f32 v26, v26
    v_cvt_pk_bf16_f32 v52, v24, v25
    v_exp_f32 v27, v27
    v_exp_f32 v28, v28
    v_mfma_f32_32x32x16_bf16 v[56:71], v[116:119], v[48:51], v[56:71]
    v_cvt_pk_bf16_f32 v53, v26, v27
    v_exp_f32 v29, v29
    v_exp_f32 v30, v30
    v_cvt_pk_bf16_f32 v54, v28, v29
    v_exp_f32 v31, v31
    s_setprio 1
    v_exp_f32 v32, v32
    v_cvt_pk_bf16_f32 v55, v30, v31
    v_exp_f32 v33, v33
    v_exp_f32 v34, v34
    v_mfma_f32_32x32x16_bf16 v[56:71], v[124:127], v[52:55], v[56:71]
    v_cvt_pk_bf16_f32 v48, v32, v33
    v_exp_f32 v35, v35
    v_exp_f32 v36, v36
    v_cvt_pk_bf16_f32 v49, v34, v35
    s_waitcnt lgkmcnt(0)
    v_mfma_f32_32x32x16_bf16 v[16:31], v[108:111], v[88:91], 0
    v_exp_f32 v37, v37
    v_exp_f32 v38, v38
    v_cvt_pk_bf16_f32 v50, v36, v37
    v_exp_f32 v39, v39
    v_exp_f32 v40, v40
    v_mfma_f32_32x32x8bf16_1k v[16:31], v[114:115], v[92:93], v[16:31]
    v_cvt_pk_bf16_f32 v51, v38, v39
    s_setprio 0
    v_exp_f32 v41, v41
    v_exp_f32 v42, v42
    v_cvt_pk_bf16_f32 v52, v40, v41
    v_exp_f32 v43, v43
    v_exp_f32 v44, v44
    v_mfma_f32_32x32x16_bf16 v[72:87], v[116:119], v[48:51], v[72:87]
    v_cvt_pk_bf16_f32 v53, v42, v43
    v_exp_f32 v45, v45
    v_exp_f32 v46, v46
    v_cvt_pk_bf16_f32 v54, v44, v45
    v_exp_f32 v47, v47
    s_setprio 1
    v_exp_f32 v16, v16
    v_cvt_pk_bf16_f32 v55, v46, v47
    v_exp_f32 v17, v17
    v_exp_f32 v18, v18
    v_mfma_f32_32x32x16_bf16 v[72:87], v[124:127], v[52:55], v[72:87]
    v_cvt_pk_bf16_f32 v48, v16, v17
    s_mov_b64 exec, s[44:45]
    ds_read_b128 v[116:119], v4 offset:51200
    ds_read_b128 v[124:127], v12 offset:51200
    s_mov_b64 exec, -1
    ds_read_b128 v[104:107], v2 offset:51200
    ds_read_b64 v[112:113], v3 offset:51200
    v_exp_f32 v19, v19
    v_exp_f32 v20, v20
    v_cvt_pk_bf16_f32 v49, v18, v19
    v_mfma_f32_32x32x16_bf16 v[32:47], v[108:111], v[96:99], 0
    v_exp_f32 v21, v21
    v_exp_f32 v22, v22
    v_cvt_pk_bf16_f32 v50, v20, v21
    v_exp_f32 v23, v23
    v_exp_f32 v24, v24
    v_mfma_f32_32x32x8bf16_1k v[32:47], v[114:115], v[100:101], v[32:47]
    v_cvt_pk_bf16_f32 v51, v22, v23
    s_setprio 0
    v_exp_f32 v25, v25
    v_exp_f32 v26, v26
    v_cvt_pk_bf16_f32 v52, v24, v25
    v_exp_f32 v27, v27
    v_exp_f32 v28, v28
    v_mfma_f32_32x32x16_bf16 v[56:71], v[120:123], v[48:51], v[56:71]
    v_cvt_pk_bf16_f32 v53, v26, v27
    v_exp_f32 v29, v29
    v_exp_f32 v30, v30
    v_cvt_pk_bf16_f32 v54, v28, v29
    v_exp_f32 v31, v31
    s_setprio 1
    v_exp_f32 v32, v32
    v_cvt_pk_bf16_f32 v55, v30, v31
    v_exp_f32 v33, v33
    v_exp_f32 v34, v34
    v_mfma_f32_32x32x16_bf16 v[56:71], v[128:131], v[52:55], v[56:71]
    v_cvt_pk_bf16_f32 v48, v32, v33
    v_exp_f32 v35, v35
    v_exp_f32 v36, v36
    v_cvt_pk_bf16_f32 v49, v34, v35
    s_waitcnt lgkmcnt(0)
    v_mfma_f32_32x32x16_bf16 v[16:31], v[104:107], v[88:91], 0
    v_exp_f32 v37, v37
    v_exp_f32 v38, v38
    v_cvt_pk_bf16_f32 v50, v36, v37
    v_exp_f32 v39, v39
    v_exp_f32 v40, v40
    v_mfma_f32_32x32x8bf16_1k v[16:31], v[112:113], v[92:93], v[16:31]
    v_cvt_pk_bf16_f32 v51, v38, v39
    s_setprio 0
    v_exp_f32 v41, v41
    v_exp_f32 v42, v42
    v_cvt_pk_bf16_f32 v52, v40, v41
    v_exp_f32 v43, v43
    v_exp_f32 v44, v44
    v_mfma_f32_32x32x16_bf16 v[72:87], v[120:123], v[48:51], v[72:87]
    v_cvt_pk_bf16_f32 v53, v42, v43
    v_exp_f32 v45, v45
    v_exp_f32 v46, v46
    v_cvt_pk_bf16_f32 v54, v44, v45
    v_exp_f32 v47, v47
    s_branch L_p3_join
L_p3_img:
    s_barrier
    ds_read_b128 v[88:91], v13
    ds_read_b128 v[96:99], v13 offset:1024
    ds_read_b64 v[92:93], v14 offset:2048
    s_waitcnt lgkmcnt(0)
    v_mov_b32 v100, 0
    v_mov_b32 v101, 0
    s_nop 1
    v_permlane32_swap_b32 v92, v100
    v_permlane32_swap_b32 v93, v101
    ds_read_b128 v[104:107], v2 offset:0
    ds_read_b64 v[112:113], v3 offset:0
    s_mov_b64 exec, s[44:45]
    ds_read_b128 v[116:119], v4 offset:0
    ds_read_b128 v[124:127], v12 offset:0
    s_mov_b64 exec, -1
    s_waitcnt lgkmcnt(0)
    v_mfma_f32_32x32x16_bf16 v[16:31], v[104:107], v[88:91], 0
    v_mfma_f32_32x32x8bf16_1k v[16:31], v[112:113], v[92:93], v[16:31]
    s_nop 15
    s_setprio 1
    v_exp_f32 v16, v16
    v_exp_f32 v17, v17
    v_exp_f32 v18, v18
    v_cvt_pk_bf16_f32 v48, v16, v17
    s_mov_b64 exec, s[44:45]
    ds_read_b128 v[120:123], v4 offset:2560
    ds_read_b128 v[128:131], v12 offset:2560
    s_mov_b64 exec, -1
    ds_read_b128 v[108:111], v2 offset:2560
    ds_read_b64 v[114:115], v3 offset:2560
    v_exp_f32 v19, v19
    v_exp_f32 v20, v20
    v_cvt_pk_bf16_f32 v49, v18, v19
    v_mfma_f32_32x32x16_bf16 v[32:47], v[104:107], v[96:99], 0
    v_exp_f32 v21, v21
    v_exp_f32 v22, v22
    v_cvt_pk_bf16_f32 v50, v20, v21
    v_exp_f32 v23, v23
    v_exp_f32 v24, v24
    v_mfma_f32_32x32x8bf16_1k v[32:47], v[112:113], v[100:101], v[32:47]
    v_cvt_pk_bf16_f32 v51, v22, v23
    s_setprio 0
    v_exp_f32 v25, v25
    v_exp_f32 v26, v26
    v_cvt_pk_bf16_f32 v52, v24, v25
    v_exp_f32 v27, v27
    v_exp_f32 v28, v28
    v_mfma_f32_32x32x16_bf16 v[56:71], v[116:119], v[48:51], v[56:71]
    v_cvt_pk_bf16_f32 v53, v26, v27
    v_exp_f32 v29, v29
    v_exp_f32 v30, v30
    v_cvt_pk_bf16_f32 v54, v28, v29
    v_exp_f32 v31, v31
    s_setprio 1
    v_exp_f32 v32, v32
    v_cvt_pk_bf16_f32 v55, v30, v31
    v_exp_f32 v33, v33
    v_exp_f32 v34, v34
    v_mfma_f32_32x32x16_bf16 v[56:71], v[124:127], v[52:55], v[56:71]
    v_cvt_pk_bf16_f32 v48, v32, v33
    v_exp_f32 v35, v35
    v_exp_f32 v36, v36
    v_cvt_pk_bf16_f32 v49, v34, v35
    s_waitcnt lgkmcnt(0)
    v_mfma_f32_32x32x16_bf16 v[16:31], v[108:111], v[88:91], 0
    v_exp_f32 v37, v37
    v_exp_f32 v38, v38
    v_cvt_pk_bf16_f32 v50, v36, v37
    v_exp_f32 v39, v39
    v_exp_f32 v40, v40
    v_mfma_f32_32x32x8bf16_1k v[16:31], v[114:115], v[92:93], v[16:31]
    v_cvt_pk_bf16_f32 v51, v38, v39
    s_setprio 0
    v_exp_f32 v41, v41
    v_exp_f32 v42, v42
    v_cvt_pk_bf16_f32 v52, v40, v41
    v_exp_f32 v43, v43
    v_exp_f32 v44, v44
    v_mfma_f32_32x32x16_bf16 v[72:87], v[116:119], v[48:51], v[72:87]
    v_cvt_pk_bf16_f32 v53, v42, v43
    v_exp_f32 v45, v45
    v_exp_f32 v46, v46
    v_cvt_pk_bf16_f32 v54, v44, v45
    v_exp_f32 v47, v47
    s_setprio 1
    v_exp_f32 v16, v16
    v_cvt_pk_bf16_f32 v55, v46, v47
    v_exp_f32 v17, v17
    v_exp_f32 v18, v18
    v_mfma_f32_32x32x16_bf16 v[72:87], v[124:127], v[52:55], v[72:87]
    v_cvt_pk_bf16_f32 v48, v16, v17
    s_mov_b64 exec, s[44:45]
    ds_read_b128 v[116:119], v4 offset:5120
    ds_read_b128 v[124:127], v12 offset:5120
    s_mov_b64 exec, -1
    ds_read_b128 v[104:107], v2 offset:5120
    ds_read_b64 v[112:113], v3 offset:5120
    v_exp_f32 v19, v19
    v_exp_f32 v20, v20
    v_cvt_pk_bf16_f32 v49, v18, v19
    v_mfma_f32_32x32x16_bf16 v[32:47], v[108:111], v[96:99], 0
    v_exp_f32 v21, v21
    v_exp_f32 v22, v22
    v_cvt_pk_bf16_f32 v50, v20, v21
    v_exp_f32 v23, v23
    v_exp_f32 v24, v24
    v_mfma_f32_32x32x8bf16_1k v[32:47], v[114:115], v[100:101], v[32:47]
    v_cvt_pk_bf16_f32 v51, v22, v23
    s_setprio 0
    v_exp_f32 v25, v25
    v_exp_f32 v26, v26
    v_cvt_pk_bf16_f32 v52, v24, v25
    v_exp_f32 v27, v27
    v_exp_f32 v28, v28
    v_mfma_f32_32x32x16_bf16 v[56:71], v[120:123], v[48:51], v[56:71]
    v_cvt_pk_bf16_f32 v53, v26, v27
    v_exp_f32 v29, v29
    v_exp_f32 v30, v30
    v_cvt_pk_bf16_f32 v54, v28, v29
    v_exp_f32 v31, v31
    s_setprio 1
    v_exp_f32 v32, v32
    v_cvt_pk_bf16_f32 v55, v30, v31
    v_exp_f32 v33, v33
    v_exp_f32 v34, v34
    v_mfma_f32_32x32x16_bf16 v[56:71], v[128:131], v[52:55], v[56:71]
    v_cvt_pk_bf16_f32 v48, v32, v33
    v_exp_f32 v35, v35
    v_exp_f32 v36, v36
    v_cvt_pk_bf16_f32 v49, v34, v35
    s_waitcnt lgkmcnt(0)
    v_mfma_f32_32x32x16_bf16 v[16:31], v[104:107], v[88:91], 0
    v_exp_f32 v37, v37
    v_exp_f32 v38, v38
    v_cvt_pk_bf16_f32 v50, v36, v37
    v_exp_f32 v39, v39
    v_exp_f32 v40, v40
    v_mfma_f32_32x32x8bf16_1k v[16:31], v[112:113], v[92:93], v[16:31]
    v_cvt_pk_bf16_f32 v51, v38, v39
    s_setprio 0
    v_exp_f32 v41, v41
    v_exp_f32 v42, v42
    v_cvt_pk_bf16_f32 v52, v40, v41
    v_exp_f32 v43, v43
    v_exp_f32 v44, v44
    v_mfma_f32_32x32x16_bf16 v[72:87], v[120:123], v[48:51], v[72:87]
    v_cvt_pk_bf16_f32 v53, v42, v43
    v_exp_f32 v45, v45
    v_exp_f32 v46, v46
    v_cvt_pk_bf16_f32 v54, v44, v45
    v_exp_f32 v47, v47
    s_barrier
    s_setprio 1
    v_exp_f32 v16, v16
    v_cvt_pk_bf16_f32 v55, v46, v47
    v_exp_f32 v17, v17
    v_exp_f32 v18, v18
    v_mfma_f32_32x32x16_bf16 v[72:87], v[128:131], v[52:55], v[72:87]
    v_cvt_pk_bf16_f32 v48, v16, v17
    s_mov_b64 exec, s[44:45]
    ds_read_b128 v[120:123], v4 offset:7680
    ds_read_b128 v[128:131], v12 offset:7680
    s_mov_b64 exec, -1
    ds_read_b128 v[108:111], v2 offset:7680
    ds_read_b64 v[114:115], v3 offset:7680
    v_exp_f32 v19, v19
    v_exp_f32 v20, v20
    v_cvt_pk_bf16_f32 v49, v18, v19
    v_mfma_f32_32x32x16_bf16 v[32:47], v[104:107], v[96:99], 0
    v_exp_f32 v21, v21
    v_exp_f32 v22, v22
    v_cvt_pk_bf16_f32 v50, v20, v21
    v_exp_f32 v23, v23
    v_exp_f32 v24, v24
    v_mfma_f32_32x32x8bf16_1k v[32:47], v[112:113], v[100:101], v[32:47]
    v_cvt_pk_bf16_f32 v51, v22, v23
    s_setprio 0
    s_and_b32 s30, s4, 3
    s_lshl_b32 s30, s30, 12
    s_add_u32 m0, s30, 65536
    s_nop 0
    buffer_load_dwordx4 v240, s[16:19], 0 offen nt lds
    s_and_b32 s30, s4, 3
    s_lshl_b32 s30, s30, 12
    s_add_u32 m0, s30, 66560
    s_nop 0
    buffer_load_dwordx4 v241, s[16:19], 0 offen nt lds
    s_and_b32 s30, s4, 3
    s_lshl_b32 s30, s30, 12
    s_add_u32 m0, s30, 67584
    s_nop 0
    buffer_load_dwordx4 v242, s[32:35], 0 offen nt lds
    s_and_b32 s30, s4, 3
    s_lshl_b32 s30, s30, 12
    s_add_u32 m0, s30, 68608
    s_nop 0
    buffer_load_dwordx4 v243, s[32:35], 0 offen nt lds
    s_and_b32 s30, s4, 3
    s_lshl_b32 s30, s30, 12
    s_add_u32 m0, s30, 147456
    s_nop 0
    buffer_load_dwordx4 v244, s[36:39], 0 offen nt lds
    s_and_b32 s30, s4, 3
    s_lshl_b32 s30, s30, 12
    s_add_u32 m0, s30, 148480
    s_nop 0
    buffer_load_dwordx4 v245, s[36:39], 0 offen nt lds
    s_and_b32 s30, s4, 3
    s_lshl_b32 s30, s30, 12
    s_add_u32 m0, s30, 149504
    s_nop 0
    buffer_load_dwordx4 v246, s[40:43], 0 offen nt lds
    s_and_b32 s30, s4, 3
    s_lshl_b32 s30, s30, 12
    s_add_u32 m0, s30, 150528
    s_nop 0
    buffer_load_dwordx4 v247, s[40:43], 0 offen nt lds
    v_exp_f32 v25, v25
    v_exp_f32 v26, v26
    v_cvt_pk_bf16_f32 v52, v24, v25
    v_exp_f32 v27, v27
    v_exp_f32 v28, v28
    v_mfma_f32_32x32x16_bf16 v[56:71], v[116:119], v[48:51], v[56:71]
    v_cvt_pk_bf16_f32 v53, v26, v27
    v_exp_f32 v29, v29
    v_exp_f32 v30, v30
    v_cvt_pk_bf16_f32 v54, v28, v29
    v_exp_f32 v31, v31
    s_setprio 1
    v_exp_f32 v32, v32
    v_cvt_pk_bf16_f32 v55, v30, v31
    v_exp_f32 v33, v33
    v_exp_f32 v34, v34
    v_mfma_f32_32x32x16_bf16 v[56:71], v[124:127], v[52:55], v[56:71]
    v_cvt_pk_bf16_f32 v48, v32, v33
    v_exp_f32 v35, v35
    v_exp_f32 v36, v36
    v_cvt_pk_bf16_f32 v49, v34, v35
    s_waitcnt lgkmcnt(0)
    v_mfma_f32_32x32x16_bf16 v[16:31], v[108:111], v[88:91], 0
    v_exp_f32 v37, v37
    v_exp_f32 v38, v38
    v_cvt_pk_bf16_f32 v50, v36, v37
    v_exp_f32 v39, v39
    v_exp_f32 v40, v40
    v_mfma_f32_32x32x8bf16_1k v[16:31], v[114:115], v[92:93], v[16:31]
    v_cvt_pk_bf16_f32 v51, v38, v39
    s_setprio 0
    v_exp_f32 v41, v41
    v_exp_f32 v42, v42
    v_cvt_pk_bf16_f32 v52, v40, v41
    v_exp_f32 v43, v43
    v_exp_f32 v44, v44
    v_mfma_f32_32x32x16_bf16 v[72:87], v[116:119], v[48:51], v[72:87]
    v_cvt_pk_bf16_f32 v53, v42, v43
    v_exp_f32 v45, v45
    v_exp_f32 v46, v46
    v_cvt_pk_bf16_f32 v54, v44, v45
    v_exp_f32 v47, v47
    s_setprio 1
    v_exp_f32 v16, v16
    v_cvt_pk_bf16_f32 v55, v46, v47
    v_exp_f32 v17, v17
    v_exp_f32 v18, v18
    v_mfma_f32_32x32x16_bf16 v[72:87], v[124:127], v[52:55], v[72:87]
    v_cvt_pk_bf16_f32 v48, v16, v17
    s_mov_b64 exec, s[44:45]
    ds_read_b128 v[116:119], v4 offset:10240
    ds_read_b128 v[124:127], v12 offset:10240
    s_mov_b64 exec, -1
    ds_read_b128 v[104:107], v2 offset:10240
    ds_read_b64 v[112:113], v3 offset:10240
    v_exp_f32 v19, v19
    v_exp_f32 v20, v20
    v_cvt_pk_bf16_f32 v49, v18, v19
    v_mfma_f32_32x32x16_bf16 v[32:47], v[108:111], v[96:99], 0
    v_exp_f32 v21, v21
    v_exp_f32 v22, v22
    v_cvt_pk_bf16_f32 v50, v20, v21
    v_exp_f32 v23, v23
    v_exp_f32 v24, v24
    v_mfma_f32_32x32x8bf16_1k v[32:47], v[114:115], v[100:101], v[32:47]
    v_cvt_pk_bf16_f32 v51, v22, v23
    s_setprio 0
    v_exp_f32 v25, v25
    v_exp_f32 v26, v26
    v_cvt_pk_bf16_f32 v52, v24, v25
    v_exp_f32 v27, v27
    v_exp_f32 v28, v28
    v_mfma_f32_32x32x16_bf16 v[56:71], v[120:123], v[48:51], v[56:71]
    v_cvt_pk_bf16_f32 v53, v26, v27
    v_exp_f32 v29, v29
    v_exp_f32 v30, v30
    v_cvt_pk_bf16_f32 v54, v28, v29
    v_exp_f32 v31, v31
    s_setprio 1
    v_exp_f32 v32, v32
    v_cvt_pk_bf16_f32 v55, v30, v31
    v_exp_f32 v33, v33
    v_exp_f32 v34, v34
    v_mfma_f32_32x32x16_bf16 v[56:71], v[128:131], v[52:55], v[56:71]
    v_cvt_pk_bf16_f32 v48, v32, v33
    v_exp_f32 v35, v35
    v_exp_f32 v36, v36
    v_cvt_pk_bf16_f32 v49, v34, v35
    s_waitcnt lgkmcnt(0)
    v_mfma_f32_32x32x16_bf16 v[16:31], v[104:107], v[88:91], 0
    v_exp_f32 v37, v37
    v_exp_f32 v38, v38
    v_cvt_pk_bf16_f32 v50, v36, v37
    v_exp_f32 v39, v39
    v_exp_f32 v40, v40
    v_mfma_f32_32x32x8bf16_1k v[16:31], v[112:113], v[92:93], v[16:31]
    v_cvt_pk_bf16_f32 v51, v38, v39
    s_setprio 0
    v_exp_f32 v41, v41
    v_exp_f32 v42, v42
    v_cvt_pk_bf16_f32 v52, v40, v41
    v_exp_f32 v43, v43
    v_exp_f32 v44, v44
    v_mfma_f32_32x32x16_bf16 v[72:87], v[120:123], v[48:51], v[72:87]
    v_cvt_pk_bf16_f32 v53, v42, v43
    v_exp_f32 v45, v45
    v_exp_f32 v46, v46
    v_cvt_pk_bf16_f32 v54, v44, v45
    v_exp_f32 v47, v47
    s_setprio 1
    v_exp_f32 v16, v16
    v_cvt_pk_bf16_f32 v55, v46, v47
    v_exp_f32 v17, v17
    v_exp_f32 v18, v18
    v_mfma_f32_32x32x16_bf16 v[72:87], v[128:131], v[52:55], v[72:87]
    v_cvt_pk_bf16_f32 v48, v16, v17
    s_mov_b64 exec, s[44:45]
    ds_read_b128 v[120:123], v4 offset:12800
    ds_read_b128 v[128:131], v12 offset:12800
    s_mov_b64 exec, -1
    ds_read_b128 v[108:111], v2 offset:12800
    ds_read_b64 v[114:115], v3 offset:12800
    v_exp_f32 v19, v19
    v_exp_f32 v20, v20
    v_cvt_pk_bf16_f32 v49, v18, v19
    v_mfma_f32_32x32x16_bf16 v[32:47], v[104:107], v[96:99], 0
    v_exp_f32 v21, v21
    v_exp_f32 v22, v22
    v_cvt_pk_bf16_f32 v50, v20, v21
    v_exp_f32 v23, v23
    v_exp_f32 v24, v24
    v_mfma_f32_32x32x8bf16_1k v[32:47], v[112:113], v[100:101], v[32:47]
    v_cvt_pk_bf16_f32 v51, v22, v23
    s_setprio 0
    v_exp_f32 v25, v25
    v_exp_f32 v26, v26
    v_cvt_pk_bf16_f32 v52, v24, v25
    v_exp_f32 v27, v27
    v_exp_f32 v28, v28
    v_mfma_f32_32x32x16_bf16 v[56:71], v[116:119], v[48:51], v[56:71]
    v_cvt_pk_bf16_f32 v53, v26, v27
    v_exp_f32 v29, v29
    v_exp_f32 v30, v30
    v_cvt_pk_bf16_f32 v54, v28, v29
    v_exp_f32 v31, v31
    s_setprio 1
    v_exp_f32 v32, v32
    v_cvt_pk_bf16_f32 v55, v30, v31
    v_exp_f32 v33, v33
    v_exp_f32 v34, v34
    v_mfma_f32_32x32x16_bf16 v[56:71], v[124:127], v[52:55], v[56:71]
    v_cvt_pk_bf16_f32 v48, v32, v33
    v_exp_f32 v35, v35
    v_exp_f32 v36, v36
    v_cvt_pk_bf16_f32 v49, v34, v35
    s_waitcnt lgkmcnt(0)
    v_mfma_f32_32x32x16_bf16 v[16:31], v[108:111], v[88:91], 0
    v_exp_f32 v37, v37
    v_exp_f32 v38, v38
    v_cvt_pk_bf16_f32 v50, v36, v37
    v_exp_f32 v39, v39
    v_exp_f32 v40, v40
    v_mfma_f32_32x32x8bf16_1k v[16:31], v[114:115], v[92:93], v[16:31]
    v_cvt_pk_bf16_f32 v51, v38, v39
    s_setprio 0
    v_exp_f32 v41, v41
    v_exp_f32 v42, v42
    v_cvt_pk_bf16_f32 v52, v40, v41
    v_exp_f32 v43, v43
    v_exp_f32 v44, v44
    v_mfma_f32_32x32x16_bf16 v[72:87], v[116:119], v[48:51], v[72:87]
    v_cvt_pk_bf16_f32 v53, v42, v43
    v_exp_f32 v45, v45
    v_exp_f32 v46, v46
    v_cvt_pk_bf16_f32 v54, v44, v45
    v_exp_f32 v47, v47
    s_barrier
    s_setprio 1
    v_exp_f32 v16, v16
    v_cvt_pk_bf16_f32 v55, v46, v47
    v_exp_f32 v17, v17
    v_exp_f32 v18, v18
    v_mfma_f32_32x32x16_bf16 v[72:87], v[124:127], v[52:55], v[72:87]
    v_cvt_pk_bf16_f32 v48, v16, v17
    s_mov_b64 exec, s[44:45]
    ds_read_b128 v[116:119], v4 offset:15360
    ds_read_b128 v[124:127], v12 offset:15360
    s_mov_b64 exec, -1
    ds_read_b128 v[104:107], v2 offset:15360
    ds_read_b64 v[112:113], v3 offset:15360
    v_exp_f32 v19, v19
    v_exp_f32 v20, v20
    v_cvt_pk_bf16_f32 v49, v18, v19
    v_mfma_f32_32x32x16_bf16 v[32:47], v[108:111], v[96:99], 0
    v_exp_f32 v21, v21
    v_exp_f32 v22, v22
    v_cvt_pk_bf16_f32 v50, v20, v21
    v_exp_f32 v23, v23
    v_exp_f32 v24, v24
    v_mfma_f32_32x32x8bf16_1k v[32:47], v[114:115], v[100:101], v[32:47]
    v_cvt_pk_bf16_f32 v51, v22, v23
    s_setprio 0
    v_exp_f32 v25, v25
    v_exp_f32 v26, v26
    v_cvt_pk_bf16_f32 v52, v24, v25
    v_exp_f32 v27, v27
    v_exp_f32 v28, v28
    v_mfma_f32_32x32x16_bf16 v[56:71], v[120:123], v[48:51], v[56:71]
    v_cvt_pk_bf16_f32 v53, v26, v27
    v_exp_f32 v29, v29
    v_exp_f32 v30, v30
    v_cvt_pk_bf16_f32 v54, v28, v29
    v_exp_f32 v31, v31
    s_setprio 1
    v_exp_f32 v32, v32
    v_cvt_pk_bf16_f32 v55, v30, v31
    v_exp_f32 v33, v33
    v_exp_f32 v34, v34
    v_mfma_f32_32x32x16_bf16 v[56:71], v[128:131], v[52:55], v[56:71]
    v_cvt_pk_bf16_f32 v48, v32, v33
    v_exp_f32 v35, v35
    v_exp_f32 v36, v36
    v_cvt_pk_bf16_f32 v49, v34, v35
    s_waitcnt lgkmcnt(0)
    v_mfma_f32_32x32x16_bf16 v[16:31], v[104:107], v[88:91], 0
    v_exp_f32 v37, v37
    v_exp_f32 v38, v38
    v_cvt_pk_bf16_f32 v50, v36, v37
    v_exp_f32 v39, v39
    v_exp_f32 v40, v40
    v_mfma_f32_32x32x8bf16_1k v[16:31], v[112:113], v[92:93], v[16:31]
    v_cvt_pk_bf16_f32 v51, v38, v39
    s_setprio 0
    v_exp_f32 v41, v41
    v_exp_f32 v42, v42
    v_cvt_pk_bf16_f32 v52, v40, v41
    v_exp_f32 v43, v43
    v_exp_f32 v44, v44
    v_mfma_f32_32x32x16_bf16 v[72:87], v[120:123], v[48:51], v[72:87]
    v_cvt_pk_bf16_f32 v53, v42, v43
    v_exp_f32 v45, v45
    v_exp_f32 v46, v46
    v_cvt_pk_bf16_f32 v54, v44, v45
    v_exp_f32 v47, v47
    s_setprio 1
    v_exp_f32 v16, v16
    v_cvt_pk_bf16_f32 v55, v46, v47
    v_exp_f32 v17, v17
    v_exp_f32 v18, v18
    v_mfma_f32_32x32x16_bf16 v[72:87], v[128:131], v[52:55], v[72:87]
    v_cvt_pk_bf16_f32 v48, v16, v17
    s_mov_b64 exec, s[44:45]
    ds_read_b128 v[120:123], v4 offset:17920
    ds_read_b128 v[128:131], v12 offset:17920
    s_mov_b64 exec, -1
    ds_read_b128 v[108:111], v2 offset:17920
    ds_read_b64 v[114:115], v3 offset:17920
    v_exp_f32 v19, v19
    v_exp_f32 v20, v20
    v_cvt_pk_bf16_f32 v49, v18, v19
    v_mfma_f32_32x32x16_bf16 v[32:47], v[104:107], v[96:99], 0
    v_exp_f32 v21, v21
    v_exp_f32 v22, v22
    v_cvt_pk_bf16_f32 v50, v20, v21
    v_exp_f32 v23, v23
    v_exp_f32 v24, v24
    v_mfma_f32_32x32x8bf16_1k v[32:47], v[112:113], v[100:101], v[32:47]
    v_cvt_pk_bf16_f32 v51, v22, v23
    s_setprio 0
    v_exp_f32 v25, v25
    v_exp_f32 v26, v26
    v_cvt_pk_bf16_f32 v52, v24, v25
    v_exp_f32 v27, v27
    v_exp_f32 v28, v28
    v_mfma_f32_32x32x16_bf16 v[56:71], v[116:119], v[48:51], v[56:71]
    v_cvt_pk_bf16_f32 v53, v26, v27
    v_exp_f32 v29, v29
    v_exp_f32 v30, v30
    v_cvt_pk_bf16_f32 v54, v28, v29
    v_exp_f32 v31, v31
    s_setprio 1
    v_exp_f32 v32, v32
    v_cvt_pk_bf16_f32 v55, v30, v31
    v_exp_f32 v33, v33
    v_exp_f32 v34, v34
    v_mfma_f32_32x32x16_bf16 v[56:71], v[124:127], v[52:55], v[56:71]
    v_cvt_pk_bf16_f32 v48, v32, v33
    v_exp_f32 v35, v35
    v_exp_f32 v36, v36
    v_cvt_pk_bf16_f32 v49, v34, v35
    s_waitcnt lgkmcnt(0)
    v_mfma_f32_32x32x16_bf16 v[16:31], v[108:111], v[88:91], 0
    v_exp_f32 v37, v37
    v_exp_f32 v38, v38
    v_cvt_pk_bf16_f32 v50, v36, v37
    v_exp_f32 v39, v39
    v_exp_f32 v40, v40
    v_mfma_f32_32x32x8bf16_1k v[16:31], v[114:115], v[92:93], v[16:31]
    v_cvt_pk_bf16_f32 v51, v38, v39
    s_setprio 0
    v_exp_f32 v41, v41
    v_exp_f32 v42, v42
    v_cvt_pk_bf16_f32 v52, v40, v41
    v_exp_f32 v43, v43
    v_exp_f32 v44, v44
    v_mfma_f32_32x32x16_bf16 v[72:87], v[116:119], v[48:51], v[72:87]
    v_cvt_pk_bf16_f32 v53, v42, v43
    v_exp_f32 v45, v45
    v_exp_f32 v46, v46
    v_cvt_pk_bf16_f32 v54, v44, v45
    v_exp_f32 v47, v47
    s_cmp_eq_u32 s4, 4
    s_cbranch_scc0 L_p3_nocc0
    s_and_b32 s30, s2, 15
    s_add_u32 s30, s30, 136
    s_lshl_b32 s30, s30, 7
    s_add_u32 s30, s30, 31719424
    v_mov_b32 v250, s30
    global_load_dword v252, v250, s[6:7] sc1
L_p3_nocc0:
    s_setprio 1
    v_exp_f32 v16, v16
    v_cvt_pk_bf16_f32 v55, v46, v47
    v_exp_f32 v17, v17
    v_exp_f32 v18, v18
    v_mfma_f32_32x32x16_bf16 v[72:87], v[124:127], v[52:55], v[72:87]
    v_cvt_pk_bf16_f32 v48, v16, v17
    s_mov_b64 exec, s[44:45]
    ds_read_b128 v[116:119], v4 offset:20480
    ds_read_b128 v[124:127], v12 offset:20480
    s_mov_b64 exec, -1
    ds_read_b128 v[104:107], v2 offset:20480
    ds_read_b64 v[112:113], v3 offset:20480
    v_exp_f32 v19, v19
    v_exp_f32 v20, v20
    v_cvt_pk_bf16_f32 v49, v18, v19
    v_mfma_f32_32x32x16_bf16 v[32:47], v[108:111], v[96:99], 0
    v_exp_f32 v21, v21
    v_exp_f32 v22, v22
    v_cvt_pk_bf16_f32 v50, v20, v21
    v_exp_f32 v23, v23
    v_exp_f32 v24, v24
    v_mfma_f32_32x32x8bf16_1k v[32:47], v[114:115], v[100:101], v[32:47]
    v_cvt_pk_bf16_f32 v51, v22, v23
    s_setprio 0
    v_exp_f32 v25, v25
    v_exp_f32 v26, v26
    v_cvt_pk_bf16_f32 v52, v24, v25
    v_exp_f32 v27, v27
    v_exp_f32 v28, v28
    v_mfma_f32_32x32x16_bf16 v[56:71], v[120:123], v[48:51], v[56:71]
    v_cvt_pk_bf16_f32 v53, v26, v27
    v_exp_f32 v29, v29
    v_exp_f32 v30, v30
    v_cvt_pk_bf16_f32 v54, v28, v29
    v_exp_f32 v31, v31
    s_setprio 1
    v_exp_f32 v32, v32
    v_cvt_pk_bf16_f32 v55, v30, v31
    v_exp_f32 v33, v33
    v_exp_f32 v34, v34
    v_mfma_f32_32x32x16_bf16 v[56:71], v[128:131], v[52:55], v[56:71]
    v_cvt_pk_bf16_f32 v48, v32, v33
    v_exp_f32 v35, v35
    v_exp_f32 v36, v36
    v_cvt_pk_bf16_f32 v49, v34, v35
    s_waitcnt lgkmcnt(0)
    v_mfma_f32_32x32x16_bf16 v[16:31], v[104:107], v[88:91], 0
    v_exp_f32 v37, v37
    v_exp_f32 v38, v38
    v_cvt_pk_bf16_f32 v50, v36, v37
    v_exp_f32 v39, v39
    v_exp_f32 v40, v40
    v_mfma_f32_32x32x8bf16_1k v[16:31], v[112:113], v[92:93], v[16:31]
    v_cvt_pk_bf16_f32 v51, v38, v39
    s_setprio 0
    v_exp_f32 v41, v41
    v_exp_f32 v42, v42
    v_cvt_pk_bf16_f32 v52, v40, v41
    v_exp_f32 v43, v43
    v_exp_f32 v44, v44
    v_mfma_f32_32x32x16_bf16 v[72:87], v[120:123], v[48:51], v[72:87]
    v_cvt_pk_bf16_f32 v53, v42, v43
    v_exp_f32 v45, v45
    v_exp_f32 v46, v46
    v_cvt_pk_bf16_f32 v54, v44, v45
    v_exp_f32 v47, v47
    s_setprio 1
    v_exp_f32 v16, v16
    v_cvt_pk_bf16_f32 v55, v46, v47
    v_exp_f32 v17, v17
    v_exp_f32 v18, v18
    v_mfma_f32_32x32x16_bf16 v[72:87], v[128:131], v[52:55], v[72:87]
    v_cvt_pk_bf16_f32 v48, v16, v17
    s_mov_b64 exec, s[44:45]
    ds_read_b128 v[120:123], v4 offset:23040
    ds_read_b128 v[128:131], v12 offset:23040
    s_mov_b64 exec, -1
    ds_read_b128 v[108:111], v2 offset:23040
    ds_read_b64 v[114:115], v3 offset:23040
    v_exp_f32 v19, v19
    v_exp_f32 v20, v20
    v_cvt_pk_bf16_f32 v49, v18, v19
    v_mfma_f32_32x32x16_bf16 v[32:47], v[104:107], v[96:99], 0
    v_exp_f32 v21, v21
    v_exp_f32 v22, v22
    v_cvt_pk_bf16_f32 v50, v20, v21
    v_exp_f32 v23, v23
    v_exp_f32 v24, v24
    v_mfma_f32_32x32x8bf16_1k v[32:47], v[112:113], v[100:101], v[32:47]
    v_cvt_pk_bf16_f32 v51, v22, v23
    s_setprio 0
    v_exp_f32 v25, v25
    v_exp_f32 v26, v26
    v_cvt_pk_bf16_f32 v52, v24, v25
    v_exp_f32 v27, v27
    v_exp_f32 v28, v28
    v_mfma_f32_32x32x16_bf16 v[56:71], v[116:119], v[48:51], v[56:71]
    v_cvt_pk_bf16_f32 v53, v26, v27
    v_exp_f32 v29, v29
    v_exp_f32 v30, v30
    v_cvt_pk_bf16_f32 v54, v28, v29
    v_exp_f32 v31, v31
    s_setprio 1
    v_exp_f32 v32, v32
    v_cvt_pk_bf16_f32 v55, v30, v31
    v_exp_f32 v33, v33
    v_exp_f32 v34, v34
    v_mfma_f32_32x32x16_bf16 v[56:71], v[124:127], v[52:55], v[56:71]
    v_cvt_pk_bf16_f32 v48, v32, v33
    v_exp_f32 v35, v35
    v_exp_f32 v36, v36
    v_cvt_pk_bf16_f32 v49, v34, v35
    s_waitcnt lgkmcnt(0)
    v_mfma_f32_32x32x16_bf16 v[16:31], v[108:111], v[88:91], 0
    v_exp_f32 v37, v37
    v_exp_f32 v38, v38
    v_cvt_pk_bf16_f32 v50, v36, v37
    v_exp_f32 v39, v39
    v_exp_f32 v40, v40
    v_mfma_f32_32x32x8bf16_1k v[16:31], v[114:115], v[92:93], v[16:31]
    v_cvt_pk_bf16_f32 v51, v38, v39
    s_setprio 0
    v_exp_f32 v41, v41
    v_exp_f32 v42, v42
    v_cvt_pk_bf16_f32 v52, v40, v41
    v_exp_f32 v43, v43
    v_exp_f32 v44, v44
    v_mfma_f32_32x32x16_bf16 v[72:87], v[116:119], v[48:51], v[72:87]
    v_cvt_pk_bf16_f32 v53, v42, v43
    v_exp_f32 v45, v45
    v_exp_f32 v46, v46
    v_cvt_pk_bf16_f32 v54, v44, v45
    v_exp_f32 v47, v47
    s_setprio 1
    v_exp_f32 v16, v16
    v_cvt_pk_bf16_f32 v55, v46, v47
    v_exp_f32 v17, v17
    v_exp_f32 v18, v18
    v_mfma_f32_32x32x16_bf16 v[72:87], v[124:127], v[52:55], v[72:87]
    v_cvt_pk_bf16_f32 v48, v16, v17
    s_mov_b64 exec, s[44:45]
    ds_read_b128 v[116:119], v4 offset:25600
    ds_read_b128 v[124:127], v12 offset:25600
    s_mov_b64 exec, -1
    ds_read_b128 v[104:107], v2 offset:25600
    ds_read_b64 v[112:113], v3 offset:25600
    v_exp_f32 v19, v19
    v_exp_f32 v20, v20
    v_cvt_pk_bf16_f32 v49, v18, v19
    v_mfma_f32_32x32x16_bf16 v[32:47], v[108:111], v[96:99], 0
    v_exp_f32 v21, v21
    v_exp_f32 v22, v22
    v_cvt_pk_bf16_f32 v50, v20, v21
    v_exp_f32 v23, v23
    v_exp_f32 v24, v24
    v_mfma_f32_32x32x8bf16_1k v[32:47], v[114:115], v[100:101], v[32:47]
    v_cvt_pk_bf16_f32 v51, v22, v23
    s_setprio 0
    v_exp_f32 v25, v25
    v_exp_f32 v26, v26
    v_cvt_pk_bf16_f32 v52, v24, v25
    v_exp_f32 v27, v27
    v_exp_f32 v28, v28
    v_mfma_f32_32x32x16_bf16 v[56:71], v[120:123], v[48:51], v[56:71]
    v_cvt_pk_bf16_f32 v53, v26, v27
    v_exp_f32 v29, v29
    v_exp_f32 v30, v30
    v_cvt_pk_bf16_f32 v54, v28, v29
    v_exp_f32 v31, v31
    s_setprio 1
    v_exp_f32 v32, v32
    v_cvt_pk_bf16_f32 v55, v30, v31
    v_exp_f32 v33, v33
    v_exp_f32 v34, v34
    v_mfma_f32_32x32x16_bf16 v[56:71], v[128:131], v[52:55], v[56:71]
    v_cvt_pk_bf16_f32 v48, v32, v33
    v_exp_f32 v35, v35
    v_exp_f32 v36, v36
    v_cvt_pk_bf16_f32 v49, v34, v35
    s_waitcnt lgkmcnt(0)
    v_mfma_f32_32x32x16_bf16 v[16:31], v[104:107], v[88:91], 0
    v_exp_f32 v37, v37
    v_exp_f32 v38, v38
    v_cvt_pk_bf16_f32 v50, v36, v37
    v_exp_f32 v39, v39
    v_exp_f32 v40, v40
    v_mfma_f32_32x32x8bf16_1k v[16:31], v[112:113], v[92:93], v[16:31]
    v_cvt_pk_bf16_f32 v51, v38, v39
    s_setprio 0
    v_exp_f32 v41, v41
    v_exp_f32 v42, v42
    v_cvt_pk_bf16_f32 v52, v40, v41
    v_exp_f32 v43, v43
    v_exp_f32 v44, v44
    v_mfma_f32_32x32x16_bf16 v[72:87], v[120:123], v[48:51], v[72:87]
    v_cvt_pk_bf16_f32 v53, v42, v43
    v_exp_f32 v45, v45
    v_exp_f32 v46, v46
    v_cvt_pk_bf16_f32 v54, v44, v45
    v_exp_f32 v47, v47
    s_cmp_eq_u32 s4, 4
    s_cbranch_scc0 L_p3_nocc
    s_waitcnt vmcnt(0)
    v_cmp_le_u32 vcc, 40, v252
    s_nop 0
    s_cmp_eq_u64 vcc, -1
    s_cbranch_scc1 L_p3_nocc
    s_and_b32 s47, s2, 15
    s_mov_b32 s3, 136
    s_add_u32 s3, s3, s47
    v_mov_b32 v250, s3
    v_mov_b32 v251, 40
    v_lshlrev_b32 v250, 7, v250
    v_add_u32 v250, 31719424, v250
    s_mov_b32 s3, 0
L_poll_p3c:
    global_load_dword v252, v250, s[6:7] sc1
    s_waitcnt vmcnt(0)
    v_cmp_ge_u32 vcc, v252, v251
    s_nop 0
    s_cmp_eq_u64 vcc, -1
    s_cbranch_scc1 L_polled_p3c
    s_add_u32 s3, s3, 1
    s_cmp_lt_u32 s3, 0x200000
    s_cbranch_scc1 L_poll_p3c
L_polled_p3c:
L_p3_nocc:
    s_setprio 1
    v_exp_f32 v16, v16
    v_cvt_pk_bf16_f32 v55, v46, v47
    v_exp_f32 v17, v17
    v_exp_f32 v18, v18
    v_mfma_f32_32x32x16_bf16 v[72:87], v[128:131], v[52:55], v[72:87]
    v_cvt_pk_bf16_f32 v48, v16, v17
    s_mov_b64 exec, s[44:45]
    ds_read_b128 v[120:123], v4 offset:28160
    ds_read_b128 v[128:131], v12 offset:28160
    s_mov_b64 exec, -1
    ds_read_b128 v[108:111], v2 offset:28160
    ds_read_b64 v[114:115], v3 offset:28160
    v_exp_f32 v19, v19
    v_exp_f32 v20, v20
    v_cvt_pk_bf16_f32 v49, v18, v19
    v_mfma_f32_32x32x16_bf16 v[32:47], v[104:107], v[96:99], 0
    v_exp_f32 v21, v21
    v_exp_f32 v22, v22
    v_cvt_pk_bf16_f32 v50, v20, v21
    v_exp_f32 v23, v23
    v_exp_f32 v24, v24
    v_mfma_f32_32x32x8bf16_1k v[32:47], v[112:113], v[100:101], v[32:47]
    v_cvt_pk_bf16_f32 v51, v22, v23
    s_setprio 0
    v_exp_f32 v25, v25
    v_exp_f32 v26, v26
    v_cvt_pk_bf16_f32 v52, v24, v25
    v_exp_f32 v27, v27
    v_exp_f32 v28, v28
    v_mfma_f32_32x32x16_bf16 v[56:71], v[116:119], v[48:51], v[56:71]
    v_cvt_pk_bf16_f32 v53, v26, v27
    v_exp_f32 v29, v29
    v_exp_f32 v30, v30
    v_cvt_pk_bf16_f32 v54, v28, v29
    v_exp_f32 v31, v31
    s_setprio 1
    v_exp_f32 v32, v32
    v_cvt_pk_bf16_f32 v55, v30, v31
    v_exp_f32 v33, v33
    v_exp_f32 v34, v34
    v_mfma_f32_32x32x16_bf16 v[56:71], v[124:127], v[52:55], v[56:71]
    v_cvt_pk_bf16_f32 v48, v32, v33
    v_exp_f32 v35, v35
    v_exp_f32 v36, v36
    v_cvt_pk_bf16_f32 v49, v34, v35
    s_waitcnt lgkmcnt(0)
    v_mfma_f32_32x32x16_bf16 v[16:31], v[108:111], v[88:91], 0
    v_exp_f32 v37, v37
    v_exp_f32 v38, v38
    v_cvt_pk_bf16_f32 v50, v36, v37
    v_exp_f32 v39, v39
    v_exp_f32 v40, v40
    v_mfma_f32_32x32x8bf16_1k v[16:31], v[114:115], v[92:93], v[16:31]
    v_cvt_pk_bf16_f32 v51, v38, v39
    s_setprio 0
    v_exp_f32 v41, v41
    v_exp_f32 v42, v42
    v_cvt_pk_bf16_f32 v52, v40, v41
    v_exp_f32 v43, v43
    v_exp_f32 v44, v44
    v_mfma_f32_32x32x16_bf16 v[72:87], v[116:119], v[48:51], v[72:87]
    v_cvt_pk_bf16_f32 v53, v42, v43
    v_exp_f32 v45, v45
    v_exp_f32 v46, v46
    v_cvt_pk_bf16_f32 v54, v44, v45
    v_exp_f32 v47, v47
    s_barrier
    v_mov_b32 v5, v176
    buffer_load_dwordx4 v[176:179], v5, s[12:15], 0 offen
    buffer_load_dwordx4 v[180:183], v5, s[12:15], 0 offen offset:16
    v_mov_b32 v5, v184
    buffer_load_dwordx4 v[184:187], v5, s[12:15], 0 offen
    buffer_load_dwordx4 v[188:191], v5, s[12:15], 0 offen offset:16
    s_mov_b32 s40, 12288
    s_setprio 1
    v_exp_f32 v16, v16
    v_cvt_pk_bf16_f32 v55, v46, v47
    v_exp_f32 v17, v17
    v_exp_f32 v18, v18
    v_mfma_f32_32x32x16_bf16 v[72:87], v[124:127], v[52:55], v[72:87]
    v_cvt_pk_bf16_f32 v48, v16, v17
    s_mov_b64 exec, s[44:45]
    ds_read_b128 v[116:119], v4 offset:30720
    ds_read_b128 v[124:127], v12 offset:30720
    s_mov_b64 exec, -1
    ds_read_b128 v[104:107], v2 offset:30720
    ds_read_b64 v[112:113], v3 offset:30720
    v_exp_f32 v19, v19
    v_exp_f32 v20, v20
    v_cvt_pk_bf16_f32 v49, v18, v19
    v_mfma_f32_32x32x16_bf16 v[32:47], v[108:111], v[96:99], 0
    v_exp_f32 v21, v21
    v_exp_f32 v22, v22
    v_cvt_pk_bf16_f32 v50, v20, v21
    v_exp_f32 v23, v23
    v_exp_f32 v24, v24
    v_mfma_f32_32x32x8bf16_1k v[32:47], v[114:115], v[100:101], v[32:47]
    v_cvt_pk_bf16_f32 v51, v22, v23
    s_setprio 0
    v_exp_f32 v25, v25
    v_exp_f32 v26, v26
    v_cvt_pk_bf16_f32 v52, v24, v25
    v_exp_f32 v27, v27
    v_exp_f32 v28, v28
    v_mfma_f32_32x32x16_bf16 v[56:71], v[120:123], v[48:51], v[56:71]
    v_cvt_pk_bf16_f32 v53, v26, v27
    v_exp_f32 v29, v29
    v_exp_f32 v30, v30
    v_cvt_pk_bf16_f32 v54, v28, v29
    v_exp_f32 v31, v31
    s_setprio 1
    v_exp_f32 v32, v32
    v_cvt_pk_bf16_f32 v55, v30, v31
    v_exp_f32 v33, v33
    v_exp_f32 v34, v34
    v_mfma_f32_32x32x16_bf16 v[56:71], v[128:131], v[52:55], v[56:71]
    v_cvt_pk_bf16_f32 v48, v32, v33
    v_exp_f32 v35, v35
    v_exp_f32 v36, v36
    v_cvt_pk_bf16_f32 v49, v34, v35
    s_waitcnt lgkmcnt(0)
    v_mfma_f32_32x32x16_bf16 v[16:31], v[104:107], v[88:91], 0
    v_exp_f32 v37, v37
    v_exp_f32 v38, v38
    v_cvt_pk_bf16_f32 v50, v36, v37
    v_exp_f32 v39, v39
    v_exp_f32 v40, v40
    v_mfma_f32_32x32x8bf16_1k v[16:31], v[112:113], v[92:93], v[16:31]
    v_cvt_pk_bf16_f32 v51, v38, v39
    s_setprio 0
    v_exp_f32 v41, v41
    v_exp_f32 v42, v42
    v_cvt_pk_bf16_f32 v52, v40, v41
    v_exp_f32 v43, v43
    v_exp_f32 v44, v44
    v_mfma_f32_32x32x16_bf16 v[72:87], v[120:123], v[48:51], v[72:87]
    v_cvt_pk_bf16_f32 v53, v42, v43
    v_exp_f32 v45, v45
    v_exp_f32 v46, v46
    v_cvt_pk_bf16_f32 v54, v44, v45
    v_exp_f32 v47, v47
    s_setprio 1
    v_exp_f32 v16, v16
    v_cvt_pk_bf16_f32 v55, v46, v47
    v_exp_f32 v17, v17
    v_exp_f32 v18, v18
    v_mfma_f32_32x32x16_bf16 v[72:87], v[128:131], v[52:55], v[72:87]
    v_cvt_pk_bf16_f32 v48, v16, v17
    s_mov_b64 exec, s[44:45]
    ds_read_b128 v[120:123], v4 offset:33280
    ds_read_b128 v[128:131], v12 offset:33280
    s_mov_b64 exec, -1
    ds_read_b128 v[108:111], v2 offset:33280
    ds_read_b64 v[114:115], v3 offset:33280
    v_exp_f32 v19, v19
    v_exp_f32 v20, v20
    v_cvt_pk_bf16_f32 v49, v18, v19
    v_mfma_f32_32x32x16_bf16 v[32:47], v[104:107], v[96:99], 0
    v_exp_f32 v21, v21
    v_exp_f32 v22, v22
    v_cvt_pk_bf16_f32 v50, v20, v21
    v_exp_f32 v23, v23
    v_exp_f32 v24, v24
    v_mfma_f32_32x32x8bf16_1k v[32:47], v[112:113], v[100:101], v[32:47]
    v_cvt_pk_bf16_f32 v51, v22, v23
    s_setprio 0
    v_exp_f32 v25, v25
    v_exp_f32 v26, v26
    v_cvt_pk_bf16_f32 v52, v24, v25
    v_exp_f32 v27, v27
    v_exp_f32 v28, v28
    v_mfma_f32_32x32x16_bf16 v[56:71], v[116:119], v[48:51], v[56:71]
    v_cvt_pk_bf16_f32 v53, v26, v27
    v_exp_f32 v29, v29
    v_exp_f32 v30, v30
    v_cvt_pk_bf16_f32 v54, v28, v29
    v_exp_f32 v31, v31
    s_setprio 1
    v_exp_f32 v32, v32
    v_cvt_pk_bf16_f32 v55, v30, v31
    v_exp_f32 v33, v33
    v_exp_f32 v34, v34
    v_mfma_f32_32x32x16_bf16 v[56:71], v[124:127], v[52:55], v[56:71]
    v_cvt_pk_bf16_f32 v48, v32, v33
    v_exp_f32 v35, v35
    v_exp_f32 v36, v36
    v_cvt_pk_bf16_f32 v49, v34, v35
    s_waitcnt lgkmcnt(0)
    v_mfma_f32_32x32x16_bf16 v[16:31], v[108:111], v[88:91], 0
    v_exp_f32 v37, v37
    v_exp_f32 v38, v38
    v_cvt_pk_bf16_f32 v50, v36, v37
    v_exp_f32 v39, v39
    v_exp_f32 v40, v40
    v_mfma_f32_32x32x8bf16_1k v[16:31], v[114:115], v[92:93], v[16:31]
    v_cvt_pk_bf16_f32 v51, v38, v39
    s_setprio 0
    v_exp_f32 v41, v41
    v_exp_f32 v42, v42
    v_cvt_pk_bf16_f32 v52, v40, v41
    v_exp_f32 v43, v43
    v_exp_f32 v44, v44
    v_mfma_f32_32x32x16_bf16 v[72:87], v[116:119], v[48:51], v[72:87]
    v_cvt_pk_bf16_f32 v53, v42, v43
    v_exp_f32 v45, v45
    v_exp_f32 v46, v46
    v_cvt_pk_bf16_f32 v54, v44, v45
    v_exp_f32 v47, v47
    s_setprio 1
    v_exp_f32 v16, v16
    v_cvt_pk_bf16_f32 v55, v46, v47
    v_exp_f32 v17, v17
    v_exp_f32 v18, v18
    v_mfma_f32_32x32x16_bf16 v[72:87], v[124:127], v[52:55], v[72:87]
    v_cvt_pk_bf16_f32 v48, v16, v17
    s_mov_b64 exec, s[44:45]
    ds_read_b128 v[116:119], v4 offset:35840
    ds_read_b128 v[124:127], v12 offset:35840
    s_mov_b64 exec, -1
    ds_read_b128 v[104:107], v2 offset:35840
    ds_read_b64 v[112:113], v3 offset:35840
    v_exp_f32 v19, v19
    v_exp_f32 v20, v20
    v_cvt_pk_bf16_f32 v49, v18, v19
    v_mfma_f32_32x32x16_bf16 v[32:47], v[108:111], v[96:99], 0
    v_exp_f32 v21, v21
    v_exp_f32 v22, v22
    v_cvt_pk_bf16_f32 v50, v20, v21
    v_exp_f32 v23, v23
    v_exp_f32 v24, v24
    v_mfma_f32_32x32x8bf16_1k v[32:47], v[114:115], v[100:101], v[32:47]
    v_cvt_pk_bf16_f32 v51, v22, v23
    s_setprio 0
    s_waitcnt vmcnt(0)
    s_mov_b32 s43, 0x07060302
    ds_read_b64_tr_b16 v[192:193], v172 offset:0
    ds_read_b64_tr_b16 v[194:195], v172 offset:512
    ds_read_b64_tr_b16 v[196:197], v172 offset:32
    ds_read_b64_tr_b16 v[198:199], v172 offset:544
    ds_read_b64_tr_b16 v[200:201], v172 offset:64
    ds_read_b64_tr_b16 v[202:203], v172 offset:576
    ds_read_b64_tr_b16 v[204:205], v172 offset:96
    ds_read_b64_tr_b16 v[206:207], v172 offset:608
    v_perm_b32 v176, v177, v176, s43
    v_perm_b32 v177, v179, v178, s43
    v_perm_b32 v178, v181, v180, s43
    v_perm_b32 v179, v183, v182, s43
    v_exp_f32 v25, v25
    v_exp_f32 v26, v26
    v_cvt_pk_bf16_f32 v52, v24, v25
    v_exp_f32 v27, v27
    v_exp_f32 v28, v28
    v_mfma_f32_32x32x16_bf16 v[56:71], v[120:123], v[48:51], v[56:71]
    v_cvt_pk_bf16_f32 v53, v26, v27
    v_exp_f32 v29, v29
    v_exp_f32 v30, v30
    v_cvt_pk_bf16_f32 v54, v28, v29
    v_exp_f32 v31, v31
    s_setprio 1
    v_exp_f32 v32, v32
    v_cvt_pk_bf16_f32 v55, v30, v31
    v_exp_f32 v33, v33
    v_exp_f32 v34, v34
    v_mfma_f32_32x32x16_bf16 v[56:71], v[128:131], v[52:55], v[56:71]
    v_cvt_pk_bf16_f32 v48, v32, v33
    v_exp_f32 v35, v35
    v_exp_f32 v36, v36
    v_cvt_pk_bf16_f32 v49, v34, v35
    s_waitcnt lgkmcnt(0)
    v_mfma_f32_32x32x16_bf16 v[16:31], v[104:107], v[88:91], 0
    v_exp_f32 v37, v37
    v_exp_f32 v38, v38
    v_cvt_pk_bf16_f32 v50, v36, v37
    v_exp_f32 v39, v39
    v_exp_f32 v40, v40
    v_mfma_f32_32x32x8bf16_1k v[16:31], v[112:113], v[92:93], v[16:31]
    v_cvt_pk_bf16_f32 v51, v38, v39
    s_setprio 0
    ds_read_b64_tr_b16 v[208:209], v173 offset:0
    ds_read_b64_tr_b16 v[210:211], v173 offset:512
    ds_read_b64_tr_b16 v[212:213], v173 offset:32
    ds_read_b64_tr_b16 v[214:215], v173 offset:544
    ds_read_b64_tr_b16 v[216:217], v173 offset:64
    ds_read_b64_tr_b16 v[218:219], v173 offset:576
    ds_read_b64_tr_b16 v[220:221], v173 offset:96
    ds_read_b64_tr_b16 v[222:223], v173 offset:608
    v_perm_b32 v184, v185, v184, s43
    v_perm_b32 v185, v187, v186, s43
    v_perm_b32 v186, v189, v188, s43
    v_perm_b32 v187, v191, v190, s43
    v_exp_f32 v41, v41
    v_exp_f32 v42, v42
    v_cvt_pk_bf16_f32 v52, v40, v41
    v_exp_f32 v43, v43
    v_exp_f32 v44, v44
    v_mfma_f32_32x32x16_bf16 v[72:87], v[120:123], v[48:51], v[72:87]
    v_cvt_pk_bf16_f32 v53, v42, v43
    v_exp_f32 v45, v45
    v_exp_f32 v46, v46
    v_cvt_pk_bf16_f32 v54, v44, v45
    v_exp_f32 v47, v47
    s_setprio 1
    v_exp_f32 v16, v16
    v_cvt_pk_bf16_f32 v55, v46, v47
    v_exp_f32 v17, v17
    v_exp_f32 v18, v18
    v_mfma_f32_32x32x16_bf16 v[72:87], v[128:131], v[52:55], v[72:87]
    v_cvt_pk_bf16_f32 v48, v16, v17
    s_mov_b64 exec, s[44:45]
    ds_read_b128 v[120:123], v4 offset:38400
    ds_read_b128 v[128:131], v12 offset:38400
    s_mov_b64 exec, -1
    ds_read_b128 v[108:111], v2 offset:38400
    ds_read_b64 v[114:115], v3 offset:38400
    v_exp_f32 v19, v19
    v_exp_f32 v20, v20
    v_cvt_pk_bf16_f32 v49, v18, v19
    v_mfma_f32_32x32x16_bf16 v[32:47], v[104:107], v[96:99], 0
    v_exp_f32 v21, v21
    v_exp_f32 v22, v22
    v_cvt_pk_bf16_f32 v50, v20, v21
    v_exp_f32 v23, v23
    v_exp_f32 v24, v24
    v_mfma_f32_32x32x8bf16_1k v[32:47], v[112:113], v[100:101], v[32:47]
    v_cvt_pk_bf16_f32 v51, v22, v23
    s_setprio 0
    v_exp_f32 v25, v25
    v_exp_f32 v26, v26
    v_cvt_pk_bf16_f32 v52, v24, v25
    v_exp_f32 v27, v27
    v_exp_f32 v28, v28
    v_mfma_f32_32x32x16_bf16 v[56:71], v[116:119], v[48:51], v[56:71]
    v_cvt_pk_bf16_f32 v53, v26, v27
    v_exp_f32 v29, v29
    v_exp_f32 v30, v30
    v_cvt_pk_bf16_f32 v54, v28, v29
    v_exp_f32 v31, v31
    s_setprio 1
    v_exp_f32 v32, v32
    v_cvt_pk_bf16_f32 v55, v30, v31
    v_exp_f32 v33, v33
    v_exp_f32 v34, v34
    v_mfma_f32_32x32x16_bf16 v[56:71], v[124:127], v[52:55], v[56:71]
    v_cvt_pk_bf16_f32 v48, v32, v33
    v_exp_f32 v35, v35
    v_exp_f32 v36, v36
    v_cvt_pk_bf16_f32 v49, v34, v35
    s_waitcnt lgkmcnt(0)
    v_mfma_f32_32x32x16_bf16 v[16:31], v[108:111], v[88:91], 0
    v_exp_f32 v37, v37
    v_exp_f32 v38, v38
    v_cvt_pk_bf16_f32 v50, v36, v37
    v_exp_f32 v39, v39
    v_exp_f32 v40, v40
    v_mfma_f32_32x32x8bf16_1k v[16:31], v[114:115], v[92:93], v[16:31]
    v_cvt_pk_bf16_f32 v51, v38, v39
    s_setprio 0
    buffer_store_dwordx4 v[192:195], v164, s[12:15], 0 offen sc1
    v_mfma_f32_32x32x16_bf16 v[132:147], v[176:179], v[192:195], 0
    v_exp_f32 v41, v41
    v_exp_f32 v42, v42
    v_cvt_pk_bf16_f32 v52, v40, v41
    v_exp_f32 v43, v43
    v_exp_f32 v44, v44
    v_mfma_f32_32x32x16_bf16 v[72:87], v[116:119], v[48:51], v[72:87]
    v_cvt_pk_bf16_f32 v53, v42, v43
    v_exp_f32 v45, v45
    v_exp_f32 v46, v46
    v_cvt_pk_bf16_f32 v54, v44, v45
    v_exp_f32 v47, v47
    s_barrier
    s_setprio 1
    v_exp_f32 v16, v16
    v_cvt_pk_bf16_f32 v55, v46, v47
    v_exp_f32 v17, v17
    v_exp_f32 v18, v18
    v_mfma_f32_32x32x16_bf16 v[72:87], v[124:127], v[52:55], v[72:87]
    v_cvt_pk_bf16_f32 v48, v16, v17
    s_mov_b64 exec, s[44:45]
    ds_read_b128 v[116:119], v4 offset:40960
    ds_read_b128 v[124:127], v12 offset:40960
    s_mov_b64 exec, -1
    ds_read_b128 v[104:107], v2 offset:40960
    ds_read_b64 v[112:113], v3 offset:40960
    v_exp_f32 v19, v19
    v_exp_f32 v20, v20
    v_cvt_pk_bf16_f32 v49, v18, v19
    v_mfma_f32_32x32x16_bf16 v[32:47], v[108:111], v[96:99], 0
    v_exp_f32 v21, v21
    v_exp_f32 v22, v22
    v_cvt_pk_bf16_f32 v50, v20, v21
    v_exp_f32 v23, v23
    v_exp_f32 v24, v24
    v_mfma_f32_32x32x8bf16_1k v[32:47], v[114:115], v[100:101], v[32:47]
    v_cvt_pk_bf16_f32 v51, v22, v23
    s_setprio 0
    buffer_store_dwordx4 v[196:199], v165, s[12:15], 0 offen sc1
    v_mfma_f32_32x32x16_bf16 v[148:163], v[176:179], v[196:199], 0
    s_mov_b32 exec_hi, 0
    buffer_atomic_add_f32 v132, v174, s[12:15], 0 offen offset:0
    buffer_atomic_add_f32 v133, v174, s[12:15], s40 offen offset:0
    s_mov_b32 exec_hi, -1
    v_exp_f32 v25, v25
    v_exp_f32 v26, v26
    v_cvt_pk_bf16_f32 v52, v24, v25
    v_exp_f32 v27, v27
    v_exp_f32 v28, v28
    v_mfma_f32_32x32x16_bf16 v[56:71], v[120:123], v[48:51], v[56:71]
    v_cvt_pk_bf16_f32 v53, v26, v27
    v_exp_f32 v29, v29
    v_exp_f32 v30, v30
    v_cvt_pk_bf16_f32 v54, v28, v29
    v_exp_f32 v31, v31
    s_setprio 1
    v_exp_f32 v32, v32
    v_cvt_pk_bf16_f32 v55, v30, v31
    v_exp_f32 v33, v33
    v_exp_f32 v34, v34
    v_mfma_f32_32x32x16_bf16 v[56:71], v[128:131], v[52:55], v[56:71]
    v_cvt_pk_bf16_f32 v48, v32, v33
    v_exp_f32 v35, v35
    v_exp_f32 v36, v36
    v_cvt_pk_bf16_f32 v49, v34, v35
    s_waitcnt lgkmcnt(0)
    v_mfma_f32_32x32x16_bf16 v[16:31], v[104:107], v[88:91], 0
    v_exp_f32 v37, v37
    v_exp_f32 v38, v38
    v_cvt_pk_bf16_f32 v50, v36, v37
    v_exp_f32 v39, v39
    v_exp_f32 v40, v40
    v_mfma_f32_32x32x8bf16_1k v[16:31], v[112:113], v[92:93], v[16:31]
    v_cvt_pk_bf16_f32 v51, v38, v39
    s_setprio 0
    buffer_store_dwordx4 v[200:203], v166, s[12:15], 0 offen sc1
    v_mfma_f32_32x32x16_bf16 v[224:239], v[176:179], v[200:203], 0
    s_mov_b32 exec_hi, 0
    buffer_atomic_add_f32 v148, v174, s[12:15], 0 offen offset:128
    buffer_atomic_add_f32 v149, v174, s[12:15], s40 offen offset:128
    s_mov_b32 exec_hi, -1
    v_exp_f32 v41, v41
    v_exp_f32 v42, v42
    v_cvt_pk_bf16_f32 v52, v40, v41
    v_exp_f32 v43, v43
    v_exp_f32 v44, v44
    v_mfma_f32_32x32x16_bf16 v[72:87], v[120:123], v[48:51], v[72:87]
    v_cvt_pk_bf16_f32 v53, v42, v43
    v_exp_f32 v45, v45
    v_exp_f32 v46, v46
    v_cvt_pk_bf16_f32 v54, v44, v45
    v_exp_f32 v47, v47
    s_setprio 1
    v_exp_f32 v16, v16
    v_cvt_pk_bf16_f32 v55, v46, v47
    v_exp_f32 v17, v17
    v_exp_f32 v18, v18
    v_mfma_f32_32x32x16_bf16 v[72:87], v[128:131], v[52:55], v[72:87]
    v_cvt_pk_bf16_f32 v48, v16, v17
    s_mov_b64 exec, s[44:45]
    ds_read_b128 v[120:123], v4 offset:43520
    ds_read_b128 v[128:131], v12 offset:43520
    s_mov_b64 exec, -1
    ds_read_b128 v[108:111], v2 offset:43520
    ds_read_b64 v[114:115], v3 offset:43520
    v_exp_f32 v19, v19
    v_exp_f32 v20, v20
    v_cvt_pk_bf16_f32 v49, v18, v19
    v_mfma_f32_32x32x16_bf16 v[32:47], v[104:107], v[96:99], 0
    v_exp_f32 v21, v21
    v_exp_f32 v22, v22
    v_cvt_pk_bf16_f32 v50, v20, v21
    v_exp_f32 v23, v23
    v_exp_f32 v24, v24
    v_mfma_f32_32x32x8bf16_1k v[32:47], v[112:113], v[100:101], v[32:47]
    v_cvt_pk_bf16_f32 v51, v22, v23
    s_setprio 0
    buffer_store_dwordx4 v[204:207], v167, s[12:15], 0 offen sc1
    v_mfma_f32_32x32x16_bf16 v[240:255], v[176:179], v[204:207], 0
    s_mov_b32 exec_hi, 0
    buffer_atomic_add_f32 v224, v174, s[12:15], 0 offen offset:256
    buffer_atomic_add_f32 v225, v174, s[12:15], s40 offen offset:256
    s_mov_b32 exec_hi, -1
    v_exp_f32 v25, v25
    v_exp_f32 v26, v26
    v_cvt_pk_bf16_f32 v52, v24, v25
    v_exp_f32 v27, v27
    v_exp_f32 v28, v28
    v_mfma_f32_32x32x16_bf16 v[56:71], v[116:119], v[48:51], v[56:71]
    v_cvt_pk_bf16_f32 v53, v26, v27
    v_exp_f32 v29, v29
    v_exp_f32 v30, v30
    v_cvt_pk_bf16_f32 v54, v28, v29
    v_exp_f32 v31, v31
    s_setprio 1
    v_exp_f32 v32, v32
    v_cvt_pk_bf16_f32 v55, v30, v31
    v_exp_f32 v33, v33
    v_exp_f32 v34, v34
    v_mfma_f32_32x32x16_bf16 v[56:71], v[124:127], v[52:55], v[56:71]
    v_cvt_pk_bf16_f32 v48, v32, v33
    v_exp_f32 v35, v35
    v_exp_f32 v36, v36
    v_cvt_pk_bf16_f32 v49, v34, v35
    s_waitcnt lgkmcnt(0)
    v_mfma_f32_32x32x16_bf16 v[16:31], v[108:111], v[88:91], 0
    v_exp_f32 v37, v37
    v_exp_f32 v38, v38
    v_cvt_pk_bf16_f32 v50, v36, v37
    v_exp_f32 v39, v39
    v_exp_f32 v40, v40
    v_mfma_f32_32x32x8bf16_1k v[16:31], v[114:115], v[92:93], v[16:31]
    v_cvt_pk_bf16_f32 v51, v38, v39
    s_setprio 0
    buffer_store_dwordx4 v[208:211], v168, s[12:15], 0 offen sc1
    v_mfma_f32_32x32x16_bf16 v[132:147], v[184:187], v[208:211], 0
    s_mov_b32 exec_hi, 0
    buffer_atomic_add_f32 v240, v174, s[12:15], 0 offen offset:384
    buffer_atomic_add_f32 v241, v174, s[12:15], s40 offen offset:384
    s_mov_b32 exec_hi, -1
    v_exp_f32 v41, v41
    v_exp_f32 v42, v42
    v_cvt_pk_bf16_f32 v52, v40, v41
    v_exp_f32 v43, v43
    v_exp_f32 v44, v44
    v_mfma_f32_32x32x16_bf16 v[72:87], v[116:119], v[48:51], v[72:87]
    v_cvt_pk_bf16_f32 v53, v42, v43
    v_exp_f32 v45, v45
    v_exp_f32 v46, v46
    v_cvt_pk_bf16_f32 v54, v44, v45
    v_exp_f32 v47, v47
    s_setprio 1
    v_exp_f32 v16, v16
    v_cvt_pk_bf16_f32 v55, v46, v47
    v_exp_f32 v17, v17
    v_exp_f32 v18, v18
    v_mfma_f32_32x32x16_bf16 v[72:87], v[124:127], v[52:55], v[72:87]
    v_cvt_pk_bf16_f32 v48, v16, v17
    s_mov_b64 exec, s[44:45]
    ds_read_b128 v[116:119], v4 offset:46080
    ds_read_b128 v[124:127], v12 offset:46080
    s_mov_b64 exec, -1
    ds_read_b128 v[104:107], v2 offset:46080
    ds_read_b64 v[112:113], v3 offset:46080
    v_exp_f32 v19, v19
    v_exp_f32 v20, v20
    v_cvt_pk_bf16_f32 v49, v18, v19
    v_mfma_f32_32x32x16_bf16 v[32:47], v[108:111], v[96:99], 0
    v_exp_f32 v21, v21
    v_exp_f32 v22, v22
    v_cvt_pk_bf16_f32 v50, v20, v21
    v_exp_f32 v23, v23
    v_exp_f32 v24, v24
    v_mfma_f32_32x32x8bf16_1k v[32:47], v[114:115], v[100:101], v[32:47]
    v_cvt_pk_bf16_f32 v51, v22, v23
    s_setprio 0
    buffer_store_dwordx4 v[212:215], v169, s[12:15], 0 offen sc1
    v_mfma_f32_32x32x16_bf16 v[148:163], v[184:187], v[212:215], 0
    s_mov_b32 exec_hi, 0
    buffer_atomic_add_f32 v132, v175, s[12:15], 0 offen offset:0
    buffer_atomic_add_f32 v133, v175, s[12:15], s40 offen offset:0
    s_mov_b32 exec_hi, -1
    v_exp_f32 v25, v25
    v_exp_f32 v26, v26
    v_cvt_pk_bf16_f32 v52, v24, v25
    v_exp_f32 v27, v27
    v_exp_f32 v28, v28
    v_mfma_f32_32x32x16_bf16 v[56:71], v[120:123], v[48:51], v[56:71]
    v_cvt_pk_bf16_f32 v53, v26, v27
    v_exp_f32 v29, v29
    v_exp_f32 v30, v30
    v_cvt_pk_bf16_f32 v54, v28, v29
    v_exp_f32 v31, v31
    s_setprio 1
    v_exp_f32 v32, v32
    v_cvt_pk_bf16_f32 v55, v30, v31
    v_exp_f32 v33, v33
    v_exp_f32 v34, v34
    v_mfma_f32_32x32x16_bf16 v[56:71], v[128:131], v[52:55], v[56:71]
    v_cvt_pk_bf16_f32 v48, v32, v33
    v_exp_f32 v35, v35
    v_exp_f32 v36, v36
    v_cvt_pk_bf16_f32 v49, v34, v35
    s_waitcnt lgkmcnt(0)
    v_mfma_f32_32x32x16_bf16 v[16:31], v[104:107], v[88:91], 0
    v_exp_f32 v37, v37
    v_exp_f32 v38, v38
    v_cvt_pk_bf16_f32 v50, v36, v37
    v_exp_f32 v39, v39
    v_exp_f32 v40, v40
    v_mfma_f32_32x32x8bf16_1k v[16:31], v[112:113], v[92:93], v[16:31]
    v_cvt_pk_bf16_f32 v51, v38, v39
    s_setprio 0
    buffer_store_dwordx4 v[216:219], v170, s[12:15], 0 offen sc1
    v_mfma_f32_32x32x16_bf16 v[224:239], v[184:187], v[216:219], 0
    s_mov_b32 exec_hi, 0
    buffer_atomic_add_f32 v148, v175, s[12:15], 0 offen offset:128
    buffer_atomic_add_f32 v149, v175, s[12:15], s40 offen offset:128
    s_mov_b32 exec_hi, -1
    v_exp_f32 v41, v41
    v_exp_f32 v42, v42
    v_cvt_pk_bf16_f32 v52, v40, v41
    v_exp_f32 v43, v43
    v_exp_f32 v44, v44
    v_mfma_f32_32x32x16_bf16 v[72:87], v[120:123], v[48:51], v[72:87]
    v_cvt_pk_bf16_f32 v53, v42, v43
    v_exp_f32 v45, v45
    v_exp_f32 v46, v46
    v_cvt_pk_bf16_f32 v54, v44, v45
    v_exp_f32 v47, v47
    s_setprio 1
    v_exp_f32 v16, v16
    v_cvt_pk_bf16_f32 v55, v46, v47
    v_exp_f32 v17, v17
    v_exp_f32 v18, v18
    v_mfma_f32_32x32x16_bf16 v[72:87], v[128:131], v[52:55], v[72:87]
    v_cvt_pk_bf16_f32 v48, v16, v17
    s_mov_b64 exec, s[44:45]
    ds_read_b128 v[120:123], v4 offset:48640
    ds_read_b128 v[128:131], v12 offset:48640
    s_mov_b64 exec, -1
    ds_read_b128 v[108:111], v2 offset:48640
    ds_read_b64 v[114:115], v3 offset:48640
    v_exp_f32 v19, v19
    v_exp_f32 v20, v20
    v_cvt_pk_bf16_f32 v49, v18, v19
    v_mfma_f32_32x32x16_bf16 v[32:47], v[104:107], v[96:99], 0
    v_exp_f32 v21, v21
    v_exp_f32 v22, v22
    v_cvt_pk_bf16_f32 v50, v20, v21
    v_exp_f32 v23, v23
    v_exp_f32 v24, v24
    v_mfma_f32_32x32x8bf16_1k v[32:47], v[112:113], v[100:101], v[32:47]
    v_cvt_pk_bf16_f32 v51, v22, v23
    s_setprio 0
    buffer_store_dwordx4 v[220:223], v171, s[12:15], 0 offen sc1
    v_mfma_f32_32x32x16_bf16 v[240:255], v[184:187], v[220:223], 0
    s_mov_b32 exec_hi, 0
    buffer_atomic_add_f32 v224, v175, s[12:15], 0 offen offset:256
    buffer_atomic_add_f32 v225, v175, s[12:15], s40 offen offset:256
    s_mov_b32 exec_hi, -1
    v_exp_f32 v25, v25
    v_exp_f32 v26, v26
    v_cvt_pk_bf16_f32 v52, v24, v25
    v_exp_f32 v27, v27
    v_exp_f32 v28, v28
    v_mfma_f32_32x32x16_bf16 v[56:71], v[116:119], v[48:51], v[56:71]
    v_cvt_pk_bf16_f32 v53, v26, v27
    v_exp_f32 v29, v29
    v_exp_f32 v30, v30
    v_cvt_pk_bf16_f32 v54, v28, v29
    v_exp_f32 v31, v31
    s_setprio 1
    v_exp_f32 v32, v32
    v_cvt_pk_bf16_f32 v55, v30, v31
    v_exp_f32 v33, v33
    v_exp_f32 v34, v34
    v_mfma_f32_32x32x16_bf16 v[56:71], v[124:127], v[52:55], v[56:71]
    v_cvt_pk_bf16_f32 v48, v32, v33
    v_exp_f32 v35, v35
    v_exp_f32 v36, v36
    v_cvt_pk_bf16_f32 v49, v34, v35
    s_waitcnt lgkmcnt(0)
    v_mfma_f32_32x32x16_bf16 v[16:31], v[108:111], v[88:91], 0
    v_exp_f32 v37, v37
    v_exp_f32 v38, v38
    v_cvt_pk_bf16_f32 v50, v36, v37
    v_exp_f32 v39, v39
    v_exp_f32 v40, v40
    v_mfma_f32_32x32x8bf16_1k v[16:31], v[114:115], v[92:93], v[16:31]
    v_cvt_pk_bf16_f32 v51, v38, v39
    s_setprio 0
    s_mov_b32 exec_hi, 0
    buffer_atomic_add_f32 v240, v175, s[12:15], 0 offen offset:384
    buffer_atomic_add_f32 v241, v175, s[12:15], s40 offen offset:384
    s_mov_b32 exec_hi, -1
    v_exp_f32 v41, v41
    v_exp_f32 v42, v42
    v_cvt_pk_bf16_f32 v52, v40, v41
    v_exp_f32 v43, v43
    v_exp_f32 v44, v44
    v_mfma_f32_32x32x16_bf16 v[72:87], v[116:119], v[48:51], v[72:87]
    v_cvt_pk_bf16_f32 v53, v42, v43
    v_exp_f32 v45, v45
    v_exp_f32 v46, v46
    v_cvt_pk_bf16_f32 v54, v44, v45
    v_exp_f32 v47, v47
    s_setprio 1
    v_exp_f32 v16, v16
    v_cvt_pk_bf16_f32 v55, v46, v47
    v_exp_f32 v17, v17
    v_exp_f32 v18, v18
    v_mfma_f32_32x32x16_bf16 v[72:87], v[124:127], v[52:55], v[72:87]
    v_cvt_pk_bf16_f32 v48, v16, v17
    s_mov_b64 exec, s[44:45]
    ds_read_b128 v[116:119], v4 offset:51200
    ds_read_b128 v[124:127], v12 offset:51200
    s_mov_b64 exec, -1
    ds_read_b128 v[104:107], v2 offset:51200
    ds_read_b64 v[112:113], v3 offset:51200
    v_exp_f32 v19, v19
    v_exp_f32 v20, v20
    v_cvt_pk_bf16_f32 v49, v18, v19
    v_mfma_f32_32x32x16_bf16 v[32:47], v[108:111], v[96:99], 0
    v_exp_f32 v21, v21
    v_exp_f32 v22, v22
    v_cvt_pk_bf16_f32 v50, v20, v21
    v_exp_f32 v23, v23
    v_exp_f32 v24, v24
    v_mfma_f32_32x32x8bf16_1k v[32:47], v[114:115], v[100:101], v[32:47]
    v_cvt_pk_bf16_f32 v51, v22, v23
    s_setprio 0
    v_exp_f32 v25, v25
    v_exp_f32 v26, v26
    v_cvt_pk_bf16_f32 v52, v24, v25
    v_exp_f32 v27, v27
    v_exp_f32 v28, v28
    v_mfma_f32_32x32x16_bf16 v[56:71], v[120:123], v[48:51], v[56:71]
    v_cvt_pk_bf16_f32 v53, v26, v27
    v_exp_f32 v29, v29
    v_exp_f32 v30, v30
    v_cvt_pk_bf16_f32 v54, v28, v29
    v_exp_f32 v31, v31
    s_setprio 1
    v_exp_f32 v32, v32
    v_cvt_pk_bf16_f32 v55, v30, v31
    v_exp_f32 v33, v33
    v_exp_f32 v34, v34
    v_mfma_f32_32x32x16_bf16 v[56:71], v[128:131], v[52:55], v[56:71]
    v_cvt_pk_bf16_f32 v48, v32, v33
    v_exp_f32 v35, v35
    v_exp_f32 v36, v36
    v_cvt_pk_bf16_f32 v49, v34, v35
    s_waitcnt lgkmcnt(0)
    v_mfma_f32_32x32x16_bf16 v[16:31], v[104:107], v[88:91], 0
    v_exp_f32 v37, v37
    v_exp_f32 v38, v38
    v_cvt_pk_bf16_f32 v50, v36, v37
    v_exp_f32 v39, v39
    v_exp_f32 v40, v40
    v_mfma_f32_32x32x8bf16_1k v[16:31], v[112:113], v[92:93], v[16:31]
    v_cvt_pk_bf16_f32 v51, v38, v39
    s_setprio 0
    v_exp_f32 v41, v41
    v_exp_f32 v42, v42
    v_cvt_pk_bf16_f32 v52, v40, v41
    v_exp_f32 v43, v43
    v_exp_f32 v44, v44
    v_mfma_f32_32x32x16_bf16 v[72:87], v[120:123], v[48:51], v[72:87]
    v_cvt_pk_bf16_f32 v53, v42, v43
    v_exp_f32 v45, v45
    v_exp_f32 v46, v46
    v_cvt_pk_bf16_f32 v54, v44, v45
    v_exp_f32 v47, v47
L_p3_join:
    v_add_u32 v2, 51200, v2
    v_add_u32 v3, 51200, v3
    v_add_u32 v4, 51200, v4
    v_add_u32 v12, 51200, v12
    s_setprio 1
    v_exp_f32 v16, v16
    v_cvt_pk_bf16_f32 v55, v46, v47
    v_exp_f32 v17, v17
    v_exp_f32 v18, v18
    v_mfma_f32_32x32x16_bf16 v[72:87], v[128:131], v[52:55], v[72:87]
    v_cvt_pk_bf16_f32 v48, v16, v17
    s_mov_b64 exec, s[44:45]
    ds_read_b128 v[120:123], v4 offset:2560
    ds_read_b128 v[128:131], v12 offset:2560
    s_mov_b64 exec, -1
    ds_read_b128 v[108:111], v2 offset:2560
    ds_read_b64 v[114:115], v3 offset:2560
    v_exp_f32 v19, v19
    v_exp_f32 v20, v20
    v_cvt_pk_bf16_f32 v49, v18, v19
    v_mfma_f32_32x32x16_bf16 v[32:47], v[104:107], v[96:99], 0
    v_exp_f32 v21, v21
    v_exp_f32 v22, v22
    v_cvt_pk_bf16_f32 v50, v20, v21
    v_exp_f32 v23, v23
    v_exp_f32 v24, v24
    v_mfma_f32_32x32x8bf16_1k v[32:47], v[112:113], v[100:101], v[32:47]
    v_cvt_pk_bf16_f32 v51, v22, v23
    s_setprio 0
    v_exp_f32 v25, v25
    v_exp_f32 v26, v26
    v_cvt_pk_bf16_f32 v52, v24, v25
    v_exp_f32 v27, v27
    v_exp_f32 v28, v28
    v_mfma_f32_32x32x16_bf16 v[56:71], v[116:119], v[48:51], v[56:71]
    v_cvt_pk_bf16_f32 v53, v26, v27
    v_exp_f32 v29, v29
    v_exp_f32 v30, v30
    v_cvt_pk_bf16_f32 v54, v28, v29
    v_exp_f32 v31, v31
    s_setprio 1
    v_exp_f32 v32, v32
    v_cvt_pk_bf16_f32 v55, v30, v31
    v_exp_f32 v33, v33
    v_exp_f32 v34, v34
    v_mfma_f32_32x32x16_bf16 v[56:71], v[124:127], v[52:55], v[56:71]
    v_cvt_pk_bf16_f32 v48, v32, v33
    v_exp_f32 v35, v35
    v_exp_f32 v36, v36
    v_cvt_pk_bf16_f32 v49, v34, v35
    s_waitcnt lgkmcnt(0)
    v_mfma_f32_32x32x16_bf16 v[16:31], v[108:111], v[88:91], 0
    v_exp_f32 v37, v37
    v_exp_f32 v38, v38
    v_cvt_pk_bf16_f32 v50, v36, v37
    v_exp_f32 v39, v39
    v_exp_f32 v40, v40
    v_mfma_f32_32x32x8bf16_1k v[16:31], v[114:115], v[92:93], v[16:31]
    v_cvt_pk_bf16_f32 v51, v38, v39
    s_setprio 0
    v_exp_f32 v41, v41
    v_exp_f32 v42, v42
    v_cvt_pk_bf16_f32 v52, v40, v41
    v_exp_f32 v43, v43
    v_exp_f32 v44, v44
    v_mfma_f32_32x32x16_bf16 v[72:87], v[116:119], v[48:51], v[72:87]
    v_cvt_pk_bf16_f32 v53, v42, v43
    v_exp_f32 v45, v45
    v_exp_f32 v46, v46
    v_cvt_pk_bf16_f32 v54, v44, v45
    v_exp_f32 v47, v47
    s_setprio 1
    v_exp_f32 v16, v16
    v_cvt_pk_bf16_f32 v55, v46, v47
    v_exp_f32 v17, v17
    v_exp_f32 v18, v18
    v_mfma_f32_32x32x16_bf16 v[72:87], v[124:127], v[52:55], v[72:87]
    v_cvt_pk_bf16_f32 v48, v16, v17
    s_mov_b64 exec, s[44:45]
    ds_read_b128 v[116:119], v4 offset:5120
    ds_read_b128 v[124:127], v12 offset:5120
    s_mov_b64 exec, -1
    ds_read_b128 v[104:107], v2 offset:5120
    ds_read_b64 v[112:113], v3 offset:5120
    v_exp_f32 v19, v19
    v_exp_f32 v20, v20
    v_cvt_pk_bf16_f32 v49, v18, v19
    v_mfma_f32_32x32x16_bf16 v[32:47], v[108:111], v[96:99], 0
    v_exp_f32 v21, v21
    v_exp_f32 v22, v22
    v_cvt_pk_bf16_f32 v50, v20, v21
    v_exp_f32 v23, v23
    v_exp_f32 v24, v24
    v_mfma_f32_32x32x8bf16_1k v[32:47], v[114:115], v[100:101], v[32:47]
    v_cvt_pk_bf16_f32 v51, v22, v23
    s_setprio 0
    v_exp_f32 v25, v25
    v_exp_f32 v26, v26
    v_cvt_pk_bf16_f32 v52, v24, v25
    v_exp_f32 v27, v27
    v_exp_f32 v28, v28
    v_mfma_f32_32x32x16_bf16 v[56:71], v[120:123], v[48:51], v[56:71]
    v_cvt_pk_bf16_f32 v53, v26, v27
    v_exp_f32 v29, v29
    v_exp_f32 v30, v30
    v_cvt_pk_bf16_f32 v54, v28, v29
    v_exp_f32 v31, v31
    s_setprio 1
    v_exp_f32 v32, v32
    v_cvt_pk_bf16_f32 v55, v30, v31
    v_exp_f32 v33, v33
    v_exp_f32 v34, v34
    v_mfma_f32_32x32x16_bf16 v[56:71], v[128:131], v[52:55], v[56:71]
    v_cvt_pk_bf16_f32 v48, v32, v33
    v_exp_f32 v35, v35
    v_exp_f32 v36, v36
    v_cvt_pk_bf16_f32 v49, v34, v35
    s_waitcnt lgkmcnt(0)
    v_mfma_f32_32x32x16_bf16 v[16:31], v[104:107], v[88:91], 0
    v_exp_f32 v37, v37
    v_exp_f32 v38, v38
    v_cvt_pk_bf16_f32 v50, v36, v37
    v_exp_f32 v39, v39
    v_exp_f32 v40, v40
    v_mfma_f32_32x32x8bf16_1k v[16:31], v[112:113], v[92:93], v[16:31]
    v_cvt_pk_bf16_f32 v51, v38, v39
    s_setprio 0
    v_exp_f32 v41, v41
    v_exp_f32 v42, v42
    v_cvt_pk_bf16_f32 v52, v40, v41
    v_exp_f32 v43, v43
    v_exp_f32 v44, v44
    v_mfma_f32_32x32x16_bf16 v[72:87], v[120:123], v[48:51], v[72:87]
    v_cvt_pk_bf16_f32 v53, v42, v43
    v_exp_f32 v45, v45
    v_exp_f32 v46, v46
    v_cvt_pk_bf16_f32 v54, v44, v45
    v_exp_f32 v47, v47
    s_setprio 1
    v_exp_f32 v16, v16
    v_cvt_pk_bf16_f32 v55, v46, v47
    v_exp_f32 v17, v17
    v_exp_f32 v18, v18
    v_mfma_f32_32x32x16_bf16 v[72:87], v[128:131], v[52:55], v[72:87]
    v_cvt_pk_bf16_f32 v48, v16, v17
    s_mov_b64 exec, s[44:45]
    ds_read_b128 v[120:123], v4 offset:7680
    ds_read_b128 v[128:131], v12 offset:7680
    s_mov_b64 exec, -1
    ds_read_b128 v[108:111], v2 offset:7680
    ds_read_b64 v[114:115], v3 offset:7680
    v_exp_f32 v19, v19
    v_exp_f32 v20, v20
    v_cvt_pk_bf16_f32 v49, v18, v19
    v_mfma_f32_32x32x16_bf16 v[32:47], v[104:107], v[96:99], 0
    v_exp_f32 v21, v21
    v_exp_f32 v22, v22
    v_cvt_pk_bf16_f32 v50, v20, v21
    v_exp_f32 v23, v23
    v_exp_f32 v24, v24
    v_mfma_f32_32x32x8bf16_1k v[32:47], v[112:113], v[100:101], v[32:47]
    v_cvt_pk_bf16_f32 v51, v22, v23
    s_setprio 0
    v_exp_f32 v25, v25
    v_exp_f32 v26, v26
    v_cvt_pk_bf16_f32 v52, v24, v25
    v_exp_f32 v27, v27
    v_exp_f32 v28, v28
    v_mfma_f32_32x32x16_bf16 v[56:71], v[116:119], v[48:51], v[56:71]
    v_cvt_pk_bf16_f32 v53, v26, v27
    v_exp_f32 v29, v29
    v_exp_f32 v30, v30
    v_cvt_pk_bf16_f32 v54, v28, v29
    v_exp_f32 v31, v31
    s_setprio 1
    v_exp_f32 v32, v32
    v_cvt_pk_bf16_f32 v55, v30, v31
    v_exp_f32 v33, v33
    v_exp_f32 v34, v34
    v_mfma_f32_32x32x16_bf16 v[56:71], v[124:127], v[52:55], v[56:71]
    v_cvt_pk_bf16_f32 v48, v32, v33
    v_exp_f32 v35, v35
    v_exp_f32 v36, v36
    v_cvt_pk_bf16_f32 v49, v34, v35
    s_waitcnt lgkmcnt(0)
    v_mfma_f32_32x32x16_bf16 v[16:31], v[108:111], v[88:91], 0
    v_exp_f32 v37, v37
    v_exp_f32 v38, v38
    v_cvt_pk_bf16_f32 v50, v36, v37
    v_exp_f32 v39, v39
    v_exp_f32 v40, v40
    v_mfma_f32_32x32x8bf16_1k v[16:31], v[114:115], v[92:93], v[16:31]
    v_cvt_pk_bf16_f32 v51, v38, v39
    s_setprio 0
    v_exp_f32 v41, v41
    v_exp_f32 v42, v42
    v_cvt_pk_bf16_f32 v52, v40, v41
    v_exp_f32 v43, v43
    v_exp_f32 v44, v44
    v_mfma_f32_32x32x16_bf16 v[72:87], v[116:119], v[48:51], v[72:87]
    v_cvt_pk_bf16_f32 v53, v42, v43
    v_exp_f32 v45, v45
    v_exp_f32 v46, v46
    v_cvt_pk_bf16_f32 v54, v44, v45
    v_exp_f32 v47, v47
    s_setprio 1
    v_exp_f32 v16, v16
    v_cvt_pk_bf16_f32 v55, v46, v47
    v_exp_f32 v17, v17
    v_exp_f32 v18, v18
    v_mfma_f32_32x32x16_bf16 v[72:87], v[124:127], v[52:55], v[72:87]
    v_cvt_pk_bf16_f32 v48, v16, v17
    s_mov_b64 exec, s[44:45]
    ds_read_b128 v[116:119], v4 offset:10240
    ds_read_b128 v[124:127], v12 offset:10240
    s_mov_b64 exec, -1
    ds_read_b128 v[104:107], v2 offset:10240
    ds_read_b64 v[112:113], v3 offset:10240
    v_exp_f32 v19, v19
    v_exp_f32 v20, v20
    v_cvt_pk_bf16_f32 v49, v18, v19
    v_mfma_f32_32x32x16_bf16 v[32:47], v[108:111], v[96:99], 0
    v_exp_f32 v21, v21
    v_exp_f32 v22, v22
    v_cvt_pk_bf16_f32 v50, v20, v21
    v_exp_f32 v23, v23
    v_exp_f32 v24, v24
    v_mfma_f32_32x32x8bf16_1k v[32:47], v[114:115], v[100:101], v[32:47]
    v_cvt_pk_bf16_f32 v51, v22, v23
    s_setprio 0
    v_exp_f32 v25, v25
    v_exp_f32 v26, v26
    v_cvt_pk_bf16_f32 v52, v24, v25
    v_exp_f32 v27, v27
    v_exp_f32 v28, v28
    v_mfma_f32_32x32x16_bf16 v[56:71], v[120:123], v[48:51], v[56:71]
    v_cvt_pk_bf16_f32 v53, v26, v27
    v_exp_f32 v29, v29
    v_exp_f32 v30, v30
    v_cvt_pk_bf16_f32 v54, v28, v29
    v_exp_f32 v31, v31
    s_setprio 1
    v_exp_f32 v32, v32
    v_cvt_pk_bf16_f32 v55, v30, v31
    v_exp_f32 v33, v33
    v_exp_f32 v34, v34
    v_mfma_f32_32x32x16_bf16 v[56:71], v[128:131], v[52:55], v[56:71]
    v_cvt_pk_bf16_f32 v48, v32, v33
    v_exp_f32 v35, v35
    v_exp_f32 v36, v36
    v_cvt_pk_bf16_f32 v49, v34, v35
    s_waitcnt lgkmcnt(0)
    v_mfma_f32_32x32x16_bf16 v[16:31], v[104:107], v[88:91], 0
    v_exp_f32 v37, v37
    v_exp_f32 v38, v38
    v_cvt_pk_bf16_f32 v50, v36, v37
    v_exp_f32 v39, v39
    v_exp_f32 v40, v40
    v_mfma_f32_32x32x8bf16_1k v[16:31], v[112:113], v[92:93], v[16:31]
    v_cvt_pk_bf16_f32 v51, v38, v39
    s_setprio 0
    v_exp_f32 v41, v41
    v_exp_f32 v42, v42
    v_cvt_pk_bf16_f32 v52, v40, v41
    v_exp_f32 v43, v43
    v_exp_f32 v44, v44
    v_mfma_f32_32x32x16_bf16 v[72:87], v[120:123], v[48:51], v[72:87]
    v_cvt_pk_bf16_f32 v53, v42, v43
    v_exp_f32 v45, v45
    v_exp_f32 v46, v46
    v_cvt_pk_bf16_f32 v54, v44, v45
    v_exp_f32 v47, v47
    s_waitcnt vmcnt(0)
    s_barrier
    s_cmp_eq_u32 s4, 4
    s_cbranch_scc0 L_p3_noce
    s_and_b32 s31, s2, 7
    s_lshr_b32 s32, s2, 3
    s_mul_i32 s30, s31, 64
    s_add_u32 s30, s30, 1208
    s_and_b32 s3, s32, 3
    s_lshl_b32 s3, s3, 4
    s_add_u32 s30, s30, s3
    s_lshl_b32 s3, s30, 7
    s_add_u32 s3, s3, 31719424
    v_lshlrev_b32 v250, 7, v0
    v_add_u32 v250, s3, v250
    v_mov_b32 v251, 1
    s_mov_b32 exec_lo, 65535
    s_mov_b32 exec_hi, 0
    global_atomic_add v250, v251, s[6:7] sc1
    s_mov_b64 exec, -1
L_p3_noce:
    s_setprio 1
    v_exp_f32 v16, v16
    v_cvt_pk_bf16_f32 v55, v46, v47
    v_exp_f32 v17, v17
    v_exp_f32 v18, v18
    v_mfma_f32_32x32x16_bf16 v[72:87], v[128:131], v[52:55], v[72:87]
    v_cvt_pk_bf16_f32 v48, v16, v17
    s_mov_b64 exec, s[44:45]
    ds_read_b128 v[120:123], v4 offset:12800
    ds_read_b128 v[128:131], v12 offset:12800
    s_mov_b64 exec, -1
    ds_read_b128 v[108:111], v2 offset:12800
    ds_read_b64 v[114:115], v3 offset:12800
    v_exp_f32 v19, v19
    v_exp_f32 v20, v20
    v_cvt_pk_bf16_f32 v49, v18, v19
    v_mfma_f32_32x32x16_bf16 v[32:47], v[104:107], v[96:99], 0
    v_exp_f32 v21, v21
    v_exp_f32 v22, v22
    v_cvt_pk_bf16_f32 v50, v20, v21
    v_exp_f32 v23, v23
    v_exp_f32 v24, v24
    v_mfma_f32_32x32x8bf16_1k v[32:47], v[112:113], v[100:101], v[32:47]
    v_cvt_pk_bf16_f32 v51, v22, v23
    s_setprio 0
    v_exp_f32 v25, v25
    v_exp_f32 v26, v26
    v_cvt_pk_bf16_f32 v52, v24, v25
    v_exp_f32 v27, v27
    v_exp_f32 v28, v28
    v_mfma_f32_32x32x16_bf16 v[56:71], v[116:119], v[48:51], v[56:71]
    v_cvt_pk_bf16_f32 v53, v26, v27
    v_exp_f32 v29, v29
    v_exp_f32 v30, v30
    v_cvt_pk_bf16_f32 v54, v28, v29
    v_exp_f32 v31, v31
    s_setprio 1
    v_exp_f32 v32, v32
    v_cvt_pk_bf16_f32 v55, v30, v31
    v_exp_f32 v33, v33
    v_exp_f32 v34, v34
    v_mfma_f32_32x32x16_bf16 v[56:71], v[124:127], v[52:55], v[56:71]
    v_cvt_pk_bf16_f32 v48, v32, v33
    v_exp_f32 v35, v35
    v_exp_f32 v36, v36
    v_cvt_pk_bf16_f32 v49, v34, v35
    s_waitcnt lgkmcnt(0)
    v_mfma_f32_32x32x16_bf16 v[16:31], v[108:111], v[88:91], 0
    v_exp_f32 v37, v37
    v_exp_f32 v38, v38
    v_cvt_pk_bf16_f32 v50, v36, v37
    v_exp_f32 v39, v39
    v_exp_f32 v40, v40
    v_mfma_f32_32x32x8bf16_1k v[16:31], v[114:115], v[92:93], v[16:31]
    v_cvt_pk_bf16_f32 v51, v38, v39
    s_setprio 0
    v_exp_f32 v41, v41
    v_exp_f32 v42, v42
    v_cvt_pk_bf16_f32 v52, v40, v41
    v_exp_f32 v43, v43
    v_exp_f32 v44, v44
    v_mfma_f32_32x32x16_bf16 v[72:87], v[116:119], v[48:51], v[72:87]
    v_cvt_pk_bf16_f32 v53, v42, v43
    v_exp_f32 v45, v45
    v_exp_f32 v46, v46
    v_cvt_pk_bf16_f32 v54, v44, v45
    v_exp_f32 v47, v47
    s_setprio 1
    v_exp_f32 v16, v16
    v_cvt_pk_bf16_f32 v55, v46, v47
    v_exp_f32 v17, v17
    v_exp_f32 v18, v18
    v_mfma_f32_32x32x16_bf16 v[72:87], v[124:127], v[52:55], v[72:87]
    v_cvt_pk_bf16_f32 v48, v16, v17
    s_mov_b64 exec, s[44:45]
    ds_read_b128 v[116:119], v4 offset:15360
    ds_read_b128 v[124:127], v12 offset:15360
    s_mov_b64 exec, -1
    ds_read_b128 v[104:107], v2 offset:15360
    ds_read_b64 v[112:113], v3 offset:15360
    v_exp_f32 v19, v19
    v_exp_f32 v20, v20
    v_cvt_pk_bf16_f32 v49, v18, v19
    v_mfma_f32_32x32x16_bf16 v[32:47], v[108:111], v[96:99], 0
    v_exp_f32 v21, v21
    v_exp_f32 v22, v22
    v_cvt_pk_bf16_f32 v50, v20, v21
    v_exp_f32 v23, v23
    v_exp_f32 v24, v24
    v_mfma_f32_32x32x8bf16_1k v[32:47], v[114:115], v[100:101], v[32:47]
    v_cvt_pk_bf16_f32 v51, v22, v23
    s_setprio 0
    v_exp_f32 v25, v25
    v_exp_f32 v26, v26
    v_cvt_pk_bf16_f32 v52, v24, v25
    v_exp_f32 v27, v27
    v_exp_f32 v28, v28
    v_mfma_f32_32x32x16_bf16 v[56:71], v[120:123], v[48:51], v[56:71]
    v_cvt_pk_bf16_f32 v53, v26, v27
    v_exp_f32 v29, v29
    v_exp_f32 v30, v30
    v_cvt_pk_bf16_f32 v54, v28, v29
    v_exp_f32 v31, v31
    s_setprio 1
    v_exp_f32 v32, v32
    v_cvt_pk_bf16_f32 v55, v30, v31
    v_exp_f32 v33, v33
    v_exp_f32 v34, v34
    v_mfma_f32_32x32x16_bf16 v[56:71], v[128:131], v[52:55], v[56:71]
    v_cvt_pk_bf16_f32 v48, v32, v33
    v_exp_f32 v35, v35
    v_exp_f32 v36, v36
    v_cvt_pk_bf16_f32 v49, v34, v35
    s_waitcnt lgkmcnt(0)
    v_mfma_f32_32x32x16_bf16 v[16:31], v[104:107], v[88:91], 0
    v_exp_f32 v37, v37
    v_exp_f32 v38, v38
    v_cvt_pk_bf16_f32 v50, v36, v37
    v_exp_f32 v39, v39
    v_exp_f32 v40, v40
    v_mfma_f32_32x32x8bf16_1k v[16:31], v[112:113], v[92:93], v[16:31]
    v_cvt_pk_bf16_f32 v51, v38, v39
    s_setprio 0
    v_exp_f32 v41, v41
    v_exp_f32 v42, v42
    v_cvt_pk_bf16_f32 v52, v40, v41
    v_exp_f32 v43, v43
    v_exp_f32 v44, v44
    v_mfma_f32_32x32x16_bf16 v[72:87], v[120:123], v[48:51], v[72:87]
    v_cvt_pk_bf16_f32 v53, v42, v43
    v_exp_f32 v45, v45
    v_exp_f32 v46, v46
    v_cvt_pk_bf16_f32 v54, v44, v45
    v_exp_f32 v47, v47
    s_setprio 1
    v_exp_f32 v16, v16
    v_cvt_pk_bf16_f32 v55, v46, v47
    v_exp_f32 v17, v17
    v_exp_f32 v18, v18
    v_mfma_f32_32x32x16_bf16 v[72:87], v[128:131], v[52:55], v[72:87]
    v_cvt_pk_bf16_f32 v48, v16, v17
    s_mov_b64 exec, s[44:45]
    ds_read_b128 v[120:123], v4 offset:17920
    ds_read_b128 v[128:131], v12 offset:17920
    s_mov_b64 exec, -1
    ds_read_b128 v[108:111], v2 offset:17920
    ds_read_b64 v[114:115], v3 offset:17920
    v_exp_f32 v19, v19
    v_exp_f32 v20, v20
    v_cvt_pk_bf16_f32 v49, v18, v19
    v_mfma_f32_32x32x16_bf16 v[32:47], v[104:107], v[96:99], 0
    v_exp_f32 v21, v21
    v_exp_f32 v22, v22
    v_cvt_pk_bf16_f32 v50, v20, v21
    v_exp_f32 v23, v23
    v_exp_f32 v24, v24
    v_mfma_f32_32x32x8bf16_1k v[32:47], v[112:113], v[100:101], v[32:47]
    v_cvt_pk_bf16_f32 v51, v22, v23
    s_setprio 0
    v_exp_f32 v25, v25
    v_exp_f32 v26, v26
    v_cvt_pk_bf16_f32 v52, v24, v25
    v_exp_f32 v27, v27
    v_exp_f32 v28, v28
    v_mfma_f32_32x32x16_bf16 v[56:71], v[116:119], v[48:51], v[56:71]
    v_cvt_pk_bf16_f32 v53, v26, v27
    v_exp_f32 v29, v29
    v_exp_f32 v30, v30
    v_cvt_pk_bf16_f32 v54, v28, v29
    v_exp_f32 v31, v31
    s_setprio 1
    v_exp_f32 v32, v32
    v_cvt_pk_bf16_f32 v55, v30, v31
    v_exp_f32 v33, v33
    v_exp_f32 v34, v34
    v_mfma_f32_32x32x16_bf16 v[56:71], v[124:127], v[52:55], v[56:71]
    v_cvt_pk_bf16_f32 v48, v32, v33
    v_exp_f32 v35, v35
    v_exp_f32 v36, v36
    v_cvt_pk_bf16_f32 v49, v34, v35
    s_waitcnt lgkmcnt(0)
    v_mfma_f32_32x32x16_bf16 v[16:31], v[108:111], v[88:91], 0
    v_exp_f32 v37, v37
    v_exp_f32 v38, v38
    v_cvt_pk_bf16_f32 v50, v36, v37
    v_exp_f32 v39, v39
    v_exp_f32 v40, v40
    v_mfma_f32_32x32x8bf16_1k v[16:31], v[114:115], v[92:93], v[16:31]
    v_cvt_pk_bf16_f32 v51, v38, v39
    s_setprio 0
    v_exp_f32 v41, v41
    v_exp_f32 v42, v42
    v_cvt_pk_bf16_f32 v52, v40, v41
    v_exp_f32 v43, v43
    v_exp_f32 v44, v44
    v_mfma_f32_32x32x16_bf16 v[72:87], v[116:119], v[48:51], v[72:87]
    v_cvt_pk_bf16_f32 v53, v42, v43
    v_exp_f32 v45, v45
    v_exp_f32 v46, v46
    v_cvt_pk_bf16_f32 v54, v44, v45
    v_exp_f32 v47, v47
    s_setprio 1
    v_exp_f32 v16, v16
    v_cvt_pk_bf16_f32 v55, v46, v47
    v_exp_f32 v17, v17
    v_exp_f32 v18, v18
    v_mfma_f32_32x32x16_bf16 v[72:87], v[124:127], v[52:55], v[72:87]
    v_cvt_pk_bf16_f32 v48, v16, v17
    s_mov_b64 exec, s[44:45]
    ds_read_b128 v[116:119], v4 offset:20480
    ds_read_b128 v[124:127], v12 offset:20480
    s_mov_b64 exec, -1
    ds_read_b128 v[104:107], v2 offset:20480
    ds_read_b64 v[112:113], v3 offset:20480
    v_exp_f32 v19, v19
    v_exp_f32 v20, v20
    v_cvt_pk_bf16_f32 v49, v18, v19
    v_mfma_f32_32x32x16_bf16 v[32:47], v[108:111], v[96:99], 0
    v_exp_f32 v21, v21
    v_exp_f32 v22, v22
    v_cvt_pk_bf16_f32 v50, v20, v21
    v_exp_f32 v23, v23
    v_exp_f32 v24, v24
    v_mfma_f32_32x32x8bf16_1k v[32:47], v[114:115], v[100:101], v[32:47]
    v_cvt_pk_bf16_f32 v51, v22, v23
    s_setprio 0
    v_exp_f32 v25, v25
    v_exp_f32 v26, v26
    v_cvt_pk_bf16_f32 v52, v24, v25
    v_exp_f32 v27, v27
    v_exp_f32 v28, v28
    v_mfma_f32_32x32x16_bf16 v[56:71], v[120:123], v[48:51], v[56:71]
    v_cvt_pk_bf16_f32 v53, v26, v27
    v_exp_f32 v29, v29
    v_exp_f32 v30, v30
    v_cvt_pk_bf16_f32 v54, v28, v29
    v_exp_f32 v31, v31
    s_setprio 1
    v_exp_f32 v32, v32
    v_cvt_pk_bf16_f32 v55, v30, v31
    v_exp_f32 v33, v33
    v_exp_f32 v34, v34
    v_mfma_f32_32x32x16_bf16 v[56:71], v[128:131], v[52:55], v[56:71]
    v_cvt_pk_bf16_f32 v48, v32, v33
    v_exp_f32 v35, v35
    v_exp_f32 v36, v36
    v_cvt_pk_bf16_f32 v49, v34, v35
    s_waitcnt lgkmcnt(0)
    v_mfma_f32_32x32x16_bf16 v[16:31], v[104:107], v[88:91], 0
    v_exp_f32 v37, v37
    v_exp_f32 v38, v38
    v_cvt_pk_bf16_f32 v50, v36, v37
    v_exp_f32 v39, v39
    v_exp_f32 v40, v40
    v_mfma_f32_32x32x8bf16_1k v[16:31], v[112:113], v[92:93], v[16:31]
    v_cvt_pk_bf16_f32 v51, v38, v39
    s_setprio 0
    v_exp_f32 v41, v41
    v_exp_f32 v42, v42
    v_cvt_pk_bf16_f32 v52, v40, v41
    v_exp_f32 v43, v43
    v_exp_f32 v44, v44
    v_mfma_f32_32x32x16_bf16 v[72:87], v[120:123], v[48:51], v[72:87]
    v_cvt_pk_bf16_f32 v53, v42, v43
    v_exp_f32 v45, v45
    v_exp_f32 v46, v46
    v_cvt_pk_bf16_f32 v54, v44, v45
    v_exp_f32 v47, v47
    s_cmp_lt_u32 s4, 4
    s_cbranch_scc0 L_p3_noce1
    v_and_b32 v250, 31, v0
    v_lshlrev_b32 v250, 4, v250
    s_and_b32 s30, s2, 15
    s_add_u32 s30, s30, 1208
    v_add_u32 v250, s30, v250
    v_lshlrev_b32 v250, 7, v250
    v_add_u32 v250, 31719424, v250
    global_load_dword v252, v250, s[6:7] sc1
L_p3_noce1:
    s_setprio 1
    v_exp_f32 v16, v16
    v_cvt_pk_bf16_f32 v55, v46, v47
    v_exp_f32 v17, v17
    v_exp_f32 v18, v18
    v_mfma_f32_32x32x16_bf16 v[72:87], v[128:131], v[52:55], v[72:87]
    v_cvt_pk_bf16_f32 v48, v16, v17
    s_mov_b64 exec, s[44:45]
    ds_read_b128 v[120:123], v4 offset:23040
    ds_read_b128 v[128:131], v12 offset:23040
    s_mov_b64 exec, -1
    ds_read_b128 v[108:111], v2 offset:23040
    ds_read_b64 v[114:115], v3 offset:23040
    v_exp_f32 v19, v19
    v_exp_f32 v20, v20
    v_cvt_pk_bf16_f32 v49, v18, v19
    v_mfma_f32_32x32x16_bf16 v[32:47], v[104:107], v[96:99], 0
    v_exp_f32 v21, v21
    v_exp_f32 v22, v22
    v_cvt_pk_bf16_f32 v50, v20, v21
    v_exp_f32 v23, v23
    v_exp_f32 v24, v24
    v_mfma_f32_32x32x8bf16_1k v[32:47], v[112:113], v[100:101], v[32:47]
    v_cvt_pk_bf16_f32 v51, v22, v23
    s_setprio 0
    v_exp_f32 v25, v25
    v_exp_f32 v26, v26
    v_cvt_pk_bf16_f32 v52, v24, v25
    v_exp_f32 v27, v27
    v_exp_f32 v28, v28
    v_mfma_f32_32x32x16_bf16 v[56:71], v[116:119], v[48:51], v[56:71]
    v_cvt_pk_bf16_f32 v53, v26, v27
    v_exp_f32 v29, v29
    v_exp_f32 v30, v30
    v_cvt_pk_bf16_f32 v54, v28, v29
    v_exp_f32 v31, v31
    s_setprio 1
    v_exp_f32 v32, v32
    v_cvt_pk_bf16_f32 v55, v30, v31
    v_exp_f32 v33, v33
    v_exp_f32 v34, v34
    v_mfma_f32_32x32x16_bf16 v[56:71], v[124:127], v[52:55], v[56:71]
    v_cvt_pk_bf16_f32 v48, v32, v33
    v_exp_f32 v35, v35
    v_exp_f32 v36, v36
    v_cvt_pk_bf16_f32 v49, v34, v35
    s_waitcnt lgkmcnt(0)
    v_mfma_f32_32x32x16_bf16 v[16:31], v[108:111], v[88:91], 0
    v_exp_f32 v37, v37
    v_exp_f32 v38, v38
    v_cvt_pk_bf16_f32 v50, v36, v37
    v_exp_f32 v39, v39
    v_exp_f32 v40, v40
    v_mfma_f32_32x32x8bf16_1k v[16:31], v[114:115], v[92:93], v[16:31]
    v_cvt_pk_bf16_f32 v51, v38, v39
    s_setprio 0
    v_exp_f32 v41, v41
    v_exp_f32 v42, v42
    v_cvt_pk_bf16_f32 v52, v40, v41
    v_exp_f32 v43, v43
    v_exp_f32 v44, v44
    v_mfma_f32_32x32x16_bf16 v[72:87], v[116:119], v[48:51], v[72:87]
    v_cvt_pk_bf16_f32 v53, v42, v43
    v_exp_f32 v45, v45
    v_exp_f32 v46, v46
    v_cvt_pk_bf16_f32 v54, v44, v45
    v_exp_f32 v47, v47
    s_setprio 1
    v_exp_f32 v16, v16
    v_cvt_pk_bf16_f32 v55, v46, v47
    v_exp_f32 v17, v17
    v_exp_f32 v18, v18
    v_mfma_f32_32x32x16_bf16 v[72:87], v[124:127], v[52:55], v[72:87]
    v_cvt_pk_bf16_f32 v48, v16, v17
    s_mov_b64 exec, s[44:45]
    ds_read_b128 v[116:119], v4 offset:25600
    ds_read_b128 v[124:127], v12 offset:25600
    s_mov_b64 exec, -1
    ds_read_b128 v[104:107], v2 offset:25600
    ds_read_b64 v[112:113], v3 offset:25600
    v_exp_f32 v19, v19
    v_exp_f32 v20, v20
    v_cvt_pk_bf16_f32 v49, v18, v19
    v_mfma_f32_32x32x16_bf16 v[32:47], v[108:111], v[96:99], 0
    v_exp_f32 v21, v21
    v_exp_f32 v22, v22
    v_cvt_pk_bf16_f32 v50, v20, v21
    v_exp_f32 v23, v23
    v_exp_f32 v24, v24
    v_mfma_f32_32x32x8bf16_1k v[32:47], v[114:115], v[100:101], v[32:47]
    v_cvt_pk_bf16_f32 v51, v22, v23
    s_setprio 0
    v_exp_f32 v25, v25
    v_exp_f32 v26, v26
    v_cvt_pk_bf16_f32 v52, v24, v25
    v_exp_f32 v27, v27
    v_exp_f32 v28, v28
    v_mfma_f32_32x32x16_bf16 v[56:71], v[120:123], v[48:51], v[56:71]
    v_cvt_pk_bf16_f32 v53, v26, v27
    v_exp_f32 v29, v29
    v_exp_f32 v30, v30
    v_cvt_pk_bf16_f32 v54, v28, v29
    v_exp_f32 v31, v31
    s_setprio 1
    v_exp_f32 v32, v32
    v_cvt_pk_bf16_f32 v55, v30, v31
    v_exp_f32 v33, v33
    v_exp_f32 v34, v34
    v_mfma_f32_32x32x16_bf16 v[56:71], v[128:131], v[52:55], v[56:71]
    v_cvt_pk_bf16_f32 v48, v32, v33
    v_exp_f32 v35, v35
    v_exp_f32 v36, v36
    v_cvt_pk_bf16_f32 v49, v34, v35
    s_waitcnt lgkmcnt(0)
    v_mfma_f32_32x32x16_bf16 v[16:31], v[104:107], v[88:91], 0
    v_exp_f32 v37, v37
    v_exp_f32 v38, v38
    v_cvt_pk_bf16_f32 v50, v36, v37
    v_exp_f32 v39, v39
    v_exp_f32 v40, v40
    v_mfma_f32_32x32x8bf16_1k v[16:31], v[112:113], v[92:93], v[16:31]
    v_cvt_pk_bf16_f32 v51, v38, v39
    s_setprio 0
    v_exp_f32 v41, v41
    v_exp_f32 v42, v42
    v_cvt_pk_bf16_f32 v52, v40, v41
    v_exp_f32 v43, v43
    v_exp_f32 v44, v44
    v_mfma_f32_32x32x16_bf16 v[72:87], v[120:123], v[48:51], v[72:87]
    v_cvt_pk_bf16_f32 v53, v42, v43
    v_exp_f32 v45, v45
    v_exp_f32 v46, v46
    v_cvt_pk_bf16_f32 v54, v44, v45
    v_exp_f32 v47, v47
    s_setprio 1
    v_exp_f32 v16, v16
    v_cvt_pk_bf16_f32 v55, v46, v47
    v_exp_f32 v17, v17
    v_exp_f32 v18, v18
    v_mfma_f32_32x32x16_bf16 v[72:87], v[128:131], v[52:55], v[72:87]
    v_cvt_pk_bf16_f32 v48, v16, v17
    s_mov_b64 exec, s[44:45]
    ds_read_b128 v[120:123], v4 offset:28160
    ds_read_b128 v[128:131], v12 offset:28160
    s_mov_b64 exec, -1
    ds_read_b128 v[108:111], v2 offset:28160
    ds_read_b64 v[114:115], v3 offset:28160
    v_exp_f32 v19, v19
    v_exp_f32 v20, v20
    v_cvt_pk_bf16_f32 v49, v18, v19
    v_mfma_f32_32x32x16_bf16 v[32:47], v[104:107], v[96:99], 0
    v_exp_f32 v21, v21
    v_exp_f32 v22, v22
    v_cvt_pk_bf16_f32 v50, v20, v21
    v_exp_f32 v23, v23
    v_exp_f32 v24, v24
    v_mfma_f32_32x32x8bf16_1k v[32:47], v[112:113], v[100:101], v[32:47]
    v_cvt_pk_bf16_f32 v51, v22, v23
    s_setprio 0
    v_exp_f32 v25, v25
    v_exp_f32 v26, v26
    v_cvt_pk_bf16_f32 v52, v24, v25
    v_exp_f32 v27, v27
    v_exp_f32 v28, v28
    v_mfma_f32_32x32x16_bf16 v[56:71], v[116:119], v[48:51], v[56:71]
    v_cvt_pk_bf16_f32 v53, v26, v27
    v_exp_f32 v29, v29
    v_exp_f32 v30, v30
    v_cvt_pk_bf16_f32 v54, v28, v29
    v_exp_f32 v31, v31
    s_setprio 1
    v_exp_f32 v32, v32
    v_cvt_pk_bf16_f32 v55, v30, v31
    v_exp_f32 v33, v33
    v_exp_f32 v34, v34
    v_mfma_f32_32x32x16_bf16 v[56:71], v[124:127], v[52:55], v[56:71]
    v_cvt_pk_bf16_f32 v48, v32, v33
    v_exp_f32 v35, v35
    v_exp_f32 v36, v36
    v_cvt_pk_bf16_f32 v49, v34, v35
    s_waitcnt lgkmcnt(0)
    v_mfma_f32_32x32x16_bf16 v[16:31], v[108:111], v[88:91], 0
    v_exp_f32 v37, v37
    v_exp_f32 v38, v38
    v_cvt_pk_bf16_f32 v50, v36, v37
    v_exp_f32 v39, v39
    v_exp_f32 v40, v40
    v_mfma_f32_32x32x8bf16_1k v[16:31], v[114:115], v[92:93], v[16:31]
    v_cvt_pk_bf16_f32 v51, v38, v39
    s_setprio 0
    v_exp_f32 v41, v41
    v_exp_f32 v42, v42
    v_cvt_pk_bf16_f32 v52, v40, v41
    v_exp_f32 v43, v43
    v_exp_f32 v44, v44
    v_mfma_f32_32x32x16_bf16 v[72:87], v[116:119], v[48:51], v[72:87]
    v_cvt_pk_bf16_f32 v53, v42, v43
    v_exp_f32 v45, v45
    v_exp_f32 v46, v46
    v_cvt_pk_bf16_f32 v54, v44, v45
    v_exp_f32 v47, v47
    s_setprio 1
    v_exp_f32 v16, v16
    v_cvt_pk_bf16_f32 v55, v46, v47
    v_exp_f32 v17, v17
    v_exp_f32 v18, v18
    v_mfma_f32_32x32x16_bf16 v[72:87], v[124:127], v[52:55], v[72:87]
    v_cvt_pk_bf16_f32 v48, v16, v17
    v_exp_f32 v19, v19
    v_exp_f32 v20, v20
    v_cvt_pk_bf16_f32 v49, v18, v19
    v_mfma_f32_32x32x16_bf16 v[32:47], v[108:111], v[96:99], 0
    v_exp_f32 v21, v21
    v_exp_f32 v22, v22
    v_cvt_pk_bf16_f32 v50, v20, v21
    v_exp_f32 v23, v23
    v_exp_f32 v24, v24
    v_mfma_f32_32x32x8bf16_1k v[32:47], v[114:115], v[100:101], v[32:47]
    v_cvt_pk_bf16_f32 v51, v22, v23
    s_setprio 0
    v_exp_f32 v25, v25
    v_exp_f32 v26, v26
    v_cvt_pk_bf16_f32 v52, v24, v25
    v_exp_f32 v27, v27
    v_exp_f32 v28, v28
    v_mfma_f32_32x32x16_bf16 v[56:71], v[120:123], v[48:51], v[56:71]
    v_cvt_pk_bf16_f32 v53, v26, v27
    v_exp_f32 v29, v29
    v_exp_f32 v30, v30
    v_cvt_pk_bf16_f32 v54, v28, v29
    v_exp_f32 v31, v31
    s_setprio 1
    v_exp_f32 v32, v32
    v_cvt_pk_bf16_f32 v55, v30, v31
    v_exp_f32 v33, v33
    v_exp_f32 v34, v34
    v_mfma_f32_32x32x16_bf16 v[56:71], v[128:131], v[52:55], v[56:71]
    v_cvt_pk_bf16_f32 v48, v32, v33
    v_exp_f32 v35, v35
    v_exp_f32 v36, v36
    v_cvt_pk_bf16_f32 v49, v34, v35
    v_exp_f32 v37, v37
    v_exp_f32 v38, v38
    v_cvt_pk_bf16_f32 v50, v36, v37
    v_exp_f32 v39, v39
    v_exp_f32 v40, v40
    v_cvt_pk_bf16_f32 v51, v38, v39
    s_setprio 0
    v_exp_f32 v41, v41
    v_exp_f32 v42, v42
    v_cvt_pk_bf16_f32 v52, v40, v41
    v_exp_f32 v43, v43
    v_exp_f32 v44, v44
    v_mfma_f32_32x32x16_bf16 v[72:87], v[120:123], v[48:51], v[72:87]
    v_cvt_pk_bf16_f32 v53, v42, v43
    v_exp_f32 v45, v45
    v_exp_f32 v46, v46
    v_cvt_pk_bf16_f32 v54, v44, v45
    v_exp_f32 v47, v47
    s_nop 0
    v_cvt_pk_bf16_f32 v55, v46, v47
    s_nop 1
    v_mfma_f32_32x32x16_bf16 v[72:87], v[128:131], v[52:55], v[72:87]
    s_mov_b32 s46, 0
    s_cmp_lt_u32 s4, 4
    s_cbranch_scc0 L_p3_noce2
    s_waitcnt vmcnt(0)
    v_cmp_le_u32 vcc, 8, v252
    s_nop 0
    s_cmp_eq_u64 vcc, -1
    s_cbranch_scc0 L_p3_noce2
    s_lshr_b32 s34, s2, 3
    s_and_b32 s34, s34, 7
    s_mul_i32 s34, s34, 102400
    s_lshl_b32 s30, s4, 10
    s_add_u32 s34, s34, s30
    s_add_u32 s34, s34, 15933440
    v_lshlrev_b32 v5, 4, v0
    s_mov_b32 m0, s30
    s_nop 0
    buffer_load_dwordx4 v5, s[12:15], s34 offen lds
    s_add_u32 s34, s34, 4096
    s_add_u32 m0, m0, 4096
    s_nop 0
    buffer_load_dwordx4 v5, s[12:15], s34 offen lds
    s_add_u32 s34, s34, 4096
    s_add_u32 m0, m0, 4096
    s_nop 0
    buffer_load_dwordx4 v5, s[12:15], s34 offen lds
    s_add_u32 s34, s34, 4096
    s_add_u32 m0, m0, 4096
    s_nop 0
    buffer_load_dwordx4 v5, s[12:15], s34 offen lds
    s_add_u32 s34, s34, 4096
    s_add_u32 m0, m0, 4096
    s_nop 0
    buffer_load_dwordx4 v5, s[12:15], s34 offen lds
    s_add_u32 s34, s34, 4096
    s_add_u32 m0, m0, 4096
    s_nop 0
    buffer_load_dwordx4 v5, s[12:15], s34 offen lds
    s_add_u32 s34, s34, 4096
    s_add_u32 m0, m0, 4096
    s_nop 0
    buffer_load_dwordx4 v5, s[12:15], s34 offen lds
    s_add_u32 s34, s34, 4096
    s_add_u32 m0, m0, 4096
    s_nop 0
    buffer_load_dwordx4 v5, s[12:15], s34 offen lds
    s_add_u32 s34, s34, 4096
    s_add_u32 m0, m0, 4096
    s_nop 0
    buffer_load_dwordx4 v5, s[12:15], s34 offen lds
    s_add_u32 s34, s34, 4096
    s_add_u32 m0, m0, 4096
    s_nop 0
    buffer_load_dwordx4 v5, s[12:15], s34 offen lds
    s_add_u32 s34, s34, 4096
    s_add_u32 m0, m0, 4096
    s_nop 0
    buffer_load_dwordx4 v5, s[12:15], s34 offen lds
    s_add_u32 s34, s34, 4096
    s_add_u32 m0, m0, 4096
    s_nop 0
    buffer_load_dwordx4 v5, s[12:15], s34 offen lds
    s_add_u32 s34, s34, 4096
    s_add_u32 m0, m0, 4096
    s_cmp_lt_u32 s4, 2
    s_cbranch_scc0 L_p3_w1
    buffer_load_dwordx4 v5, s[12:15], s34 offen lds
L_p3_w1:
    s_sub_u32 s34, s34, 49152
    s_add_u32 s34, s34, 51200
    s_add_u32 m0, s30, 81920
    s_nop 0
    buffer_load_dwordx4 v5, s[12:15], s34 offen lds
    s_add_u32 s34, s34, 4096
    s_add_u32 m0, m0, 4096
    s_nop 0
    buffer_load_dwordx4 v5, s[12:15], s34 offen lds
    s_add_u32 s34, s34, 4096
    s_add_u32 m0, m0, 4096
    s_nop 0
    buffer_load_dwordx4 v5, s[12:15], s34 offen lds
    s_add_u32 s34, s34, 4096
    s_add_u32 m0, m0, 4096
    s_nop 0
    buffer_load_dwordx4 v5, s[12:15], s34 offen lds
    s_add_u32 s34, s34, 4096
    s_add_u32 m0, m0, 4096
    s_nop 0
    buffer_load_dwordx4 v5, s[12:15], s34 offen lds
    s_add_u32 s34, s34, 4096
    s_add_u32 m0, m0, 4096
    s_nop 0
    buffer_load_dwordx4 v5, s[12:15], s34 offen lds
    s_add_u32 s34, s34, 4096
    s_add_u32 m0, m0, 4096
    s_nop 0
    buffer_load_dwordx4 v5, s[12:15], s34 offen lds
    s_add_u32 s34, s34, 4096
    s_add_u32 m0, m0, 4096
    s_nop 0
    buffer_load_dwordx4 v5, s[12:15], s34 offen lds
    s_add_u32 s34, s34, 4096
    s_add_u32 m0, m0, 4096
    s_nop 0
    buffer_load_dwordx4 v5, s[12:15], s34 offen lds
    s_add_u32 s34, s34, 4096
    s_add_u32 m0, m0, 4096
    s_nop 0
    buffer_load_dwordx4 v5, s[12:15], s34 offen lds
    s_add_u32 s34, s34, 4096
    s_add_u32 m0, m0, 4096
    s_nop 0
    buffer_load_dwordx4 v5, s[12:15], s34 offen lds
    s_add_u32 s34, s34, 4096
    s_add_u32 m0, m0, 4096
    s_nop 0
    buffer_load_dwordx4 v5, s[12:15], s34 offen lds
    s_add_u32 s34, s34, 4096
    s_add_u32 m0, m0, 4096
    s_cmp_lt_u32 s4, 2
    s_cbranch_scc0 L_p3_w2
    buffer_load_dwordx4 v5, s[12:15], s34 offen lds
L_p3_w2:
    s_mov_b32 s46, 1
L_p3_noce2:
    s_cmp_lt_u32 s4, 4
    s_cbranch_scc0 L_p3_noflag
    s_lshl_b32 s30, s4, 2
    s_add_u32 s30, s30, 51200
    v_mov_b32 v5, s30
    v_mov_b32 v6, s46
    ds_write_b32 v5, v6
L_p3_noflag:
    s_waitcnt lgkmcnt(0)
    s_barrier
    s_mul_i32 s30, s23, 3072
    s_cmp_eq_u32 s24, 0
    s_mov_b32 s31, 151552
    s_cselect_b32 s32, 69632, s31
    s_cselect_b32 s31, s31, 69632
    s_add_u32 s32, s32, s30
    s_add_u32 s31, s31, s30
    v_add_u32 v8, s32, v7
    v_add_u32 v9, s31, v7
    s_cmp_eq_u32 s24, 0
    s_cbranch_scc1 L_p3_x0
    s_nop 7
    ds_write_b128 v8, v[56:59] offset:0
    ds_write_b128 v8, v[60:63] offset:1024
    ds_write_b128 v8, v[64:67] offset:2048
    v_mov_b32 v56, v72
    v_mov_b32 v57, v73
    v_mov_b32 v58, v74
    v_mov_b32 v59, v75
    v_mov_b32 v60, v76
    v_mov_b32 v61, v77
    v_mov_b32 v62, v78
    v_mov_b32 v63, v79
    v_mov_b32 v64, v80
    v_mov_b32 v65, v81
    v_mov_b32 v66, v82
    v_mov_b32 v67, v83
    v_mov_b32 v88, v96
    v_mov_b32 v89, v97
    v_mov_b32 v90, v98
    v_mov_b32 v91, v99
    v_mov_b32 v92, v100
    v_mov_b32 v93, v101
    s_branch L_p3_x1
L_p3_x0:
    s_nop 7
    ds_write_b128 v8, v[72:75] offset:0
    ds_write_b128 v8, v[76:79] offset:1024
    ds_write_b128 v8, v[80:83] offset:2048
L_p3_x1:
    s_waitcnt lgkmcnt(0)
    s_barrier
    ds_read_b128 v[16:19], v9 offset:0
    ds_read_b128 v[20:23], v9 offset:1024
    ds_read_b128 v[24:27], v9 offset:2048
    s_add_u32 s22, s22, s24
    s_waitcnt lgkmcnt(0)
    v_add_f32 v56, v56, v16
    v_add_f32 v57, v57, v17
    v_add_f32 v58, v58, v18
    v_add_f32 v59, v59, v19
    v_add_f32 v60, v60, v20
    v_add_f32 v61, v61, v21
    v_add_f32 v62, v62, v22
    v_add_f32 v63, v63, v23
    v_add_f32 v64, v64, v24
    v_add_f32 v65, v65, v25
    v_add_f32 v66, v66, v26
    v_add_f32 v67, v67, v27
    v_mov_b32 v10, v64
    v_mov_b32 v11, v64
    s_nop 1
    v_permlane32_swap_b32 v10, v11
    v_cmp_gt_f32 vcc, 0x5d800000, v11
    s_nop 0
    s_mov_b64 s[32:33], vcc
    v_cmp_lt_f32 vcc, 0x21800000, v11
    s_nop 0
    s_and_b64 s[32:33], s[32:33], vcc
    s_cmp_eq_u64 s[32:33], -1
    s_cbranch_scc1 L_p3_fin
    v_and_b32 v5, 31, v0
    v_lshrrev_b32 v6, 5, v0
    v_lshlrev_b32 v8, 3, v5
    v_add_u32 v8, 1024, v8
    v_lshlrev_b32 v9, 8, v6
    v_lshl_add_u32 v9, v5, 4, v9
    v_add_u32 v13, 512, v9
    v_lshlrev_b32 v14, 6, v6
    v_lshl_add_u32 v14, v5, 4, v14
    v_add_u32 v14, 768, v14
    v_add_u32 v15, 128, v14
    v_cmp_le_u32 vcc, 16, v5
    s_nop 1
    v_cndmask_b32 v9, v9, v14, vcc
    v_cndmask_b32 v13, v13, v15, vcc
    v_add_u32 v9, 1280, v9
    v_add_u32 v13, 1280, v13
    v_mov_b32 v10, 0xff800000
    s_mov_b32 s30, 64
    s_mov_b32 s31, s26
L_p3_max:
    buffer_load_dwordx4 v[104:107], v7, s[12:15], s31 offen
    buffer_load_dwordx2 v[112:113], v8, s[12:15], s31 offen
    s_waitcnt vmcnt(0)
    v_mfma_f32_32x32x16_bf16 v[16:31], v[104:107], v[88:91], 0
    v_mfma_f32_32x32x8bf16_1k v[16:31], v[112:113], v[92:93], v[16:31]
    s_nop 15
    v_max3_f32 v10, v16, v17, v10
    v_max3_f32 v10, v18, v19, v10
    v_max3_f32 v10, v20, v21, v10
    v_max3_f32 v10, v22, v23, v10
    v_max3_f32 v10, v24, v25, v10
    v_max3_f32 v10, v26, v27, v10
    v_max3_f32 v10, v28, v29, v10
    v_max3_f32 v10, v30, v31, v10
    s_add_u32 s31, s31, 2560
    s_sub_u32 s30, s30, 1
    s_cmp_lg_u32 s30, 0
    s_cbranch_scc1 L_p3_max
    v_mov_b32 v11, v10
    s_nop 1
    v_permlane32_swap_b32 v10, v11
    v_max_f32 v10, v10, v11
    v_sub_f32 v10, 0, v10
    v_mov_b32 v132, v10
    v_mov_b32 v56, 0
    v_mov_b32 v133, v10
    v_mov_b32 v57, 0
    v_mov_b32 v134, v10
    v_mov_b32 v58, 0
    v_mov_b32 v135, v10
    v_mov_b32 v59, 0
    v_mov_b32 v136, v10
    v_mov_b32 v60, 0
    v_mov_b32 v137, v10
    v_mov_b32 v61, 0
    v_mov_b32 v138, v10
    v_mov_b32 v62, 0
    v_mov_b32 v139, v10
    v_mov_b32 v63, 0
    v_mov_b32 v140, v10
    v_mov_b32 v64, 0
    v_mov_b32 v141, v10
    v_mov_b32 v65, 0
    v_mov_b32 v142, v10
    v_mov_b32 v66, 0
    v_mov_b32 v143, v10
    v_mov_b32 v67, 0
    v_mov_b32 v144, v10
    v_mov_b32 v68, 0
    v_mov_b32 v145, v10
    v_mov_b32 v69, 0
    v_mov_b32 v146, v10
    v_mov_b32 v70, 0
    v_mov_b32 v147, v10
    v_mov_b32 v71, 0
    s_mov_b32 s30, 64
    s_mov_b32 s31, s26
L_p3_slow:
    buffer_load_dwordx4 v[104:107], v7, s[12:15], s31 offen
    buffer_load_dwordx2 v[112:113], v8, s[12:15], s31 offen
    s_mov_b64 exec, s[44:45]
    buffer_load_dwordx4 v[116:119], v9, s[12:15], s31 offen
    buffer_load_dwordx4 v[124:127], v13, s[12:15], s31 offen
    s_mov_b64 exec, -1
    s_waitcnt vmcnt(0)
    v_mfma_f32_32x32x16_bf16 v[16:31], v[104:107], v[88:91], v[132:147]
    v_mfma_f32_32x32x8bf16_1k v[16:31], v[112:113], v[92:93], v[16:31]
    s_nop 15
    v_exp_f32 v16, v16
    v_exp_f32 v17, v17
    v_exp_f32 v18, v18
    v_exp_f32 v19, v19
    v_exp_f32 v20, v20
    v_exp_f32 v21, v21
    v_exp_f32 v22, v22
    v_exp_f32 v23, v23
    v_exp_f32 v24, v24
    v_exp_f32 v25, v25
    v_exp_f32 v26, v26
    v_exp_f32 v27, v27
    v_exp_f32 v28, v28
    v_exp_f32 v29, v29
    v_exp_f32 v30, v30
    v_exp_f32 v31, v31
    s_nop 0
    v_cvt_pk_bf16_f32 v48, v16, v17
    v_cvt_pk_bf16_f32 v49, v18, v19
    v_cvt_pk_bf16_f32 v50, v20, v21
    v_cvt_pk_bf16_f32 v51, v22, v23
    v_cvt_pk_bf16_f32 v52, v24, v25
    v_cvt_pk_bf16_f32 v53, v26, v27
    v_cvt_pk_bf16_f32 v54, v28, v29
    v_cvt_pk_bf16_f32 v55, v30, v31
    s_nop 1
    v_mfma_f32_32x32x16_bf16 v[56:71], v[116:119], v[48:51], v[56:71]
    v_mfma_f32_32x32x16_bf16 v[56:71], v[124:127], v[52:55], v[56:71]
    s_add_u32 s31, s31, 2560
    s_sub_u32 s30, s30, 1
    s_cmp_lg_u32 s30, 0
    s_cbranch_scc1 L_p3_slow
    s_nop 15
    v_mov_b32 v10, v64
    v_mov_b32 v11, v64
    s_nop 1
    v_permlane32_swap_b32 v10, v11
L_p3_fin:
    v_rcp_f32 v7, v11
    v_and_b32 v5, 31, v0
    v_lshrrev_b32 v6, 5, v0
    s_lshl_b32 s27, s22, 5
    v_add_u32 v8, s27, v5
    v_lshrrev_b32 v9, 6, v8
    s_mov_b32 s28, 81920
    v_mul_lo_u32 v9, v9, s28
    v_bfe_u32 v10, v8, 4, 2
    v_lshl_add_u32 v9, v10, 10, v9
    v_and_b32 v10, 15, v8
    v_lshl_add_u32 v9, v10, 4, v9
    v_mul_f32 v56, v56, v7
    v_mul_f32 v57, v57, v7
    v_mul_f32 v58, v58, v7
    v_mul_f32 v59, v59, v7
    v_mul_f32 v60, v60, v7
    v_mul_f32 v61, v61, v7
    v_mul_f32 v62, v62, v7
    v_mul_f32 v63, v63, v7
    v_mul_f32 v64, v64, v7
    v_mul_f32 v65, v65, v7
    v_mul_f32 v66, v66, v7
    v_mul_f32 v67, v67, v7
    v_cvt_pk_bf16_f32 v56, v56, v57
    v_cvt_pk_bf16_f32 v57, v58, v59
    v_cvt_pk_bf16_f32 v58, v60, v61
    v_cvt_pk_bf16_f32 v59, v62, v63
    v_cvt_pk_bf16_f32 v60, v64, v65
    v_cvt_pk_bf16_f32 v61, v66, v67
    s_lshl_b32 s28, s20, 1
    v_add_u32 v10, s28, v6
    v_and_b32 v11, 3, v10
    v_lshl_add_u32 v12, v11, 8, v9
    v_lshrrev_b32 v11, 2, v10
    v_lshl_add_u32 v12, v11, 12, v12
    v_permlane32_swap_b32 v56, v58
    v_permlane32_swap_b32 v57, v59
    s_mov_b32 s29, 13312000
    buffer_store_dwordx4 v[56:59], v12, s[12:15], s29 offen sc1
    s_lshr_b32 s28, s20, 1
    s_add_u32 s28, s28, 64
    s_and_b32 s30, s28, 3
    s_lshl_b32 s30, s30, 8
    s_lshr_b32 s28, s28, 2
    s_lshl_b32 s28, s28, 12
    s_add_u32 s28, s28, s30
    s_and_b32 s30, s20, 1
    s_lshl_b32 s30, s30, 3
    s_add_u32 s28, s28, s30
    s_add_u32 s28, s28, 13312000
    s_mov_b32 exec_hi, 0
    buffer_store_dwordx2 v[60:61], v9, s[12:15], s28 offen sc1
    s_mov_b64 exec, -1
    v_mov_b32 v250, 51216
    v_mov_b32 v251, 0
    s_cmp_eq_u32 s4, 5
    s_cbranch_scc0 L_pz_4
    ds_write_b32 v250, v251
L_pz_4:
    s_waitcnt lgkmcnt(0)
    s_barrier
    v_mov_b32 v251, 1
    s_cmp_ge_u32 s4, 6
    s_cbranch_scc0 L_pf_4
    v_mov_b32 v250, 51200
    ds_read_b128 v[252:255], v250
    s_waitcnt lgkmcnt(0)
    v_and_b32 v252, v252, v253
    v_and_b32 v254, v254, v255
    v_and_b32 v252, v252, v254
    s_nop 0
    v_readfirstlane_b32 s46, v252
    v_mov_b32 v250, 51216
    v_mov_b32 v251, 1
    s_waitcnt vmcnt(0)
    s_mov_b64 exec, 1
    ds_add_u32 v250, v251
    s_mov_b64 exec, -1
    s_cmp_eq_u32 s46, 1
    s_cbranch_scc1 L_p4_pfd
    s_and_b32 s47, s2, 15
    s_mov_b32 s3, 1208
    s_add_u32 s3, s3, s47
    v_mov_b32 v250, s3
    v_mov_b32 v251, 8
    s_mov_b32 s3, 1224
    s_add_u32 s3, s3, s47
    v_writelane_b32 v250, s3, 1
    s_mov_b32 s3, 1240
    s_add_u32 s3, s3, s47
    v_writelane_b32 v250, s3, 2
    s_mov_b32 s3, 1256
    s_add_u32 s3, s3, s47
    v_writelane_b32 v250, s3, 3
    s_mov_b32 s3, 1272
    s_add_u32 s3, s3, s47
    v_writelane_b32 v250, s3, 4
    s_mov_b32 s3, 1288
    s_add_u32 s3, s3, s47
    v_writelane_b32 v250, s3, 5
    s_mov_b32 s3, 1304
    s_add_u32 s3, s3, s47
    v_writelane_b32 v250, s3, 6
    s_mov_b32 s3, 1320
    s_add_u32 s3, s3, s47
    v_writelane_b32 v250, s3, 7
    s_mov_b32 s3, 1336
    s_add_u32 s3, s3, s47
    v_writelane_b32 v250, s3, 8
    s_mov_b32 s3, 1352
    s_add_u32 s3, s3, s47
    v_writelane_b32 v250, s3, 9
    s_mov_b32 s3, 1368
    s_add_u32 s3, s3, s47
    v_writelane_b32 v250, s3, 10
    s_mov_b32 s3, 1384
    s_add_u32 s3, s3, s47
    v_writelane_b32 v250, s3, 11
    s_mov_b32 s3, 1400
    s_add_u32 s3, s3, s47
    v_writelane_b32 v250, s3, 12
    s_mov_b32 s3, 1416
    s_add_u32 s3, s3, s47
    v_writelane_b32 v250, s3, 13
    s_mov_b32 s3, 1432
    s_add_u32 s3, s3, s47
    v_writelane_b32 v250, s3, 14
    s_mov_b32 s3, 1448
    s_add_u32 s3, s3, s47
    v_writelane_b32 v250, s3, 15
    s_mov_b32 s3, 1464
    s_add_u32 s3, s3, s47
    v_writelane_b32 v250, s3, 16
    s_mov_b32 s3, 1480
    s_add_u32 s3, s3, s47
    v_writelane_b32 v250, s3, 17
    s_mov_b32 s3, 1496
    s_add_u32 s3, s3, s47
    v_writelane_b32 v250, s3, 18
    s_mov_b32 s3, 1512
    s_add_u32 s3, s3, s47
    v_writelane_b32 v250, s3, 19
    s_mov_b32 s3, 1528
    s_add_u32 s3, s3, s47
    v_writelane_b32 v250, s3, 20
    s_mov_b32 s3, 1544
    s_add_u32 s3, s3, s47
    v_writelane_b32 v250, s3, 21
    s_mov_b32 s3, 1560
    s_add_u32 s3, s3, s47
    v_writelane_b32 v250, s3, 22
    s_mov_b32 s3, 1576
    s_add_u32 s3, s3, s47
    v_writelane_b32 v250, s3, 23
    s_mov_b32 s3, 1592
    s_add_u32 s3, s3, s47
    v_writelane_b32 v250, s3, 24
    s_mov_b32 s3, 1608
    s_add_u32 s3, s3, s47
    v_writelane_b32 v250, s3, 25
    s_mov_b32 s3, 1624
    s_add_u32 s3, s3, s47
    v_writelane_b32 v250, s3, 26
    s_mov_b32 s3, 1640
    s_add_u32 s3, s3, s47
    v_writelane_b32 v250, s3, 27
    s_mov_b32 s3, 1656
    s_add_u32 s3, s3, s47
    v_writelane_b32 v250, s3, 28
    s_mov_b32 s3, 1672
    s_add_u32 s3, s3, s47
    v_writelane_b32 v250, s3, 29
    s_mov_b32 s3, 1688
    s_add_u32 s3, s3, s47
    v_writelane_b32 v250, s3, 30
    s_mov_b32 s3, 1704
    s_add_u32 s3, s3, s47
    v_writelane_b32 v250, s3, 31
    v_lshlrev_b32 v250, 7, v250
    v_add_u32 v250, 31719424, v250
    s_mov_b32 s3, 0
L_poll_p4e:
    global_load_dword v252, v250, s[6:7] sc1
    s_waitcnt vmcnt(0)
    v_cmp_ge_u32 vcc, v252, v251
    s_nop 0
    s_cmp_eq_u64 vcc, -1
    s_cbranch_scc1 L_polled_p4e
    s_add_u32 s3, s3, 1
    s_cmp_lt_u32 s3, 0x200000
    s_cbranch_scc1 L_poll_p4e
L_polled_p4e:
    v_lshlrev_b32 v2, 4, v0
    s_lshr_b32 s21, s2, 3
    s_and_b32 s21, s21, 7
    s_sub_u32 s30, s4, 6
    s_mul_i32 s32, s21, 102400
    s_mul_i32 s33, s30, 5120
    s_add_u32 s32, s32, s33
    s_add_u32 s32, s32, 15933440
    s_add_u32 m0, s33, 0
    s_add_u32 s38, s32, 0
    buffer_load_dwordx4 v2, s[12:15], s38 offen offset:0 lds
    buffer_load_dwordx4 v2, s[12:15], s38 offen offset:1024 lds
    buffer_load_dwordx4 v2, s[12:15], s38 offen offset:2048 lds
    buffer_load_dwordx4 v2, s[12:15], s38 offen offset:3072 lds
    s_add_u32 m0, m0, 4096
    s_add_u32 s38, s38, 4096
    buffer_load_dwordx4 v2, s[12:15], s38 offen lds
    s_add_u32 m0, s33, 10240
    s_add_u32 s38, s32, 10240
    buffer_load_dwordx4 v2, s[12:15], s38 offen offset:0 lds
    buffer_load_dwordx4 v2, s[12:15], s38 offen offset:1024 lds
    buffer_load_dwordx4 v2, s[12:15], s38 offen offset:2048 lds
    buffer_load_dwordx4 v2, s[12:15], s38 offen offset:3072 lds
    s_add_u32 m0, m0, 4096
    s_add_u32 s38, s38, 4096
    buffer_load_dwordx4 v2, s[12:15], s38 offen lds
    s_add_u32 m0, s33, 20480
    s_add_u32 s38, s32, 20480
    buffer_load_dwordx4 v2, s[12:15], s38 offen offset:0 lds
    buffer_load_dwordx4 v2, s[12:15], s38 offen offset:1024 lds
    buffer_load_dwordx4 v2, s[12:15], s38 offen offset:2048 lds
    buffer_load_dwordx4 v2, s[12:15], s38 offen offset:3072 lds
    s_add_u32 m0, m0, 4096
    s_add_u32 s38, s38, 4096
    buffer_load_dwordx4 v2, s[12:15], s38 offen lds
    s_add_u32 m0, s33, 30720
    s_add_u32 s38, s32, 30720
    buffer_load_dwordx4 v2, s[12:15], s38 offen offset:0 lds
    buffer_load_dwordx4 v2, s[12:15], s38 offen offset:1024 lds
    buffer_load_dwordx4 v2, s[12:15], s38 offen offset:2048 lds
    buffer_load_dwordx4 v2, s[12:15], s38 offen offset:3072 lds
    s_add_u32 m0, m0, 4096
    s_add_u32 s38, s38, 4096
    buffer_load_dwordx4 v2, s[12:15], s38 offen lds
    s_add_u32 m0, s33, 40960
    s_add_u32 s38, s32, 40960
    buffer_load_dwordx4 v2, s[12:15], s38 offen offset:0 lds
    buffer_load_dwordx4 v2, s[12:15], s38 offen offset:1024 lds
    buffer_load_dwordx4 v2, s[12:15], s38 offen offset:2048 lds
    buffer_load_dwordx4 v2, s[12:15], s38 offen offset:3072 lds
    s_add_u32 m0, m0, 4096
    s_add_u32 s38, s38, 4096
    buffer_load_dwordx4 v2, s[12:15], s38 offen lds
    s_add_u32 m0, s33, 81920
    s_add_u32 s38, s32, 51200
    buffer_load_dwordx4 v2, s[12:15], s38 offen offset:0 lds
    buffer_load_dwordx4 v2, s[12:15], s38 offen offset:1024 lds
    buffer_load_dwordx4 v2, s[12:15], s38 offen offset:2048 lds
    buffer_load_dwordx4 v2, s[12:15], s38 offen offset:3072 lds
    s_add_u32 m0, m0, 4096
    s_add_u32 s38, s38, 4096
    buffer_load_dwordx4 v2, s[12:15], s38 offen lds
    s_add_u32 m0, s33, 92160
    s_add_u32 s38, s32, 61440
    buffer_load_dwordx4 v2, s[12:15], s38 offen offset:0 lds
    buffer_load_dwordx4 v2, s[12:15], s38 offen offset:1024 lds
    buffer_load_dwordx4 v2, s[12:15], s38 offen offset:2048 lds
    buffer_load_dwordx4 v2, s[12:15], s38 offen offset:3072 lds
    s_add_u32 m0, m0, 4096
    s_add_u32 s38, s38, 4096
    buffer_load_dwordx4 v2, s[12:15], s38 offen lds
    s_add_u32 m0, s33, 102400
    s_add_u32 s38, s32, 71680
    buffer_load_dwordx4 v2, s[12:15], s38 offen offset:0 lds
    buffer_load_dwordx4 v2, s[12:15], s38 offen offset:1024 lds
    buffer_load_dwordx4 v2, s[12:15], s38 offen offset:2048 lds
    buffer_load_dwordx4 v2, s[12:15], s38 offen offset:3072 lds
    s_add_u32 m0, m0, 4096
    s_add_u32 s38, s38, 4096
    buffer_load_dwordx4 v2, s[12:15], s38 offen lds
    s_add_u32 m0, s33, 112640
    s_add_u32 s38, s32, 81920
    buffer_load_dwordx4 v2, s[12:15], s38 offen offset:0 lds
    buffer_load_dwordx4 v2, s[12:15], s38 offen offset:1024 lds
    buffer_load_dwordx4 v2, s[12:15], s38 offen offset:2048 lds
    buffer_load_dwordx4 v2, s[12:15], s38 offen offset:3072 lds
    s_add_u32 m0, m0, 4096
    s_add_u32 s38, s38, 4096
    buffer_load_dwordx4 v2, s[12:15], s38 offen lds
    s_add_u32 m0, s33, 122880
    s_add_u32 s38, s32, 92160
    buffer_load_dwordx4 v2, s[12:15], s38 offen offset:0 lds
    buffer_load_dwordx4 v2, s[12:15], s38 offen offset:1024 lds
    buffer_load_dwordx4 v2, s[12:15], s38 offen offset:2048 lds
    buffer_load_dwordx4 v2, s[12:15], s38 offen offset:3072 lds
    s_add_u32 m0, m0, 4096
    s_add_u32 s38, s38, 4096
    buffer_load_dwordx4 v2, s[12:15], s38 offen lds
L_p4_pfd:
    s_branch L_pf2_4
L_pf_4:
    s_waitcnt vmcnt(0)
    s_mov_b64 exec, 1
    ds_add_u32 v250, v251
    s_mov_b64 exec, -1
L_pf2_4:
    s_and_b32 s24, s2, 7
    s_lshr_b32 s25, s2, 3
    s_lshl_b32 s20, s24, 2
    s_lshr_b32 s26, s25, 3
    s_add_u32 s20, s20, s26
    s_and_b32 s21, s25, 7
    s_mov_b32 s16, s48
    s_mov_b32 s17, s49
    s_mov_b32 s18, 2621440
    s_mov_b32 s19, 0x00020000
    s_cmp_ge_u32 s4, 4
    s_cbranch_scc1 L_p4_prod
    v_lshlrev_b32 v2, 4, v0
    s_lshl_b32 s32, s4, 10
    v_add_u32 v3, s32, v2
    v_add_u32 v4, 133120, v3
    v_add_u32 v3, 51200, v3
    v_add_u32 v5, 81920, v2
    v_and_b32 v7, 15, v0
    v_lshrrev_b32 v8, 4, v0
    s_lshl_b32 s33, s20, 6
    s_lshl_b32 s34, s4, 4
    s_add_u32 s33, s33, s34
    v_add_u32 v9, s33, v7
    v_mul_u32_u24 v10, 1280, v9
    v_lshl_add_u32 v10, v8, 3, v10
    s_mul_i32 s34, s21, 160
    v_lshlrev_b32 v11, 4, v8
    s_mul_i32 s35, s21, 320
    s_add_u32 s35, s35, 5435392
    s_add_u32 s36, s35, 5120
    v_mov_b32 v64, 0
    v_mov_b32 v65, 0
    v_mov_b32 v66, 0
    v_mov_b32 v67, 0
    v_mov_b32 v68, 0
    v_mov_b32 v69, 0
    v_mov_b32 v70, 0
    v_mov_b32 v71, 0
    v_mov_b32 v72, 0
    v_mov_b32 v73, 0
    v_mov_b32 v74, 0
    v_mov_b32 v75, 0
    v_mov_b32 v76, 0
    v_mov_b32 v77, 0
    v_mov_b32 v78, 0
    v_mov_b32 v79, 0
    v_mov_b32 v80, 0
    v_mov_b32 v81, 0
    v_mov_b32 v82, 0
    v_mov_b32 v83, 0
    buffer_load_dwordx2 v[120:121], v10, s[16:19], s34 offen offset:0
    buffer_load_dwordx2 v[122:123], v10, s[16:19], s34 offen offset:32
    buffer_load_dwordx2 v[124:125], v10, s[16:19], s34 offen offset:64
    buffer_load_dwordx2 v[126:127], v10, s[16:19], s34 offen offset:96
    buffer_load_dwordx2 v[128:129], v10, s[16:19], s34 offen offset:128
    buffer_load_dwordx4 v[130:133], v11, s[12:15], s35 offen offset:0
    buffer_load_dwordx4 v[150:153], v11, s[12:15], s36 offen offset:0
    buffer_load_dwordx4 v[134:137], v11, s[12:15], s35 offen offset:64
    buffer_load_dwordx4 v[154:157], v11, s[12:15], s36 offen offset:64
    buffer_load_dwordx4 v[138:141], v11, s[12:15], s35 offen offset:128
    buffer_load_dwordx4 v[158:161], v11, s[12:15], s36 offen offset:128
    buffer_load_dwordx4 v[142:145], v11, s[12:15], s35 offen offset:192
    buffer_load_dwordx4 v[162:165], v11, s[12:15], s36 offen offset:192
    buffer_load_dwordx4 v[146:149], v11, s[12:15], s35 offen offset:256
    buffer_load_dwordx4 v[166:169], v11, s[12:15], s36 offen offset:256
    s_barrier
    ds_read_b128 v[24:27], v3 offset:0
    ds_read_b128 v[28:31], v2 offset:0
    ds_read_b128 v[32:35], v2 offset:1024
    ds_read_b128 v[36:39], v2 offset:2048
    ds_read_b128 v[40:43], v2 offset:3072
    ds_read_b128 v[44:47], v2 offset:4096
    ds_read_b128 v[96:99], v3 offset:4096
    ds_read_b128 v[100:103], v2 offset:5120
    ds_read_b128 v[104:107], v2 offset:6144
    ds_read_b128 v[108:111], v2 offset:7168
    ds_read_b128 v[112:115], v2 offset:8192
    ds_read_b128 v[116:119], v2 offset:9216
    s_waitcnt lgkmcnt(6)
    v_mfma_f32_16x16x32_bf16 v[64:67], v[28:31], v[24:27], v[64:67]
    s_barrier
    ds_read_b128 v[176:179], v3 offset:8192
    v_mfma_f32_16x16x32_bf16 v[68:71], v[32:35], v[24:27], v[68:71]
    ds_read_b128 v[180:183], v2 offset:10240
    v_mfma_f32_16x16x32_bf16 v[72:75], v[36:39], v[24:27], v[72:75]
    ds_read_b128 v[184:187], v2 offset:11264
    v_mfma_f32_16x16x32_bf16 v[76:79], v[40:43], v[24:27], v[76:79]
    ds_read_b128 v[188:191], v2 offset:12288
    v_mfma_f32_16x16x32_bf16 v[80:83], v[44:47], v[24:27], v[80:83]
    ds_read_b128 v[192:195], v2 offset:13312
    ds_read_b128 v[196:199], v2 offset:14336
    s_waitcnt lgkmcnt(6)
    v_mfma_f32_16x16x32_bf16 v[64:67], v[100:103], v[96:99], v[64:67]
    ds_read_b128 v[24:27], v3 offset:12288
    v_mfma_f32_16x16x32_bf16 v[68:71], v[104:107], v[96:99], v[68:71]
    ds_read_b128 v[28:31], v2 offset:15360
    v_mfma_f32_16x16x32_bf16 v[72:75], v[108:111], v[96:99], v[72:75]
    ds_read_b128 v[32:35], v2 offset:16384
    v_mfma_f32_16x16x32_bf16 v[76:79], v[112:115], v[96:99], v[76:79]
    ds_read_b128 v[36:39], v2 offset:17408
    v_mfma_f32_16x16x32_bf16 v[80:83], v[116:119], v[96:99], v[80:83]
    ds_read_b128 v[40:43], v2 offset:18432
    ds_read_b128 v[44:47], v2 offset:19456
    s_waitcnt lgkmcnt(6)
    v_mfma_f32_16x16x32_bf16 v[64:67], v[180:183], v[176:179], v[64:67]
    s_barrier
    ds_read_b128 v[96:99], v3 offset:16384
    v_mfma_f32_16x16x32_bf16 v[68:71], v[184:187], v[176:179], v[68:71]
    ds_read_b128 v[100:103], v2 offset:20480
    v_mfma_f32_16x16x32_bf16 v[72:75], v[188:191], v[176:179], v[72:75]
    ds_read_b128 v[104:107], v2 offset:21504
    v_mfma_f32_16x16x32_bf16 v[76:79], v[192:195], v[176:179], v[76:79]
    ds_read_b128 v[108:111], v2 offset:22528
    v_mfma_f32_16x16x32_bf16 v[80:83], v[196:199], v[176:179], v[80:83]
    ds_read_b128 v[112:115], v2 offset:23552
    ds_read_b128 v[116:119], v2 offset:24576
    s_waitcnt lgkmcnt(6)
    v_mfma_f32_16x16x32_bf16 v[64:67], v[28:31], v[24:27], v[64:67]
    ds_read_b128 v[176:179], v3 offset:20480
    v_mfma_f32_16x16x32_bf16 v[68:71], v[32:35], v[24:27], v[68:71]
    ds_read_b128 v[180:183], v2 offset:25600
    v_mfma_f32_16x16x32_bf16 v[72:75], v[36:39], v[24:27], v[72:75]
    ds_read_b128 v[184:187], v2 offset:26624
    v_mfma_f32_16x16x32_bf16 v[76:79], v[40:43], v[24:27], v[76:79]
    ds_read_b128 v[188:191], v2 offset:27648
    v_mfma_f32_16x16x32_bf16 v[80:83], v[44:47], v[24:27], v[80:83]
    ds_read_b128 v[192:195], v2 offset:28672
    ds_read_b128 v[196:199], v2 offset:29696
    s_waitcnt lgkmcnt(6)
    v_mfma_f32_16x16x32_bf16 v[64:67], v[100:103], v[96:99], v[64:67]
    s_barrier
    ds_read_b128 v[24:27], v4 offset:0
    v_mfma_f32_16x16x32_bf16 v[68:71], v[104:107], v[96:99], v[68:71]
    ds_read_b128 v[28:31], v2 offset:30720
    v_mfma_f32_16x16x32_bf16 v[72:75], v[108:111], v[96:99], v[72:75]
    ds_read_b128 v[32:35], v2 offset:31744
    v_mfma_f32_16x16x32_bf16 v[76:79], v[112:115], v[96:99], v[76:79]
    ds_read_b128 v[36:39], v2 offset:32768
    v_mfma_f32_16x16x32_bf16 v[80:83], v[116:119], v[96:99], v[80:83]
    ds_read_b128 v[40:43], v2 offset:33792
    ds_read_b128 v[44:47], v2 offset:34816
    s_waitcnt lgkmcnt(6)
    v_mfma_f32_16x16x32_bf16 v[64:67], v[180:183], v[176:179], v[64:67]
    ds_read_b128 v[96:99], v4 offset:4096
    v_mfma_f32_16x16x32_bf16 v[68:71], v[184:187], v[176:179], v[68:71]
    ds_read_b128 v[100:103], v2 offset:35840
    v_mfma_f32_16x16x32_bf16 v[72:75], v[188:191], v[176:179], v[72:75]
    ds_read_b128 v[104:107], v2 offset:36864
    v_mfma_f32_16x16x32_bf16 v[76:79], v[192:195], v[176:179], v[76:79]
    ds_read_b128 v[108:111], v2 offset:37888
    v_mfma_f32_16x16x32_bf16 v[80:83], v[196:199], v[176:179], v[80:83]
    ds_read_b128 v[112:115], v2 offset:38912
    ds_read_b128 v[116:119], v2 offset:39936
    s_waitcnt lgkmcnt(6)
    v_mfma_f32_16x16x32_bf16 v[64:67], v[28:31], v[24:27], v[64:67]
    s_barrier
    ds_read_b128 v[176:179], v4 offset:8192
    v_mfma_f32_16x16x32_bf16 v[68:71], v[32:35], v[24:27], v[68:71]
    ds_read_b128 v[180:183], v2 offset:40960
    v_mfma_f32_16x16x32_bf16 v[72:75], v[36:39], v[24:27], v[72:75]
    ds_read_b128 v[184:187], v2 offset:41984
    v_mfma_f32_16x16x32_bf16 v[76:79], v[40:43], v[24:27], v[76:79]
    ds_read_b128 v[188:191], v2 offset:43008
    v_mfma_f32_16x16x32_bf16 v[80:83], v[44:47], v[24:27], v[80:83]
    ds_read_b128 v[192:195], v2 offset:44032
    ds_read_b128 v[196:199], v2 offset:45056
    s_waitcnt lgkmcnt(6)
    v_mfma_f32_16x16x32_bf16 v[64:67], v[100:103], v[96:99], v[64:67]
    ds_read_b128 v[24:27], v4 offset:12288
    v_mfma_f32_16x16x32_bf16 v[68:71], v[104:107], v[96:99], v[68:71]
    ds_read_b128 v[28:31], v2 offset:46080
    v_mfma_f32_16x16x32_bf16 v[72:75], v[108:111], v[96:99], v[72:75]
    ds_read_b128 v[32:35], v2 offset:47104
    v_mfma_f32_16x16x32_bf16 v[76:79], v[112:115], v[96:99], v[76:79]
    ds_read_b128 v[36:39], v2 offset:48128
    v_mfma_f32_16x16x32_bf16 v[80:83], v[116:119], v[96:99], v[80:83]
    ds_read_b128 v[40:43], v2 offset:49152
    ds_read_b128 v[44:47], v2 offset:50176
    s_waitcnt lgkmcnt(6)
    v_mfma_f32_16x16x32_bf16 v[64:67], v[180:183], v[176:179], v[64:67]
    s_barrier
    ds_read_b128 v[96:99], v4 offset:16384
    v_mfma_f32_16x16x32_bf16 v[68:71], v[184:187], v[176:179], v[68:71]
    ds_read_b128 v[100:103], v5 offset:0
    v_mfma_f32_16x16x32_bf16 v[72:75], v[188:191], v[176:179], v[72:75]
    ds_read_b128 v[104:107], v5 offset:1024
    v_mfma_f32_16x16x32_bf16 v[76:79], v[192:195], v[176:179], v[76:79]
    ds_read_b128 v[108:111], v5 offset:2048
    v_mfma_f32_16x16x32_bf16 v[80:83], v[196:199], v[176:179], v[80:83]
    ds_read_b128 v[112:115], v5 offset:3072
    ds_read_b128 v[116:119], v5 offset:4096
    s_waitcnt lgkmcnt(6)
    v_mfma_f32_16x16x32_bf16 v[64:67], v[28:31], v[24:27], v[64:67]
    ds_read_b128 v[176:179], v4 offset:20480
    v_mfma_f32_16x16x32_bf16 v[68:71], v[32:35], v[24:27], v[68:71]
    ds_read_b128 v[180:183], v5 offset:5120
    v_mfma_f32_16x16x32_bf16 v[72:75], v[36:39], v[24:27], v[72:75]
    ds_read_b128 v[184:187], v5 offset:6144
    v_mfma_f32_16x16x32_bf16 v[76:79], v[40:43], v[24:27], v[76:79]
    ds_read_b128 v[188:191], v5 offset:7168
    v_mfma_f32_16x16x32_bf16 v[80:83], v[44:47], v[24:27], v[80:83]
    ds_read_b128 v[192:195], v5 offset:8192
    ds_read_b128 v[196:199], v5 offset:9216
    s_waitcnt lgkmcnt(6)
    v_mfma_f32_16x16x32_bf16 v[64:67], v[100:103], v[96:99], v[64:67]
    s_barrier
    ds_read_b128 v[24:27], v3 offset:0
    v_mfma_f32_16x16x32_bf16 v[68:71], v[104:107], v[96:99], v[68:71]
    ds_read_b128 v[28:31], v5 offset:10240
    v_mfma_f32_16x16x32_bf16 v[72:75], v[108:111], v[96:99], v[72:75]
    ds_read_b128 v[32:35], v5 offset:11264
    v_mfma_f32_16x16x32_bf16 v[76:79], v[112:115], v[96:99], v[76:79]
    ds_read_b128 v[36:39], v5 offset:12288
    v_mfma_f32_16x16x32_bf16 v[80:83], v[116:119], v[96:99], v[80:83]
    ds_read_b128 v[40:43], v5 offset:13312
    ds_read_b128 v[44:47], v5 offset:14336
    s_waitcnt lgkmcnt(6)
    v_mfma_f32_16x16x32_bf16 v[64:67], v[180:183], v[176:179], v[64:67]
    ds_read_b128 v[96:99], v3 offset:4096
    v_mfma_f32_16x16x32_bf16 v[68:71], v[184:187], v[176:179], v[68:71]
    ds_read_b128 v[100:103], v5 offset:15360
    v_mfma_f32_16x16x32_bf16 v[72:75], v[188:191], v[176:179], v[72:75]
    ds_read_b128 v[104:107], v5 offset:16384
    v_mfma_f32_16x16x32_bf16 v[76:79], v[192:195], v[176:179], v[76:79]
    ds_read_b128 v[108:111], v5 offset:17408
    v_mfma_f32_16x16x32_bf16 v[80:83], v[196:199], v[176:179], v[80:83]
    ds_read_b128 v[112:115], v5 offset:18432
    ds_read_b128 v[116:119], v5 offset:19456
    s_waitcnt lgkmcnt(6)
    v_mfma_f32_16x16x32_bf16 v[64:67], v[28:31], v[24:27], v[64:67]
    s_barrier
    ds_read_b128 v[176:179], v3 offset:8192
    v_mfma_f32_16x16x32_bf16 v[68:71], v[32:35], v[24:27], v[68:71]
    ds_read_b128 v[180:183], v5 offset:20480
    v_mfma_f32_16x16x32_bf16 v[72:75], v[36:39], v[24:27], v[72:75]
    ds_read_b128 v[184:187], v5 offset:21504
    v_mfma_f32_16x16x32_bf16 v[76:79], v[40:43], v[24:27], v[76:79]
    ds_read_b128 v[188:191], v5 offset:22528
    v_mfma_f32_16x16x32_bf16 v[80:83], v[44:47], v[24:27], v[80:83]
    ds_read_b128 v[192:195], v5 offset:23552
    ds_read_b128 v[196:199], v5 offset:24576
    s_waitcnt lgkmcnt(6)
    v_mfma_f32_16x16x32_bf16 v[64:67], v[100:103], v[96:99], v[64:67]
    ds_read_b128 v[24:27], v3 offset:12288
    v_mfma_f32_16x16x32_bf16 v[68:71], v[104:107], v[96:99], v[68:71]
    ds_read_b128 v[28:31], v5 offset:25600
    v_mfma_f32_16x16x32_bf16 v[72:75], v[108:111], v[96:99], v[72:75]
    ds_read_b128 v[32:35], v5 offset:26624
    v_mfma_f32_16x16x32_bf16 v[76:79], v[112:115], v[96:99], v[76:79]
    ds_read_b128 v[36:39], v5 offset:27648
    v_mfma_f32_16x16x32_bf16 v[80:83], v[116:119], v[96:99], v[80:83]
    ds_read_b128 v[40:43], v5 offset:28672
    ds_read_b128 v[44:47], v5 offset:29696
    s_waitcnt lgkmcnt(6)
    v_mfma_f32_16x16x32_bf16 v[64:67], v[180:183], v[176:179], v[64:67]
    s_barrier
    ds_read_b128 v[96:99], v3 offset:16384
    v_mfma_f32_16x16x32_bf16 v[68:71], v[184:187], v[176:179], v[68:71]
    ds_read_b128 v[100:103], v5 offset:30720
    v_mfma_f32_16x16x32_bf16 v[72:75], v[188:191], v[176:179], v[72:75]
    ds_read_b128 v[104:107], v5 offset:31744
    v_mfma_f32_16x16x32_bf16 v[76:79], v[192:195], v[176:179], v[76:79]
    ds_read_b128 v[108:111], v5 offset:32768
    v_mfma_f32_16x16x32_bf16 v[80:83], v[196:199], v[176:179], v[80:83]
    ds_read_b128 v[112:115], v5 offset:33792
    ds_read_b128 v[116:119], v5 offset:34816
    s_waitcnt lgkmcnt(6)
    v_mfma_f32_16x16x32_bf16 v[64:67], v[28:31], v[24:27], v[64:67]
    ds_read_b128 v[176:179], v3 offset:20480
    v_mfma_f32_16x16x32_bf16 v[68:71], v[32:35], v[24:27], v[68:71]
    ds_read_b128 v[180:183], v5 offset:35840
    v_mfma_f32_16x16x32_bf16 v[72:75], v[36:39], v[24:27], v[72:75]
    ds_read_b128 v[184:187], v5 offset:36864
    v_mfma_f32_16x16x32_bf16 v[76:79], v[40:43], v[24:27], v[76:79]
    ds_read_b128 v[188:191], v5 offset:37888
    v_mfma_f32_16x16x32_bf16 v[80:83], v[44:47], v[24:27], v[80:83]
    ds_read_b128 v[192:195], v5 offset:38912
    ds_read_b128 v[196:199], v5 offset:39936
    s_waitcnt lgkmcnt(6)
    v_mfma_f32_16x16x32_bf16 v[64:67], v[100:103], v[96:99], v[64:67]
    s_barrier
    ds_read_b128 v[24:27], v4 offset:0
    v_mfma_f32_16x16x32_bf16 v[68:71], v[104:107], v[96:99], v[68:71]
    ds_read_b128 v[28:31], v5 offset:40960
    v_mfma_f32_16x16x32_bf16 v[72:75], v[108:111], v[96:99], v[72:75]
    ds_read_b128 v[32:35], v5 offset:41984
    v_mfma_f32_16x16x32_bf16 v[76:79], v[112:115], v[96:99], v[76:79]
    ds_read_b128 v[36:39], v5 offset:43008
    v_mfma_f32_16x16x32_bf16 v[80:83], v[116:119], v[96:99], v[80:83]
    ds_read_b128 v[40:43], v5 offset:44032
    ds_read_b128 v[44:47], v5 offset:45056
    s_waitcnt lgkmcnt(6)
    v_mfma_f32_16x16x32_bf16 v[64:67], v[180:183], v[176:179], v[64:67]
    ds_read_b128 v[96:99], v4 offset:4096
    v_mfma_f32_16x16x32_bf16 v[68:71], v[184:187], v[176:179], v[68:71]
    ds_read_b128 v[100:103], v5 offset:46080
    v_mfma_f32_16x16x32_bf16 v[72:75], v[188:191], v[176:179], v[72:75]
    ds_read_b128 v[104:107], v5 offset:47104
    v_mfma_f32_16x16x32_bf16 v[76:79], v[192:195], v[176:179], v[76:79]
    ds_read_b128 v[108:111], v5 offset:48128
    v_mfma_f32_16x16x32_bf16 v[80:83], v[196:199], v[176:179], v[80:83]
    ds_read_b128 v[112:115], v5 offset:49152
    ds_read_b128 v[116:119], v5 offset:50176
    s_waitcnt lgkmcnt(6)
    v_mfma_f32_16x16x32_bf16 v[64:67], v[28:31], v[24:27], v[64:67]
    v_mfma_f32_16x16x32_bf16 v[68:71], v[32:35], v[24:27], v[68:71]
    v_mfma_f32_16x16x32_bf16 v[72:75], v[36:39], v[24:27], v[72:75]
    v_mfma_f32_16x16x32_bf16 v[76:79], v[40:43], v[24:27], v[76:79]
    v_mfma_f32_16x16x32_bf16 v[80:83], v[44:47], v[24:27], v[80:83]
    s_waitcnt lgkmcnt(0)
    v_mfma_f32_16x16x32_bf16 v[64:67], v[100:103], v[96:99], v[64:67]
    v_mfma_f32_16x16x32_bf16 v[68:71], v[104:107], v[96:99], v[68:71]
    v_mfma_f32_16x16x32_bf16 v[72:75], v[108:111], v[96:99], v[72:75]
    v_mfma_f32_16x16x32_bf16 v[76:79], v[112:115], v[96:99], v[76:79]
    v_mfma_f32_16x16x32_bf16 v[80:83], v[116:119], v[96:99], v[80:83]
    s_waitcnt vmcnt(0)
    v_mov_b32 v12, 0
    v_mov_b32 v13, 0
    v_lshlrev_b32 v14, 16, v120
    v_and_b32 v15, 0xffff0000, v120
    v_lshlrev_b32 v16, 16, v121
    v_and_b32 v17, 0xffff0000, v121
    v_fma_f32 v64, v64, v130, v14
    v_fma_f32 v65, v65, v131, v15
    v_fma_f32 v66, v66, v132, v16
    v_fma_f32 v67, v67, v133, v17
    v_cvt_pk_bf16_f32 v240, v64, v65
    v_cvt_pk_bf16_f32 v241, v66, v67
    v_lshlrev_b32 v14, 16, v240
    v_and_b32 v15, 0xffff0000, v240
    v_lshlrev_b32 v16, 16, v241
    v_and_b32 v17, 0xffff0000, v241
    v_add_f32 v12, v12, v14
    v_fmac_f32 v13, v14, v14
    v_add_f32 v12, v12, v15
    v_fmac_f32 v13, v15, v15
    v_add_f32 v12, v12, v16
    v_fmac_f32 v13, v16, v16
    v_add_f32 v12, v12, v17
    v_fmac_f32 v13, v17, v17
    v_mul_f32 v14, v14, v150
    v_mul_f32 v15, v15, v151
    v_mul_f32 v16, v16, v152
    v_mul_f32 v17, v17, v153
    v_cvt_pk_bf16_f32 v100, v14, v15
    v_cvt_pk_bf16_f32 v101, v16, v17
    v_lshlrev_b32 v14, 16, v122
    v_and_b32 v15, 0xffff0000, v122
    v_lshlrev_b32 v16, 16, v123
    v_and_b32 v17, 0xffff0000, v123
    v_fma_f32 v68, v68, v134, v14
    v_fma_f32 v69, v69, v135, v15
    v_fma_f32 v70, v70, v136, v16
    v_fma_f32 v71, v71, v137, v17
    v_cvt_pk_bf16_f32 v242, v68, v69
    v_cvt_pk_bf16_f32 v243, v70, v71
    v_lshlrev_b32 v14, 16, v242
    v_and_b32 v15, 0xffff0000, v242
    v_lshlrev_b32 v16, 16, v243
    v_and_b32 v17, 0xffff0000, v243
    v_add_f32 v12, v12, v14
    v_fmac_f32 v13, v14, v14
    v_add_f32 v12, v12, v15
    v_fmac_f32 v13, v15, v15
    v_add_f32 v12, v12, v16
    v_fmac_f32 v13, v16, v16
    v_add_f32 v12, v12, v17
    v_fmac_f32 v13, v17, v17
    v_mul_f32 v14, v14, v154
    v_mul_f32 v15, v15, v155
    v_mul_f32 v16, v16, v156
    v_mul_f32 v17, v17, v157
    v_cvt_pk_bf16_f32 v102, v14, v15
    v_cvt_pk_bf16_f32 v103, v16, v17
    v_lshlrev_b32 v14, 16, v124
    v_and_b32 v15, 0xffff0000, v124
    v_lshlrev_b32 v16, 16, v125
    v_and_b32 v17, 0xffff0000, v125
    v_fma_f32 v72, v72, v138, v14
    v_fma_f32 v73, v73, v139, v15
    v_fma_f32 v74, v74, v140, v16
    v_fma_f32 v75, v75, v141, v17
    v_cvt_pk_bf16_f32 v244, v72, v73
    v_cvt_pk_bf16_f32 v245, v74, v75
    v_lshlrev_b32 v14, 16, v244
    v_and_b32 v15, 0xffff0000, v244
    v_lshlrev_b32 v16, 16, v245
    v_and_b32 v17, 0xffff0000, v245
    v_add_f32 v12, v12, v14
    v_fmac_f32 v13, v14, v14
    v_add_f32 v12, v12, v15
    v_fmac_f32 v13, v15, v15
    v_add_f32 v12, v12, v16
    v_fmac_f32 v13, v16, v16
    v_add_f32 v12, v12, v17
    v_fmac_f32 v13, v17, v17
    v_mul_f32 v14, v14, v158
    v_mul_f32 v15, v15, v159
    v_mul_f32 v16, v16, v160
    v_mul_f32 v17, v17, v161
    v_cvt_pk_bf16_f32 v104, v14, v15
    v_cvt_pk_bf16_f32 v105, v16, v17
    v_lshlrev_b32 v14, 16, v126
    v_and_b32 v15, 0xffff0000, v126
    v_lshlrev_b32 v16, 16, v127
    v_and_b32 v17, 0xffff0000, v127
    v_fma_f32 v76, v76, v142, v14
    v_fma_f32 v77, v77, v143, v15
    v_fma_f32 v78, v78, v144, v16
    v_fma_f32 v79, v79, v145, v17
    v_cvt_pk_bf16_f32 v246, v76, v77
    v_cvt_pk_bf16_f32 v247, v78, v79
    v_lshlrev_b32 v14, 16, v246
    v_and_b32 v15, 0xffff0000, v246
    v_lshlrev_b32 v16, 16, v247
    v_and_b32 v17, 0xffff0000, v247
    v_add_f32 v12, v12, v14
    v_fmac_f32 v13, v14, v14
    v_add_f32 v12, v12, v15
    v_fmac_f32 v13, v15, v15
    v_add_f32 v12, v12, v16
    v_fmac_f32 v13, v16, v16
    v_add_f32 v12, v12, v17
    v_fmac_f32 v13, v17, v17
    v_mul_f32 v14, v14, v162
    v_mul_f32 v15, v15, v163
    v_mul_f32 v16, v16, v164
    v_mul_f32 v17, v17, v165
    v_cvt_pk_bf16_f32 v106, v14, v15
    v_cvt_pk_bf16_f32 v107, v16, v17
    v_lshlrev_b32 v14, 16, v128
    v_and_b32 v15, 0xffff0000, v128
    v_lshlrev_b32 v16, 16, v129
    v_and_b32 v17, 0xffff0000, v129
    v_fma_f32 v80, v80, v146, v14
    v_fma_f32 v81, v81, v147, v15
    v_fma_f32 v82, v82, v148, v16
    v_fma_f32 v83, v83, v149, v17
    v_cvt_pk_bf16_f32 v248, v80, v81
    v_cvt_pk_bf16_f32 v249, v82, v83
    v_lshlrev_b32 v14, 16, v248
    v_and_b32 v15, 0xffff0000, v248
    v_lshlrev_b32 v16, 16, v249
    v_and_b32 v17, 0xffff0000, v249
    v_add_f32 v12, v12, v14
    v_fmac_f32 v13, v14, v14
    v_add_f32 v12, v12, v15
    v_fmac_f32 v13, v15, v15
    v_add_f32 v12, v12, v16
    v_fmac_f32 v13, v16, v16
    v_add_f32 v12, v12, v17
    v_fmac_f32 v13, v17, v17
    v_mul_f32 v14, v14, v166
    v_mul_f32 v15, v15, v167
    v_mul_f32 v16, v16, v168
    v_mul_f32 v17, v17, v169
    v_cvt_pk_bf16_f32 v108, v14, v15
    v_cvt_pk_bf16_f32 v109, v16, v17
    v_lshrrev_b32 v19, 7, v9
    s_mov_b32 s35, 163840
    v_mul_lo_u32 v19, v19, s35
    v_bfe_u32 v20, v9, 5, 2
    v_lshl_add_u32 v19, v20, 10, v19
    v_and_b32 v20, 31, v9
    v_lshl_add_u32 v19, v20, 4, v19
    v_lshrrev_b32 v21, 1, v8
    v_lshl_add_u32 v22, v21, 9, v19
    v_and_b32 v20, 1, v8
    v_lshl_add_u32 v23, v20, 12, v22
    v_lshl_add_u32 v24, v20, 3, v22
    s_mul_i32 s35, s21, 20480
    s_add_u32 s35, s35, 22650880
    v_permlane16_swap_b32 v100, v102
    v_permlane16_swap_b32 v101, v103
    buffer_store_dwordx4 v[100:103], v23, s[12:15], s35 offen sc1
    s_add_u32 s35, s35, 8192
    v_permlane16_swap_b32 v104, v106
    v_permlane16_swap_b32 v105, v107
    buffer_store_dwordx4 v[104:107], v23, s[12:15], s35 offen sc1
    s_add_u32 s35, s35, 8192
    buffer_store_dwordx2 v[108:109], v24, s[12:15], s35 offen sc1
    v_mov_b32 v14, v12
    s_nop 1
    v_permlane32_swap_b32 v12, v14
    v_add_f32 v12, v12, v14
    v_mov_b32 v14, v12
    s_nop 1
    v_permlane16_swap_b32 v12, v14
    v_add_f32 v12, v12, v14
    v_mov_b32 v14, v13
    s_nop 1
    v_permlane32_swap_b32 v13, v14
    v_add_f32 v13, v13, v14
    v_mov_b32 v14, v13
    s_nop 1
    v_permlane16_swap_b32 v13, v14
    v_add_f32 v13, v13, v14
    v_lshlrev_b32 v20, 3, v9
    s_lshl_b32 s35, s21, 14
    s_add_u32 s35, s35, 25272320
    s_mov_b32 exec_lo, 0xffff
    s_mov_b32 exec_hi, 0
    buffer_store_dwordx2 v[12:13], v20, s[12:15], s35 offen sc1
    s_branch L_p4_end
L_p4_prod:
    v_lshlrev_b32 v2, 4, v0
    s_cmp_ge_u32 s4, 6
    s_cbranch_scc1 L_p4_w
    s_cmp_eq_u32 s4, 5
    s_cbranch_scc1 L_p4_idle
    s_mul_i32 s32, s20, 81920
    s_add_u32 s32, s32, 13312000
    s_lshr_b32 s38, s2, 3
    s_and_b32 s38, s38, 7
    s_lshr_b32 s39, s2, 6
    s_mul_i32 s38, s38, 64
    s_add_u32 s38, s38, 1720
    s_and_b32 s3, s39, 3
    s_lshl_b32 s3, s3, 4
    s_add_u32 s38, s38, s3
    v_mov_b32 v250, 51216
    s_mov_b32 s3, 0
L_dr_4:
    ds_read_b32 v252, v250
    s_waitcnt lgkmcnt(0)
    v_readfirstlane_b32 s47, v252
    s_nop 0
    s_cmp_ge_u32 s47, 8
    s_cbranch_scc1 L_drd_4
    s_add_u32 s3, s3, 1
    s_cmp_lt_u32 s3, 0x400000
    s_cbranch_scc1 L_dr_4
L_drd_4:
    s_lshl_b32 s3, s38, 7
    s_add_u32 s3, s3, 31719424
    v_lshlrev_b32 v250, 7, v0
    v_add_u32 v250, s3, v250
    v_mov_b32 v251, 1
    s_mov_b32 exec_lo, 65535
    s_mov_b32 exec_hi, 0
    global_atomic_add v250, v251, s[6:7] sc1
    s_mov_b64 exec, -1
    s_and_b32 s38, s2, 7
    s_mul_i32 s38, s38, 64
    s_add_u32 s38, s38, 1720
    s_and_b32 s47, s2, 15
    s_add_u32 s3, s38, 0
    s_add_u32 s3, s3, s47
    v_mov_b32 v250, s3
    v_mov_b32 v251, 8
    s_add_u32 s3, s38, 16
    s_add_u32 s3, s3, s47
    v_writelane_b32 v250, s3, 1
    s_add_u32 s3, s38, 32
    s_add_u32 s3, s3, s47
    v_writelane_b32 v250, s3, 2
    s_add_u32 s3, s38, 48
    s_add_u32 s3, s3, s47
    v_writelane_b32 v250, s3, 3
    v_lshlrev_b32 v250, 7, v250
    v_add_u32 v250, 31719424, v250
    s_mov_b32 s3, 0
L_poll_p4:
    global_load_dword v252, v250, s[6:7] sc1
    s_waitcnt vmcnt(0)
    v_cmp_ge_u32 vcc, v252, v251
    s_nop 0
    s_cmp_eq_u64 vcc, -1
    s_cbranch_scc1 L_polled_p4
    s_add_u32 s3, s3, 1
    s_cmp_lt_u32 s3, 0x200000
    s_cbranch_scc1 L_poll_p4
L_polled_p4:
    s_mov_b32 m0, 51200
    s_add_u32 s38, s32, 0
    buffer_load_dwordx4 v2, s[12:15], s38 offen offset:0 lds
    buffer_load_dwordx4 v2, s[12:15], s38 offen offset:1024 lds
    buffer_load_dwordx4 v2, s[12:15], s38 offen offset:2048 lds
    buffer_load_dwordx4 v2, s[12:15], s38 offen offset:3072 lds
    s_add_u32 m0, m0, 4096
    s_add_u32 s38, s38, 4096
    buffer_load_dwordx4 v2, s[12:15], s38 offen offset:0 lds
    buffer_load_dwordx4 v2, s[12:15], s38 offen offset:1024 lds
    buffer_load_dwordx4 v2, s[12:15], s38 offen offset:2048 lds
    buffer_load_dwordx4 v2, s[12:15], s38 offen offset:3072 lds
    s_mov_b32 m0, 59392
    s_add_u32 s38, s32, 8192
    buffer_load_dwordx4 v2, s[12:15], s38 offen offset:0 lds
    buffer_load_dwordx4 v2, s[12:15], s38 offen offset:1024 lds
    buffer_load_dwordx4 v2, s[12:15], s38 offen offset:2048 lds
    buffer_load_dwordx4 v2, s[12:15], s38 offen offset:3072 lds
    s_add_u32 m0, m0, 4096
    s_add_u32 s38, s38, 4096
    buffer_load_dwordx4 v2, s[12:15], s38 offen offset:0 lds
    buffer_load_dwordx4 v2, s[12:15], s38 offen offset:1024 lds
    buffer_load_dwordx4 v2, s[12:15], s38 offen offset:2048 lds
    buffer_load_dwordx4 v2, s[12:15], s38 offen offset:3072 lds
    s_mov_b32 m0, 67584
    s_add_u32 s38, s32, 16384
    buffer_load_dwordx4 v2, s[12:15], s38 offen offset:0 lds
    buffer_load_dwordx4 v2, s[12:15], s38 offen offset:1024 lds
    buffer_load_dwordx4 v2, s[12:15], s38 offen offset:2048 lds
    buffer_load_dwordx4 v2, s[12:15], s38 offen offset:3072 lds
    s_add_u32 m0, m0, 4096
    s_add_u32 s38, s38, 4096
    buffer_load_dwordx4 v2, s[12:15], s38 offen offset:0 lds
    buffer_load_dwordx4 v2, s[12:15], s38 offen offset:1024 lds
    buffer_load_dwordx4 v2, s[12:15], s38 offen offset:2048 lds
    buffer_load_dwordx4 v2, s[12:15], s38 offen offset:3072 lds
    s_mov_b32 m0, 133120
    s_add_u32 s38, s32, 24576
    buffer_load_dwordx4 v2, s[12:15], s38 offen offset:0 lds
    buffer_load_dwordx4 v2, s[12:15], s38 offen offset:1024 lds
    buffer_load_dwordx4 v2, s[12:15], s38 offen offset:2048 lds
    buffer_load_dwordx4 v2, s[12:15], s38 offen offset:3072 lds
    s_add_u32 m0, m0, 4096
    s_add_u32 s38, s38, 4096
    buffer_load_dwordx4 v2, s[12:15], s38 offen offset:0 lds
    buffer_load_dwordx4 v2, s[12:15], s38 offen offset:1024 lds
    buffer_load_dwordx4 v2, s[12:15], s38 offen offset:2048 lds
    buffer_load_dwordx4 v2, s[12:15], s38 offen offset:3072 lds
    s_waitcnt vmcnt(24)
    s_barrier
    s_mov_b32 m0, 141312
    s_add_u32 s38, s32, 32768
    buffer_load_dwordx4 v2, s[12:15], s38 offen offset:0 lds
    buffer_load_dwordx4 v2, s[12:15], s38 offen offset:1024 lds
    buffer_load_dwordx4 v2, s[12:15], s38 offen offset:2048 lds
    buffer_load_dwordx4 v2, s[12:15], s38 offen offset:3072 lds
    s_add_u32 m0, m0, 4096
    s_add_u32 s38, s38, 4096
    buffer_load_dwordx4 v2, s[12:15], s38 offen offset:0 lds
    buffer_load_dwordx4 v2, s[12:15], s38 offen offset:1024 lds
    buffer_load_dwordx4 v2, s[12:15], s38 offen offset:2048 lds
    buffer_load_dwordx4 v2, s[12:15], s38 offen offset:3072 lds
    s_waitcnt vmcnt(24)
    s_barrier
    s_mov_b32 m0, 149504
    s_add_u32 s38, s32, 40960
    buffer_load_dwordx4 v2, s[12:15], s38 offen offset:0 lds
    buffer_load_dwordx4 v2, s[12:15], s38 offen offset:1024 lds
    buffer_load_dwordx4 v2, s[12:15], s38 offen offset:2048 lds
    buffer_load_dwordx4 v2, s[12:15], s38 offen offset:3072 lds
    s_add_u32 m0, m0, 4096
    s_add_u32 s38, s38, 4096
    buffer_load_dwordx4 v2, s[12:15], s38 offen offset:0 lds
    buffer_load_dwordx4 v2, s[12:15], s38 offen offset:1024 lds
    buffer_load_dwordx4 v2, s[12:15], s38 offen offset:2048 lds
    buffer_load_dwordx4 v2, s[12:15], s38 offen offset:3072 lds
    s_waitcnt vmcnt(24)
    s_barrier
    s_mov_b32 m0, 51200
    s_add_u32 s38, s32, 49152
    buffer_load_dwordx4 v2, s[12:15], s38 offen offset:0 lds
    buffer_load_dwordx4 v2, s[12:15], s38 offen offset:1024 lds
    buffer_load_dwordx4 v2, s[12:15], s38 offen offset:2048 lds
    buffer_load_dwordx4 v2, s[12:15], s38 offen offset:3072 lds
    s_add_u32 m0, m0, 4096
    s_add_u32 s38, s38, 4096
    buffer_load_dwordx4 v2, s[12:15], s38 offen offset:0 lds
    buffer_load_dwordx4 v2, s[12:15], s38 offen offset:1024 lds
    buffer_load_dwordx4 v2, s[12:15], s38 offen offset:2048 lds
    buffer_load_dwordx4 v2, s[12:15], s38 offen offset:3072 lds
    s_waitcnt vmcnt(24)
    s_barrier
    s_mov_b32 m0, 59392
    s_add_u32 s38, s32, 57344
    buffer_load_dwordx4 v2, s[12:15], s38 offen offset:0 lds
    buffer_load_dwordx4 v2, s[12:15], s38 offen offset:1024 lds
    buffer_load_dwordx4 v2, s[12:15], s38 offen offset:2048 lds
    buffer_load_dwordx4 v2, s[12:15], s38 offen offset:3072 lds
    s_add_u32 m0, m0, 4096
    s_add_u32 s38, s38, 4096
    buffer_load_dwordx4 v2, s[12:15], s38 offen offset:0 lds
    buffer_load_dwordx4 v2, s[12:15], s38 offen offset:1024 lds
    buffer_load_dwordx4 v2, s[12:15], s38 offen offset:2048 lds
    buffer_load_dwordx4 v2, s[12:15], s38 offen offset:3072 lds
    s_waitcnt vmcnt(24)
    s_barrier
    s_mov_b32 m0, 67584
    s_add_u32 s38, s32, 65536
    buffer_load_dwordx4 v2, s[12:15], s38 offen offset:0 lds
    buffer_load_dwordx4 v2, s[12:15], s38 offen offset:1024 lds
    buffer_load_dwordx4 v2, s[12:15], s38 offen offset:2048 lds
    buffer_load_dwordx4 v2, s[12:15], s38 offen offset:3072 lds
    s_add_u32 m0, m0, 4096
    s_add_u32 s38, s38, 4096
    buffer_load_dwordx4 v2, s[12:15], s38 offen offset:0 lds
    buffer_load_dwordx4 v2, s[12:15], s38 offen offset:1024 lds
    buffer_load_dwordx4 v2, s[12:15], s38 offen offset:2048 lds
    buffer_load_dwordx4 v2, s[12:15], s38 offen offset:3072 lds
    s_waitcnt vmcnt(24)
    s_barrier
    s_mov_b32 m0, 133120
    s_add_u32 s38, s32, 73728
    buffer_load_dwordx4 v2, s[12:15], s38 offen offset:0 lds
    buffer_load_dwordx4 v2, s[12:15], s38 offen offset:1024 lds
    buffer_load_dwordx4 v2, s[12:15], s38 offen offset:2048 lds
    buffer_load_dwordx4 v2, s[12:15], s38 offen offset:3072 lds
    s_add_u32 m0, m0, 4096
    s_add_u32 s38, s38, 4096
    buffer_load_dwordx4 v2, s[12:15], s38 offen offset:0 lds
    buffer_load_dwordx4 v2, s[12:15], s38 offen offset:1024 lds
    buffer_load_dwordx4 v2, s[12:15], s38 offen offset:2048 lds
    buffer_load_dwordx4 v2, s[12:15], s38 offen offset:3072 lds
    s_waitcnt vmcnt(24)
    s_barrier
    s_waitcnt vmcnt(16)
    s_barrier
    s_waitcnt vmcnt(8)
    s_barrier
    s_waitcnt vmcnt(0)
    s_barrier
    s_branch L_p4_end
L_p4_idle:
    s_barrier
    s_barrier
    s_barrier
    s_barrier
    s_barrier
    s_barrier
    s_barrier
    s_barrier
    s_barrier
    s_barrier
    s_branch L_p4_end
L_p4_w:
    s_waitcnt vmcnt(45)
    s_barrier
    s_waitcnt vmcnt(40)
    s_barrier
    s_waitcnt vmcnt(35)
    s_barrier
    s_waitcnt vmcnt(30)
    s_barrier
    s_waitcnt vmcnt(25)
    s_barrier
    s_waitcnt vmcnt(20)
    s_barrier
    s_waitcnt vmcnt(15)
    s_barrier
    s_waitcnt vmcnt(10)
    s_barrier
    s_waitcnt vmcnt(5)
    s_barrier
    s_waitcnt vmcnt(0)
    s_barrier
L_p4_end:
    s_mov_b64 exec, -1
    v_mov_b32 v250, 159748
    v_mov_b32 v251, 0
    s_cmp_eq_u32 s4, 5
    s_cbranch_scc0 L_pz_5
    ds_write_b32 v250, v251
L_pz_5:
    s_waitcnt lgkmcnt(0)
    s_barrier
    v_mov_b32 v251, 1
    s_cmp_ge_u32 s4, 6
    s_cbranch_scc0 L_pf_5
    s_and_b32 s24, s2, 7
    s_lshr_b32 s25, s2, 3
    s_and_b32 s26, s24, 1
    s_lshl_b32 s20, s26, 3
    s_lshr_b32 s26, s25, 2
    s_add_u32 s20, s20, s26
    s_lshr_b32 s26, s24, 1
    s_lshl_b32 s21, s26, 2
    s_and_b32 s26, s25, 3
    s_add_u32 s21, s21, s26
    v_lshlrev_b32 v2, 4, v0
    s_sub_u32 s30, s4, 6
    s_mul_i32 s32, s21, 245760
    s_mul_i32 s33, s30, 12288
    s_add_u32 s32, s32, s33
    s_add_u32 s32, s32, 18718720
    s_add_u32 s33, s33, 16384
    s_mul_i32 s38, s21, 768
    s_add_u32 s38, s38, 25403392
    s_mul_i32 s39, s30, 12288
    s_add_u32 s38, s38, s39
    s_lshl_b32 s39, s30, 10
    s_add_u32 m0, s39, 147456
    s_mov_b32 exec_hi, 0xffff
    buffer_load_dwordx4 v2, s[12:15], s38 offen lds
    s_mov_b32 exec_hi, -1
    s_add_u32 m0, s33, 0
    s_add_u32 s38, s32, 0
    buffer_load_dwordx4 v2, s[12:15], s38 offen offset:0 lds
    buffer_load_dwordx4 v2, s[12:15], s38 offen offset:1024 lds
    buffer_load_dwordx4 v2, s[12:15], s38 offen offset:2048 lds
    buffer_load_dwordx4 v2, s[12:15], s38 offen offset:3072 lds
    s_add_u32 m0, m0, 4096
    s_add_u32 s38, s38, 4096
    buffer_load_dwordx4 v2, s[12:15], s38 offen offset:0 lds
    buffer_load_dwordx4 v2, s[12:15], s38 offen offset:1024 lds
    buffer_load_dwordx4 v2, s[12:15], s38 offen offset:2048 lds
    buffer_load_dwordx4 v2, s[12:15], s38 offen offset:3072 lds
    s_add_u32 m0, m0, 4096
    s_add_u32 s38, s38, 4096
    buffer_load_dwordx4 v2, s[12:15], s38 offen offset:0 lds
    buffer_load_dwordx4 v2, s[12:15], s38 offen offset:1024 lds
    buffer_load_dwordx4 v2, s[12:15], s38 offen offset:2048 lds
    buffer_load_dwordx4 v2, s[12:15], s38 offen offset:3072 lds
    s_add_u32 m0, s33, 40960
    s_add_u32 s38, s32, 24576
    buffer_load_dwordx4 v2, s[12:15], s38 offen offset:0 lds
    buffer_load_dwordx4 v2, s[12:15], s38 offen offset:1024 lds
    buffer_load_dwordx4 v2, s[12:15], s38 offen offset:2048 lds
    buffer_load_dwordx4 v2, s[12:15], s38 offen offset:3072 lds
    s_add_u32 m0, m0, 4096
    s_add_u32 s38, s38, 4096
    buffer_load_dwordx4 v2, s[12:15], s38 offen offset:0 lds
    buffer_load_dwordx4 v2, s[12:15], s38 offen offset:1024 lds
    buffer_load_dwordx4 v2, s[12:15], s38 offen offset:2048 lds
    buffer_load_dwordx4 v2, s[12:15], s38 offen offset:3072 lds
    s_add_u32 m0, m0, 4096
    s_add_u32 s38, s38, 4096
    buffer_load_dwordx4 v2, s[12:15], s38 offen offset:0 lds
    buffer_load_dwordx4 v2, s[12:15], s38 offen offset:1024 lds
    buffer_load_dwordx4 v2, s[12:15], s38 offen offset:2048 lds
    buffer_load_dwordx4 v2, s[12:15], s38 offen offset:3072 lds
    s_add_u32 m0, s33, 81920
    s_add_u32 s38, s32, 49152
    buffer_load_dwordx4 v2, s[12:15], s38 offen offset:0 lds
    buffer_load_dwordx4 v2, s[12:15], s38 offen offset:1024 lds
    buffer_load_dwordx4 v2, s[12:15], s38 offen offset:2048 lds
    buffer_load_dwordx4 v2, s[12:15], s38 offen offset:3072 lds
    s_add_u32 m0, m0, 4096
    s_add_u32 s38, s38, 4096
    buffer_load_dwordx4 v2, s[12:15], s38 offen offset:0 lds
    buffer_load_dwordx4 v2, s[12:15], s38 offen offset:1024 lds
    buffer_load_dwordx4 v2, s[12:15], s38 offen offset:2048 lds
    buffer_load_dwordx4 v2, s[12:15], s38 offen offset:3072 lds
    s_add_u32 m0, m0, 4096
    s_add_u32 s38, s38, 4096
    buffer_load_dwordx4 v2, s[12:15], s38 offen offset:0 lds
    buffer_load_dwordx4 v2, s[12:15], s38 offen offset:1024 lds
    buffer_load_dwordx4 v2, s[12:15], s38 offen offset:2048 lds
    buffer_load_dwordx4 v2, s[12:15], s38 offen offset:3072 lds
    s_branch L_pf2_5
L_pf_5:
    s_cmp_ge_u32 s4, 4
    s_cbranch_scc1 L_pf2_5
    s_waitcnt vmcnt(0)
    s_mov_b64 exec, 1
    ds_add_u32 v250, v251
    s_mov_b64 exec, -1
L_pf2_5:
    s_and_b32 s24, s2, 7
    s_lshr_b32 s25, s2, 3
    s_and_b32 s26, s24, 1
    s_lshl_b32 s20, s26, 3
    s_lshr_b32 s26, s25, 2
    s_add_u32 s20, s20, s26
    s_lshr_b32 s26, s24, 1
    s_lshl_b32 s21, s26, 2
    s_and_b32 s26, s25, 3
    s_add_u32 s21, s21, s26
    s_mov_b32 s27, s20
    s_cmp_ge_u32 s4, 4
    s_cbranch_scc1 L_p5_prod
    s_lshr_b32 s30, s4, 1
    s_and_b32 s31, s4, 1
    v_and_b32 v6, 31, v0
    v_lshrrev_b32 v7, 5, v0
    s_lshl_b32 s32, s20, 7
    s_lshl_b32 s33, s30, 6
    s_add_u32 s32, s32, s33
    v_add_u32 v48, s32, v6
    v_lshlrev_b32 v50, 4, v7
    v_lshlrev_b32 v2, 4, v0
    s_lshl_b32 s35, s30, 11
    v_add_u32 v3, s35, v2
    v_add_u32 v4, 81920, v3
    s_mul_i32 s35, s31, 3072
    s_add_u32 s35, s35, 16384
    v_add_u32 v5, s35, v2
    v_add_u32 v51, 81920, v5
    s_lshl_b32 s35, s30, 9
    s_add_u32 s35, s35, 139264
    v_lshlrev_b32 v49, 3, v6
    v_add_u32 v49, s35, v49
    s_mul_i32 s35, s31, 384
    s_add_u32 s35, s35, 147456
    v_lshlrev_b32 v50, 2, v6
    v_xor_b32 v52, 1, v7
    v_lshl_add_u32 v50, v52, 10, v50
    v_add_u32 v50, s35, v50
    v_mov_b32 v128, 0
    v_mov_b32 v129, 0
    v_mov_b32 v130, 0
    v_mov_b32 v131, 0
    v_mov_b32 v132, 0
    v_mov_b32 v133, 0
    v_mov_b32 v134, 0
    v_mov_b32 v135, 0
    v_mov_b32 v136, 0
    v_mov_b32 v137, 0
    v_mov_b32 v138, 0
    v_mov_b32 v139, 0
    v_mov_b32 v140, 0
    v_mov_b32 v141, 0
    v_mov_b32 v142, 0
    v_mov_b32 v143, 0
    v_mov_b32 v144, 0
    v_mov_b32 v145, 0
    v_mov_b32 v146, 0
    v_mov_b32 v147, 0
    v_mov_b32 v148, 0
    v_mov_b32 v149, 0
    v_mov_b32 v150, 0
    v_mov_b32 v151, 0
    v_mov_b32 v152, 0
    v_mov_b32 v153, 0
    v_mov_b32 v154, 0
    v_mov_b32 v155, 0
    v_mov_b32 v156, 0
    v_mov_b32 v157, 0
    v_mov_b32 v158, 0
    v_mov_b32 v159, 0
    v_mov_b32 v160, 0
    v_mov_b32 v161, 0
    v_mov_b32 v162, 0
    v_mov_b32 v163, 0
    v_mov_b32 v164, 0
    v_mov_b32 v165, 0
    v_mov_b32 v166, 0
    v_mov_b32 v167, 0
    v_mov_b32 v168, 0
    v_mov_b32 v169, 0
    v_mov_b32 v170, 0
    v_mov_b32 v171, 0
    v_mov_b32 v172, 0
    v_mov_b32 v173, 0
    v_mov_b32 v174, 0
    v_mov_b32 v175, 0
    v_mov_b32 v176, 0
    v_mov_b32 v177, 0
    v_mov_b32 v178, 0
    v_mov_b32 v179, 0
    v_mov_b32 v180, 0
    v_mov_b32 v181, 0
    v_mov_b32 v182, 0
    v_mov_b32 v183, 0
    v_mov_b32 v184, 0
    v_mov_b32 v185, 0
    v_mov_b32 v186, 0
    v_mov_b32 v187, 0
    v_mov_b32 v188, 0
    v_mov_b32 v189, 0
    v_mov_b32 v190, 0
    v_mov_b32 v191, 0
    v_mov_b32 v192, 0
    v_mov_b32 v193, 0
    v_mov_b32 v194, 0
    v_mov_b32 v195, 0
    v_mov_b32 v196, 0
    v_mov_b32 v197, 0
    v_mov_b32 v198, 0
    v_mov_b32 v199, 0
    v_mov_b32 v200, 0
    v_mov_b32 v201, 0
    v_mov_b32 v202, 0
    v_mov_b32 v203, 0
    v_mov_b32 v204, 0
    v_mov_b32 v205, 0
    v_mov_b32 v206, 0
    v_mov_b32 v207, 0
    v_mov_b32 v208, 0
    v_mov_b32 v209, 0
    v_mov_b32 v210, 0
    v_mov_b32 v211, 0
    v_mov_b32 v212, 0
    v_mov_b32 v213, 0
    v_mov_b32 v214, 0
    v_mov_b32 v215, 0
    v_mov_b32 v216, 0
    v_mov_b32 v217, 0
    v_mov_b32 v218, 0
    v_mov_b32 v219, 0
    v_mov_b32 v220, 0
    v_mov_b32 v221, 0
    v_mov_b32 v222, 0
    v_mov_b32 v223, 0
    s_barrier
    ds_read_b128 v[8:11], v3 offset:0
    ds_read_b128 v[12:15], v3 offset:1024
    ds_read_b128 v[16:19], v5 offset:0
    ds_read_b128 v[20:23], v5 offset:1024
    ds_read_b128 v[24:27], v5 offset:2048
    ds_read_b128 v[28:31], v3 offset:4096
    ds_read_b128 v[32:35], v3 offset:5120
    ds_read_b128 v[36:39], v5 offset:6144
    ds_read_b128 v[40:43], v5 offset:7168
    ds_read_b128 v[44:47], v5 offset:8192
    s_waitcnt lgkmcnt(5)
    v_mfma_f32_32x32x16_bf16 v[128:143], v[16:19], v[8:11], v[128:143]
    ds_read_b128 v[224:227], v3 offset:8192
    v_mfma_f32_32x32x16_bf16 v[144:159], v[20:23], v[8:11], v[144:159]
    ds_read_b128 v[228:231], v3 offset:9216
    v_mfma_f32_32x32x16_bf16 v[160:175], v[24:27], v[8:11], v[160:175]
    ds_read_b128 v[116:119], v5 offset:12288
    v_mfma_f32_32x32x16_bf16 v[176:191], v[16:19], v[12:15], v[176:191]
    ds_read_b128 v[120:123], v5 offset:13312
    v_mfma_f32_32x32x16_bf16 v[192:207], v[20:23], v[12:15], v[192:207]
    ds_read_b128 v[124:127], v5 offset:14336
    v_mfma_f32_32x32x16_bf16 v[208:223], v[24:27], v[12:15], v[208:223]
    s_waitcnt lgkmcnt(5)
    v_mfma_f32_32x32x16_bf16 v[128:143], v[36:39], v[28:31], v[128:143]
    ds_read_b128 v[8:11], v3 offset:12288
    v_mfma_f32_32x32x16_bf16 v[144:159], v[40:43], v[28:31], v[144:159]
    ds_read_b128 v[12:15], v3 offset:13312
    v_mfma_f32_32x32x16_bf16 v[160:175], v[44:47], v[28:31], v[160:175]
    ds_read_b128 v[16:19], v5 offset:18432
    v_mfma_f32_32x32x16_bf16 v[176:191], v[36:39], v[32:35], v[176:191]
    ds_read_b128 v[20:23], v5 offset:19456
    v_mfma_f32_32x32x16_bf16 v[192:207], v[40:43], v[32:35], v[192:207]
    ds_read_b128 v[24:27], v5 offset:20480
    v_mfma_f32_32x32x16_bf16 v[208:223], v[44:47], v[32:35], v[208:223]
    s_waitcnt lgkmcnt(5)
    v_mfma_f32_32x32x16_bf16 v[128:143], v[116:119], v[224:227], v[128:143]
    s_barrier
    ds_read_b128 v[28:31], v3 offset:40960
    v_mfma_f32_32x32x16_bf16 v[144:159], v[120:123], v[224:227], v[144:159]
    ds_read_b128 v[32:35], v3 offset:41984
    v_mfma_f32_32x32x16_bf16 v[160:175], v[124:127], v[224:227], v[160:175]
    ds_read_b128 v[36:39], v5 offset:40960
    v_mfma_f32_32x32x16_bf16 v[176:191], v[116:119], v[228:231], v[176:191]
    ds_read_b128 v[40:43], v5 offset:41984
    v_mfma_f32_32x32x16_bf16 v[192:207], v[120:123], v[228:231], v[192:207]
    ds_read_b128 v[44:47], v5 offset:43008
    v_mfma_f32_32x32x16_bf16 v[208:223], v[124:127], v[228:231], v[208:223]
    ds_read_b64 v[56:57], v49 offset:0
    ds_read_b64 v[58:59], v49 offset:1024
    ds_read_b64 v[60:61], v49 offset:2048
    ds_read_b64 v[62:63], v49 offset:3072
    ds_read_b64 v[64:65], v49 offset:4096
    ds_read_b64 v[66:67], v49 offset:5120
    ds_read_b64 v[68:69], v49 offset:6144
    ds_read_b64 v[70:71], v49 offset:7168
    ds_read_b64 v[72:73], v49 offset:256
    ds_read_b64 v[74:75], v49 offset:1280
    ds_read_b64 v[76:77], v49 offset:2304
    ds_read_b64 v[78:79], v49 offset:3328
    ds_read_b64 v[80:81], v49 offset:4352
    ds_read_b64 v[82:83], v49 offset:5376
    ds_read_b64 v[84:85], v49 offset:6400
    ds_read_b64 v[86:87], v49 offset:7424
    ds_read_b32 v92, v50 offset:0
    ds_read_b32 v93, v50 offset:128
    ds_read_b32 v94, v50 offset:256
    s_waitcnt lgkmcnt(5)
    v_mfma_f32_32x32x16_bf16 v[128:143], v[16:19], v[8:11], v[128:143]
    ds_read_b128 v[224:227], v3 offset:45056
    v_mfma_f32_32x32x16_bf16 v[144:159], v[20:23], v[8:11], v[144:159]
    ds_read_b128 v[228:231], v3 offset:46080
    v_mfma_f32_32x32x16_bf16 v[160:175], v[24:27], v[8:11], v[160:175]
    ds_read_b128 v[116:119], v5 offset:47104
    v_mfma_f32_32x32x16_bf16 v[176:191], v[16:19], v[12:15], v[176:191]
    ds_read_b128 v[120:123], v5 offset:48128
    v_mfma_f32_32x32x16_bf16 v[192:207], v[20:23], v[12:15], v[192:207]
    ds_read_b128 v[124:127], v5 offset:49152
    v_mfma_f32_32x32x16_bf16 v[208:223], v[24:27], v[12:15], v[208:223]
    s_waitcnt lgkmcnt(5)
    v_mfma_f32_32x32x16_bf16 v[128:143], v[36:39], v[28:31], v[128:143]
    ds_read_b128 v[8:11], v3 offset:49152
    v_mfma_f32_32x32x16_bf16 v[144:159], v[40:43], v[28:31], v[144:159]
    ds_read_b128 v[12:15], v3 offset:50176
    v_mfma_f32_32x32x16_bf16 v[160:175], v[44:47], v[28:31], v[160:175]
    ds_read_b128 v[16:19], v5 offset:53248
    v_mfma_f32_32x32x16_bf16 v[176:191], v[36:39], v[32:35], v[176:191]
    ds_read_b128 v[20:23], v5 offset:54272
    v_mfma_f32_32x32x16_bf16 v[192:207], v[40:43], v[32:35], v[192:207]
    ds_read_b128 v[24:27], v5 offset:55296
    v_mfma_f32_32x32x16_bf16 v[208:223], v[44:47], v[32:35], v[208:223]
    s_waitcnt lgkmcnt(5)
    v_mfma_f32_32x32x16_bf16 v[128:143], v[116:119], v[224:227], v[128:143]
    ds_read_b128 v[28:31], v3 offset:53248
    v_mfma_f32_32x32x16_bf16 v[144:159], v[120:123], v[224:227], v[144:159]
    ds_read_b128 v[32:35], v3 offset:54272
    v_mfma_f32_32x32x16_bf16 v[160:175], v[124:127], v[224:227], v[160:175]
    ds_read_b128 v[36:39], v5 offset:59392
    v_mfma_f32_32x32x16_bf16 v[176:191], v[116:119], v[228:231], v[176:191]
    ds_read_b128 v[40:43], v5 offset:60416
    v_mfma_f32_32x32x16_bf16 v[192:207], v[120:123], v[228:231], v[192:207]
    ds_read_b128 v[44:47], v5 offset:61440
    v_mfma_f32_32x32x16_bf16 v[208:223], v[124:127], v[228:231], v[208:223]
    s_waitcnt lgkmcnt(5)
    v_mfma_f32_32x32x16_bf16 v[128:143], v[16:19], v[8:11], v[128:143]
    s_barrier
    ds_read_b128 v[224:227], v4 offset:0
    v_mfma_f32_32x32x16_bf16 v[144:159], v[20:23], v[8:11], v[144:159]
    ds_read_b128 v[228:231], v4 offset:1024
    v_mfma_f32_32x32x16_bf16 v[160:175], v[24:27], v[8:11], v[160:175]
    ds_read_b128 v[116:119], v51 offset:0
    v_mfma_f32_32x32x16_bf16 v[176:191], v[16:19], v[12:15], v[176:191]
    ds_read_b128 v[120:123], v51 offset:1024
    v_mfma_f32_32x32x16_bf16 v[192:207], v[20:23], v[12:15], v[192:207]
    ds_read_b128 v[124:127], v51 offset:2048
    v_mfma_f32_32x32x16_bf16 v[208:223], v[24:27], v[12:15], v[208:223]
    s_waitcnt lgkmcnt(5)
    v_mfma_f32_32x32x16_bf16 v[128:143], v[36:39], v[28:31], v[128:143]
    ds_read_b128 v[8:11], v4 offset:4096
    v_add_f32 v56, v56, v58
    v_add_f32 v57, v57, v59
    v_mfma_f32_32x32x16_bf16 v[144:159], v[40:43], v[28:31], v[144:159]
    ds_read_b128 v[12:15], v4 offset:5120
    v_add_f32 v56, v56, v60
    v_add_f32 v57, v57, v61
    v_mfma_f32_32x32x16_bf16 v[160:175], v[44:47], v[28:31], v[160:175]
    ds_read_b128 v[16:19], v51 offset:6144
    v_add_f32 v56, v56, v62
    v_add_f32 v57, v57, v63
    v_mfma_f32_32x32x16_bf16 v[176:191], v[36:39], v[32:35], v[176:191]
    ds_read_b128 v[20:23], v51 offset:7168
    v_add_f32 v56, v56, v64
    v_add_f32 v57, v57, v65
    v_mfma_f32_32x32x16_bf16 v[192:207], v[40:43], v[32:35], v[192:207]
    ds_read_b128 v[24:27], v51 offset:8192
    v_add_f32 v56, v56, v66
    v_add_f32 v57, v57, v67
    v_mfma_f32_32x32x16_bf16 v[208:223], v[44:47], v[32:35], v[208:223]
    v_add_f32 v56, v56, v68
    v_add_f32 v57, v57, v69
    s_waitcnt lgkmcnt(5)
    v_mfma_f32_32x32x16_bf16 v[128:143], v[116:119], v[224:227], v[128:143]
    ds_read_b128 v[28:31], v4 offset:8192
    v_add_f32 v56, v56, v70
    v_add_f32 v57, v57, v71
    v_mfma_f32_32x32x16_bf16 v[144:159], v[120:123], v[224:227], v[144:159]
    ds_read_b128 v[32:35], v4 offset:9216
    v_mul_f32 v52, 0x3acccccd, v56
    v_mul_f32 v57, 0x3acccccd, v57
    v_mfma_f32_32x32x16_bf16 v[160:175], v[124:127], v[224:227], v[160:175]
    ds_read_b128 v[36:39], v51 offset:12288
    v_fma_f32 v57, -v52, v52, v57
    v_max_f32 v57, 0, v57
    v_mfma_f32_32x32x16_bf16 v[176:191], v[116:119], v[228:231], v[176:191]
    ds_read_b128 v[40:43], v51 offset:13312
    v_add_f32 v57, 0x3727c5ac, v57
    v_sqrt_f32 v54, v57
    v_mfma_f32_32x32x16_bf16 v[192:207], v[120:123], v[228:231], v[192:207]
    ds_read_b128 v[44:47], v51 offset:14336
    v_rsq_f32 v88, v57
    v_add_f32 v72, v72, v74
    v_mfma_f32_32x32x16_bf16 v[208:223], v[124:127], v[228:231], v[208:223]
    v_add_f32 v73, v73, v75
    v_add_f32 v72, v72, v76
    s_waitcnt lgkmcnt(5)
    v_mfma_f32_32x32x16_bf16 v[128:143], v[16:19], v[8:11], v[128:143]
    ds_read_b128 v[224:227], v4 offset:12288
    v_add_f32 v73, v73, v77
    v_add_f32 v72, v72, v78
    v_mfma_f32_32x32x16_bf16 v[144:159], v[20:23], v[8:11], v[144:159]
    ds_read_b128 v[228:231], v4 offset:13312
    v_add_f32 v73, v73, v79
    v_add_f32 v72, v72, v80
    v_mfma_f32_32x32x16_bf16 v[160:175], v[24:27], v[8:11], v[160:175]
    ds_read_b128 v[116:119], v51 offset:18432
    v_add_f32 v73, v73, v81
    v_add_f32 v72, v72, v82
    v_mfma_f32_32x32x16_bf16 v[176:191], v[16:19], v[12:15], v[176:191]
    ds_read_b128 v[120:123], v51 offset:19456
    v_add_f32 v73, v73, v83
    v_add_f32 v72, v72, v84
    v_mfma_f32_32x32x16_bf16 v[192:207], v[20:23], v[12:15], v[192:207]
    ds_read_b128 v[124:127], v51 offset:20480
    v_add_f32 v73, v73, v85
    v_add_f32 v72, v72, v86
    v_mfma_f32_32x32x16_bf16 v[208:223], v[24:27], v[12:15], v[208:223]
    v_add_f32 v73, v73, v87
    v_mul_f32 v53, 0x3acccccd, v72
    s_waitcnt lgkmcnt(5)
    v_mfma_f32_32x32x16_bf16 v[128:143], v[36:39], v[28:31], v[128:143]
    s_barrier
    ds_read_b128 v[8:11], v4 offset:40960
    v_mul_f32 v73, 0x3acccccd, v73
    v_fma_f32 v73, -v53, v53, v73
    v_mfma_f32_32x32x16_bf16 v[144:159], v[40:43], v[28:31], v[144:159]
    ds_read_b128 v[12:15], v4 offset:41984
    v_max_f32 v73, 0, v73
    v_add_f32 v73, 0x3727c5ac, v73
    v_mfma_f32_32x32x16_bf16 v[160:175], v[44:47], v[28:31], v[160:175]
    ds_read_b128 v[16:19], v51 offset:40960
    v_sqrt_f32 v55, v73
    v_rsq_f32 v89, v73
    v_mfma_f32_32x32x16_bf16 v[176:191], v[36:39], v[32:35], v[176:191]
    ds_read_b128 v[20:23], v51 offset:41984
    v_cmp_gt_u32 vcc, 32, v0
    v_sub_f32 v56, 0, v52
    v_mfma_f32_32x32x16_bf16 v[192:207], v[40:43], v[32:35], v[192:207]
    ds_read_b128 v[24:27], v51 offset:43008
    v_cndmask_b32 v56, v56, v54, vcc
    v_cvt_pk_bf16_f32 v57, v56, v56
    v_mfma_f32_32x32x16_bf16 v[208:223], v[44:47], v[32:35], v[208:223]
    v_lshlrev_b32 v58, 16, v57
    v_sub_f32 v58, v56, v58
    s_waitcnt lgkmcnt(5)
    v_mfma_f32_32x32x16_bf16 v[128:143], v[116:119], v[224:227], v[128:143]
    ds_read_b128 v[28:31], v4 offset:45056
    v_cvt_pk_bf16_f32 v58, v58, v58
    v_and_b32 v57, 0xffff, v57
    v_mfma_f32_32x32x16_bf16 v[144:159], v[120:123], v[224:227], v[144:159]
    ds_read_b128 v[32:35], v4 offset:46080
    v_lshl_or_b32 v108, v58, 16, v57
    v_mov_b32 v109, v57
    v_mfma_f32_32x32x16_bf16 v[160:175], v[124:127], v[224:227], v[160:175]
    ds_read_b128 v[36:39], v51 offset:47104
    v_mov_b32 v110, 0
    v_mov_b32 v111, 0
    v_mfma_f32_32x32x16_bf16 v[176:191], v[116:119], v[228:231], v[176:191]
    ds_read_b128 v[40:43], v51 offset:48128
    v_cmp_gt_u32 vcc, 32, v0
    v_sub_f32 v56, 0, v53
    v_mfma_f32_32x32x16_bf16 v[192:207], v[120:123], v[228:231], v[192:207]
    ds_read_b128 v[44:47], v51 offset:49152
    v_cndmask_b32 v56, v56, v55, vcc
    v_cvt_pk_bf16_f32 v57, v56, v56
    v_mfma_f32_32x32x16_bf16 v[208:223], v[124:127], v[228:231], v[208:223]
    v_lshlrev_b32 v58, 16, v57
    v_sub_f32 v58, v56, v58
    s_waitcnt lgkmcnt(5)
    v_mfma_f32_32x32x16_bf16 v[128:143], v[16:19], v[8:11], v[128:143]
    ds_read_b128 v[224:227], v4 offset:49152
    v_cvt_pk_bf16_f32 v58, v58, v58
    v_and_b32 v57, 0xffff, v57
    v_mfma_f32_32x32x16_bf16 v[144:159], v[20:23], v[8:11], v[144:159]
    ds_read_b128 v[228:231], v4 offset:50176
    v_lshl_or_b32 v112, v58, 16, v57
    v_mov_b32 v113, v57
    v_mfma_f32_32x32x16_bf16 v[160:175], v[24:27], v[8:11], v[160:175]
    ds_read_b128 v[116:119], v51 offset:53248
    v_mov_b32 v114, 0
    v_mov_b32 v115, 0
    v_mfma_f32_32x32x16_bf16 v[176:191], v[16:19], v[12:15], v[176:191]
    ds_read_b128 v[120:123], v51 offset:54272
    v_cvt_pk_bf16_f32 v96, v92, v92
    v_lshlrev_b32 v58, 16, v96
    v_mfma_f32_32x32x16_bf16 v[192:207], v[20:23], v[12:15], v[192:207]
    ds_read_b128 v[124:127], v51 offset:55296
    v_sub_f32 v58, v92, v58
    v_cvt_pk_bf16_f32 v58, v58, v58
    v_mfma_f32_32x32x16_bf16 v[208:223], v[24:27], v[12:15], v[208:223]
    v_and_b32 v97, 0xffff, v58
    v_mov_b32 v98, 0
    s_waitcnt lgkmcnt(5)
    v_mfma_f32_32x32x16_bf16 v[128:143], v[36:39], v[28:31], v[128:143]
    ds_read_b128 v[8:11], v4 offset:53248
    v_mov_b32 v99, 0
    v_cvt_pk_bf16_f32 v100, v93, v93
    v_mfma_f32_32x32x16_bf16 v[144:159], v[40:43], v[28:31], v[144:159]
    ds_read_b128 v[12:15], v4 offset:54272
    v_lshlrev_b32 v58, 16, v100
    v_sub_f32 v58, v93, v58
    v_mfma_f32_32x32x16_bf16 v[160:175], v[44:47], v[28:31], v[160:175]
    ds_read_b128 v[16:19], v51 offset:59392
    v_cvt_pk_bf16_f32 v58, v58, v58
    v_and_b32 v101, 0xffff, v58
    v_mfma_f32_32x32x16_bf16 v[176:191], v[36:39], v[32:35], v[176:191]
    ds_read_b128 v[20:23], v51 offset:60416
    v_mov_b32 v102, 0
    v_mov_b32 v103, 0
    v_mfma_f32_32x32x16_bf16 v[192:207], v[40:43], v[32:35], v[192:207]
    ds_read_b128 v[24:27], v51 offset:61440
    v_cvt_pk_bf16_f32 v104, v94, v94
    v_lshlrev_b32 v58, 16, v104
    v_mfma_f32_32x32x16_bf16 v[208:223], v[44:47], v[32:35], v[208:223]
    v_sub_f32 v58, v94, v58
    v_cvt_pk_bf16_f32 v58, v58, v58
    s_waitcnt lgkmcnt(5)
    v_mfma_f32_32x32x16_bf16 v[128:143], v[116:119], v[224:227], v[128:143]
    s_barrier
    ds_read_b128 v[28:31], v3 offset:0
    v_and_b32 v105, 0xffff, v58
    v_mov_b32 v106, 0
    v_mfma_f32_32x32x16_bf16 v[144:159], v[120:123], v[224:227], v[144:159]
    ds_read_b128 v[32:35], v3 offset:1024
    v_mov_b32 v107, 0
    v_mfma_f32_32x32x16_bf16 v[160:175], v[124:127], v[224:227], v[160:175]
    ds_read_b128 v[36:39], v5 offset:0
    v_mfma_f32_32x32x16_bf16 v[176:191], v[116:119], v[228:231], v[176:191]
    ds_read_b128 v[40:43], v5 offset:1024
    v_mfma_f32_32x32x16_bf16 v[192:207], v[120:123], v[228:231], v[192:207]
    ds_read_b128 v[44:47], v5 offset:2048
    v_mfma_f32_32x32x16_bf16 v[208:223], v[124:127], v[228:231], v[208:223]
    s_waitcnt lgkmcnt(5)
    v_mfma_f32_32x32x16_bf16 v[128:143], v[16:19], v[8:11], v[128:143]
    ds_read_b128 v[224:227], v3 offset:4096
    v_mfma_f32_32x32x16_bf16 v[144:159], v[20:23], v[8:11], v[144:159]
    ds_read_b128 v[228:231], v3 offset:5120
    v_mfma_f32_32x32x16_bf16 v[160:175], v[24:27], v[8:11], v[160:175]
    ds_read_b128 v[116:119], v5 offset:6144
    v_mfma_f32_32x32x16_bf16 v[176:191], v[16:19], v[12:15], v[176:191]
    ds_read_b128 v[120:123], v5 offset:7168
    v_mfma_f32_32x32x16_bf16 v[192:207], v[20:23], v[12:15], v[192:207]
    ds_read_b128 v[124:127], v5 offset:8192
    v_mfma_f32_32x32x16_bf16 v[208:223], v[24:27], v[12:15], v[208:223]
    s_waitcnt lgkmcnt(5)
    v_mfma_f32_32x32x16_bf16 v[128:143], v[36:39], v[28:31], v[128:143]
    ds_read_b128 v[8:11], v3 offset:8192
    v_mfma_f32_32x32x16_bf16 v[144:159], v[40:43], v[28:31], v[144:159]
    ds_read_b128 v[12:15], v3 offset:9216
    v_mfma_f32_32x32x16_bf16 v[160:175], v[44:47], v[28:31], v[160:175]
    ds_read_b128 v[16:19], v5 offset:12288
    v_mfma_f32_32x32x16_bf16 v[176:191], v[36:39], v[32:35], v[176:191]
    ds_read_b128 v[20:23], v5 offset:13312
    v_mfma_f32_32x32x16_bf16 v[192:207], v[40:43], v[32:35], v[192:207]
    ds_read_b128 v[24:27], v5 offset:14336
    v_mfma_f32_32x32x16_bf16 v[208:223], v[44:47], v[32:35], v[208:223]
    s_waitcnt lgkmcnt(5)
    v_mfma_f32_32x32x16_bf16 v[128:143], v[116:119], v[224:227], v[128:143]
    ds_read_b128 v[28:31], v3 offset:12288
    v_mfma_f32_32x32x16_bf16 v[144:159], v[120:123], v[224:227], v[144:159]
    ds_read_b128 v[32:35], v3 offset:13312
    v_mfma_f32_32x32x16_bf16 v[160:175], v[124:127], v[224:227], v[160:175]
    ds_read_b128 v[36:39], v5 offset:18432
    v_mfma_f32_32x32x16_bf16 v[176:191], v[116:119], v[228:231], v[176:191]
    ds_read_b128 v[40:43], v5 offset:19456
    v_mfma_f32_32x32x16_bf16 v[192:207], v[120:123], v[228:231], v[192:207]
    ds_read_b128 v[44:47], v5 offset:20480
    v_mfma_f32_32x32x16_bf16 v[208:223], v[124:127], v[228:231], v[208:223]
    s_waitcnt lgkmcnt(5)
    v_mfma_f32_32x32x16_bf16 v[128:143], v[16:19], v[8:11], v[128:143]
    s_barrier
    ds_read_b128 v[224:227], v3 offset:40960
    v_mfma_f32_32x32x16_bf16 v[144:159], v[20:23], v[8:11], v[144:159]
    ds_read_b128 v[228:231], v3 offset:41984
    v_mfma_f32_32x32x16_bf16 v[160:175], v[24:27], v[8:11], v[160:175]
    ds_read_b128 v[116:119], v5 offset:40960
    v_mfma_f32_32x32x16_bf16 v[176:191], v[16:19], v[12:15], v[176:191]
    ds_read_b128 v[120:123], v5 offset:41984
    v_mfma_f32_32x32x16_bf16 v[192:207], v[20:23], v[12:15], v[192:207]
    ds_read_b128 v[124:127], v5 offset:43008
    v_mfma_f32_32x32x16_bf16 v[208:223], v[24:27], v[12:15], v[208:223]
    s_waitcnt lgkmcnt(5)
    v_mfma_f32_32x32x16_bf16 v[128:143], v[36:39], v[28:31], v[128:143]
    ds_read_b128 v[8:11], v3 offset:45056
    v_mfma_f32_32x32x16_bf16 v[144:159], v[40:43], v[28:31], v[144:159]
    ds_read_b128 v[12:15], v3 offset:46080
    v_mfma_f32_32x32x16_bf16 v[160:175], v[44:47], v[28:31], v[160:175]
    ds_read_b128 v[16:19], v5 offset:47104
    v_mfma_f32_32x32x16_bf16 v[176:191], v[36:39], v[32:35], v[176:191]
    ds_read_b128 v[20:23], v5 offset:48128
    v_mfma_f32_32x32x16_bf16 v[192:207], v[40:43], v[32:35], v[192:207]
    ds_read_b128 v[24:27], v5 offset:49152
    v_mfma_f32_32x32x16_bf16 v[208:223], v[44:47], v[32:35], v[208:223]
    s_waitcnt lgkmcnt(5)
    v_mfma_f32_32x32x16_bf16 v[128:143], v[116:119], v[224:227], v[128:143]
    ds_read_b128 v[28:31], v3 offset:49152
    v_mfma_f32_32x32x16_bf16 v[144:159], v[120:123], v[224:227], v[144:159]
    ds_read_b128 v[32:35], v3 offset:50176
    v_mfma_f32_32x32x16_bf16 v[160:175], v[124:127], v[224:227], v[160:175]
    ds_read_b128 v[36:39], v5 offset:53248
    v_mfma_f32_32x32x16_bf16 v[176:191], v[116:119], v[228:231], v[176:191]
    ds_read_b128 v[40:43], v5 offset:54272
    v_mfma_f32_32x32x16_bf16 v[192:207], v[120:123], v[228:231], v[192:207]
    ds_read_b128 v[44:47], v5 offset:55296
    v_mfma_f32_32x32x16_bf16 v[208:223], v[124:127], v[228:231], v[208:223]
    s_waitcnt lgkmcnt(5)
    v_mfma_f32_32x32x16_bf16 v[128:143], v[16:19], v[8:11], v[128:143]
    ds_read_b128 v[224:227], v3 offset:53248
    v_mfma_f32_32x32x16_bf16 v[144:159], v[20:23], v[8:11], v[144:159]
    ds_read_b128 v[228:231], v3 offset:54272
    v_mfma_f32_32x32x16_bf16 v[160:175], v[24:27], v[8:11], v[160:175]
    ds_read_b128 v[116:119], v5 offset:59392
    v_mfma_f32_32x32x16_bf16 v[176:191], v[16:19], v[12:15], v[176:191]
    ds_read_b128 v[120:123], v5 offset:60416
    v_mfma_f32_32x32x16_bf16 v[192:207], v[20:23], v[12:15], v[192:207]
    ds_read_b128 v[124:127], v5 offset:61440
    v_mfma_f32_32x32x16_bf16 v[208:223], v[24:27], v[12:15], v[208:223]
    s_waitcnt lgkmcnt(5)
    v_mfma_f32_32x32x16_bf16 v[128:143], v[36:39], v[28:31], v[128:143]
    s_barrier
    ds_read_b128 v[8:11], v4 offset:0
    v_mfma_f32_32x32x16_bf16 v[144:159], v[40:43], v[28:31], v[144:159]
    ds_read_b128 v[12:15], v4 offset:1024
    v_mfma_f32_32x32x16_bf16 v[160:175], v[44:47], v[28:31], v[160:175]
    ds_read_b128 v[16:19], v51 offset:0
    v_mfma_f32_32x32x16_bf16 v[176:191], v[36:39], v[32:35], v[176:191]
    ds_read_b128 v[20:23], v51 offset:1024
    v_mfma_f32_32x32x16_bf16 v[192:207], v[40:43], v[32:35], v[192:207]
    ds_read_b128 v[24:27], v51 offset:2048
    v_mfma_f32_32x32x16_bf16 v[208:223], v[44:47], v[32:35], v[208:223]
    s_waitcnt lgkmcnt(5)
    v_mfma_f32_32x32x16_bf16 v[128:143], v[116:119], v[224:227], v[128:143]
    ds_read_b128 v[28:31], v4 offset:4096
    v_mfma_f32_32x32x16_bf16 v[144:159], v[120:123], v[224:227], v[144:159]
    ds_read_b128 v[32:35], v4 offset:5120
    v_mfma_f32_32x32x16_bf16 v[160:175], v[124:127], v[224:227], v[160:175]
    ds_read_b128 v[36:39], v51 offset:6144
    v_mfma_f32_32x32x16_bf16 v[176:191], v[116:119], v[228:231], v[176:191]
    ds_read_b128 v[40:43], v51 offset:7168
    v_mfma_f32_32x32x16_bf16 v[192:207], v[120:123], v[228:231], v[192:207]
    ds_read_b128 v[44:47], v51 offset:8192
    v_mfma_f32_32x32x16_bf16 v[208:223], v[124:127], v[228:231], v[208:223]
    s_waitcnt lgkmcnt(5)
    v_mfma_f32_32x32x16_bf16 v[128:143], v[16:19], v[8:11], v[128:143]
    ds_read_b128 v[224:227], v4 offset:8192
    v_mfma_f32_32x32x16_bf16 v[144:159], v[20:23], v[8:11], v[144:159]
    ds_read_b128 v[228:231], v4 offset:9216
    v_mfma_f32_32x32x16_bf16 v[160:175], v[24:27], v[8:11], v[160:175]
    ds_read_b128 v[116:119], v51 offset:12288
    v_mfma_f32_32x32x16_bf16 v[176:191], v[16:19], v[12:15], v[176:191]
    ds_read_b128 v[120:123], v51 offset:13312
    v_mfma_f32_32x32x16_bf16 v[192:207], v[20:23], v[12:15], v[192:207]
    ds_read_b128 v[124:127], v51 offset:14336
    v_mfma_f32_32x32x16_bf16 v[208:223], v[24:27], v[12:15], v[208:223]
    s_waitcnt lgkmcnt(5)
    v_mfma_f32_32x32x16_bf16 v[128:143], v[36:39], v[28:31], v[128:143]
    ds_read_b128 v[8:11], v4 offset:12288
    v_mfma_f32_32x32x16_bf16 v[144:159], v[40:43], v[28:31], v[144:159]
    ds_read_b128 v[12:15], v4 offset:13312
    v_mfma_f32_32x32x16_bf16 v[160:175], v[44:47], v[28:31], v[160:175]
    ds_read_b128 v[16:19], v51 offset:18432
    v_mfma_f32_32x32x16_bf16 v[176:191], v[36:39], v[32:35], v[176:191]
    ds_read_b128 v[20:23], v51 offset:19456
    v_mfma_f32_32x32x16_bf16 v[192:207], v[40:43], v[32:35], v[192:207]
    ds_read_b128 v[24:27], v51 offset:20480
    v_mfma_f32_32x32x16_bf16 v[208:223], v[44:47], v[32:35], v[208:223]
    s_waitcnt lgkmcnt(5)
    v_mfma_f32_32x32x16_bf16 v[128:143], v[116:119], v[224:227], v[128:143]
    s_barrier
    ds_read_b128 v[28:31], v4 offset:40960
    v_mfma_f32_32x32x16_bf16 v[144:159], v[120:123], v[224:227], v[144:159]
    ds_read_b128 v[32:35], v4 offset:41984
    v_mfma_f32_32x32x16_bf16 v[160:175], v[124:127], v[224:227], v[160:175]
    ds_read_b128 v[36:39], v51 offset:40960
    v_mfma_f32_32x32x16_bf16 v[176:191], v[116:119], v[228:231], v[176:191]
    ds_read_b128 v[40:43], v51 offset:41984
    v_mfma_f32_32x32x16_bf16 v[192:207], v[120:123], v[228:231], v[192:207]
    ds_read_b128 v[44:47], v51 offset:43008
    v_mfma_f32_32x32x16_bf16 v[208:223], v[124:127], v[228:231], v[208:223]
    s_waitcnt lgkmcnt(5)
    v_mfma_f32_32x32x16_bf16 v[128:143], v[16:19], v[8:11], v[128:143]
    ds_read_b128 v[224:227], v4 offset:45056
    v_mfma_f32_32x32x16_bf16 v[144:159], v[20:23], v[8:11], v[144:159]
    ds_read_b128 v[228:231], v4 offset:46080
    v_mfma_f32_32x32x16_bf16 v[160:175], v[24:27], v[8:11], v[160:175]
    ds_read_b128 v[116:119], v51 offset:47104
    v_mfma_f32_32x32x16_bf16 v[176:191], v[16:19], v[12:15], v[176:191]
    ds_read_b128 v[120:123], v51 offset:48128
    v_mfma_f32_32x32x16_bf16 v[192:207], v[20:23], v[12:15], v[192:207]
    ds_read_b128 v[124:127], v51 offset:49152
    v_mfma_f32_32x32x16_bf16 v[208:223], v[24:27], v[12:15], v[208:223]
    s_waitcnt lgkmcnt(5)
    v_mfma_f32_32x32x16_bf16 v[128:143], v[36:39], v[28:31], v[128:143]
    ds_read_b128 v[8:11], v4 offset:49152
    v_mfma_f32_32x32x16_bf16 v[144:159], v[40:43], v[28:31], v[144:159]
    ds_read_b128 v[12:15], v4 offset:50176
    v_mfma_f32_32x32x16_bf16 v[160:175], v[44:47], v[28:31], v[160:175]
    ds_read_b128 v[16:19], v51 offset:53248
    v_mfma_f32_32x32x16_bf16 v[176:191], v[36:39], v[32:35], v[176:191]
    ds_read_b128 v[20:23], v51 offset:54272
    v_mfma_f32_32x32x16_bf16 v[192:207], v[40:43], v[32:35], v[192:207]
    ds_read_b128 v[24:27], v51 offset:55296
    v_mfma_f32_32x32x16_bf16 v[208:223], v[44:47], v[32:35], v[208:223]
    s_waitcnt lgkmcnt(5)
    v_mfma_f32_32x32x16_bf16 v[128:143], v[116:119], v[224:227], v[128:143]
    ds_read_b128 v[28:31], v4 offset:53248
    v_mfma_f32_32x32x16_bf16 v[144:159], v[120:123], v[224:227], v[144:159]
    ds_read_b128 v[32:35], v4 offset:54272
    v_mfma_f32_32x32x16_bf16 v[160:175], v[124:127], v[224:227], v[160:175]
    ds_read_b128 v[36:39], v51 offset:59392
    v_mfma_f32_32x32x16_bf16 v[176:191], v[116:119], v[228:231], v[176:191]
    ds_read_b128 v[40:43], v51 offset:60416
    v_mfma_f32_32x32x16_bf16 v[192:207], v[120:123], v[228:231], v[192:207]
    ds_read_b128 v[44:47], v51 offset:61440
    v_mfma_f32_32x32x16_bf16 v[208:223], v[124:127], v[228:231], v[208:223]
    s_waitcnt lgkmcnt(5)
    v_mfma_f32_32x32x16_bf16 v[128:143], v[16:19], v[8:11], v[128:143]
    s_barrier
    ds_read_b128 v[224:227], v3 offset:0
    v_mfma_f32_32x32x16_bf16 v[144:159], v[20:23], v[8:11], v[144:159]
    ds_read_b128 v[228:231], v3 offset:1024
    v_mfma_f32_32x32x16_bf16 v[160:175], v[24:27], v[8:11], v[160:175]
    ds_read_b128 v[116:119], v5 offset:0
    v_mfma_f32_32x32x16_bf16 v[176:191], v[16:19], v[12:15], v[176:191]
    ds_read_b128 v[120:123], v5 offset:1024
    v_mfma_f32_32x32x16_bf16 v[192:207], v[20:23], v[12:15], v[192:207]
    ds_read_b128 v[124:127], v5 offset:2048
    v_mfma_f32_32x32x16_bf16 v[208:223], v[24:27], v[12:15], v[208:223]
    s_waitcnt lgkmcnt(5)
    v_mfma_f32_32x32x16_bf16 v[128:143], v[36:39], v[28:31], v[128:143]
    ds_read_b128 v[8:11], v3 offset:4096
    v_mfma_f32_32x32x16_bf16 v[144:159], v[40:43], v[28:31], v[144:159]
    ds_read_b128 v[12:15], v3 offset:5120
    v_mfma_f32_32x32x16_bf16 v[160:175], v[44:47], v[28:31], v[160:175]
    ds_read_b128 v[16:19], v5 offset:6144
    v_mfma_f32_32x32x16_bf16 v[176:191], v[36:39], v[32:35], v[176:191]
    ds_read_b128 v[20:23], v5 offset:7168
    v_mfma_f32_32x32x16_bf16 v[192:207], v[40:43], v[32:35], v[192:207]
    ds_read_b128 v[24:27], v5 offset:8192
    v_mfma_f32_32x32x16_bf16 v[208:223], v[44:47], v[32:35], v[208:223]
    v_mfma_f32_32x32x16_bf16 v[128:143], v[96:99], v[108:111], v[128:143]
    v_mfma_f32_32x32x16_bf16 v[144:159], v[100:103], v[108:111], v[144:159]
    v_mfma_f32_32x32x16_bf16 v[160:175], v[104:107], v[108:111], v[160:175]
    v_mfma_f32_32x32x16_bf16 v[176:191], v[96:99], v[112:115], v[176:191]
    v_mfma_f32_32x32x16_bf16 v[192:207], v[100:103], v[112:115], v[192:207]
    v_mfma_f32_32x32x16_bf16 v[208:223], v[104:107], v[112:115], v[208:223]
    s_waitcnt lgkmcnt(5)
    v_mfma_f32_32x32x16_bf16 v[128:143], v[116:119], v[224:227], v[128:143]
    ds_read_b128 v[28:31], v3 offset:8192
    v_mfma_f32_32x32x16_bf16 v[144:159], v[120:123], v[224:227], v[144:159]
    ds_read_b128 v[32:35], v3 offset:9216
    v_mfma_f32_32x32x16_bf16 v[160:175], v[124:127], v[224:227], v[160:175]
    ds_read_b128 v[36:39], v5 offset:12288
    v_mfma_f32_32x32x16_bf16 v[176:191], v[116:119], v[228:231], v[176:191]
    ds_read_b128 v[40:43], v5 offset:13312
    v_mfma_f32_32x32x16_bf16 v[192:207], v[120:123], v[228:231], v[192:207]
    ds_read_b128 v[44:47], v5 offset:14336
    v_mfma_f32_32x32x16_bf16 v[208:223], v[124:127], v[228:231], v[208:223]
    s_waitcnt lgkmcnt(5)
    v_mfma_f32_32x32x16_bf16 v[128:143], v[16:19], v[8:11], v[128:143]
    ds_read_b128 v[224:227], v3 offset:12288
    v_mfma_f32_32x32x16_bf16 v[144:159], v[20:23], v[8:11], v[144:159]
    ds_read_b128 v[228:231], v3 offset:13312
    v_mfma_f32_32x32x16_bf16 v[160:175], v[24:27], v[8:11], v[160:175]
    ds_read_b128 v[116:119], v5 offset:18432
    v_mfma_f32_32x32x16_bf16 v[176:191], v[16:19], v[12:15], v[176:191]
    ds_read_b128 v[120:123], v5 offset:19456
    v_mfma_f32_32x32x16_bf16 v[192:207], v[20:23], v[12:15], v[192:207]
    ds_read_b128 v[124:127], v5 offset:20480
    v_mfma_f32_32x32x16_bf16 v[208:223], v[24:27], v[12:15], v[208:223]
    s_waitcnt lgkmcnt(5)
    v_mfma_f32_32x32x16_bf16 v[128:143], v[36:39], v[28:31], v[128:143]
    s_barrier
    ds_read_b128 v[8:11], v3 offset:40960
    v_mfma_f32_32x32x16_bf16 v[144:159], v[40:43], v[28:31], v[144:159]
    ds_read_b128 v[12:15], v3 offset:41984
    v_mfma_f32_32x32x16_bf16 v[160:175], v[44:47], v[28:31], v[160:175]
    ds_read_b128 v[16:19], v5 offset:40960
    v_mfma_f32_32x32x16_bf16 v[176:191], v[36:39], v[32:35], v[176:191]
    ds_read_b128 v[20:23], v5 offset:41984
    v_mfma_f32_32x32x16_bf16 v[192:207], v[40:43], v[32:35], v[192:207]
    ds_read_b128 v[24:27], v5 offset:43008
    v_mfma_f32_32x32x16_bf16 v[208:223], v[44:47], v[32:35], v[208:223]
    s_waitcnt lgkmcnt(5)
    v_mfma_f32_32x32x16_bf16 v[128:143], v[116:119], v[224:227], v[128:143]
    ds_read_b128 v[28:31], v3 offset:45056
    v_mfma_f32_32x32x16_bf16 v[144:159], v[120:123], v[224:227], v[144:159]
    ds_read_b128 v[32:35], v3 offset:46080
    v_mfma_f32_32x32x16_bf16 v[160:175], v[124:127], v[224:227], v[160:175]
    ds_read_b128 v[36:39], v5 offset:47104
    v_mfma_f32_32x32x16_bf16 v[176:191], v[116:119], v[228:231], v[176:191]
    ds_read_b128 v[40:43], v5 offset:48128
    v_mfma_f32_32x32x16_bf16 v[192:207], v[120:123], v[228:231], v[192:207]
    ds_read_b128 v[44:47], v5 offset:49152
    v_mfma_f32_32x32x16_bf16 v[208:223], v[124:127], v[228:231], v[208:223]
    s_waitcnt lgkmcnt(5)
    v_mfma_f32_32x32x16_bf16 v[128:143], v[16:19], v[8:11], v[128:143]
    ds_read_b128 v[224:227], v3 offset:49152
    v_mfma_f32_32x32x16_bf16 v[144:159], v[20:23], v[8:11], v[144:159]
    ds_read_b128 v[228:231], v3 offset:50176
    v_mfma_f32_32x32x16_bf16 v[160:175], v[24:27], v[8:11], v[160:175]
    ds_read_b128 v[116:119], v5 offset:53248
    v_mfma_f32_32x32x16_bf16 v[176:191], v[16:19], v[12:15], v[176:191]
    ds_read_b128 v[120:123], v5 offset:54272
    v_mfma_f32_32x32x16_bf16 v[192:207], v[20:23], v[12:15], v[192:207]
    ds_read_b128 v[124:127], v5 offset:55296
    v_mfma_f32_32x32x16_bf16 v[208:223], v[24:27], v[12:15], v[208:223]
    s_waitcnt lgkmcnt(5)
    v_mfma_f32_32x32x16_bf16 v[128:143], v[36:39], v[28:31], v[128:143]
    ds_read_b128 v[8:11], v3 offset:53248
    v_mfma_f32_32x32x16_bf16 v[144:159], v[40:43], v[28:31], v[144:159]
    ds_read_b128 v[12:15], v3 offset:54272
    v_mfma_f32_32x32x16_bf16 v[160:175], v[44:47], v[28:31], v[160:175]
    ds_read_b128 v[16:19], v5 offset:59392
    v_mfma_f32_32x32x16_bf16 v[176:191], v[36:39], v[32:35], v[176:191]
    ds_read_b128 v[20:23], v5 offset:60416
    v_mfma_f32_32x32x16_bf16 v[192:207], v[40:43], v[32:35], v[192:207]
    ds_read_b128 v[24:27], v5 offset:61440
    v_mfma_f32_32x32x16_bf16 v[208:223], v[44:47], v[32:35], v[208:223]
    s_waitcnt lgkmcnt(5)
    v_mfma_f32_32x32x16_bf16 v[128:143], v[116:119], v[224:227], v[128:143]
    v_mfma_f32_32x32x16_bf16 v[144:159], v[120:123], v[224:227], v[144:159]
    v_mfma_f32_32x32x16_bf16 v[160:175], v[124:127], v[224:227], v[160:175]
    v_mfma_f32_32x32x16_bf16 v[176:191], v[116:119], v[228:231], v[176:191]
    v_mfma_f32_32x32x16_bf16 v[192:207], v[120:123], v[228:231], v[192:207]
    v_mfma_f32_32x32x16_bf16 v[208:223], v[124:127], v[228:231], v[208:223]
    s_waitcnt lgkmcnt(0)
    v_mfma_f32_32x32x16_bf16 v[128:143], v[16:19], v[8:11], v[128:143]
    v_mfma_f32_32x32x16_bf16 v[144:159], v[20:23], v[8:11], v[144:159]
    v_mfma_f32_32x32x16_bf16 v[160:175], v[24:27], v[8:11], v[160:175]
    v_mfma_f32_32x32x16_bf16 v[176:191], v[16:19], v[12:15], v[176:191]
    v_mfma_f32_32x32x16_bf16 v[192:207], v[20:23], v[12:15], v[192:207]
    v_mfma_f32_32x32x16_bf16 v[208:223], v[24:27], v[12:15], v[208:223]
    s_barrier
    s_mov_b32 s36, 0xc0135761
    s_mov_b32 s37, 0xbdd2d3e8
    v_mov_b32 v24, s37
    v_mov_b32 v25, s37
    v_mov_b32 v26, s36
    v_mov_b32 v27, s36
    v_mov_b32 v28, 1.0
    v_mov_b32 v29, 1.0
    v_lshrrev_b32 v9, 6, v48
    s_mov_b32 s35, 196608
    v_mul_lo_u32 v9, v9, s35
    s_mul_i32 s38, s21, 12
    s_mul_i32 s39, s31, 6
    s_add_u32 s40, s38, s39
    v_add_u32 v10, 0, v48
    v_bfe_u32 v11, v10, 4, 2
    v_lshl_add_u32 v12, v11, 10, v9
    v_and_b32 v11, 15, v10
    v_lshl_add_u32 v12, v11, 4, v12
    v_pk_mul_f32 v[128:129], v[128:129], v[88:89] op_sel_hi:[1,0]
    v_pk_mul_f32 v[130:131], v[130:131], v[88:89] op_sel_hi:[1,0]
    v_pk_mul_f32 v[132:133], v[132:133], v[88:89] op_sel_hi:[1,0]
    v_pk_mul_f32 v[134:135], v[134:135], v[88:89] op_sel_hi:[1,0]
    v_pk_mul_f32 v[136:137], v[136:137], v[88:89] op_sel_hi:[1,0]
    v_pk_mul_f32 v[138:139], v[138:139], v[88:89] op_sel_hi:[1,0]
    v_pk_mul_f32 v[140:141], v[140:141], v[88:89] op_sel_hi:[1,0]
    v_pk_mul_f32 v[142:143], v[142:143], v[88:89] op_sel_hi:[1,0]
    v_pk_mul_f32 v[20:21], v[128:129], v[128:129]
    v_pk_mul_f32 v[22:23], v[130:131], v[130:131]
    v_pk_fma_f32 v[20:21], v[20:21], v[24:25], v[26:27]
    v_pk_fma_f32 v[22:23], v[22:23], v[24:25], v[26:27]
    v_pk_mul_f32 v[20:21], v[20:21], v[128:129]
    v_pk_mul_f32 v[22:23], v[22:23], v[130:131]
    v_exp_f32 v20, v20
    v_exp_f32 v21, v21
    v_exp_f32 v22, v22
    v_exp_f32 v23, v23
    v_pk_mul_f32 v[136:137], v[136:137], v[128:129]
    v_pk_mul_f32 v[138:139], v[138:139], v[130:131]
    v_pk_add_f32 v[20:21], v[20:21], v[28:29]
    v_pk_add_f32 v[22:23], v[22:23], v[28:29]
    v_rcp_f32 v20, v20
    v_rcp_f32 v21, v21
    v_rcp_f32 v22, v22
    v_rcp_f32 v23, v23
    s_nop 0
    v_pk_mul_f32 v[128:129], v[136:137], v[20:21]
    v_pk_mul_f32 v[130:131], v[138:139], v[22:23]
    v_pk_mul_f32 v[20:21], v[132:133], v[132:133]
    v_pk_mul_f32 v[22:23], v[134:135], v[134:135]
    v_pk_fma_f32 v[20:21], v[20:21], v[24:25], v[26:27]
    v_pk_fma_f32 v[22:23], v[22:23], v[24:25], v[26:27]
    v_pk_mul_f32 v[20:21], v[20:21], v[132:133]
    v_pk_mul_f32 v[22:23], v[22:23], v[134:135]
    v_exp_f32 v20, v20
    v_exp_f32 v21, v21
    v_exp_f32 v22, v22
    v_exp_f32 v23, v23
    v_pk_mul_f32 v[140:141], v[140:141], v[132:133]
    v_pk_mul_f32 v[142:143], v[142:143], v[134:135]
    v_pk_add_f32 v[20:21], v[20:21], v[28:29]
    v_pk_add_f32 v[22:23], v[22:23], v[28:29]
    v_rcp_f32 v20, v20
    v_rcp_f32 v21, v21
    v_rcp_f32 v22, v22
    v_rcp_f32 v23, v23
    s_nop 0
    v_pk_mul_f32 v[132:133], v[140:141], v[20:21]
    v_pk_mul_f32 v[134:135], v[142:143], v[22:23]
    v_cvt_pk_bf16_f32 v128, v128, v129
    v_cvt_pk_bf16_f32 v129, v130, v131
    v_cvt_pk_bf16_f32 v130, v132, v133
    v_cvt_pk_bf16_f32 v131, v134, v135
    v_add_u32 v16, 0, v7
    v_add_u32 v16, s40, v16
    v_and_b32 v17, 3, v16
    v_lshl_add_u32 v18, v17, 8, v12
    v_lshrrev_b32 v17, 2, v16
    v_lshl_add_u32 v18, v17, 12, v18
    v_permlane32_swap_b32 v128, v130
    v_permlane32_swap_b32 v129, v131
    s_mov_b32 s38, 25427968
    buffer_store_dwordx4 v[128:131], v18, s[12:15], s38 offen sc1
    v_pk_mul_f32 v[144:145], v[144:145], v[88:89] op_sel_hi:[1,0]
    v_pk_mul_f32 v[146:147], v[146:147], v[88:89] op_sel_hi:[1,0]
    v_pk_mul_f32 v[148:149], v[148:149], v[88:89] op_sel_hi:[1,0]
    v_pk_mul_f32 v[150:151], v[150:151], v[88:89] op_sel_hi:[1,0]
    v_pk_mul_f32 v[152:153], v[152:153], v[88:89] op_sel_hi:[1,0]
    v_pk_mul_f32 v[154:155], v[154:155], v[88:89] op_sel_hi:[1,0]
    v_pk_mul_f32 v[156:157], v[156:157], v[88:89] op_sel_hi:[1,0]
    v_pk_mul_f32 v[158:159], v[158:159], v[88:89] op_sel_hi:[1,0]
    v_pk_mul_f32 v[20:21], v[144:145], v[144:145]
    v_pk_mul_f32 v[22:23], v[146:147], v[146:147]
    v_pk_fma_f32 v[20:21], v[20:21], v[24:25], v[26:27]
    v_pk_fma_f32 v[22:23], v[22:23], v[24:25], v[26:27]
    v_pk_mul_f32 v[20:21], v[20:21], v[144:145]
    v_pk_mul_f32 v[22:23], v[22:23], v[146:147]
    v_exp_f32 v20, v20
    v_exp_f32 v21, v21
    v_exp_f32 v22, v22
    v_exp_f32 v23, v23
    v_pk_mul_f32 v[152:153], v[152:153], v[144:145]
    v_pk_mul_f32 v[154:155], v[154:155], v[146:147]
    v_pk_add_f32 v[20:21], v[20:21], v[28:29]
    v_pk_add_f32 v[22:23], v[22:23], v[28:29]
    v_rcp_f32 v20, v20
    v_rcp_f32 v21, v21
    v_rcp_f32 v22, v22
    v_rcp_f32 v23, v23
    s_nop 0
    v_pk_mul_f32 v[144:145], v[152:153], v[20:21]
    v_pk_mul_f32 v[146:147], v[154:155], v[22:23]
    v_pk_mul_f32 v[20:21], v[148:149], v[148:149]
    v_pk_mul_f32 v[22:23], v[150:151], v[150:151]
    v_pk_fma_f32 v[20:21], v[20:21], v[24:25], v[26:27]
    v_pk_fma_f32 v[22:23], v[22:23], v[24:25], v[26:27]
    v_pk_mul_f32 v[20:21], v[20:21], v[148:149]
    v_pk_mul_f32 v[22:23], v[22:23], v[150:151]
    v_exp_f32 v20, v20
    v_exp_f32 v21, v21
    v_exp_f32 v22, v22
    v_exp_f32 v23, v23
    v_pk_mul_f32 v[156:157], v[156:157], v[148:149]
    v_pk_mul_f32 v[158:159], v[158:159], v[150:151]
    v_pk_add_f32 v[20:21], v[20:21], v[28:29]
    v_pk_add_f32 v[22:23], v[22:23], v[28:29]
    v_rcp_f32 v20, v20
    v_rcp_f32 v21, v21
    v_rcp_f32 v22, v22
    v_rcp_f32 v23, v23
    s_nop 0
    v_pk_mul_f32 v[148:149], v[156:157], v[20:21]
    v_pk_mul_f32 v[150:151], v[158:159], v[22:23]
    v_cvt_pk_bf16_f32 v144, v144, v145
    v_cvt_pk_bf16_f32 v145, v146, v147
    v_cvt_pk_bf16_f32 v146, v148, v149
    v_cvt_pk_bf16_f32 v147, v150, v151
    v_add_u32 v16, 2, v7
    v_add_u32 v16, s40, v16
    v_and_b32 v17, 3, v16
    v_lshl_add_u32 v18, v17, 8, v12
    v_lshrrev_b32 v17, 2, v16
    v_lshl_add_u32 v18, v17, 12, v18
    v_permlane32_swap_b32 v144, v146
    v_permlane32_swap_b32 v145, v147
    s_mov_b32 s38, 25427968
    buffer_store_dwordx4 v[144:147], v18, s[12:15], s38 offen sc1
    v_pk_mul_f32 v[160:161], v[160:161], v[88:89] op_sel_hi:[1,0]
    v_pk_mul_f32 v[162:163], v[162:163], v[88:89] op_sel_hi:[1,0]
    v_pk_mul_f32 v[164:165], v[164:165], v[88:89] op_sel_hi:[1,0]
    v_pk_mul_f32 v[166:167], v[166:167], v[88:89] op_sel_hi:[1,0]
    v_pk_mul_f32 v[168:169], v[168:169], v[88:89] op_sel_hi:[1,0]
    v_pk_mul_f32 v[170:171], v[170:171], v[88:89] op_sel_hi:[1,0]
    v_pk_mul_f32 v[172:173], v[172:173], v[88:89] op_sel_hi:[1,0]
    v_pk_mul_f32 v[174:175], v[174:175], v[88:89] op_sel_hi:[1,0]
    v_pk_mul_f32 v[20:21], v[160:161], v[160:161]
    v_pk_mul_f32 v[22:23], v[162:163], v[162:163]
    v_pk_fma_f32 v[20:21], v[20:21], v[24:25], v[26:27]
    v_pk_fma_f32 v[22:23], v[22:23], v[24:25], v[26:27]
    v_pk_mul_f32 v[20:21], v[20:21], v[160:161]
    v_pk_mul_f32 v[22:23], v[22:23], v[162:163]
    v_exp_f32 v20, v20
    v_exp_f32 v21, v21
    v_exp_f32 v22, v22
    v_exp_f32 v23, v23
    v_pk_mul_f32 v[168:169], v[168:169], v[160:161]
    v_pk_mul_f32 v[170:171], v[170:171], v[162:163]
    v_pk_add_f32 v[20:21], v[20:21], v[28:29]
    v_pk_add_f32 v[22:23], v[22:23], v[28:29]
    v_rcp_f32 v20, v20
    v_rcp_f32 v21, v21
    v_rcp_f32 v22, v22
    v_rcp_f32 v23, v23
    s_nop 0
    v_pk_mul_f32 v[160:161], v[168:169], v[20:21]
    v_pk_mul_f32 v[162:163], v[170:171], v[22:23]
    v_pk_mul_f32 v[20:21], v[164:165], v[164:165]
    v_pk_mul_f32 v[22:23], v[166:167], v[166:167]
    v_pk_fma_f32 v[20:21], v[20:21], v[24:25], v[26:27]
    v_pk_fma_f32 v[22:23], v[22:23], v[24:25], v[26:27]
    v_pk_mul_f32 v[20:21], v[20:21], v[164:165]
    v_pk_mul_f32 v[22:23], v[22:23], v[166:167]
    v_exp_f32 v20, v20
    v_exp_f32 v21, v21
    v_exp_f32 v22, v22
    v_exp_f32 v23, v23
    v_pk_mul_f32 v[172:173], v[172:173], v[164:165]
    v_pk_mul_f32 v[174:175], v[174:175], v[166:167]
    v_pk_add_f32 v[20:21], v[20:21], v[28:29]
    v_pk_add_f32 v[22:23], v[22:23], v[28:29]
    v_rcp_f32 v20, v20
    v_rcp_f32 v21, v21
    v_rcp_f32 v22, v22
    v_rcp_f32 v23, v23
    s_nop 0
    v_pk_mul_f32 v[164:165], v[172:173], v[20:21]
    v_pk_mul_f32 v[166:167], v[174:175], v[22:23]
    v_cvt_pk_bf16_f32 v160, v160, v161
    v_cvt_pk_bf16_f32 v161, v162, v163
    v_cvt_pk_bf16_f32 v162, v164, v165
    v_cvt_pk_bf16_f32 v163, v166, v167
    v_add_u32 v16, 4, v7
    v_add_u32 v16, s40, v16
    v_and_b32 v17, 3, v16
    v_lshl_add_u32 v18, v17, 8, v12
    v_lshrrev_b32 v17, 2, v16
    v_lshl_add_u32 v18, v17, 12, v18
    v_permlane32_swap_b32 v160, v162
    v_permlane32_swap_b32 v161, v163
    s_mov_b32 s38, 25427968
    buffer_store_dwordx4 v[160:163], v18, s[12:15], s38 offen sc1
    v_add_u32 v10, 32, v48
    v_bfe_u32 v11, v10, 4, 2
    v_lshl_add_u32 v12, v11, 10, v9
    v_and_b32 v11, 15, v10
    v_lshl_add_u32 v12, v11, 4, v12
    v_pk_mul_f32 v[176:177], v[176:177], v[88:89] op_sel:[0,1] op_sel_hi:[1,1]
    v_pk_mul_f32 v[178:179], v[178:179], v[88:89] op_sel:[0,1] op_sel_hi:[1,1]
    v_pk_mul_f32 v[180:181], v[180:181], v[88:89] op_sel:[0,1] op_sel_hi:[1,1]
    v_pk_mul_f32 v[182:183], v[182:183], v[88:89] op_sel:[0,1] op_sel_hi:[1,1]
    v_pk_mul_f32 v[184:185], v[184:185], v[88:89] op_sel:[0,1] op_sel_hi:[1,1]
    v_pk_mul_f32 v[186:187], v[186:187], v[88:89] op_sel:[0,1] op_sel_hi:[1,1]
    v_pk_mul_f32 v[188:189], v[188:189], v[88:89] op_sel:[0,1] op_sel_hi:[1,1]
    v_pk_mul_f32 v[190:191], v[190:191], v[88:89] op_sel:[0,1] op_sel_hi:[1,1]
    v_pk_mul_f32 v[20:21], v[176:177], v[176:177]
    v_pk_mul_f32 v[22:23], v[178:179], v[178:179]
    v_pk_fma_f32 v[20:21], v[20:21], v[24:25], v[26:27]
    v_pk_fma_f32 v[22:23], v[22:23], v[24:25], v[26:27]
    v_pk_mul_f32 v[20:21], v[20:21], v[176:177]
    v_pk_mul_f32 v[22:23], v[22:23], v[178:179]
    v_exp_f32 v20, v20
    v_exp_f32 v21, v21
    v_exp_f32 v22, v22
    v_exp_f32 v23, v23
    v_pk_mul_f32 v[184:185], v[184:185], v[176:177]
    v_pk_mul_f32 v[186:187], v[186:187], v[178:179]
    v_pk_add_f32 v[20:21], v[20:21], v[28:29]
    v_pk_add_f32 v[22:23], v[22:23], v[28:29]
    v_rcp_f32 v20, v20
    v_rcp_f32 v21, v21
    v_rcp_f32 v22, v22
    v_rcp_f32 v23, v23
    s_nop 0
    v_pk_mul_f32 v[176:177], v[184:185], v[20:21]
    v_pk_mul_f32 v[178:179], v[186:187], v[22:23]
    v_pk_mul_f32 v[20:21], v[180:181], v[180:181]
    v_pk_mul_f32 v[22:23], v[182:183], v[182:183]
    v_pk_fma_f32 v[20:21], v[20:21], v[24:25], v[26:27]
    v_pk_fma_f32 v[22:23], v[22:23], v[24:25], v[26:27]
    v_pk_mul_f32 v[20:21], v[20:21], v[180:181]
    v_pk_mul_f32 v[22:23], v[22:23], v[182:183]
    v_exp_f32 v20, v20
    v_exp_f32 v21, v21
    v_exp_f32 v22, v22
    v_exp_f32 v23, v23
    v_pk_mul_f32 v[188:189], v[188:189], v[180:181]
    v_pk_mul_f32 v[190:191], v[190:191], v[182:183]
    v_pk_add_f32 v[20:21], v[20:21], v[28:29]
    v_pk_add_f32 v[22:23], v[22:23], v[28:29]
    v_rcp_f32 v20, v20
    v_rcp_f32 v21, v21
    v_rcp_f32 v22, v22
    v_rcp_f32 v23, v23
    s_nop 0
    v_pk_mul_f32 v[180:181], v[188:189], v[20:21]
    v_pk_mul_f32 v[182:183], v[190:191], v[22:23]
    v_cvt_pk_bf16_f32 v176, v176, v177
    v_cvt_pk_bf16_f32 v177, v178, v179
    v_cvt_pk_bf16_f32 v178, v180, v181
    v_cvt_pk_bf16_f32 v179, v182, v183
    v_add_u32 v16, 0, v7
    v_add_u32 v16, s40, v16
    v_and_b32 v17, 3, v16
    v_lshl_add_u32 v18, v17, 8, v12
    v_lshrrev_b32 v17, 2, v16
    v_lshl_add_u32 v18, v17, 12, v18
    v_permlane32_swap_b32 v176, v178
    v_permlane32_swap_b32 v177, v179
    s_mov_b32 s38, 25427968
    buffer_store_dwordx4 v[176:179], v18, s[12:15], s38 offen sc1
    v_pk_mul_f32 v[192:193], v[192:193], v[88:89] op_sel:[0,1] op_sel_hi:[1,1]
    v_pk_mul_f32 v[194:195], v[194:195], v[88:89] op_sel:[0,1] op_sel_hi:[1,1]
    v_pk_mul_f32 v[196:197], v[196:197], v[88:89] op_sel:[0,1] op_sel_hi:[1,1]
    v_pk_mul_f32 v[198:199], v[198:199], v[88:89] op_sel:[0,1] op_sel_hi:[1,1]
    v_pk_mul_f32 v[200:201], v[200:201], v[88:89] op_sel:[0,1] op_sel_hi:[1,1]
    v_pk_mul_f32 v[202:203], v[202:203], v[88:89] op_sel:[0,1] op_sel_hi:[1,1]
    v_pk_mul_f32 v[204:205], v[204:205], v[88:89] op_sel:[0,1] op_sel_hi:[1,1]
    v_pk_mul_f32 v[206:207], v[206:207], v[88:89] op_sel:[0,1] op_sel_hi:[1,1]
    v_pk_mul_f32 v[20:21], v[192:193], v[192:193]
    v_pk_mul_f32 v[22:23], v[194:195], v[194:195]
    v_pk_fma_f32 v[20:21], v[20:21], v[24:25], v[26:27]
    v_pk_fma_f32 v[22:23], v[22:23], v[24:25], v[26:27]
    v_pk_mul_f32 v[20:21], v[20:21], v[192:193]
    v_pk_mul_f32 v[22:23], v[22:23], v[194:195]
    v_exp_f32 v20, v20
    v_exp_f32 v21, v21
    v_exp_f32 v22, v22
    v_exp_f32 v23, v23
    v_pk_mul_f32 v[200:201], v[200:201], v[192:193]
    v_pk_mul_f32 v[202:203], v[202:203], v[194:195]
    v_pk_add_f32 v[20:21], v[20:21], v[28:29]
    v_pk_add_f32 v[22:23], v[22:23], v[28:29]
    v_rcp_f32 v20, v20
    v_rcp_f32 v21, v21
    v_rcp_f32 v22, v22
    v_rcp_f32 v23, v23
    s_nop 0
    v_pk_mul_f32 v[192:193], v[200:201], v[20:21]
    v_pk_mul_f32 v[194:195], v[202:203], v[22:23]
    v_pk_mul_f32 v[20:21], v[196:197], v[196:197]
    v_pk_mul_f32 v[22:23], v[198:199], v[198:199]
    v_pk_fma_f32 v[20:21], v[20:21], v[24:25], v[26:27]
    v_pk_fma_f32 v[22:23], v[22:23], v[24:25], v[26:27]
    v_pk_mul_f32 v[20:21], v[20:21], v[196:197]
    v_pk_mul_f32 v[22:23], v[22:23], v[198:199]
    v_exp_f32 v20, v20
    v_exp_f32 v21, v21
    v_exp_f32 v22, v22
    v_exp_f32 v23, v23
    v_pk_mul_f32 v[204:205], v[204:205], v[196:197]
    v_pk_mul_f32 v[206:207], v[206:207], v[198:199]
    v_pk_add_f32 v[20:21], v[20:21], v[28:29]
    v_pk_add_f32 v[22:23], v[22:23], v[28:29]
    v_rcp_f32 v20, v20
    v_rcp_f32 v21, v21
    v_rcp_f32 v22, v22
    v_rcp_f32 v23, v23
    s_nop 0
    v_pk_mul_f32 v[196:197], v[204:205], v[20:21]
    v_pk_mul_f32 v[198:199], v[206:207], v[22:23]
    v_cvt_pk_bf16_f32 v192, v192, v193
    v_cvt_pk_bf16_f32 v193, v194, v195
    v_cvt_pk_bf16_f32 v194, v196, v197
    v_cvt_pk_bf16_f32 v195, v198, v199
    v_add_u32 v16, 2, v7
    v_add_u32 v16, s40, v16
    v_and_b32 v17, 3, v16
    v_lshl_add_u32 v18, v17, 8, v12
    v_lshrrev_b32 v17, 2, v16
    v_lshl_add_u32 v18, v17, 12, v18
    v_permlane32_swap_b32 v192, v194
    v_permlane32_swap_b32 v193, v195
    s_mov_b32 s38, 25427968
    buffer_store_dwordx4 v[192:195], v18, s[12:15], s38 offen sc1
    v_pk_mul_f32 v[208:209], v[208:209], v[88:89] op_sel:[0,1] op_sel_hi:[1,1]
    v_pk_mul_f32 v[210:211], v[210:211], v[88:89] op_sel:[0,1] op_sel_hi:[1,1]
    v_pk_mul_f32 v[212:213], v[212:213], v[88:89] op_sel:[0,1] op_sel_hi:[1,1]
    v_pk_mul_f32 v[214:215], v[214:215], v[88:89] op_sel:[0,1] op_sel_hi:[1,1]
    v_pk_mul_f32 v[216:217], v[216:217], v[88:89] op_sel:[0,1] op_sel_hi:[1,1]
    v_pk_mul_f32 v[218:219], v[218:219], v[88:89] op_sel:[0,1] op_sel_hi:[1,1]
    v_pk_mul_f32 v[220:221], v[220:221], v[88:89] op_sel:[0,1] op_sel_hi:[1,1]
    v_pk_mul_f32 v[222:223], v[222:223], v[88:89] op_sel:[0,1] op_sel_hi:[1,1]
    v_pk_mul_f32 v[20:21], v[208:209], v[208:209]
    v_pk_mul_f32 v[22:23], v[210:211], v[210:211]
    v_pk_fma_f32 v[20:21], v[20:21], v[24:25], v[26:27]
    v_pk_fma_f32 v[22:23], v[22:23], v[24:25], v[26:27]
    v_pk_mul_f32 v[20:21], v[20:21], v[208:209]
    v_pk_mul_f32 v[22:23], v[22:23], v[210:211]
    v_exp_f32 v20, v20
    v_exp_f32 v21, v21
    v_exp_f32 v22, v22
    v_exp_f32 v23, v23
    v_pk_mul_f32 v[216:217], v[216:217], v[208:209]
    v_pk_mul_f32 v[218:219], v[218:219], v[210:211]
    v_pk_add_f32 v[20:21], v[20:21], v[28:29]
    v_pk_add_f32 v[22:23], v[22:23], v[28:29]
    v_rcp_f32 v20, v20
    v_rcp_f32 v21, v21
    v_rcp_f32 v22, v22
    v_rcp_f32 v23, v23
    s_nop 0
    v_pk_mul_f32 v[208:209], v[216:217], v[20:21]
    v_pk_mul_f32 v[210:211], v[218:219], v[22:23]
    v_pk_mul_f32 v[20:21], v[212:213], v[212:213]
    v_pk_mul_f32 v[22:23], v[214:215], v[214:215]
    v_pk_fma_f32 v[20:21], v[20:21], v[24:25], v[26:27]
    v_pk_fma_f32 v[22:23], v[22:23], v[24:25], v[26:27]
    v_pk_mul_f32 v[20:21], v[20:21], v[212:213]
    v_pk_mul_f32 v[22:23], v[22:23], v[214:215]
    v_exp_f32 v20, v20
    v_exp_f32 v21, v21
    v_exp_f32 v22, v22
    v_exp_f32 v23, v23
    v_pk_mul_f32 v[220:221], v[220:221], v[212:213]
    v_pk_mul_f32 v[222:223], v[222:223], v[214:215]
    v_pk_add_f32 v[20:21], v[20:21], v[28:29]
    v_pk_add_f32 v[22:23], v[22:23], v[28:29]
    v_rcp_f32 v20, v20
    v_rcp_f32 v21, v21
    v_rcp_f32 v22, v22
    v_rcp_f32 v23, v23
    s_nop 0
    v_pk_mul_f32 v[212:213], v[220:221], v[20:21]
    v_pk_mul_f32 v[214:215], v[222:223], v[22:23]
    v_cvt_pk_bf16_f32 v208, v208, v209
    v_cvt_pk_bf16_f32 v209, v210, v211
    v_cvt_pk_bf16_f32 v210, v212, v213
    v_cvt_pk_bf16_f32 v211, v214, v215
    v_add_u32 v16, 4, v7
    v_add_u32 v16, s40, v16
    v_and_b32 v17, 3, v16
    v_lshl_add_u32 v18, v17, 8, v12
    v_lshrrev_b32 v17, 2, v16
    v_lshl_add_u32 v18, v17, 12, v18
    v_permlane32_swap_b32 v208, v210
    v_permlane32_swap_b32 v209, v211
    s_mov_b32 s38, 25427968
    buffer_store_dwordx4 v[208:211], v18, s[12:15], s38 offen sc1
    s_branch L_p5_end
L_p5_prod:
    v_lshlrev_b32 v2, 4, v0
    s_cmp_ge_u32 s4, 6
    s_cbranch_scc1 L_p5_w
    s_cmp_eq_u32 s4, 5
    s_cbranch_scc1 L_p5_idle
    s_mul_i32 s32, s20, 163840
    s_add_u32 s32, s32, 22650880
    s_and_b32 s38, s2, 7
    s_lshl_b32 s38, s38, 1
    s_lshr_b32 s39, s2, 7
    s_add_u32 s38, s38, s39
    s_lshr_b32 s39, s2, 3
    s_mul_i32 s38, s38, 64
    s_add_u32 s38, s38, 2232
    s_and_b32 s3, s39, 3
    s_lshl_b32 s3, s3, 4
    s_add_u32 s38, s38, s3
    s_mov_b32 s39, s39
    v_mov_b32 v250, 159748
    s_mov_b32 s3, 0
L_dr_5:
    ds_read_b32 v252, v250
    s_waitcnt lgkmcnt(0)
    v_readfirstlane_b32 s47, v252
    s_nop 0
    s_cmp_ge_u32 s47, 4
    s_cbranch_scc1 L_drd_5
    s_add_u32 s3, s3, 1
    s_cmp_lt_u32 s3, 0x400000
    s_cbranch_scc1 L_dr_5
L_drd_5:
    s_lshl_b32 s3, s38, 7
    s_add_u32 s3, s3, 31719424
    v_lshlrev_b32 v250, 7, v0
    v_add_u32 v250, s3, v250
    v_mov_b32 v251, 1
    s_mov_b32 exec_lo, 65535
    s_mov_b32 exec_hi, 0
    global_atomic_add v250, v251, s[6:7] sc1
    s_mov_b64 exec, -1
    s_mul_i32 s38, s20, 64
    s_add_u32 s38, s38, 2232
    s_and_b32 s47, s2, 15
    s_add_u32 s3, s38, 0
    s_add_u32 s3, s3, s47
    v_mov_b32 v250, s3
    v_mov_b32 v251, 4
    s_add_u32 s3, s38, 16
    s_add_u32 s3, s3, s47
    v_writelane_b32 v250, s3, 1
    s_add_u32 s3, s38, 32
    s_add_u32 s3, s3, s47
    v_writelane_b32 v250, s3, 2
    s_add_u32 s3, s38, 48
    s_add_u32 s3, s3, s47
    v_writelane_b32 v250, s3, 3
    v_lshlrev_b32 v250, 7, v250
    v_add_u32 v250, 31719424, v250
    s_mov_b32 s3, 0
L_poll_p5:
    global_load_dword v252, v250, s[6:7] sc1
    s_waitcnt vmcnt(0)
    v_cmp_ge_u32 vcc, v252, v251
    s_nop 0
    s_cmp_eq_u64 vcc, -1
    s_cbranch_scc1 L_polled_p5
    s_add_u32 s3, s3, 1
    s_cmp_lt_u32 s3, 0x200000
    s_cbranch_scc1 L_poll_p5
L_polled_p5:
    s_mov_b32 m0, 0
    s_add_u32 s38, s32, 0
    buffer_load_dwordx4 v2, s[12:15], s38 offen offset:0 lds
    buffer_load_dwordx4 v2, s[12:15], s38 offen offset:1024 lds
    buffer_load_dwordx4 v2, s[12:15], s38 offen offset:2048 lds
    buffer_load_dwordx4 v2, s[12:15], s38 offen offset:3072 lds
    s_add_u32 m0, m0, 4096
    s_add_u32 s38, s38, 4096
    buffer_load_dwordx4 v2, s[12:15], s38 offen offset:0 lds
    buffer_load_dwordx4 v2, s[12:15], s38 offen offset:1024 lds
    buffer_load_dwordx4 v2, s[12:15], s38 offen offset:2048 lds
    buffer_load_dwordx4 v2, s[12:15], s38 offen offset:3072 lds
    s_add_u32 m0, m0, 4096
    s_add_u32 s38, s38, 4096
    buffer_load_dwordx4 v2, s[12:15], s38 offen offset:0 lds
    buffer_load_dwordx4 v2, s[12:15], s38 offen offset:1024 lds
    buffer_load_dwordx4 v2, s[12:15], s38 offen offset:2048 lds
    buffer_load_dwordx4 v2, s[12:15], s38 offen offset:3072 lds
    s_add_u32 m0, m0, 4096
    s_add_u32 s38, s38, 4096
    buffer_load_dwordx4 v2, s[12:15], s38 offen offset:0 lds
    buffer_load_dwordx4 v2, s[12:15], s38 offen offset:1024 lds
    buffer_load_dwordx4 v2, s[12:15], s38 offen offset:2048 lds
    buffer_load_dwordx4 v2, s[12:15], s38 offen offset:3072 lds
    s_lshl_b32 s38, s20, 10
    s_add_u32 s38, s38, 25272320
    s_mov_b32 m0, 139264
    s_nop 0
    buffer_load_dwordx4 v2, s[12:15], s38 offen lds
    s_add_u32 m0, m0, 1024
    s_add_u32 s38, s38, 16384
    buffer_load_dwordx4 v2, s[12:15], s38 offen lds
    s_add_u32 m0, m0, 1024
    s_add_u32 s38, s38, 16384
    buffer_load_dwordx4 v2, s[12:15], s38 offen lds
    s_add_u32 m0, m0, 1024
    s_add_u32 s38, s38, 16384
    buffer_load_dwordx4 v2, s[12:15], s38 offen lds
    s_add_u32 m0, m0, 1024
    s_add_u32 s38, s38, 16384
    buffer_load_dwordx4 v2, s[12:15], s38 offen lds
    s_add_u32 m0, m0, 1024
    s_add_u32 s38, s38, 16384
    buffer_load_dwordx4 v2, s[12:15], s38 offen lds
    s_add_u32 m0, m0, 1024
    s_add_u32 s38, s38, 16384
    buffer_load_dwordx4 v2, s[12:15], s38 offen lds
    s_add_u32 m0, m0, 1024
    s_add_u32 s38, s38, 16384
    buffer_load_dwordx4 v2, s[12:15], s38 offen lds
    s_mov_b32 m0, 40960
    s_add_u32 s38, s32, 16384
    buffer_load_dwordx4 v2, s[12:15], s38 offen offset:0 lds
    buffer_load_dwordx4 v2, s[12:15], s38 offen offset:1024 lds
    buffer_load_dwordx4 v2, s[12:15], s38 offen offset:2048 lds
    buffer_load_dwordx4 v2, s[12:15], s38 offen offset:3072 lds
    s_add_u32 m0, m0, 4096
    s_add_u32 s38, s38, 4096
    buffer_load_dwordx4 v2, s[12:15], s38 offen offset:0 lds
    buffer_load_dwordx4 v2, s[12:15], s38 offen offset:1024 lds
    buffer_load_dwordx4 v2, s[12:15], s38 offen offset:2048 lds
    buffer_load_dwordx4 v2, s[12:15], s38 offen offset:3072 lds
    s_add_u32 m0, m0, 4096
    s_add_u32 s38, s38, 4096
    buffer_load_dwordx4 v2, s[12:15], s38 offen offset:0 lds
    buffer_load_dwordx4 v2, s[12:15], s38 offen offset:1024 lds
    buffer_load_dwordx4 v2, s[12:15], s38 offen offset:2048 lds
    buffer_load_dwordx4 v2, s[12:15], s38 offen offset:3072 lds
    s_add_u32 m0, m0, 4096
    s_add_u32 s38, s38, 4096
    buffer_load_dwordx4 v2, s[12:15], s38 offen offset:0 lds
    buffer_load_dwordx4 v2, s[12:15], s38 offen offset:1024 lds
    buffer_load_dwordx4 v2, s[12:15], s38 offen offset:2048 lds
    buffer_load_dwordx4 v2, s[12:15], s38 offen offset:3072 lds
    s_waitcnt vmcnt(24)
    s_barrier
    s_mov_b32 m0, 81920
    s_add_u32 s38, s32, 32768
    buffer_load_dwordx4 v2, s[12:15], s38 offen offset:0 lds
    buffer_load_dwordx4 v2, s[12:15], s38 offen offset:1024 lds
    buffer_load_dwordx4 v2, s[12:15], s38 offen offset:2048 lds
    buffer_load_dwordx4 v2, s[12:15], s38 offen offset:3072 lds
    s_add_u32 m0, m0, 4096
    s_add_u32 s38, s38, 4096
    buffer_load_dwordx4 v2, s[12:15], s38 offen offset:0 lds
    buffer_load_dwordx4 v2, s[12:15], s38 offen offset:1024 lds
    buffer_load_dwordx4 v2, s[12:15], s38 offen offset:2048 lds
    buffer_load_dwordx4 v2, s[12:15], s38 offen offset:3072 lds
    s_add_u32 m0, m0, 4096
    s_add_u32 s38, s38, 4096
    buffer_load_dwordx4 v2, s[12:15], s38 offen offset:0 lds
    buffer_load_dwordx4 v2, s[12:15], s38 offen offset:1024 lds
    buffer_load_dwordx4 v2, s[12:15], s38 offen offset:2048 lds
    buffer_load_dwordx4 v2, s[12:15], s38 offen offset:3072 lds
    s_add_u32 m0, m0, 4096
    s_add_u32 s38, s38, 4096
    buffer_load_dwordx4 v2, s[12:15], s38 offen offset:0 lds
    buffer_load_dwordx4 v2, s[12:15], s38 offen offset:1024 lds
    buffer_load_dwordx4 v2, s[12:15], s38 offen offset:2048 lds
    buffer_load_dwordx4 v2, s[12:15], s38 offen offset:3072 lds
    s_waitcnt vmcnt(16)
    s_barrier
    s_mov_b32 m0, 122880
    s_add_u32 s38, s32, 49152
    buffer_load_dwordx4 v2, s[12:15], s38 offen offset:0 lds
    buffer_load_dwordx4 v2, s[12:15], s38 offen offset:1024 lds
    buffer_load_dwordx4 v2, s[12:15], s38 offen offset:2048 lds
    buffer_load_dwordx4 v2, s[12:15], s38 offen offset:3072 lds
    s_add_u32 m0, m0, 4096
    s_add_u32 s38, s38, 4096
    buffer_load_dwordx4 v2, s[12:15], s38 offen offset:0 lds
    buffer_load_dwordx4 v2, s[12:15], s38 offen offset:1024 lds
    buffer_load_dwordx4 v2, s[12:15], s38 offen offset:2048 lds
    buffer_load_dwordx4 v2, s[12:15], s38 offen offset:3072 lds
    s_add_u32 m0, m0, 4096
    s_add_u32 s38, s38, 4096
    buffer_load_dwordx4 v2, s[12:15], s38 offen offset:0 lds
    buffer_load_dwordx4 v2, s[12:15], s38 offen offset:1024 lds
    buffer_load_dwordx4 v2, s[12:15], s38 offen offset:2048 lds
    buffer_load_dwordx4 v2, s[12:15], s38 offen offset:3072 lds
    s_add_u32 m0, m0, 4096
    s_add_u32 s38, s38, 4096
    buffer_load_dwordx4 v2, s[12:15], s38 offen offset:0 lds
    buffer_load_dwordx4 v2, s[12:15], s38 offen offset:1024 lds
    buffer_load_dwordx4 v2, s[12:15], s38 offen offset:2048 lds
    buffer_load_dwordx4 v2, s[12:15], s38 offen offset:3072 lds
    s_waitcnt vmcnt(16)
    s_barrier
    s_mov_b32 m0, 0
    s_add_u32 s38, s32, 65536
    buffer_load_dwordx4 v2, s[12:15], s38 offen offset:0 lds
    buffer_load_dwordx4 v2, s[12:15], s38 offen offset:1024 lds
    buffer_load_dwordx4 v2, s[12:15], s38 offen offset:2048 lds
    buffer_load_dwordx4 v2, s[12:15], s38 offen offset:3072 lds
    s_add_u32 m0, m0, 4096
    s_add_u32 s38, s38, 4096
    buffer_load_dwordx4 v2, s[12:15], s38 offen offset:0 lds
    buffer_load_dwordx4 v2, s[12:15], s38 offen offset:1024 lds
    buffer_load_dwordx4 v2, s[12:15], s38 offen offset:2048 lds
    buffer_load_dwordx4 v2, s[12:15], s38 offen offset:3072 lds
    s_add_u32 m0, m0, 4096
    s_add_u32 s38, s38, 4096
    buffer_load_dwordx4 v2, s[12:15], s38 offen offset:0 lds
    buffer_load_dwordx4 v2, s[12:15], s38 offen offset:1024 lds
    buffer_load_dwordx4 v2, s[12:15], s38 offen offset:2048 lds
    buffer_load_dwordx4 v2, s[12:15], s38 offen offset:3072 lds
    s_add_u32 m0, m0, 4096
    s_add_u32 s38, s38, 4096
    buffer_load_dwordx4 v2, s[12:15], s38 offen offset:0 lds
    buffer_load_dwordx4 v2, s[12:15], s38 offen offset:1024 lds
    buffer_load_dwordx4 v2, s[12:15], s38 offen offset:2048 lds
    buffer_load_dwordx4 v2, s[12:15], s38 offen offset:3072 lds
    s_waitcnt vmcnt(16)
    s_barrier
    s_mov_b32 m0, 40960
    s_add_u32 s38, s32, 81920
    buffer_load_dwordx4 v2, s[12:15], s38 offen offset:0 lds
    buffer_load_dwordx4 v2, s[12:15], s38 offen offset:1024 lds
    buffer_load_dwordx4 v2, s[12:15], s38 offen offset:2048 lds
    buffer_load_dwordx4 v2, s[12:15], s38 offen offset:3072 lds
    s_add_u32 m0, m0, 4096
    s_add_u32 s38, s38, 4096
    buffer_load_dwordx4 v2, s[12:15], s38 offen offset:0 lds
    buffer_load_dwordx4 v2, s[12:15], s38 offen offset:1024 lds
    buffer_load_dwordx4 v2, s[12:15], s38 offen offset:2048 lds
    buffer_load_dwordx4 v2, s[12:15], s38 offen offset:3072 lds
    s_add_u32 m0, m0, 4096
    s_add_u32 s38, s38, 4096
    buffer_load_dwordx4 v2, s[12:15], s38 offen offset:0 lds
    buffer_load_dwordx4 v2, s[12:15], s38 offen offset:1024 lds
    buffer_load_dwordx4 v2, s[12:15], s38 offen offset:2048 lds
    buffer_load_dwordx4 v2, s[12:15], s38 offen offset:3072 lds
    s_add_u32 m0, m0, 4096
    s_add_u32 s38, s38, 4096
    buffer_load_dwordx4 v2, s[12:15], s38 offen offset:0 lds
    buffer_load_dwordx4 v2, s[12:15], s38 offen offset:1024 lds
    buffer_load_dwordx4 v2, s[12:15], s38 offen offset:2048 lds
    buffer_load_dwordx4 v2, s[12:15], s38 offen offset:3072 lds
    s_waitcnt vmcnt(16)
    s_barrier
    s_mov_b32 m0, 81920
    s_add_u32 s38, s32, 98304
    buffer_load_dwordx4 v2, s[12:15], s38 offen offset:0 lds
    buffer_load_dwordx4 v2, s[12:15], s38 offen offset:1024 lds
    buffer_load_dwordx4 v2, s[12:15], s38 offen offset:2048 lds
    buffer_load_dwordx4 v2, s[12:15], s38 offen offset:3072 lds
    s_add_u32 m0, m0, 4096
    s_add_u32 s38, s38, 4096
    buffer_load_dwordx4 v2, s[12:15], s38 offen offset:0 lds
    buffer_load_dwordx4 v2, s[12:15], s38 offen offset:1024 lds
    buffer_load_dwordx4 v2, s[12:15], s38 offen offset:2048 lds
    buffer_load_dwordx4 v2, s[12:15], s38 offen offset:3072 lds
    s_add_u32 m0, m0, 4096
    s_add_u32 s38, s38, 4096
    buffer_load_dwordx4 v2, s[12:15], s38 offen offset:0 lds
    buffer_load_dwordx4 v2, s[12:15], s38 offen offset:1024 lds
    buffer_load_dwordx4 v2, s[12:15], s38 offen offset:2048 lds
    buffer_load_dwordx4 v2, s[12:15], s38 offen offset:3072 lds
    s_add_u32 m0, m0, 4096
    s_add_u32 s38, s38, 4096
    buffer_load_dwordx4 v2, s[12:15], s38 offen offset:0 lds
    buffer_load_dwordx4 v2, s[12:15], s38 offen offset:1024 lds
    buffer_load_dwordx4 v2, s[12:15], s38 offen offset:2048 lds
    buffer_load_dwordx4 v2, s[12:15], s38 offen offset:3072 lds
    s_waitcnt vmcnt(16)
    s_barrier
    s_mov_b32 m0, 122880
    s_add_u32 s38, s32, 114688
    buffer_load_dwordx4 v2, s[12:15], s38 offen offset:0 lds
    buffer_load_dwordx4 v2, s[12:15], s38 offen offset:1024 lds
    buffer_load_dwordx4 v2, s[12:15], s38 offen offset:2048 lds
    buffer_load_dwordx4 v2, s[12:15], s38 offen offset:3072 lds
    s_add_u32 m0, m0, 4096
    s_add_u32 s38, s38, 4096
    buffer_load_dwordx4 v2, s[12:15], s38 offen offset:0 lds
    buffer_load_dwordx4 v2, s[12:15], s38 offen offset:1024 lds
    buffer_load_dwordx4 v2, s[12:15], s38 offen offset:2048 lds
    buffer_load_dwordx4 v2, s[12:15], s38 offen offset:3072 lds
    s_add_u32 m0, m0, 4096
    s_add_u32 s38, s38, 4096
    buffer_load_dwordx4 v2, s[12:15], s38 offen offset:0 lds
    buffer_load_dwordx4 v2, s[12:15], s38 offen offset:1024 lds
    buffer_load_dwordx4 v2, s[12:15], s38 offen offset:2048 lds
    buffer_load_dwordx4 v2, s[12:15], s38 offen offset:3072 lds
    s_add_u32 m0, m0, 4096
    s_add_u32 s38, s38, 4096
    buffer_load_dwordx4 v2, s[12:15], s38 offen offset:0 lds
    buffer_load_dwordx4 v2, s[12:15], s38 offen offset:1024 lds
    buffer_load_dwordx4 v2, s[12:15], s38 offen offset:2048 lds
    buffer_load_dwordx4 v2, s[12:15], s38 offen offset:3072 lds
    s_waitcnt vmcnt(16)
    s_barrier
    s_mov_b32 m0, 0
    s_add_u32 s38, s32, 131072
    buffer_load_dwordx4 v2, s[12:15], s38 offen offset:0 lds
    buffer_load_dwordx4 v2, s[12:15], s38 offen offset:1024 lds
    buffer_load_dwordx4 v2, s[12:15], s38 offen offset:2048 lds
    buffer_load_dwordx4 v2, s[12:15], s38 offen offset:3072 lds
    s_add_u32 m0, m0, 4096
    s_add_u32 s38, s38, 4096
    buffer_load_dwordx4 v2, s[12:15], s38 offen offset:0 lds
    buffer_load_dwordx4 v2, s[12:15], s38 offen offset:1024 lds
    buffer_load_dwordx4 v2, s[12:15], s38 offen offset:2048 lds
    buffer_load_dwordx4 v2, s[12:15], s38 offen offset:3072 lds
    s_add_u32 m0, m0, 4096
    s_add_u32 s38, s38, 4096
    buffer_load_dwordx4 v2, s[12:15], s38 offen offset:0 lds
    buffer_load_dwordx4 v2, s[12:15], s38 offen offset:1024 lds
    buffer_load_dwordx4 v2, s[12:15], s38 offen offset:2048 lds
    buffer_load_dwordx4 v2, s[12:15], s38 offen offset:3072 lds
    s_add_u32 m0, m0, 4096
    s_add_u32 s38, s38, 4096
    buffer_load_dwordx4 v2, s[12:15], s38 offen offset:0 lds
    buffer_load_dwordx4 v2, s[12:15], s38 offen offset:1024 lds
    buffer_load_dwordx4 v2, s[12:15], s38 offen offset:2048 lds
    buffer_load_dwordx4 v2, s[12:15], s38 offen offset:3072 lds
    s_waitcnt vmcnt(16)
    s_barrier
    s_mov_b32 m0, 40960
    s_add_u32 s38, s32, 147456
    buffer_load_dwordx4 v2, s[12:15], s38 offen offset:0 lds
    buffer_load_dwordx4 v2, s[12:15], s38 offen offset:1024 lds
    buffer_load_dwordx4 v2, s[12:15], s38 offen offset:2048 lds
    buffer_load_dwordx4 v2, s[12:15], s38 offen offset:3072 lds
    s_add_u32 m0, m0, 4096
    s_add_u32 s38, s38, 4096
    buffer_load_dwordx4 v2, s[12:15], s38 offen offset:0 lds
    buffer_load_dwordx4 v2, s[12:15], s38 offen offset:1024 lds
    buffer_load_dwordx4 v2, s[12:15], s38 offen offset:2048 lds
    buffer_load_dwordx4 v2, s[12:15], s38 offen offset:3072 lds
    s_add_u32 m0, m0, 4096
    s_add_u32 s38, s38, 4096
    buffer_load_dwordx4 v2, s[12:15], s38 offen offset:0 lds
    buffer_load_dwordx4 v2, s[12:15], s38 offen offset:1024 lds
    buffer_load_dwordx4 v2, s[12:15], s38 offen offset:2048 lds
    buffer_load_dwordx4 v2, s[12:15], s38 offen offset:3072 lds
    s_add_u32 m0, m0, 4096
    s_add_u32 s38, s38, 4096
    buffer_load_dwordx4 v2, s[12:15], s38 offen offset:0 lds
    buffer_load_dwordx4 v2, s[12:15], s38 offen offset:1024 lds
    buffer_load_dwordx4 v2, s[12:15], s38 offen offset:2048 lds
    buffer_load_dwordx4 v2, s[12:15], s38 offen offset:3072 lds
    s_waitcnt vmcnt(16)
    s_barrier
    s_waitcnt vmcnt(0)
    s_barrier
    s_barrier
    s_branch L_p5_end
L_p5_idle:
    s_barrier
    s_barrier
    s_barrier
    s_barrier
    s_barrier
    s_barrier
    s_barrier
    s_barrier
    s_barrier
    s_barrier
    v_mov_b32 v250, 147456
    v_mov_b32 v251, 0
    ds_write_b32 v250, v251
    s_waitcnt lgkmcnt(0)
    s_barrier
    s_branch L_p5_end
L_p5_w:
    s_sub_u32 s30, s4, 6
    s_mul_i32 s32, s21, 245760
    s_mul_i32 s33, s30, 12288
    s_add_u32 s32, s32, s33
    s_add_u32 s32, s32, 18718720
    s_add_u32 s33, s33, 16384
    s_waitcnt vmcnt(24)
    s_barrier
    s_waitcnt vmcnt(12)
    s_barrier
    s_waitcnt vmcnt(0)
    s_barrier
    s_add_u32 m0, s33, 122880
    s_add_u32 s38, s32, 73728
    buffer_load_dwordx4 v2, s[12:15], s38 offen offset:0 lds
    buffer_load_dwordx4 v2, s[12:15], s38 offen offset:1024 lds
    buffer_load_dwordx4 v2, s[12:15], s38 offen offset:2048 lds
    buffer_load_dwordx4 v2, s[12:15], s38 offen offset:3072 lds
    s_add_u32 m0, m0, 4096
    s_add_u32 s38, s38, 4096
    buffer_load_dwordx4 v2, s[12:15], s38 offen offset:0 lds
    buffer_load_dwordx4 v2, s[12:15], s38 offen offset:1024 lds
    buffer_load_dwordx4 v2, s[12:15], s38 offen offset:2048 lds
    buffer_load_dwordx4 v2, s[12:15], s38 offen offset:3072 lds
    s_add_u32 m0, m0, 4096
    s_add_u32 s38, s38, 4096
    buffer_load_dwordx4 v2, s[12:15], s38 offen offset:0 lds
    buffer_load_dwordx4 v2, s[12:15], s38 offen offset:1024 lds
    buffer_load_dwordx4 v2, s[12:15], s38 offen offset:2048 lds
    buffer_load_dwordx4 v2, s[12:15], s38 offen offset:3072 lds
    s_add_u32 m0, s33, 0
    s_add_u32 s38, s32, 98304
    buffer_load_dwordx4 v2, s[12:15], s38 offen offset:0 lds
    buffer_load_dwordx4 v2, s[12:15], s38 offen offset:1024 lds
    buffer_load_dwordx4 v2, s[12:15], s38 offen offset:2048 lds
    buffer_load_dwordx4 v2, s[12:15], s38 offen offset:3072 lds
    s_add_u32 m0, m0, 4096
    s_add_u32 s38, s38, 4096
    buffer_load_dwordx4 v2, s[12:15], s38 offen offset:0 lds
    buffer_load_dwordx4 v2, s[12:15], s38 offen offset:1024 lds
    buffer_load_dwordx4 v2, s[12:15], s38 offen offset:2048 lds
    buffer_load_dwordx4 v2, s[12:15], s38 offen offset:3072 lds
    s_add_u32 m0, m0, 4096
    s_add_u32 s38, s38, 4096
    buffer_load_dwordx4 v2, s[12:15], s38 offen offset:0 lds
    buffer_load_dwordx4 v2, s[12:15], s38 offen offset:1024 lds
    buffer_load_dwordx4 v2, s[12:15], s38 offen offset:2048 lds
    buffer_load_dwordx4 v2, s[12:15], s38 offen offset:3072 lds
    s_waitcnt vmcnt(12)
    s_barrier
    s_add_u32 m0, s33, 40960
    s_add_u32 s38, s32, 122880
    buffer_load_dwordx4 v2, s[12:15], s38 offen offset:0 lds
    buffer_load_dwordx4 v2, s[12:15], s38 offen offset:1024 lds
    buffer_load_dwordx4 v2, s[12:15], s38 offen offset:2048 lds
    buffer_load_dwordx4 v2, s[12:15], s38 offen offset:3072 lds
    s_add_u32 m0, m0, 4096
    s_add_u32 s38, s38, 4096
    buffer_load_dwordx4 v2, s[12:15], s38 offen offset:0 lds
    buffer_load_dwordx4 v2, s[12:15], s38 offen offset:1024 lds
    buffer_load_dwordx4 v2, s[12:15], s38 offen offset:2048 lds
    buffer_load_dwordx4 v2, s[12:15], s38 offen offset:3072 lds
    s_add_u32 m0, m0, 4096
    s_add_u32 s38, s38, 4096
    buffer_load_dwordx4 v2, s[12:15], s38 offen offset:0 lds
    buffer_load_dwordx4 v2, s[12:15], s38 offen offset:1024 lds
    buffer_load_dwordx4 v2, s[12:15], s38 offen offset:2048 lds
    buffer_load_dwordx4 v2, s[12:15], s38 offen offset:3072 lds
    s_waitcnt vmcnt(12)
    s_barrier
    s_add_u32 m0, s33, 81920
    s_add_u32 s38, s32, 147456
    buffer_load_dwordx4 v2, s[12:15], s38 offen offset:0 lds
    buffer_load_dwordx4 v2, s[12:15], s38 offen offset:1024 lds
    buffer_load_dwordx4 v2, s[12:15], s38 offen offset:2048 lds
    buffer_load_dwordx4 v2, s[12:15], s38 offen offset:3072 lds
    s_add_u32 m0, m0, 4096
    s_add_u32 s38, s38, 4096
    buffer_load_dwordx4 v2, s[12:15], s38 offen offset:0 lds
    buffer_load_dwordx4 v2, s[12:15], s38 offen offset:1024 lds
    buffer_load_dwordx4 v2, s[12:15], s38 offen offset:2048 lds
    buffer_load_dwordx4 v2, s[12:15], s38 offen offset:3072 lds
    s_add_u32 m0, m0, 4096
    s_add_u32 s38, s38, 4096
    buffer_load_dwordx4 v2, s[12:15], s38 offen offset:0 lds
    buffer_load_dwordx4 v2, s[12:15], s38 offen offset:1024 lds
    buffer_load_dwordx4 v2, s[12:15], s38 offen offset:2048 lds
    buffer_load_dwordx4 v2, s[12:15], s38 offen offset:3072 lds
    s_waitcnt vmcnt(12)
    s_barrier
    s_add_u32 m0, s33, 122880
    s_add_u32 s38, s32, 172032
    buffer_load_dwordx4 v2, s[12:15], s38 offen offset:0 lds
    buffer_load_dwordx4 v2, s[12:15], s38 offen offset:1024 lds
    buffer_load_dwordx4 v2, s[12:15], s38 offen offset:2048 lds
    buffer_load_dwordx4 v2, s[12:15], s38 offen offset:3072 lds
    s_add_u32 m0, m0, 4096
    s_add_u32 s38, s38, 4096
    buffer_load_dwordx4 v2, s[12:15], s38 offen offset:0 lds
    buffer_load_dwordx4 v2, s[12:15], s38 offen offset:1024 lds
    buffer_load_dwordx4 v2, s[12:15], s38 offen offset:2048 lds
    buffer_load_dwordx4 v2, s[12:15], s38 offen offset:3072 lds
    s_add_u32 m0, m0, 4096
    s_add_u32 s38, s38, 4096
    buffer_load_dwordx4 v2, s[12:15], s38 offen offset:0 lds
    buffer_load_dwordx4 v2, s[12:15], s38 offen offset:1024 lds
    buffer_load_dwordx4 v2, s[12:15], s38 offen offset:2048 lds
    buffer_load_dwordx4 v2, s[12:15], s38 offen offset:3072 lds
    s_waitcnt vmcnt(12)
    s_barrier
    s_add_u32 m0, s33, 0
    s_add_u32 s38, s32, 196608
    buffer_load_dwordx4 v2, s[12:15], s38 offen offset:0 lds
    buffer_load_dwordx4 v2, s[12:15], s38 offen offset:1024 lds
    buffer_load_dwordx4 v2, s[12:15], s38 offen offset:2048 lds
    buffer_load_dwordx4 v2, s[12:15], s38 offen offset:3072 lds
    s_add_u32 m0, m0, 4096
    s_add_u32 s38, s38, 4096
    buffer_load_dwordx4 v2, s[12:15], s38 offen offset:0 lds
    buffer_load_dwordx4 v2, s[12:15], s38 offen offset:1024 lds
    buffer_load_dwordx4 v2, s[12:15], s38 offen offset:2048 lds
    buffer_load_dwordx4 v2, s[12:15], s38 offen offset:3072 lds
    s_add_u32 m0, m0, 4096
    s_add_u32 s38, s38, 4096
    buffer_load_dwordx4 v2, s[12:15], s38 offen offset:0 lds
    buffer_load_dwordx4 v2, s[12:15], s38 offen offset:1024 lds
    buffer_load_dwordx4 v2, s[12:15], s38 offen offset:2048 lds
    buffer_load_dwordx4 v2, s[12:15], s38 offen offset:3072 lds
    s_waitcnt vmcnt(12)
    s_barrier
    s_add_u32 m0, s33, 40960
    s_add_u32 s38, s32, 221184
    buffer_load_dwordx4 v2, s[12:15], s38 offen offset:0 lds
    buffer_load_dwordx4 v2, s[12:15], s38 offen offset:1024 lds
    buffer_load_dwordx4 v2, s[12:15], s38 offen offset:2048 lds
    buffer_load_dwordx4 v2, s[12:15], s38 offen offset:3072 lds
    s_add_u32 m0, m0, 4096
    s_add_u32 s38, s38, 4096
    buffer_load_dwordx4 v2, s[12:15], s38 offen offset:0 lds
    buffer_load_dwordx4 v2, s[12:15], s38 offen offset:1024 lds
    buffer_load_dwordx4 v2, s[12:15], s38 offen offset:2048 lds
    buffer_load_dwordx4 v2, s[12:15], s38 offen offset:3072 lds
    s_add_u32 m0, m0, 4096
    s_add_u32 s38, s38, 4096
    buffer_load_dwordx4 v2, s[12:15], s38 offen offset:0 lds
    buffer_load_dwordx4 v2, s[12:15], s38 offen offset:1024 lds
    buffer_load_dwordx4 v2, s[12:15], s38 offen offset:2048 lds
    buffer_load_dwordx4 v2, s[12:15], s38 offen offset:3072 lds
    s_waitcnt vmcnt(12)
    s_barrier
    s_waitcnt vmcnt(0)
    s_barrier
    s_barrier
    s_and_b32 s24, s2, 7
    s_lshr_b32 s25, s2, 3
    s_lshl_b32 s20, s24, 2
    s_lshr_b32 s26, s25, 3
    s_add_u32 s20, s20, s26
    s_and_b32 s21, s25, 7
    v_lshlrev_b32 v2, 4, v0
    s_sub_u32 s30, s4, 6
    s_mul_i32 s32, s21, 245760
    s_mul_i32 s33, s30, 5120
    s_add_u32 s32, s32, s33
    s_add_u32 s32, s32, 16752640
    s_add_u32 s33, s33, 8192
    s_add_u32 m0, s33, 0
    s_add_u32 s38, s32, 0
    buffer_load_dwordx4 v2, s[12:15], s38 offen offset:0 lds
    buffer_load_dwordx4 v2, s[12:15], s38 offen offset:1024 lds
    buffer_load_dwordx4 v2, s[12:15], s38 offen offset:2048 lds
    buffer_load_dwordx4 v2, s[12:15], s38 offen offset:3072 lds
    s_add_u32 m0, m0, 4096
    s_add_u32 s38, s38, 4096
    buffer_load_dwordx4 v2, s[12:15], s38 offen lds
    s_add_u32 m0, s33, 18432
    s_add_u32 s38, s32, 10240
    buffer_load_dwordx4 v2, s[12:15], s38 offen offset:0 lds
    buffer_load_dwordx4 v2, s[12:15], s38 offen offset:1024 lds
    buffer_load_dwordx4 v2, s[12:15], s38 offen offset:2048 lds
    buffer_load_dwordx4 v2, s[12:15], s38 offen offset:3072 lds
    s_add_u32 m0, m0, 4096
    s_add_u32 s38, s38, 4096
    buffer_load_dwordx4 v2, s[12:15], s38 offen lds
    s_add_u32 m0, s33, 36864
    s_add_u32 s38, s32, 20480
    buffer_load_dwordx4 v2, s[12:15], s38 offen offset:0 lds
    buffer_load_dwordx4 v2, s[12:15], s38 offen offset:1024 lds
    buffer_load_dwordx4 v2, s[12:15], s38 offen offset:2048 lds
    buffer_load_dwordx4 v2, s[12:15], s38 offen offset:3072 lds
    s_add_u32 m0, m0, 4096
    s_add_u32 s38, s38, 4096
    buffer_load_dwordx4 v2, s[12:15], s38 offen lds
    s_add_u32 m0, s33, 55296
    s_add_u32 s38, s32, 30720
    buffer_load_dwordx4 v2, s[12:15], s38 offen offset:0 lds
    buffer_load_dwordx4 v2, s[12:15], s38 offen offset:1024 lds
    buffer_load_dwordx4 v2, s[12:15], s38 offen offset:2048 lds
    buffer_load_dwordx4 v2, s[12:15], s38 offen offset:3072 lds
    s_add_u32 m0, m0, 4096
    s_add_u32 s38, s38, 4096
    buffer_load_dwordx4 v2, s[12:15], s38 offen lds
    s_add_u32 m0, s33, 73728
    s_add_u32 s38, s32, 40960
    buffer_load_dwordx4 v2, s[12:15], s38 offen offset:0 lds
    buffer_load_dwordx4 v2, s[12:15], s38 offen offset:1024 lds
    buffer_load_dwordx4 v2, s[12:15], s38 offen offset:2048 lds
    buffer_load_dwordx4 v2, s[12:15], s38 offen offset:3072 lds
    s_add_u32 m0, m0, 4096
    s_add_u32 s38, s38, 4096
    buffer_load_dwordx4 v2, s[12:15], s38 offen lds
    s_add_u32 m0, s33, 92160
    s_add_u32 s38, s32, 51200
    buffer_load_dwordx4 v2, s[12:15], s38 offen offset:0 lds
    buffer_load_dwordx4 v2, s[12:15], s38 offen offset:1024 lds
    buffer_load_dwordx4 v2, s[12:15], s38 offen offset:2048 lds
    buffer_load_dwordx4 v2, s[12:15], s38 offen offset:3072 lds
    s_add_u32 m0, m0, 4096
    s_add_u32 s38, s38, 4096
    buffer_load_dwordx4 v2, s[12:15], s38 offen lds
    s_add_u32 m0, s33, 110592
    s_add_u32 s38, s32, 61440
    buffer_load_dwordx4 v2, s[12:15], s38 offen offset:0 lds
    buffer_load_dwordx4 v2, s[12:15], s38 offen offset:1024 lds
    buffer_load_dwordx4 v2, s[12:15], s38 offen offset:2048 lds
    buffer_load_dwordx4 v2, s[12:15], s38 offen offset:3072 lds
    s_add_u32 m0, m0, 4096
    s_add_u32 s38, s38, 4096
    buffer_load_dwordx4 v2, s[12:15], s38 offen lds
    s_add_u32 m0, s33, 129024
    s_add_u32 s38, s32, 71680
    buffer_load_dwordx4 v2, s[12:15], s38 offen offset:0 lds
    buffer_load_dwordx4 v2, s[12:15], s38 offen offset:1024 lds
    buffer_load_dwordx4 v2, s[12:15], s38 offen offset:2048 lds
    buffer_load_dwordx4 v2, s[12:15], s38 offen offset:3072 lds
    s_add_u32 m0, m0, 4096
    s_add_u32 s38, s38, 4096
    buffer_load_dwordx4 v2, s[12:15], s38 offen lds
L_p5_end:
    s_mov_b64 exec, -1
    s_cmp_ge_u32 s4, 4
    s_cbranch_scc1 L_pc_6
    v_mov_b32 v250, 147456
    v_mov_b32 v251, 1
    s_waitcnt vmcnt(0)
    s_mov_b64 exec, 1
    ds_add_u32 v250, v251
    s_mov_b64 exec, -1
L_pc_6:
    s_and_b32 s24, s2, 7
    s_lshr_b32 s25, s2, 3
    s_lshl_b32 s20, s24, 2
    s_lshr_b32 s26, s25, 3
    s_add_u32 s20, s20, s26
    s_and_b32 s21, s25, 7
    s_mov_b32 s16, s64
    s_mov_b32 s17, s65
    s_mov_b32 s18, 2621440
    s_mov_b32 s19, 0x00020000
    s_cmp_ge_u32 s4, 4
    s_cbranch_scc1 L_p6_prod
    v_lshlrev_b32 v2, 4, v0
    s_lshl_b32 s32, s4, 10
    v_add_u32 v3, s32, v2
    v_add_u32 v4, 8192, v2
    v_add_u32 v5, 73728, v3
    v_add_u32 v6, 73728, v4
    v_and_b32 v7, 15, v0
    v_lshrrev_b32 v8, 4, v0
    v_lshlrev_b32 v11, 4, v8
    s_mul_i32 s35, s21, 320
    s_add_u32 s35, s35, 5443072
    v_mov_b32 v64, 0
    v_mov_b32 v65, 0
    v_mov_b32 v66, 0
    v_mov_b32 v67, 0
    v_mov_b32 v68, 0
    v_mov_b32 v69, 0
    v_mov_b32 v70, 0
    v_mov_b32 v71, 0
    v_mov_b32 v72, 0
    v_mov_b32 v73, 0
    v_mov_b32 v74, 0
    v_mov_b32 v75, 0
    v_mov_b32 v76, 0
    v_mov_b32 v77, 0
    v_mov_b32 v78, 0
    v_mov_b32 v79, 0
    v_mov_b32 v80, 0
    v_mov_b32 v81, 0
    v_mov_b32 v82, 0
    v_mov_b32 v83, 0
    buffer_load_dwordx4 v[130:133], v11, s[12:15], s35 offen offset:0
    buffer_load_dwordx4 v[134:137], v11, s[12:15], s35 offen offset:64
    buffer_load_dwordx4 v[138:141], v11, s[12:15], s35 offen offset:128
    buffer_load_dwordx4 v[142:145], v11, s[12:15], s35 offen offset:192
    buffer_load_dwordx4 v[146:149], v11, s[12:15], s35 offen offset:256
    s_barrier
    ds_read_b128 v[24:27], v3 offset:0
    ds_read_b128 v[28:31], v4 offset:0
    ds_read_b128 v[32:35], v4 offset:1024
    ds_read_b128 v[36:39], v4 offset:2048
    ds_read_b128 v[40:43], v4 offset:3072
    ds_read_b128 v[44:47], v4 offset:4096
    ds_read_b128 v[96:99], v3 offset:4096
    ds_read_b128 v[100:103], v4 offset:5120
    ds_read_b128 v[104:107], v4 offset:6144
    ds_read_b128 v[108:111], v4 offset:7168
    ds_read_b128 v[112:115], v4 offset:8192
    ds_read_b128 v[116:119], v4 offset:9216
    s_waitcnt lgkmcnt(6)
    v_mfma_f32_16x16x32_bf16 v[64:67], v[28:31], v[24:27], v[64:67]
    s_barrier
    ds_read_b128 v[176:179], v3 offset:18432
    v_mfma_f32_16x16x32_bf16 v[68:71], v[32:35], v[24:27], v[68:71]
    ds_read_b128 v[180:183], v4 offset:18432
    v_mfma_f32_16x16x32_bf16 v[72:75], v[36:39], v[24:27], v[72:75]
    ds_read_b128 v[184:187], v4 offset:19456
    v_mfma_f32_16x16x32_bf16 v[76:79], v[40:43], v[24:27], v[76:79]
    ds_read_b128 v[188:191], v4 offset:20480
    v_mfma_f32_16x16x32_bf16 v[80:83], v[44:47], v[24:27], v[80:83]
    ds_read_b128 v[192:195], v4 offset:21504
    ds_read_b128 v[196:199], v4 offset:22528
    s_waitcnt lgkmcnt(6)
    v_mfma_f32_16x16x32_bf16 v[64:67], v[100:103], v[96:99], v[64:67]
    ds_read_b128 v[24:27], v3 offset:22528
    v_mfma_f32_16x16x32_bf16 v[68:71], v[104:107], v[96:99], v[68:71]
    ds_read_b128 v[28:31], v4 offset:23552
    v_mfma_f32_16x16x32_bf16 v[72:75], v[108:111], v[96:99], v[72:75]
    ds_read_b128 v[32:35], v4 offset:24576
    v_mfma_f32_16x16x32_bf16 v[76:79], v[112:115], v[96:99], v[76:79]
    ds_read_b128 v[36:39], v4 offset:25600
    v_mfma_f32_16x16x32_bf16 v[80:83], v[116:119], v[96:99], v[80:83]
    ds_read_b128 v[40:43], v4 offset:26624
    ds_read_b128 v[44:47], v4 offset:27648
    s_waitcnt lgkmcnt(6)
    v_mfma_f32_16x16x32_bf16 v[64:67], v[180:183], v[176:179], v[64:67]
    s_barrier
    ds_read_b128 v[96:99], v3 offset:36864
    v_mfma_f32_16x16x32_bf16 v[68:71], v[184:187], v[176:179], v[68:71]
    ds_read_b128 v[100:103], v4 offset:36864
    v_mfma_f32_16x16x32_bf16 v[72:75], v[188:191], v[176:179], v[72:75]
    ds_read_b128 v[104:107], v4 offset:37888
    v_mfma_f32_16x16x32_bf16 v[76:79], v[192:195], v[176:179], v[76:79]
    ds_read_b128 v[108:111], v4 offset:38912
    v_mfma_f32_16x16x32_bf16 v[80:83], v[196:199], v[176:179], v[80:83]
    ds_read_b128 v[112:115], v4 offset:39936
    ds_read_b128 v[116:119], v4 offset:40960
    s_waitcnt lgkmcnt(6)
    v_mfma_f32_16x16x32_bf16 v[64:67], v[28:31], v[24:27], v[64:67]
    ds_read_b128 v[176:179], v3 offset:40960
    v_mfma_f32_16x16x32_bf16 v[68:71], v[32:35], v[24:27], v[68:71]
    ds_read_b128 v[180:183], v4 offset:41984
    v_mfma_f32_16x16x32_bf16 v[72:75], v[36:39], v[24:27], v[72:75]
    ds_read_b128 v[184:187], v4 offset:43008
    v_mfma_f32_16x16x32_bf16 v[76:79], v[40:43], v[24:27], v[76:79]
    ds_read_b128 v[188:191], v4 offset:44032
    v_mfma_f32_16x16x32_bf16 v[80:83], v[44:47], v[24:27], v[80:83]
    ds_read_b128 v[192:195], v4 offset:45056
    ds_read_b128 v[196:199], v4 offset:46080
    s_waitcnt lgkmcnt(6)
    v_mfma_f32_16x16x32_bf16 v[64:67], v[100:103], v[96:99], v[64:67]
    s_barrier
    ds_read_b128 v[24:27], v3 offset:55296
    v_mfma_f32_16x16x32_bf16 v[68:71], v[104:107], v[96:99], v[68:71]
    ds_read_b128 v[28:31], v4 offset:55296
    v_mfma_f32_16x16x32_bf16 v[72:75], v[108:111], v[96:99], v[72:75]
    ds_read_b128 v[32:35], v4 offset:56320
    v_mfma_f32_16x16x32_bf16 v[76:79], v[112:115], v[96:99], v[76:79]
    ds_read_b128 v[36:39], v4 offset:57344
    v_mfma_f32_16x16x32_bf16 v[80:83], v[116:119], v[96:99], v[80:83]
    ds_read_b128 v[40:43], v4 offset:58368
    ds_read_b128 v[44:47], v4 offset:59392
    s_waitcnt lgkmcnt(6)
    v_mfma_f32_16x16x32_bf16 v[64:67], v[180:183], v[176:179], v[64:67]
    ds_read_b128 v[96:99], v3 offset:59392
    v_mfma_f32_16x16x32_bf16 v[68:71], v[184:187], v[176:179], v[68:71]
    ds_read_b128 v[100:103], v4 offset:60416
    v_mfma_f32_16x16x32_bf16 v[72:75], v[188:191], v[176:179], v[72:75]
    ds_read_b128 v[104:107], v4 offset:61440
    v_mfma_f32_16x16x32_bf16 v[76:79], v[192:195], v[176:179], v[76:79]
    ds_read_b128 v[108:111], v4 offset:62464
    v_mfma_f32_16x16x32_bf16 v[80:83], v[196:199], v[176:179], v[80:83]
    ds_read_b128 v[112:115], v4 offset:63488
    ds_read_b128 v[116:119], v4 offset:64512
    s_waitcnt lgkmcnt(6)
    v_mfma_f32_16x16x32_bf16 v[64:67], v[28:31], v[24:27], v[64:67]
    s_barrier
    ds_read_b128 v[176:179], v5 offset:0
    v_mfma_f32_16x16x32_bf16 v[68:71], v[32:35], v[24:27], v[68:71]
    ds_read_b128 v[180:183], v6 offset:0
    v_mfma_f32_16x16x32_bf16 v[72:75], v[36:39], v[24:27], v[72:75]
    ds_read_b128 v[184:187], v6 offset:1024
    v_mfma_f32_16x16x32_bf16 v[76:79], v[40:43], v[24:27], v[76:79]
    ds_read_b128 v[188:191], v6 offset:2048
    v_mfma_f32_16x16x32_bf16 v[80:83], v[44:47], v[24:27], v[80:83]
    ds_read_b128 v[192:195], v6 offset:3072
    ds_read_b128 v[196:199], v6 offset:4096
    s_waitcnt lgkmcnt(6)
    v_mfma_f32_16x16x32_bf16 v[64:67], v[100:103], v[96:99], v[64:67]
    ds_read_b128 v[24:27], v5 offset:4096
    v_mfma_f32_16x16x32_bf16 v[68:71], v[104:107], v[96:99], v[68:71]
    ds_read_b128 v[28:31], v6 offset:5120
    v_mfma_f32_16x16x32_bf16 v[72:75], v[108:111], v[96:99], v[72:75]
    ds_read_b128 v[32:35], v6 offset:6144
    v_mfma_f32_16x16x32_bf16 v[76:79], v[112:115], v[96:99], v[76:79]
    ds_read_b128 v[36:39], v6 offset:7168
    v_mfma_f32_16x16x32_bf16 v[80:83], v[116:119], v[96:99], v[80:83]
    ds_read_b128 v[40:43], v6 offset:8192
    ds_read_b128 v[44:47], v6 offset:9216
    s_waitcnt lgkmcnt(6)
    v_mfma_f32_16x16x32_bf16 v[64:67], v[180:183], v[176:179], v[64:67]
    s_barrier
    ds_read_b128 v[96:99], v5 offset:18432
    v_mfma_f32_16x16x32_bf16 v[68:71], v[184:187], v[176:179], v[68:71]
    ds_read_b128 v[100:103], v6 offset:18432
    v_mfma_f32_16x16x32_bf16 v[72:75], v[188:191], v[176:179], v[72:75]
    ds_read_b128 v[104:107], v6 offset:19456
    v_mfma_f32_16x16x32_bf16 v[76:79], v[192:195], v[176:179], v[76:79]
    ds_read_b128 v[108:111], v6 offset:20480
    v_mfma_f32_16x16x32_bf16 v[80:83], v[196:199], v[176:179], v[80:83]
    ds_read_b128 v[112:115], v6 offset:21504
    ds_read_b128 v[116:119], v6 offset:22528
    s_waitcnt lgkmcnt(6)
    v_mfma_f32_16x16x32_bf16 v[64:67], v[28:31], v[24:27], v[64:67]
    ds_read_b128 v[176:179], v5 offset:22528
    v_mfma_f32_16x16x32_bf16 v[68:71], v[32:35], v[24:27], v[68:71]
    ds_read_b128 v[180:183], v6 offset:23552
    v_mfma_f32_16x16x32_bf16 v[72:75], v[36:39], v[24:27], v[72:75]
    ds_read_b128 v[184:187], v6 offset:24576
    v_mfma_f32_16x16x32_bf16 v[76:79], v[40:43], v[24:27], v[76:79]
    ds_read_b128 v[188:191], v6 offset:25600
    v_mfma_f32_16x16x32_bf16 v[80:83], v[44:47], v[24:27], v[80:83]
    ds_read_b128 v[192:195], v6 offset:26624
    ds_read_b128 v[196:199], v6 offset:27648
    s_waitcnt lgkmcnt(6)
    v_mfma_f32_16x16x32_bf16 v[64:67], v[100:103], v[96:99], v[64:67]
    s_barrier
    ds_read_b128 v[24:27], v5 offset:36864
    v_mfma_f32_16x16x32_bf16 v[68:71], v[104:107], v[96:99], v[68:71]
    ds_read_b128 v[28:31], v6 offset:36864
    v_mfma_f32_16x16x32_bf16 v[72:75], v[108:111], v[96:99], v[72:75]
    ds_read_b128 v[32:35], v6 offset:37888
    v_mfma_f32_16x16x32_bf16 v[76:79], v[112:115], v[96:99], v[76:79]
    ds_read_b128 v[36:39], v6 offset:38912
    v_mfma_f32_16x16x32_bf16 v[80:83], v[116:119], v[96:99], v[80:83]
    ds_read_b128 v[40:43], v6 offset:39936
    ds_read_b128 v[44:47], v6 offset:40960
    s_waitcnt lgkmcnt(6)
    v_mfma_f32_16x16x32_bf16 v[64:67], v[180:183], v[176:179], v[64:67]
    ds_read_b128 v[96:99], v5 offset:40960
    v_mfma_f32_16x16x32_bf16 v[68:71], v[184:187], v[176:179], v[68:71]
    ds_read_b128 v[100:103], v6 offset:41984
    v_mfma_f32_16x16x32_bf16 v[72:75], v[188:191], v[176:179], v[72:75]
    ds_read_b128 v[104:107], v6 offset:43008
    v_mfma_f32_16x16x32_bf16 v[76:79], v[192:195], v[176:179], v[76:79]
    ds_read_b128 v[108:111], v6 offset:44032
    v_mfma_f32_16x16x32_bf16 v[80:83], v[196:199], v[176:179], v[80:83]
    ds_read_b128 v[112:115], v6 offset:45056
    ds_read_b128 v[116:119], v6 offset:46080
    s_waitcnt lgkmcnt(6)
    v_mfma_f32_16x16x32_bf16 v[64:67], v[28:31], v[24:27], v[64:67]
    s_barrier
    ds_read_b128 v[176:179], v5 offset:55296
    v_mfma_f32_16x16x32_bf16 v[68:71], v[32:35], v[24:27], v[68:71]
    ds_read_b128 v[180:183], v6 offset:55296
    v_mfma_f32_16x16x32_bf16 v[72:75], v[36:39], v[24:27], v[72:75]
    ds_read_b128 v[184:187], v6 offset:56320
    v_mfma_f32_16x16x32_bf16 v[76:79], v[40:43], v[24:27], v[76:79]
    ds_read_b128 v[188:191], v6 offset:57344
    v_mfma_f32_16x16x32_bf16 v[80:83], v[44:47], v[24:27], v[80:83]
    ds_read_b128 v[192:195], v6 offset:58368
    ds_read_b128 v[196:199], v6 offset:59392
    s_waitcnt lgkmcnt(6)
    v_mfma_f32_16x16x32_bf16 v[64:67], v[100:103], v[96:99], v[64:67]
    ds_read_b128 v[24:27], v5 offset:59392
    v_mfma_f32_16x16x32_bf16 v[68:71], v[104:107], v[96:99], v[68:71]
    ds_read_b128 v[28:31], v6 offset:60416
    v_mfma_f32_16x16x32_bf16 v[72:75], v[108:111], v[96:99], v[72:75]
    ds_read_b128 v[32:35], v6 offset:61440
    v_mfma_f32_16x16x32_bf16 v[76:79], v[112:115], v[96:99], v[76:79]
    ds_read_b128 v[36:39], v6 offset:62464
    v_mfma_f32_16x16x32_bf16 v[80:83], v[116:119], v[96:99], v[80:83]
    ds_read_b128 v[40:43], v6 offset:63488
    ds_read_b128 v[44:47], v6 offset:64512
    s_waitcnt lgkmcnt(6)
    v_mfma_f32_16x16x32_bf16 v[64:67], v[180:183], v[176:179], v[64:67]
    s_barrier
    ds_read_b128 v[96:99], v3 offset:0
    v_mfma_f32_16x16x32_bf16 v[68:71], v[184:187], v[176:179], v[68:71]
    ds_read_b128 v[100:103], v4 offset:0
    v_mfma_f32_16x16x32_bf16 v[72:75], v[188:191], v[176:179], v[72:75]
    ds_read_b128 v[104:107], v4 offset:1024
    v_mfma_f32_16x16x32_bf16 v[76:79], v[192:195], v[176:179], v[76:79]
    ds_read_b128 v[108:111], v4 offset:2048
    v_mfma_f32_16x16x32_bf16 v[80:83], v[196:199], v[176:179], v[80:83]
    ds_read_b128 v[112:115], v4 offset:3072
    ds_read_b128 v[116:119], v4 offset:4096
    s_waitcnt lgkmcnt(6)
    v_mfma_f32_16x16x32_bf16 v[64:67], v[28:31], v[24:27], v[64:67]
    ds_read_b128 v[176:179], v3 offset:4096
    v_mfma_f32_16x16x32_bf16 v[68:71], v[32:35], v[24:27], v[68:71]
    ds_read_b128 v[180:183], v4 offset:5120
    v_mfma_f32_16x16x32_bf16 v[72:75], v[36:39], v[24:27], v[72:75]
    ds_read_b128 v[184:187], v4 offset:6144
    v_mfma_f32_16x16x32_bf16 v[76:79], v[40:43], v[24:27], v[76:79]
    ds_read_b128 v[188:191], v4 offset:7168
    v_mfma_f32_16x16x32_bf16 v[80:83], v[44:47], v[24:27], v[80:83]
    ds_read_b128 v[192:195], v4 offset:8192
    ds_read_b128 v[196:199], v4 offset:9216
    s_waitcnt lgkmcnt(6)
    v_mfma_f32_16x16x32_bf16 v[64:67], v[100:103], v[96:99], v[64:67]
    s_barrier
    ds_read_b128 v[24:27], v3 offset:18432
    v_mfma_f32_16x16x32_bf16 v[68:71], v[104:107], v[96:99], v[68:71]
    ds_read_b128 v[28:31], v4 offset:18432
    v_mfma_f32_16x16x32_bf16 v[72:75], v[108:111], v[96:99], v[72:75]
    ds_read_b128 v[32:35], v4 offset:19456
    v_mfma_f32_16x16x32_bf16 v[76:79], v[112:115], v[96:99], v[76:79]
    ds_read_b128 v[36:39], v4 offset:20480
    v_mfma_f32_16x16x32_bf16 v[80:83], v[116:119], v[96:99], v[80:83]
    ds_read_b128 v[40:43], v4 offset:21504
    ds_read_b128 v[44:47], v4 offset:22528
    s_waitcnt lgkmcnt(6)
    v_mfma_f32_16x16x32_bf16 v[64:67], v[180:183], v[176:179], v[64:67]
    ds_read_b128 v[96:99], v3 offset:22528
    v_mfma_f32_16x16x32_bf16 v[68:71], v[184:187], v[176:179], v[68:71]
    ds_read_b128 v[100:103], v4 offset:23552
    v_mfma_f32_16x16x32_bf16 v[72:75], v[188:191], v[176:179], v[72:75]
    ds_read_b128 v[104:107], v4 offset:24576
    v_mfma_f32_16x16x32_bf16 v[76:79], v[192:195], v[176:179], v[76:79]
    ds_read_b128 v[108:111], v4 offset:25600
    v_mfma_f32_16x16x32_bf16 v[80:83], v[196:199], v[176:179], v[80:83]
    ds_read_b128 v[112:115], v4 offset:26624
    ds_read_b128 v[116:119], v4 offset:27648
    s_waitcnt lgkmcnt(6)
    v_mfma_f32_16x16x32_bf16 v[64:67], v[28:31], v[24:27], v[64:67]
    s_barrier
    ds_read_b128 v[176:179], v3 offset:36864
    v_mfma_f32_16x16x32_bf16 v[68:71], v[32:35], v[24:27], v[68:71]
    ds_read_b128 v[180:183], v4 offset:36864
    v_mfma_f32_16x16x32_bf16 v[72:75], v[36:39], v[24:27], v[72:75]
    ds_read_b128 v[184:187], v4 offset:37888
    v_mfma_f32_16x16x32_bf16 v[76:79], v[40:43], v[24:27], v[76:79]
    ds_read_b128 v[188:191], v4 offset:38912
    v_mfma_f32_16x16x32_bf16 v[80:83], v[44:47], v[24:27], v[80:83]
    ds_read_b128 v[192:195], v4 offset:39936
    ds_read_b128 v[196:199], v4 offset:40960
    s_waitcnt lgkmcnt(6)
    v_mfma_f32_16x16x32_bf16 v[64:67], v[100:103], v[96:99], v[64:67]
    ds_read_b128 v[24:27], v3 offset:40960
    v_mfma_f32_16x16x32_bf16 v[68:71], v[104:107], v[96:99], v[68:71]
    ds_read_b128 v[28:31], v4 offset:41984
    v_mfma_f32_16x16x32_bf16 v[72:75], v[108:111], v[96:99], v[72:75]
    ds_read_b128 v[32:35], v4 offset:43008
    v_mfma_f32_16x16x32_bf16 v[76:79], v[112:115], v[96:99], v[76:79]
    ds_read_b128 v[36:39], v4 offset:44032
    v_mfma_f32_16x16x32_bf16 v[80:83], v[116:119], v[96:99], v[80:83]
    ds_read_b128 v[40:43], v4 offset:45056
    ds_read_b128 v[44:47], v4 offset:46080
    s_waitcnt lgkmcnt(6)
    v_mfma_f32_16x16x32_bf16 v[64:67], v[180:183], v[176:179], v[64:67]
    s_barrier
    ds_read_b128 v[96:99], v3 offset:55296
    v_mfma_f32_16x16x32_bf16 v[68:71], v[184:187], v[176:179], v[68:71]
    ds_read_b128 v[100:103], v4 offset:55296
    v_mfma_f32_16x16x32_bf16 v[72:75], v[188:191], v[176:179], v[72:75]
    ds_read_b128 v[104:107], v4 offset:56320
    v_mfma_f32_16x16x32_bf16 v[76:79], v[192:195], v[176:179], v[76:79]
    ds_read_b128 v[108:111], v4 offset:57344
    v_mfma_f32_16x16x32_bf16 v[80:83], v[196:199], v[176:179], v[80:83]
    ds_read_b128 v[112:115], v4 offset:58368
    ds_read_b128 v[116:119], v4 offset:59392
    s_waitcnt lgkmcnt(6)
    v_mfma_f32_16x16x32_bf16 v[64:67], v[28:31], v[24:27], v[64:67]
    ds_read_b128 v[176:179], v3 offset:59392
    v_mfma_f32_16x16x32_bf16 v[68:71], v[32:35], v[24:27], v[68:71]
    ds_read_b128 v[180:183], v4 offset:60416
    v_mfma_f32_16x16x32_bf16 v[72:75], v[36:39], v[24:27], v[72:75]
    ds_read_b128 v[184:187], v4 offset:61440
    v_mfma_f32_16x16x32_bf16 v[76:79], v[40:43], v[24:27], v[76:79]
    ds_read_b128 v[188:191], v4 offset:62464
    v_mfma_f32_16x16x32_bf16 v[80:83], v[44:47], v[24:27], v[80:83]
    ds_read_b128 v[192:195], v4 offset:63488
    ds_read_b128 v[196:199], v4 offset:64512
    s_waitcnt lgkmcnt(6)
    v_mfma_f32_16x16x32_bf16 v[64:67], v[100:103], v[96:99], v[64:67]
    s_barrier
    ds_read_b128 v[24:27], v5 offset:0
    v_mfma_f32_16x16x32_bf16 v[68:71], v[104:107], v[96:99], v[68:71]
    ds_read_b128 v[28:31], v6 offset:0
    v_mfma_f32_16x16x32_bf16 v[72:75], v[108:111], v[96:99], v[72:75]
    ds_read_b128 v[32:35], v6 offset:1024
    v_mfma_f32_16x16x32_bf16 v[76:79], v[112:115], v[96:99], v[76:79]
    ds_read_b128 v[36:39], v6 offset:2048
    v_mfma_f32_16x16x32_bf16 v[80:83], v[116:119], v[96:99], v[80:83]
    ds_read_b128 v[40:43], v6 offset:3072
    ds_read_b128 v[44:47], v6 offset:4096
    s_waitcnt lgkmcnt(6)
    v_mfma_f32_16x16x32_bf16 v[64:67], v[180:183], v[176:179], v[64:67]
    ds_read_b128 v[96:99], v5 offset:4096
    v_mfma_f32_16x16x32_bf16 v[68:71], v[184:187], v[176:179], v[68:71]
    ds_read_b128 v[100:103], v6 offset:5120
    v_mfma_f32_16x16x32_bf16 v[72:75], v[188:191], v[176:179], v[72:75]
    ds_read_b128 v[104:107], v6 offset:6144
    v_mfma_f32_16x16x32_bf16 v[76:79], v[192:195], v[176:179], v[76:79]
    ds_read_b128 v[108:111], v6 offset:7168
    v_mfma_f32_16x16x32_bf16 v[80:83], v[196:199], v[176:179], v[80:83]
    ds_read_b128 v[112:115], v6 offset:8192
    ds_read_b128 v[116:119], v6 offset:9216
    s_waitcnt lgkmcnt(6)
    v_mfma_f32_16x16x32_bf16 v[64:67], v[28:31], v[24:27], v[64:67]
    s_barrier
    ds_read_b128 v[176:179], v5 offset:18432
    v_mfma_f32_16x16x32_bf16 v[68:71], v[32:35], v[24:27], v[68:71]
    ds_read_b128 v[180:183], v6 offset:18432
    v_mfma_f32_16x16x32_bf16 v[72:75], v[36:39], v[24:27], v[72:75]
    ds_read_b128 v[184:187], v6 offset:19456
    v_mfma_f32_16x16x32_bf16 v[76:79], v[40:43], v[24:27], v[76:79]
    ds_read_b128 v[188:191], v6 offset:20480
    v_mfma_f32_16x16x32_bf16 v[80:83], v[44:47], v[24:27], v[80:83]
    ds_read_b128 v[192:195], v6 offset:21504
    ds_read_b128 v[196:199], v6 offset:22528
    s_waitcnt lgkmcnt(6)
    v_mfma_f32_16x16x32_bf16 v[64:67], v[100:103], v[96:99], v[64:67]
    ds_read_b128 v[24:27], v5 offset:22528
    v_mfma_f32_16x16x32_bf16 v[68:71], v[104:107], v[96:99], v[68:71]
    ds_read_b128 v[28:31], v6 offset:23552
    v_mfma_f32_16x16x32_bf16 v[72:75], v[108:111], v[96:99], v[72:75]
    ds_read_b128 v[32:35], v6 offset:24576
    v_mfma_f32_16x16x32_bf16 v[76:79], v[112:115], v[96:99], v[76:79]
    ds_read_b128 v[36:39], v6 offset:25600
    v_mfma_f32_16x16x32_bf16 v[80:83], v[116:119], v[96:99], v[80:83]
    ds_read_b128 v[40:43], v6 offset:26624
    ds_read_b128 v[44:47], v6 offset:27648
    s_waitcnt lgkmcnt(6)
    v_mfma_f32_16x16x32_bf16 v[64:67], v[180:183], v[176:179], v[64:67]
    s_barrier
    ds_read_b128 v[96:99], v5 offset:36864
    v_mfma_f32_16x16x32_bf16 v[68:71], v[184:187], v[176:179], v[68:71]
    ds_read_b128 v[100:103], v6 offset:36864
    v_mfma_f32_16x16x32_bf16 v[72:75], v[188:191], v[176:179], v[72:75]
    ds_read_b128 v[104:107], v6 offset:37888
    v_mfma_f32_16x16x32_bf16 v[76:79], v[192:195], v[176:179], v[76:79]
    ds_read_b128 v[108:111], v6 offset:38912
    v_mfma_f32_16x16x32_bf16 v[80:83], v[196:199], v[176:179], v[80:83]
    ds_read_b128 v[112:115], v6 offset:39936
    ds_read_b128 v[116:119], v6 offset:40960
    s_waitcnt lgkmcnt(6)
    v_mfma_f32_16x16x32_bf16 v[64:67], v[28:31], v[24:27], v[64:67]
    ds_read_b128 v[176:179], v5 offset:40960
    v_mfma_f32_16x16x32_bf16 v[68:71], v[32:35], v[24:27], v[68:71]
    ds_read_b128 v[180:183], v6 offset:41984
    v_mfma_f32_16x16x32_bf16 v[72:75], v[36:39], v[24:27], v[72:75]
    ds_read_b128 v[184:187], v6 offset:43008
    v_mfma_f32_16x16x32_bf16 v[76:79], v[40:43], v[24:27], v[76:79]
    ds_read_b128 v[188:191], v6 offset:44032
    v_mfma_f32_16x16x32_bf16 v[80:83], v[44:47], v[24:27], v[80:83]
    ds_read_b128 v[192:195], v6 offset:45056
    ds_read_b128 v[196:199], v6 offset:46080
    s_waitcnt lgkmcnt(6)
    v_mfma_f32_16x16x32_bf16 v[64:67], v[100:103], v[96:99], v[64:67]
    s_barrier
    ds_read_b128 v[24:27], v5 offset:55296
    v_mfma_f32_16x16x32_bf16 v[68:71], v[104:107], v[96:99], v[68:71]
    ds_read_b128 v[28:31], v6 offset:55296
    v_mfma_f32_16x16x32_bf16 v[72:75], v[108:111], v[96:99], v[72:75]
    ds_read_b128 v[32:35], v6 offset:56320
    v_mfma_f32_16x16x32_bf16 v[76:79], v[112:115], v[96:99], v[76:79]
    ds_read_b128 v[36:39], v6 offset:57344
    v_mfma_f32_16x16x32_bf16 v[80:83], v[116:119], v[96:99], v[80:83]
    ds_read_b128 v[40:43], v6 offset:58368
    ds_read_b128 v[44:47], v6 offset:59392
    s_waitcnt lgkmcnt(6)
    v_mfma_f32_16x16x32_bf16 v[64:67], v[180:183], v[176:179], v[64:67]
    ds_read_b128 v[96:99], v5 offset:59392
    v_mfma_f32_16x16x32_bf16 v[68:71], v[184:187], v[176:179], v[68:71]
    ds_read_b128 v[100:103], v6 offset:60416
    v_mfma_f32_16x16x32_bf16 v[72:75], v[188:191], v[176:179], v[72:75]
    ds_read_b128 v[104:107], v6 offset:61440
    v_mfma_f32_16x16x32_bf16 v[76:79], v[192:195], v[176:179], v[76:79]
    ds_read_b128 v[108:111], v6 offset:62464
    v_mfma_f32_16x16x32_bf16 v[80:83], v[196:199], v[176:179], v[80:83]
    ds_read_b128 v[112:115], v6 offset:63488
    ds_read_b128 v[116:119], v6 offset:64512
    s_waitcnt lgkmcnt(6)
    v_mfma_f32_16x16x32_bf16 v[64:67], v[28:31], v[24:27], v[64:67]
    s_barrier
    ds_read_b128 v[176:179], v3 offset:0
    v_mfma_f32_16x16x32_bf16 v[68:71], v[32:35], v[24:27], v[68:71]
    ds_read_b128 v[180:183], v4 offset:0
    v_mfma_f32_16x16x32_bf16 v[72:75], v[36:39], v[24:27], v[72:75]
    ds_read_b128 v[184:187], v4 offset:1024
    v_mfma_f32_16x16x32_bf16 v[76:79], v[40:43], v[24:27], v[76:79]
    ds_read_b128 v[188:191], v4 offset:2048
    v_mfma_f32_16x16x32_bf16 v[80:83], v[44:47], v[24:27], v[80:83]
    ds_read_b128 v[192:195], v4 offset:3072
    ds_read_b128 v[196:199], v4 offset:4096
    s_waitcnt lgkmcnt(6)
    v_mfma_f32_16x16x32_bf16 v[64:67], v[100:103], v[96:99], v[64:67]
    ds_read_b128 v[24:27], v3 offset:4096
    v_mfma_f32_16x16x32_bf16 v[68:71], v[104:107], v[96:99], v[68:71]
    ds_read_b128 v[28:31], v4 offset:5120
    v_mfma_f32_16x16x32_bf16 v[72:75], v[108:111], v[96:99], v[72:75]
    ds_read_b128 v[32:35], v4 offset:6144
    v_mfma_f32_16x16x32_bf16 v[76:79], v[112:115], v[96:99], v[76:79]
    ds_read_b128 v[36:39], v4 offset:7168
    v_mfma_f32_16x16x32_bf16 v[80:83], v[116:119], v[96:99], v[80:83]
    ds_read_b128 v[40:43], v4 offset:8192
    ds_read_b128 v[44:47], v4 offset:9216
    s_waitcnt lgkmcnt(6)
    v_mfma_f32_16x16x32_bf16 v[64:67], v[180:183], v[176:179], v[64:67]
    s_barrier
    ds_read_b128 v[96:99], v3 offset:18432
    v_mfma_f32_16x16x32_bf16 v[68:71], v[184:187], v[176:179], v[68:71]
    ds_read_b128 v[100:103], v4 offset:18432
    v_mfma_f32_16x16x32_bf16 v[72:75], v[188:191], v[176:179], v[72:75]
    ds_read_b128 v[104:107], v4 offset:19456
    v_mfma_f32_16x16x32_bf16 v[76:79], v[192:195], v[176:179], v[76:79]
    ds_read_b128 v[108:111], v4 offset:20480
    v_mfma_f32_16x16x32_bf16 v[80:83], v[196:199], v[176:179], v[80:83]
    ds_read_b128 v[112:115], v4 offset:21504
    ds_read_b128 v[116:119], v4 offset:22528
    s_waitcnt lgkmcnt(6)
    v_mfma_f32_16x16x32_bf16 v[64:67], v[28:31], v[24:27], v[64:67]
    ds_read_b128 v[176:179], v3 offset:22528
    v_mfma_f32_16x16x32_bf16 v[68:71], v[32:35], v[24:27], v[68:71]
    ds_read_b128 v[180:183], v4 offset:23552
    v_mfma_f32_16x16x32_bf16 v[72:75], v[36:39], v[24:27], v[72:75]
    ds_read_b128 v[184:187], v4 offset:24576
    v_mfma_f32_16x16x32_bf16 v[76:79], v[40:43], v[24:27], v[76:79]
    ds_read_b128 v[188:191], v4 offset:25600
    v_mfma_f32_16x16x32_bf16 v[80:83], v[44:47], v[24:27], v[80:83]
    ds_read_b128 v[192:195], v4 offset:26624
    ds_read_b128 v[196:199], v4 offset:27648
    s_waitcnt lgkmcnt(6)
    v_mfma_f32_16x16x32_bf16 v[64:67], v[100:103], v[96:99], v[64:67]
    s_barrier
    ds_read_b128 v[24:27], v3 offset:36864
    v_mfma_f32_16x16x32_bf16 v[68:71], v[104:107], v[96:99], v[68:71]
    ds_read_b128 v[28:31], v4 offset:36864
    v_mfma_f32_16x16x32_bf16 v[72:75], v[108:111], v[96:99], v[72:75]
    ds_read_b128 v[32:35], v4 offset:37888
    v_mfma_f32_16x16x32_bf16 v[76:79], v[112:115], v[96:99], v[76:79]
    ds_read_b128 v[36:39], v4 offset:38912
    v_mfma_f32_16x16x32_bf16 v[80:83], v[116:119], v[96:99], v[80:83]
    ds_read_b128 v[40:43], v4 offset:39936
    ds_read_b128 v[44:47], v4 offset:40960
    s_waitcnt lgkmcnt(6)
    v_mfma_f32_16x16x32_bf16 v[64:67], v[180:183], v[176:179], v[64:67]
    ds_read_b128 v[96:99], v3 offset:40960
    v_mfma_f32_16x16x32_bf16 v[68:71], v[184:187], v[176:179], v[68:71]
    ds_read_b128 v[100:103], v4 offset:41984
    v_mfma_f32_16x16x32_bf16 v[72:75], v[188:191], v[176:179], v[72:75]
    ds_read_b128 v[104:107], v4 offset:43008
    v_mfma_f32_16x16x32_bf16 v[76:79], v[192:195], v[176:179], v[76:79]
    ds_read_b128 v[108:111], v4 offset:44032
    v_mfma_f32_16x16x32_bf16 v[80:83], v[196:199], v[176:179], v[80:83]
    ds_read_b128 v[112:115], v4 offset:45056
    ds_read_b128 v[116:119], v4 offset:46080
    s_waitcnt lgkmcnt(6)
    v_mfma_f32_16x16x32_bf16 v[64:67], v[28:31], v[24:27], v[64:67]
    s_barrier
    ds_read_b128 v[176:179], v3 offset:55296
    v_mfma_f32_16x16x32_bf16 v[68:71], v[32:35], v[24:27], v[68:71]
    ds_read_b128 v[180:183], v4 offset:55296
    v_mfma_f32_16x16x32_bf16 v[72:75], v[36:39], v[24:27], v[72:75]
    ds_read_b128 v[184:187], v4 offset:56320
    v_mfma_f32_16x16x32_bf16 v[76:79], v[40:43], v[24:27], v[76:79]
    ds_read_b128 v[188:191], v4 offset:57344
    v_mfma_f32_16x16x32_bf16 v[80:83], v[44:47], v[24:27], v[80:83]
    ds_read_b128 v[192:195], v4 offset:58368
    ds_read_b128 v[196:199], v4 offset:59392
    s_waitcnt lgkmcnt(6)
    v_mfma_f32_16x16x32_bf16 v[64:67], v[100:103], v[96:99], v[64:67]
    ds_read_b128 v[24:27], v3 offset:59392
    v_mfma_f32_16x16x32_bf16 v[68:71], v[104:107], v[96:99], v[68:71]
    ds_read_b128 v[28:31], v4 offset:60416
    v_mfma_f32_16x16x32_bf16 v[72:75], v[108:111], v[96:99], v[72:75]
    ds_read_b128 v[32:35], v4 offset:61440
    v_mfma_f32_16x16x32_bf16 v[76:79], v[112:115], v[96:99], v[76:79]
    ds_read_b128 v[36:39], v4 offset:62464
    v_mfma_f32_16x16x32_bf16 v[80:83], v[116:119], v[96:99], v[80:83]
    ds_read_b128 v[40:43], v4 offset:63488
    ds_read_b128 v[44:47], v4 offset:64512
    s_waitcnt lgkmcnt(6)
    v_mfma_f32_16x16x32_bf16 v[64:67], v[180:183], v[176:179], v[64:67]
    s_barrier
    ds_read_b128 v[96:99], v5 offset:0
    v_mfma_f32_16x16x32_bf16 v[68:71], v[184:187], v[176:179], v[68:71]
    ds_read_b128 v[100:103], v6 offset:0
    v_mfma_f32_16x16x32_bf16 v[72:75], v[188:191], v[176:179], v[72:75]
    ds_read_b128 v[104:107], v6 offset:1024
    v_mfma_f32_16x16x32_bf16 v[76:79], v[192:195], v[176:179], v[76:79]
    ds_read_b128 v[108:111], v6 offset:2048
    v_mfma_f32_16x16x32_bf16 v[80:83], v[196:199], v[176:179], v[80:83]
    ds_read_b128 v[112:115], v6 offset:3072
    ds_read_b128 v[116:119], v6 offset:4096
    s_waitcnt lgkmcnt(6)
    v_mfma_f32_16x16x32_bf16 v[64:67], v[28:31], v[24:27], v[64:67]
    ds_read_b128 v[176:179], v5 offset:4096
    v_mfma_f32_16x16x32_bf16 v[68:71], v[32:35], v[24:27], v[68:71]
    ds_read_b128 v[180:183], v6 offset:5120
    v_mfma_f32_16x16x32_bf16 v[72:75], v[36:39], v[24:27], v[72:75]
    ds_read_b128 v[184:187], v6 offset:6144
    v_mfma_f32_16x16x32_bf16 v[76:79], v[40:43], v[24:27], v[76:79]
    ds_read_b128 v[188:191], v6 offset:7168
    v_mfma_f32_16x16x32_bf16 v[80:83], v[44:47], v[24:27], v[80:83]
    ds_read_b128 v[192:195], v6 offset:8192
    ds_read_b128 v[196:199], v6 offset:9216
    s_waitcnt lgkmcnt(6)
    v_mfma_f32_16x16x32_bf16 v[64:67], v[100:103], v[96:99], v[64:67]
    s_barrier
    ds_read_b128 v[24:27], v5 offset:18432
    v_mfma_f32_16x16x32_bf16 v[68:71], v[104:107], v[96:99], v[68:71]
    ds_read_b128 v[28:31], v6 offset:18432
    v_mfma_f32_16x16x32_bf16 v[72:75], v[108:111], v[96:99], v[72:75]
    ds_read_b128 v[32:35], v6 offset:19456
    v_mfma_f32_16x16x32_bf16 v[76:79], v[112:115], v[96:99], v[76:79]
    ds_read_b128 v[36:39], v6 offset:20480
    v_mfma_f32_16x16x32_bf16 v[80:83], v[116:119], v[96:99], v[80:83]
    ds_read_b128 v[40:43], v6 offset:21504
    ds_read_b128 v[44:47], v6 offset:22528
    s_waitcnt lgkmcnt(6)
    v_mfma_f32_16x16x32_bf16 v[64:67], v[180:183], v[176:179], v[64:67]
    ds_read_b128 v[96:99], v5 offset:22528
    v_mfma_f32_16x16x32_bf16 v[68:71], v[184:187], v[176:179], v[68:71]
    ds_read_b128 v[100:103], v6 offset:23552
    v_mfma_f32_16x16x32_bf16 v[72:75], v[188:191], v[176:179], v[72:75]
    ds_read_b128 v[104:107], v6 offset:24576
    v_mfma_f32_16x16x32_bf16 v[76:79], v[192:195], v[176:179], v[76:79]
    ds_read_b128 v[108:111], v6 offset:25600
    v_mfma_f32_16x16x32_bf16 v[80:83], v[196:199], v[176:179], v[80:83]
    ds_read_b128 v[112:115], v6 offset:26624
    ds_read_b128 v[116:119], v6 offset:27648
    s_waitcnt lgkmcnt(6)
    v_mfma_f32_16x16x32_bf16 v[64:67], v[28:31], v[24:27], v[64:67]
    s_barrier
    ds_read_b128 v[176:179], v5 offset:36864
    v_mfma_f32_16x16x32_bf16 v[68:71], v[32:35], v[24:27], v[68:71]
    ds_read_b128 v[180:183], v6 offset:36864
    v_mfma_f32_16x16x32_bf16 v[72:75], v[36:39], v[24:27], v[72:75]
    ds_read_b128 v[184:187], v6 offset:37888
    v_mfma_f32_16x16x32_bf16 v[76:79], v[40:43], v[24:27], v[76:79]
    ds_read_b128 v[188:191], v6 offset:38912
    v_mfma_f32_16x16x32_bf16 v[80:83], v[44:47], v[24:27], v[80:83]
    ds_read_b128 v[192:195], v6 offset:39936
    ds_read_b128 v[196:199], v6 offset:40960
    s_waitcnt lgkmcnt(6)
    v_mfma_f32_16x16x32_bf16 v[64:67], v[100:103], v[96:99], v[64:67]
    ds_read_b128 v[24:27], v5 offset:40960
    v_mfma_f32_16x16x32_bf16 v[68:71], v[104:107], v[96:99], v[68:71]
    ds_read_b128 v[28:31], v6 offset:41984
    v_mfma_f32_16x16x32_bf16 v[72:75], v[108:111], v[96:99], v[72:75]
    ds_read_b128 v[32:35], v6 offset:43008
    v_mfma_f32_16x16x32_bf16 v[76:79], v[112:115], v[96:99], v[76:79]
    ds_read_b128 v[36:39], v6 offset:44032
    v_mfma_f32_16x16x32_bf16 v[80:83], v[116:119], v[96:99], v[80:83]
    ds_read_b128 v[40:43], v6 offset:45056
    ds_read_b128 v[44:47], v6 offset:46080
    s_waitcnt lgkmcnt(6)
    v_mfma_f32_16x16x32_bf16 v[64:67], v[180:183], v[176:179], v[64:67]
    s_barrier
    ds_read_b128 v[96:99], v5 offset:55296
    v_mfma_f32_16x16x32_bf16 v[68:71], v[184:187], v[176:179], v[68:71]
    ds_read_b128 v[100:103], v6 offset:55296
    v_mfma_f32_16x16x32_bf16 v[72:75], v[188:191], v[176:179], v[72:75]
    ds_read_b128 v[104:107], v6 offset:56320
    v_mfma_f32_16x16x32_bf16 v[76:79], v[192:195], v[176:179], v[76:79]
    ds_read_b128 v[108:111], v6 offset:57344
    v_mfma_f32_16x16x32_bf16 v[80:83], v[196:199], v[176:179], v[80:83]
    ds_read_b128 v[112:115], v6 offset:58368
    ds_read_b128 v[116:119], v6 offset:59392
    s_waitcnt lgkmcnt(6)
    v_mfma_f32_16x16x32_bf16 v[64:67], v[28:31], v[24:27], v[64:67]
    ds_read_b128 v[176:179], v5 offset:59392
    v_mfma_f32_16x16x32_bf16 v[68:71], v[32:35], v[24:27], v[68:71]
    ds_read_b128 v[180:183], v6 offset:60416
    v_mfma_f32_16x16x32_bf16 v[72:75], v[36:39], v[24:27], v[72:75]
    ds_read_b128 v[184:187], v6 offset:61440
    v_mfma_f32_16x16x32_bf16 v[76:79], v[40:43], v[24:27], v[76:79]
    ds_read_b128 v[188:191], v6 offset:62464
    v_mfma_f32_16x16x32_bf16 v[80:83], v[44:47], v[24:27], v[80:83]
    ds_read_b128 v[192:195], v6 offset:63488
    ds_read_b128 v[196:199], v6 offset:64512
    s_waitcnt lgkmcnt(6)
    v_mfma_f32_16x16x32_bf16 v[64:67], v[100:103], v[96:99], v[64:67]
    v_mfma_f32_16x16x32_bf16 v[68:71], v[104:107], v[96:99], v[68:71]
    v_mfma_f32_16x16x32_bf16 v[72:75], v[108:111], v[96:99], v[72:75]
    v_mfma_f32_16x16x32_bf16 v[76:79], v[112:115], v[96:99], v[76:79]
    v_mfma_f32_16x16x32_bf16 v[80:83], v[116:119], v[96:99], v[80:83]
    s_waitcnt lgkmcnt(0)
    v_mfma_f32_16x16x32_bf16 v[64:67], v[180:183], v[176:179], v[64:67]
    v_mfma_f32_16x16x32_bf16 v[68:71], v[184:187], v[176:179], v[68:71]
    v_mfma_f32_16x16x32_bf16 v[72:75], v[188:191], v[176:179], v[72:75]
    v_mfma_f32_16x16x32_bf16 v[76:79], v[192:195], v[176:179], v[76:79]
    v_mfma_f32_16x16x32_bf16 v[80:83], v[196:199], v[176:179], v[80:83]
    s_waitcnt vmcnt(0)
    s_lshl_b32 s33, s20, 6
    s_lshl_b32 s34, s4, 4
    s_add_u32 s33, s33, s34
    v_add_u32 v9, s33, v7
    v_mul_u32_u24 v10, 1280, v9
    v_lshl_add_u32 v12, v8, 3, v10
    v_and_b32 v13, 1, v8
    v_lshl_add_u32 v10, v13, 5, v10
    v_lshrrev_b32 v13, 1, v8
    v_lshl_add_u32 v10, v13, 4, v10
    s_mul_i32 s34, s21, 160
    v_lshlrev_b32 v14, 16, v240
    v_and_b32 v15, 0xffff0000, v240
    v_lshlrev_b32 v16, 16, v241
    v_and_b32 v17, 0xffff0000, v241
    v_fma_f32 v64, v64, v130, v14
    v_fma_f32 v65, v65, v131, v15
    v_fma_f32 v66, v66, v132, v16
    v_fma_f32 v67, v67, v133, v17
    v_cvt_pk_bf16_f32 v100, v64, v65
    v_cvt_pk_bf16_f32 v101, v66, v67
    v_lshlrev_b32 v14, 16, v242
    v_and_b32 v15, 0xffff0000, v242
    v_lshlrev_b32 v16, 16, v243
    v_and_b32 v17, 0xffff0000, v243
    v_fma_f32 v68, v68, v134, v14
    v_fma_f32 v69, v69, v135, v15
    v_fma_f32 v70, v70, v136, v16
    v_fma_f32 v71, v71, v137, v17
    v_cvt_pk_bf16_f32 v102, v68, v69
    v_cvt_pk_bf16_f32 v103, v70, v71
    v_lshlrev_b32 v14, 16, v244
    v_and_b32 v15, 0xffff0000, v244
    v_lshlrev_b32 v16, 16, v245
    v_and_b32 v17, 0xffff0000, v245
    v_fma_f32 v72, v72, v138, v14
    v_fma_f32 v73, v73, v139, v15
    v_fma_f32 v74, v74, v140, v16
    v_fma_f32 v75, v75, v141, v17
    v_cvt_pk_bf16_f32 v104, v72, v73
    v_cvt_pk_bf16_f32 v105, v74, v75
    v_lshlrev_b32 v14, 16, v246
    v_and_b32 v15, 0xffff0000, v246
    v_lshlrev_b32 v16, 16, v247
    v_and_b32 v17, 0xffff0000, v247
    v_fma_f32 v76, v76, v142, v14
    v_fma_f32 v77, v77, v143, v15
    v_fma_f32 v78, v78, v144, v16
    v_fma_f32 v79, v79, v145, v17
    v_cvt_pk_bf16_f32 v106, v76, v77
    v_cvt_pk_bf16_f32 v107, v78, v79
    v_lshlrev_b32 v14, 16, v248
    v_and_b32 v15, 0xffff0000, v248
    v_lshlrev_b32 v16, 16, v249
    v_and_b32 v17, 0xffff0000, v249
    v_fma_f32 v80, v80, v146, v14
    v_fma_f32 v81, v81, v147, v15
    v_fma_f32 v82, v82, v148, v16
    v_fma_f32 v83, v83, v149, v17
    v_cvt_pk_bf16_f32 v108, v80, v81
    v_cvt_pk_bf16_f32 v109, v82, v83
    v_permlane16_swap_b32 v100, v102
    v_permlane16_swap_b32 v101, v103
    buffer_store_dwordx4 v[100:103], v10, s[16:19], s34 offen offset:0
    v_permlane16_swap_b32 v104, v106
    v_permlane16_swap_b32 v105, v107
    buffer_store_dwordx4 v[104:107], v10, s[16:19], s34 offen offset:64
    buffer_store_dwordx2 v[108:109], v12, s[16:19], s34 offen offset:128
    s_branch L_p6_end
L_p6_prod:
    v_lshlrev_b32 v2, 4, v0
    s_cmp_ge_u32 s4, 6
    s_cbranch_scc1 L_p6_w
    s_cmp_eq_u32 s4, 5
    s_cbranch_scc1 L_p6_idle
    s_mul_i32 s32, s20, 196608
    s_add_u32 s32, s32, 25427968
    s_lshr_b32 s39, s2, 3
    s_mul_i32 s38, s27, 64
    s_add_u32 s38, s38, 3256
    s_and_b32 s3, s39, 3
    s_lshl_b32 s3, s3, 4
    s_add_u32 s38, s38, s3
    s_mov_b32 s39, s39
    v_mov_b32 v250, 147456
    s_mov_b32 s3, 0
L_dr_6:
    ds_read_b32 v252, v250
    s_waitcnt lgkmcnt(0)
    v_readfirstlane_b32 s47, v252
    s_nop 0
    s_cmp_ge_u32 s47, 4
    s_cbranch_scc1 L_drd_6
    s_add_u32 s3, s3, 1
    s_cmp_lt_u32 s3, 0x400000
    s_cbranch_scc1 L_dr_6
L_drd_6:
    s_lshl_b32 s3, s38, 7
    s_add_u32 s3, s3, 31719424
    v_lshlrev_b32 v250, 7, v0
    v_add_u32 v250, s3, v250
    v_mov_b32 v251, 1
    s_mov_b32 exec_lo, 65535
    s_mov_b32 exec_hi, 0
    global_atomic_add v250, v251, s[6:7] sc1
    s_mov_b64 exec, -1
    s_lshr_b32 s38, s20, 1
    s_mul_i32 s38, s38, 64
    s_add_u32 s38, s38, 3256
    s_and_b32 s47, s2, 15
    s_add_u32 s3, s38, 0
    s_add_u32 s3, s3, s47
    v_mov_b32 v250, s3
    v_mov_b32 v251, 4
    s_add_u32 s3, s38, 16
    s_add_u32 s3, s3, s47
    v_writelane_b32 v250, s3, 1
    s_add_u32 s3, s38, 32
    s_add_u32 s3, s3, s47
    v_writelane_b32 v250, s3, 2
    s_add_u32 s3, s38, 48
    s_add_u32 s3, s3, s47
    v_writelane_b32 v250, s3, 3
    v_lshlrev_b32 v250, 7, v250
    v_add_u32 v250, 31719424, v250
    s_mov_b32 s3, 0
L_poll_p6:
    global_load_dword v252, v250, s[6:7] sc1
    s_waitcnt vmcnt(0)
    v_cmp_ge_u32 vcc, v252, v251
    s_nop 0
    s_cmp_eq_u64 vcc, -1
    s_cbranch_scc1 L_polled_p6
    s_add_u32 s3, s3, 1
    s_cmp_lt_u32 s3, 0x200000
    s_cbranch_scc1 L_poll_p6
L_polled_p6:
    s_mov_b32 m0, 0
    s_add_u32 s38, s32, 0
    buffer_load_dwordx4 v2, s[12:15], s38 offen offset:0 lds
    buffer_load_dwordx4 v2, s[12:15], s38 offen offset:1024 lds
    buffer_load_dwordx4 v2, s[12:15], s38 offen offset:2048 lds
    buffer_load_dwordx4 v2, s[12:15], s38 offen offset:3072 lds
    s_add_u32 m0, m0, 4096
    s_add_u32 s38, s38, 4096
    buffer_load_dwordx4 v2, s[12:15], s38 offen offset:0 lds
    buffer_load_dwordx4 v2, s[12:15], s38 offen offset:1024 lds
    buffer_load_dwordx4 v2, s[12:15], s38 offen offset:2048 lds
    buffer_load_dwordx4 v2, s[12:15], s38 offen offset:3072 lds
    s_mov_b32 m0, 18432
    s_add_u32 s38, s32, 8192
    buffer_load_dwordx4 v2, s[12:15], s38 offen offset:0 lds
    buffer_load_dwordx4 v2, s[12:15], s38 offen offset:1024 lds
    buffer_load_dwordx4 v2, s[12:15], s38 offen offset:2048 lds
    buffer_load_dwordx4 v2, s[12:15], s38 offen offset:3072 lds
    s_add_u32 m0, m0, 4096
    s_add_u32 s38, s38, 4096
    buffer_load_dwordx4 v2, s[12:15], s38 offen offset:0 lds
    buffer_load_dwordx4 v2, s[12:15], s38 offen offset:1024 lds
    buffer_load_dwordx4 v2, s[12:15], s38 offen offset:2048 lds
    buffer_load_dwordx4 v2, s[12:15], s38 offen offset:3072 lds
    s_mov_b32 m0, 36864
    s_add_u32 s38, s32, 16384
    buffer_load_dwordx4 v2, s[12:15], s38 offen offset:0 lds
    buffer_load_dwordx4 v2, s[12:15], s38 offen offset:1024 lds
    buffer_load_dwordx4 v2, s[12:15], s38 offen offset:2048 lds
    buffer_load_dwordx4 v2, s[12:15], s38 offen offset:3072 lds
    s_add_u32 m0, m0, 4096
    s_add_u32 s38, s38, 4096
    buffer_load_dwordx4 v2, s[12:15], s38 offen offset:0 lds
    buffer_load_dwordx4 v2, s[12:15], s38 offen offset:1024 lds
    buffer_load_dwordx4 v2, s[12:15], s38 offen offset:2048 lds
    buffer_load_dwordx4 v2, s[12:15], s38 offen offset:3072 lds
    s_mov_b32 m0, 55296
    s_add_u32 s38, s32, 24576
    buffer_load_dwordx4 v2, s[12:15], s38 offen offset:0 lds
    buffer_load_dwordx4 v2, s[12:15], s38 offen offset:1024 lds
    buffer_load_dwordx4 v2, s[12:15], s38 offen offset:2048 lds
    buffer_load_dwordx4 v2, s[12:15], s38 offen offset:3072 lds
    s_add_u32 m0, m0, 4096
    s_add_u32 s38, s38, 4096
    buffer_load_dwordx4 v2, s[12:15], s38 offen offset:0 lds
    buffer_load_dwordx4 v2, s[12:15], s38 offen offset:1024 lds
    buffer_load_dwordx4 v2, s[12:15], s38 offen offset:2048 lds
    buffer_load_dwordx4 v2, s[12:15], s38 offen offset:3072 lds
    s_waitcnt vmcnt(24)
    s_barrier
    s_mov_b32 m0, 73728
    s_add_u32 s38, s32, 32768
    buffer_load_dwordx4 v2, s[12:15], s38 offen offset:0 lds
    buffer_load_dwordx4 v2, s[12:15], s38 offen offset:1024 lds
    buffer_load_dwordx4 v2, s[12:15], s38 offen offset:2048 lds
    buffer_load_dwordx4 v2, s[12:15], s38 offen offset:3072 lds
    s_add_u32 m0, m0, 4096
    s_add_u32 s38, s38, 4096
    buffer_load_dwordx4 v2, s[12:15], s38 offen offset:0 lds
    buffer_load_dwordx4 v2, s[12:15], s38 offen offset:1024 lds
    buffer_load_dwordx4 v2, s[12:15], s38 offen offset:2048 lds
    buffer_load_dwordx4 v2, s[12:15], s38 offen offset:3072 lds
    s_waitcnt vmcnt(24)
    s_barrier
    s_mov_b32 m0, 92160
    s_add_u32 s38, s32, 40960
    buffer_load_dwordx4 v2, s[12:15], s38 offen offset:0 lds
    buffer_load_dwordx4 v2, s[12:15], s38 offen offset:1024 lds
    buffer_load_dwordx4 v2, s[12:15], s38 offen offset:2048 lds
    buffer_load_dwordx4 v2, s[12:15], s38 offen offset:3072 lds
    s_add_u32 m0, m0, 4096
    s_add_u32 s38, s38, 4096
    buffer_load_dwordx4 v2, s[12:15], s38 offen offset:0 lds
    buffer_load_dwordx4 v2, s[12:15], s38 offen offset:1024 lds
    buffer_load_dwordx4 v2, s[12:15], s38 offen offset:2048 lds
    buffer_load_dwordx4 v2, s[12:15], s38 offen offset:3072 lds
    s_waitcnt vmcnt(24)
    s_barrier
    s_mov_b32 m0, 110592
    s_add_u32 s38, s32, 49152
    buffer_load_dwordx4 v2, s[12:15], s38 offen offset:0 lds
    buffer_load_dwordx4 v2, s[12:15], s38 offen offset:1024 lds
    buffer_load_dwordx4 v2, s[12:15], s38 offen offset:2048 lds
    buffer_load_dwordx4 v2, s[12:15], s38 offen offset:3072 lds
    s_add_u32 m0, m0, 4096
    s_add_u32 s38, s38, 4096
    buffer_load_dwordx4 v2, s[12:15], s38 offen offset:0 lds
    buffer_load_dwordx4 v2, s[12:15], s38 offen offset:1024 lds
    buffer_load_dwordx4 v2, s[12:15], s38 offen offset:2048 lds
    buffer_load_dwordx4 v2, s[12:15], s38 offen offset:3072 lds
    s_waitcnt vmcnt(24)
    s_barrier
    s_mov_b32 m0, 129024
    s_add_u32 s38, s32, 57344
    buffer_load_dwordx4 v2, s[12:15], s38 offen offset:0 lds
    buffer_load_dwordx4 v2, s[12:15], s38 offen offset:1024 lds
    buffer_load_dwordx4 v2, s[12:15], s38 offen offset:2048 lds
    buffer_load_dwordx4 v2, s[12:15], s38 offen offset:3072 lds
    s_add_u32 m0, m0, 4096
    s_add_u32 s38, s38, 4096
    buffer_load_dwordx4 v2, s[12:15], s38 offen offset:0 lds
    buffer_load_dwordx4 v2, s[12:15], s38 offen offset:1024 lds
    buffer_load_dwordx4 v2, s[12:15], s38 offen offset:2048 lds
    buffer_load_dwordx4 v2, s[12:15], s38 offen offset:3072 lds
    s_waitcnt vmcnt(24)
    s_barrier
    s_mov_b32 m0, 0
    s_add_u32 s38, s32, 65536
    buffer_load_dwordx4 v2, s[12:15], s38 offen offset:0 lds
    buffer_load_dwordx4 v2, s[12:15], s38 offen offset:1024 lds
    buffer_load_dwordx4 v2, s[12:15], s38 offen offset:2048 lds
    buffer_load_dwordx4 v2, s[12:15], s38 offen offset:3072 lds
    s_add_u32 m0, m0, 4096
    s_add_u32 s38, s38, 4096
    buffer_load_dwordx4 v2, s[12:15], s38 offen offset:0 lds
    buffer_load_dwordx4 v2, s[12:15], s38 offen offset:1024 lds
    buffer_load_dwordx4 v2, s[12:15], s38 offen offset:2048 lds
    buffer_load_dwordx4 v2, s[12:15], s38 offen offset:3072 lds
    s_waitcnt vmcnt(24)
    s_barrier
    s_mov_b32 m0, 18432
    s_add_u32 s38, s32, 73728
    buffer_load_dwordx4 v2, s[12:15], s38 offen offset:0 lds
    buffer_load_dwordx4 v2, s[12:15], s38 offen offset:1024 lds
    buffer_load_dwordx4 v2, s[12:15], s38 offen offset:2048 lds
    buffer_load_dwordx4 v2, s[12:15], s38 offen offset:3072 lds
    s_add_u32 m0, m0, 4096
    s_add_u32 s38, s38, 4096
    buffer_load_dwordx4 v2, s[12:15], s38 offen offset:0 lds
    buffer_load_dwordx4 v2, s[12:15], s38 offen offset:1024 lds
    buffer_load_dwordx4 v2, s[12:15], s38 offen offset:2048 lds
    buffer_load_dwordx4 v2, s[12:15], s38 offen offset:3072 lds
    s_waitcnt vmcnt(24)
    s_barrier
    s_mov_b32 m0, 36864
    s_add_u32 s38, s32, 81920
    buffer_load_dwordx4 v2, s[12:15], s38 offen offset:0 lds
    buffer_load_dwordx4 v2, s[12:15], s38 offen offset:1024 lds
    buffer_load_dwordx4 v2, s[12:15], s38 offen offset:2048 lds
    buffer_load_dwordx4 v2, s[12:15], s38 offen offset:3072 lds
    s_add_u32 m0, m0, 4096
    s_add_u32 s38, s38, 4096
    buffer_load_dwordx4 v2, s[12:15], s38 offen offset:0 lds
    buffer_load_dwordx4 v2, s[12:15], s38 offen offset:1024 lds
    buffer_load_dwordx4 v2, s[12:15], s38 offen offset:2048 lds
    buffer_load_dwordx4 v2, s[12:15], s38 offen offset:3072 lds
    s_waitcnt vmcnt(24)
    s_barrier
    s_mov_b32 m0, 55296
    s_add_u32 s38, s32, 90112
    buffer_load_dwordx4 v2, s[12:15], s38 offen offset:0 lds
    buffer_load_dwordx4 v2, s[12:15], s38 offen offset:1024 lds
    buffer_load_dwordx4 v2, s[12:15], s38 offen offset:2048 lds
    buffer_load_dwordx4 v2, s[12:15], s38 offen offset:3072 lds
    s_add_u32 m0, m0, 4096
    s_add_u32 s38, s38, 4096
    buffer_load_dwordx4 v2, s[12:15], s38 offen offset:0 lds
    buffer_load_dwordx4 v2, s[12:15], s38 offen offset:1024 lds
    buffer_load_dwordx4 v2, s[12:15], s38 offen offset:2048 lds
    buffer_load_dwordx4 v2, s[12:15], s38 offen offset:3072 lds
    s_waitcnt vmcnt(24)
    s_barrier
    s_mov_b32 m0, 73728
    s_add_u32 s38, s32, 98304
    buffer_load_dwordx4 v2, s[12:15], s38 offen offset:0 lds
    buffer_load_dwordx4 v2, s[12:15], s38 offen offset:1024 lds
    buffer_load_dwordx4 v2, s[12:15], s38 offen offset:2048 lds
    buffer_load_dwordx4 v2, s[12:15], s38 offen offset:3072 lds
    s_add_u32 m0, m0, 4096
    s_add_u32 s38, s38, 4096
    buffer_load_dwordx4 v2, s[12:15], s38 offen offset:0 lds
    buffer_load_dwordx4 v2, s[12:15], s38 offen offset:1024 lds
    buffer_load_dwordx4 v2, s[12:15], s38 offen offset:2048 lds
    buffer_load_dwordx4 v2, s[12:15], s38 offen offset:3072 lds
    s_waitcnt vmcnt(24)
    s_barrier
    s_mov_b32 m0, 92160
    s_add_u32 s38, s32, 106496
    buffer_load_dwordx4 v2, s[12:15], s38 offen offset:0 lds
    buffer_load_dwordx4 v2, s[12:15], s38 offen offset:1024 lds
    buffer_load_dwordx4 v2, s[12:15], s38 offen offset:2048 lds
    buffer_load_dwordx4 v2, s[12:15], s38 offen offset:3072 lds
    s_add_u32 m0, m0, 4096
    s_add_u32 s38, s38, 4096
    buffer_load_dwordx4 v2, s[12:15], s38 offen offset:0 lds
    buffer_load_dwordx4 v2, s[12:15], s38 offen offset:1024 lds
    buffer_load_dwordx4 v2, s[12:15], s38 offen offset:2048 lds
    buffer_load_dwordx4 v2, s[12:15], s38 offen offset:3072 lds
    s_waitcnt vmcnt(24)
    s_barrier
    s_mov_b32 m0, 110592
    s_add_u32 s38, s32, 114688
    buffer_load_dwordx4 v2, s[12:15], s38 offen offset:0 lds
    buffer_load_dwordx4 v2, s[12:15], s38 offen offset:1024 lds
    buffer_load_dwordx4 v2, s[12:15], s38 offen offset:2048 lds
    buffer_load_dwordx4 v2, s[12:15], s38 offen offset:3072 lds
    s_add_u32 m0, m0, 4096
    s_add_u32 s38, s38, 4096
    buffer_load_dwordx4 v2, s[12:15], s38 offen offset:0 lds
    buffer_load_dwordx4 v2, s[12:15], s38 offen offset:1024 lds
    buffer_load_dwordx4 v2, s[12:15], s38 offen offset:2048 lds
    buffer_load_dwordx4 v2, s[12:15], s38 offen offset:3072 lds
    s_waitcnt vmcnt(24)
    s_barrier
    s_mov_b32 m0, 129024
    s_add_u32 s38, s32, 122880
    buffer_load_dwordx4 v2, s[12:15], s38 offen offset:0 lds
    buffer_load_dwordx4 v2, s[12:15], s38 offen offset:1024 lds
    buffer_load_dwordx4 v2, s[12:15], s38 offen offset:2048 lds
    buffer_load_dwordx4 v2, s[12:15], s38 offen offset:3072 lds
    s_add_u32 m0, m0, 4096
    s_add_u32 s38, s38, 4096
    buffer_load_dwordx4 v2, s[12:15], s38 offen offset:0 lds
    buffer_load_dwordx4 v2, s[12:15], s38 offen offset:1024 lds
    buffer_load_dwordx4 v2, s[12:15], s38 offen offset:2048 lds
    buffer_load_dwordx4 v2, s[12:15], s38 offen offset:3072 lds
    s_waitcnt vmcnt(24)
    s_barrier
    s_mov_b32 m0, 0
    s_add_u32 s38, s32, 131072
    buffer_load_dwordx4 v2, s[12:15], s38 offen offset:0 lds
    buffer_load_dwordx4 v2, s[12:15], s38 offen offset:1024 lds
    buffer_load_dwordx4 v2, s[12:15], s38 offen offset:2048 lds
    buffer_load_dwordx4 v2, s[12:15], s38 offen offset:3072 lds
    s_add_u32 m0, m0, 4096
    s_add_u32 s38, s38, 4096
    buffer_load_dwordx4 v2, s[12:15], s38 offen offset:0 lds
    buffer_load_dwordx4 v2, s[12:15], s38 offen offset:1024 lds
    buffer_load_dwordx4 v2, s[12:15], s38 offen offset:2048 lds
    buffer_load_dwordx4 v2, s[12:15], s38 offen offset:3072 lds
    s_waitcnt vmcnt(24)
    s_barrier
    s_mov_b32 m0, 18432
    s_add_u32 s38, s32, 139264
    buffer_load_dwordx4 v2, s[12:15], s38 offen offset:0 lds
    buffer_load_dwordx4 v2, s[12:15], s38 offen offset:1024 lds
    buffer_load_dwordx4 v2, s[12:15], s38 offen offset:2048 lds
    buffer_load_dwordx4 v2, s[12:15], s38 offen offset:3072 lds
    s_add_u32 m0, m0, 4096
    s_add_u32 s38, s38, 4096
    buffer_load_dwordx4 v2, s[12:15], s38 offen offset:0 lds
    buffer_load_dwordx4 v2, s[12:15], s38 offen offset:1024 lds
    buffer_load_dwordx4 v2, s[12:15], s38 offen offset:2048 lds
    buffer_load_dwordx4 v2, s[12:15], s38 offen offset:3072 lds
    s_waitcnt vmcnt(24)
    s_barrier
    s_mov_b32 m0, 36864
    s_add_u32 s38, s32, 147456
    buffer_load_dwordx4 v2, s[12:15], s38 offen offset:0 lds
    buffer_load_dwordx4 v2, s[12:15], s38 offen offset:1024 lds
    buffer_load_dwordx4 v2, s[12:15], s38 offen offset:2048 lds
    buffer_load_dwordx4 v2, s[12:15], s38 offen offset:3072 lds
    s_add_u32 m0, m0, 4096
    s_add_u32 s38, s38, 4096
    buffer_load_dwordx4 v2, s[12:15], s38 offen offset:0 lds
    buffer_load_dwordx4 v2, s[12:15], s38 offen offset:1024 lds
    buffer_load_dwordx4 v2, s[12:15], s38 offen offset:2048 lds
    buffer_load_dwordx4 v2, s[12:15], s38 offen offset:3072 lds
    s_waitcnt vmcnt(24)
    s_barrier
    s_mov_b32 m0, 55296
    s_add_u32 s38, s32, 155648
    buffer_load_dwordx4 v2, s[12:15], s38 offen offset:0 lds
    buffer_load_dwordx4 v2, s[12:15], s38 offen offset:1024 lds
    buffer_load_dwordx4 v2, s[12:15], s38 offen offset:2048 lds
    buffer_load_dwordx4 v2, s[12:15], s38 offen offset:3072 lds
    s_add_u32 m0, m0, 4096
    s_add_u32 s38, s38, 4096
    buffer_load_dwordx4 v2, s[12:15], s38 offen offset:0 lds
    buffer_load_dwordx4 v2, s[12:15], s38 offen offset:1024 lds
    buffer_load_dwordx4 v2, s[12:15], s38 offen offset:2048 lds
    buffer_load_dwordx4 v2, s[12:15], s38 offen offset:3072 lds
    s_waitcnt vmcnt(24)
    s_barrier
    s_mov_b32 m0, 73728
    s_add_u32 s38, s32, 163840
    buffer_load_dwordx4 v2, s[12:15], s38 offen offset:0 lds
    buffer_load_dwordx4 v2, s[12:15], s38 offen offset:1024 lds
    buffer_load_dwordx4 v2, s[12:15], s38 offen offset:2048 lds
    buffer_load_dwordx4 v2, s[12:15], s38 offen offset:3072 lds
    s_add_u32 m0, m0, 4096
    s_add_u32 s38, s38, 4096
    buffer_load_dwordx4 v2, s[12:15], s38 offen offset:0 lds
    buffer_load_dwordx4 v2, s[12:15], s38 offen offset:1024 lds
    buffer_load_dwordx4 v2, s[12:15], s38 offen offset:2048 lds
    buffer_load_dwordx4 v2, s[12:15], s38 offen offset:3072 lds
    s_waitcnt vmcnt(24)
    s_barrier
    s_mov_b32 m0, 92160
    s_add_u32 s38, s32, 172032
    buffer_load_dwordx4 v2, s[12:15], s38 offen offset:0 lds
    buffer_load_dwordx4 v2, s[12:15], s38 offen offset:1024 lds
    buffer_load_dwordx4 v2, s[12:15], s38 offen offset:2048 lds
    buffer_load_dwordx4 v2, s[12:15], s38 offen offset:3072 lds
    s_add_u32 m0, m0, 4096
    s_add_u32 s38, s38, 4096
    buffer_load_dwordx4 v2, s[12:15], s38 offen offset:0 lds
    buffer_load_dwordx4 v2, s[12:15], s38 offen offset:1024 lds
    buffer_load_dwordx4 v2, s[12:15], s38 offen offset:2048 lds
    buffer_load_dwordx4 v2, s[12:15], s38 offen offset:3072 lds
    s_waitcnt vmcnt(24)
    s_barrier
    s_mov_b32 m0, 110592
    s_add_u32 s38, s32, 180224
    buffer_load_dwordx4 v2, s[12:15], s38 offen offset:0 lds
    buffer_load_dwordx4 v2, s[12:15], s38 offen offset:1024 lds
    buffer_load_dwordx4 v2, s[12:15], s38 offen offset:2048 lds
    buffer_load_dwordx4 v2, s[12:15], s38 offen offset:3072 lds
    s_add_u32 m0, m0, 4096
    s_add_u32 s38, s38, 4096
    buffer_load_dwordx4 v2, s[12:15], s38 offen offset:0 lds
    buffer_load_dwordx4 v2, s[12:15], s38 offen offset:1024 lds
    buffer_load_dwordx4 v2, s[12:15], s38 offen offset:2048 lds
    buffer_load_dwordx4 v2, s[12:15], s38 offen offset:3072 lds
    s_waitcnt vmcnt(24)
    s_barrier
    s_mov_b32 m0, 129024
    s_add_u32 s38, s32, 188416
    buffer_load_dwordx4 v2, s[12:15], s38 offen offset:0 lds
    buffer_load_dwordx4 v2, s[12:15], s38 offen offset:1024 lds
    buffer_load_dwordx4 v2, s[12:15], s38 offen offset:2048 lds
    buffer_load_dwordx4 v2, s[12:15], s38 offen offset:3072 lds
    s_add_u32 m0, m0, 4096
    s_add_u32 s38, s38, 4096
    buffer_load_dwordx4 v2, s[12:15], s38 offen offset:0 lds
    buffer_load_dwordx4 v2, s[12:15], s38 offen offset:1024 lds
    buffer_load_dwordx4 v2, s[12:15], s38 offen offset:2048 lds
    buffer_load_dwordx4 v2, s[12:15], s38 offen offset:3072 lds
    s_waitcnt vmcnt(24)
    s_barrier
    s_waitcnt vmcnt(16)
    s_barrier
    s_waitcnt vmcnt(8)
    s_barrier
    s_waitcnt vmcnt(0)
    s_barrier
    s_branch L_p6_end
L_p6_idle:
    s_barrier
    s_barrier
    s_barrier
    s_barrier
    s_barrier
    s_barrier
    s_barrier
    s_barrier
    s_barrier
    s_barrier
    s_barrier
    s_barrier
    s_barrier
    s_barrier
    s_barrier
    s_barrier
    s_barrier
    s_barrier
    s_barrier
    s_barrier
    s_barrier
    s_barrier
    s_barrier
    s_barrier
    s_branch L_p6_end
L_p6_w:
    s_sub_u32 s30, s4, 6
    s_mul_i32 s32, s21, 245760
    s_mul_i32 s33, s30, 5120
    s_add_u32 s32, s32, s33
    s_add_u32 s32, s32, 16752640
    s_add_u32 s33, s33, 8192
    s_waitcnt vmcnt(35)
    s_barrier
    s_waitcnt vmcnt(30)
    s_barrier
    s_waitcnt vmcnt(25)
    s_barrier
    s_add_u32 m0, s33, 0
    s_add_u32 s38, s32, 81920
    buffer_load_dwordx4 v2, s[12:15], s38 offen offset:0 lds
    buffer_load_dwordx4 v2, s[12:15], s38 offen offset:1024 lds
    buffer_load_dwordx4 v2, s[12:15], s38 offen offset:2048 lds
    buffer_load_dwordx4 v2, s[12:15], s38 offen offset:3072 lds
    s_add_u32 m0, m0, 4096
    s_add_u32 s38, s38, 4096
    buffer_load_dwordx4 v2, s[12:15], s38 offen lds
    s_waitcnt vmcnt(25)
    s_barrier
    s_add_u32 m0, s33, 18432
    s_add_u32 s38, s32, 92160
    buffer_load_dwordx4 v2, s[12:15], s38 offen offset:0 lds
    buffer_load_dwordx4 v2, s[12:15], s38 offen offset:1024 lds
    buffer_load_dwordx4 v2, s[12:15], s38 offen offset:2048 lds
    buffer_load_dwordx4 v2, s[12:15], s38 offen offset:3072 lds
    s_add_u32 m0, m0, 4096
    s_add_u32 s38, s38, 4096
    buffer_load_dwordx4 v2, s[12:15], s38 offen lds
    s_waitcnt vmcnt(25)
    s_barrier
    s_add_u32 m0, s33, 36864
    s_add_u32 s38, s32, 102400
    buffer_load_dwordx4 v2, s[12:15], s38 offen offset:0 lds
    buffer_load_dwordx4 v2, s[12:15], s38 offen offset:1024 lds
    buffer_load_dwordx4 v2, s[12:15], s38 offen offset:2048 lds
    buffer_load_dwordx4 v2, s[12:15], s38 offen offset:3072 lds
    s_add_u32 m0, m0, 4096
    s_add_u32 s38, s38, 4096
    buffer_load_dwordx4 v2, s[12:15], s38 offen lds
    s_waitcnt vmcnt(25)
    s_barrier
    s_add_u32 m0, s33, 55296
    s_add_u32 s38, s32, 112640
    buffer_load_dwordx4 v2, s[12:15], s38 offen offset:0 lds
    buffer_load_dwordx4 v2, s[12:15], s38 offen offset:1024 lds
    buffer_load_dwordx4 v2, s[12:15], s38 offen offset:2048 lds
    buffer_load_dwordx4 v2, s[12:15], s38 offen offset:3072 lds
    s_add_u32 m0, m0, 4096
    s_add_u32 s38, s38, 4096
    buffer_load_dwordx4 v2, s[12:15], s38 offen lds
    s_waitcnt vmcnt(25)
    s_barrier
    s_add_u32 m0, s33, 73728
    s_add_u32 s38, s32, 122880
    buffer_load_dwordx4 v2, s[12:15], s38 offen offset:0 lds
    buffer_load_dwordx4 v2, s[12:15], s38 offen offset:1024 lds
    buffer_load_dwordx4 v2, s[12:15], s38 offen offset:2048 lds
    buffer_load_dwordx4 v2, s[12:15], s38 offen offset:3072 lds
    s_add_u32 m0, m0, 4096
    s_add_u32 s38, s38, 4096
    buffer_load_dwordx4 v2, s[12:15], s38 offen lds
    s_waitcnt vmcnt(25)
    s_barrier
    s_add_u32 m0, s33, 92160
    s_add_u32 s38, s32, 133120
    buffer_load_dwordx4 v2, s[12:15], s38 offen offset:0 lds
    buffer_load_dwordx4 v2, s[12:15], s38 offen offset:1024 lds
    buffer_load_dwordx4 v2, s[12:15], s38 offen offset:2048 lds
    buffer_load_dwordx4 v2, s[12:15], s38 offen offset:3072 lds
    s_add_u32 m0, m0, 4096
    s_add_u32 s38, s38, 4096
    buffer_load_dwordx4 v2, s[12:15], s38 offen lds
    s_waitcnt vmcnt(25)
    s_barrier
    s_add_u32 m0, s33, 110592
    s_add_u32 s38, s32, 143360
    buffer_load_dwordx4 v2, s[12:15], s38 offen offset:0 lds
    buffer_load_dwordx4 v2, s[12:15], s38 offen offset:1024 lds
    buffer_load_dwordx4 v2, s[12:15], s38 offen offset:2048 lds
    buffer_load_dwordx4 v2, s[12:15], s38 offen offset:3072 lds
    s_add_u32 m0, m0, 4096
    s_add_u32 s38, s38, 4096
    buffer_load_dwordx4 v2, s[12:15], s38 offen lds
    s_waitcnt vmcnt(25)
    s_barrier
    s_add_u32 m0, s33, 129024
    s_add_u32 s38, s32, 153600
    buffer_load_dwordx4 v2, s[12:15], s38 offen offset:0 lds
    buffer_load_dwordx4 v2, s[12:15], s38 offen offset:1024 lds
    buffer_load_dwordx4 v2, s[12:15], s38 offen offset:2048 lds
    buffer_load_dwordx4 v2, s[12:15], s38 offen offset:3072 lds
    s_add_u32 m0, m0, 4096
    s_add_u32 s38, s38, 4096
    buffer_load_dwordx4 v2, s[12:15], s38 offen lds
    s_waitcnt vmcnt(25)
    s_barrier
    s_add_u32 m0, s33, 0
    s_add_u32 s38, s32, 163840
    buffer_load_dwordx4 v2, s[12:15], s38 offen offset:0 lds
    buffer_load_dwordx4 v2, s[12:15], s38 offen offset:1024 lds
    buffer_load_dwordx4 v2, s[12:15], s38 offen offset:2048 lds
    buffer_load_dwordx4 v2, s[12:15], s38 offen offset:3072 lds
    s_add_u32 m0, m0, 4096
    s_add_u32 s38, s38, 4096
    buffer_load_dwordx4 v2, s[12:15], s38 offen lds
    s_waitcnt vmcnt(25)
    s_barrier
    s_add_u32 m0, s33, 18432
    s_add_u32 s38, s32, 174080
    buffer_load_dwordx4 v2, s[12:15], s38 offen offset:0 lds
    buffer_load_dwordx4 v2, s[12:15], s38 offen offset:1024 lds
    buffer_load_dwordx4 v2, s[12:15], s38 offen offset:2048 lds
    buffer_load_dwordx4 v2, s[12:15], s38 offen offset:3072 lds
    s_add_u32 m0, m0, 4096
    s_add_u32 s38, s38, 4096
    buffer_load_dwordx4 v2, s[12:15], s38 offen lds
    s_waitcnt vmcnt(25)
    s_barrier
    s_add_u32 m0, s33, 36864
    s_add_u32 s38, s32, 184320
    buffer_load_dwordx4 v2, s[12:15], s38 offen offset:0 lds
    buffer_load_dwordx4 v2, s[12:15], s38 offen offset:1024 lds
    buffer_load_dwordx4 v2, s[12:15], s38 offen offset:2048 lds
    buffer_load_dwordx4 v2, s[12:15], s38 offen offset:3072 lds
    s_add_u32 m0, m0, 4096
    s_add_u32 s38, s38, 4096
    buffer_load_dwordx4 v2, s[12:15], s38 offen lds
    s_waitcnt vmcnt(25)
    s_barrier
    s_add_u32 m0, s33, 55296
    s_add_u32 s38, s32, 194560
    buffer_load_dwordx4 v2, s[12:15], s38 offen offset:0 lds
    buffer_load_dwordx4 v2, s[12:15], s38 offen offset:1024 lds
    buffer_load_dwordx4 v2, s[12:15], s38 offen offset:2048 lds
    buffer_load_dwordx4 v2, s[12:15], s38 offen offset:3072 lds
    s_add_u32 m0, m0, 4096
    s_add_u32 s38, s38, 4096
    buffer_load_dwordx4 v2, s[12:15], s38 offen lds
    s_waitcnt vmcnt(25)
    s_barrier
    s_add_u32 m0, s33, 73728
    s_add_u32 s38, s32, 204800
    buffer_load_dwordx4 v2, s[12:15], s38 offen offset:0 lds
    buffer_load_dwordx4 v2, s[12:15], s38 offen offset:1024 lds
    buffer_load_dwordx4 v2, s[12:15], s38 offen offset:2048 lds
    buffer_load_dwordx4 v2, s[12:15], s38 offen offset:3072 lds
    s_add_u32 m0, m0, 4096
    s_add_u32 s38, s38, 4096
    buffer_load_dwordx4 v2, s[12:15], s38 offen lds
    s_waitcnt vmcnt(25)
    s_barrier
    s_add_u32 m0, s33, 92160
    s_add_u32 s38, s32, 215040
    buffer_load_dwordx4 v2, s[12:15], s38 offen offset:0 lds
    buffer_load_dwordx4 v2, s[12:15], s38 offen offset:1024 lds
    buffer_load_dwordx4 v2, s[12:15], s38 offen offset:2048 lds
    buffer_load_dwordx4 v2, s[12:15], s38 offen offset:3072 lds
    s_add_u32 m0, m0, 4096
    s_add_u32 s38, s38, 4096
    buffer_load_dwordx4 v2, s[12:15], s38 offen lds
    s_waitcnt vmcnt(25)
    s_barrier
    s_add_u32 m0, s33, 110592
    s_add_u32 s38, s32, 225280
    buffer_load_dwordx4 v2, s[12:15], s38 offen offset:0 lds
    buffer_load_dwordx4 v2, s[12:15], s38 offen offset:1024 lds
    buffer_load_dwordx4 v2, s[12:15], s38 offen offset:2048 lds
    buffer_load_dwordx4 v2, s[12:15], s38 offen offset:3072 lds
    s_add_u32 m0, m0, 4096
    s_add_u32 s38, s38, 4096
    buffer_load_dwordx4 v2, s[12:15], s38 offen lds
    s_waitcnt vmcnt(25)
    s_barrier
    s_add_u32 m0, s33, 129024
    s_add_u32 s38, s32, 235520
    buffer_load_dwordx4 v2, s[12:15], s38 offen offset:0 lds
    buffer_load_dwordx4 v2, s[12:15], s38 offen offset:1024 lds
    buffer_load_dwordx4 v2, s[12:15], s38 offen offset:2048 lds
    buffer_load_dwordx4 v2, s[12:15], s38 offen offset:3072 lds
    s_add_u32 m0, m0, 4096
    s_add_u32 s38, s38, 4096
    buffer_load_dwordx4 v2, s[12:15], s38 offen lds
    s_waitcnt vmcnt(25)
    s_barrier
    s_waitcnt vmcnt(20)
    s_barrier
    s_waitcnt vmcnt(15)
    s_barrier
    s_waitcnt vmcnt(10)
    s_barrier
    s_waitcnt vmcnt(5)
    s_barrier
    s_waitcnt vmcnt(0)
    s_barrier
L_p6_end:
    s_endpgm
L_end:
    s_endpgm
.section .rodata,"a"
.p2align 6
.amdhsa_kernel adaLN_cond__mha_block__geglu_ffn__prompt_kernel
  .amdhsa_next_free_vgpr 256
  .amdhsa_next_free_sgpr 102
  .amdhsa_accum_offset 256
  .amdhsa_group_segment_fixed_size 0
  .amdhsa_kernarg_size 96
  .amdhsa_user_sgpr_count 2
  .amdhsa_user_sgpr_kernarg_segment_ptr 1
  .amdhsa_system_sgpr_workgroup_id_x 1
.end_amdhsa_kernel
```
